```python
import torch

def _softmax(x, axis=-1):
    return torch.softmax(x, dim=axis)

def _gelu(x):
    return torch.nn.functional.gelu(x, approximate='tanh')

def _silu(x):
    return torch.nn.functional.silu(x)

def _sigmoid(x):
    return torch.sigmoid(x)

def _layernorm(x, axis=-1, eps=1e-05):
    m = x.mean(dim=axis, keepdim=True)
    v = x.var(dim=axis, keepdim=True, unbiased=False)
    return (x - m) / torch.sqrt(v + eps)

def _scatter_add(tgt, idx, src, axis=0):
    return tgt.clone().index_add_(axis, idx, src)

def _segment_sum(src, seg, n):
    out = torch.zeros((n,) + src.shape[1:], dtype=src.dtype)
    return out.index_add_(0, seg, src)

def _pad(x, pw):
    flat = tuple((v for pair in reversed(pw) for v in pair))
    return torch.nn.functional.pad(x, flat)
kernel_name = 'adaLN_cond__memory_aug_recurrent_mem_tr__glu_gated_geglu__prompt'

def setup_inputs():

    _w = lambda a: (lambda t: t.to(torch.bfloat16) if t.is_floating_point() else t)(torch.as_tensor(a))

    def _A_setup():
        B, S, Dm = (1, 2048, 512)
        H, Dh = (32, 128)
        M, seg = (8, 32)
        seg = min(seg, S)
        S = S // seg * seg
        return {'x': _w((lambda *s: torch.randn(*s, dtype=torch.bfloat16) * 0.05)(B, S, Dm)), 'mem0': _w((lambda *s: torch.randn(*s, dtype=torch.bfloat16) * 0.8)(B, M, Dm)), 'Wq': _w((lambda *s: torch.randn(*s, dtype=torch.bfloat16) * 0.8)(Dm, H, Dh) * Dm ** (-0.5)), 'Wk': _w((lambda *s: torch.randn(*s, dtype=torch.bfloat16) * 0.8)(Dm, H, Dh) * Dm ** (-0.5)), 'Wv': _w((lambda *s: torch.randn(*s, dtype=torch.bfloat16) * 0.8)(Dm, H, Dh) * Dm ** (-0.5)), 'Wo': _w((lambda *s: torch.randn(*s, dtype=torch.bfloat16) * 0.8)(H, Dh, Dm) * (H * Dh) ** (-0.5)), 'seg_len': seg}
    _A_in = _A_setup()

    def _B_setup():
        B, S, Dm, Df = (1, 2048, 512, 1376)
        return {'x': _w((lambda *s: torch.randn(*s, dtype=torch.bfloat16) * 0.05)(B, S, Dm)), 'w_gate': _w((lambda *s: torch.randn(*s, dtype=torch.bfloat16) * 0.4)(Dm, Df) * Dm ** (-0.5)), 'w_up': _w((lambda *s: torch.randn(*s, dtype=torch.bfloat16) * 0.4)(Dm, Df) * Dm ** (-0.5)), 'w_down': _w((lambda *s: torch.randn(*s, dtype=torch.bfloat16) * 0.4)(Df, Dm) * Df ** (-0.5))}
    _B_in = _B_setup()
    return {'A_x': _A_in['x'], 'A_mem0': _A_in['mem0'], 'A_Wq': _A_in['Wq'], 'A_Wk': _A_in['Wk'], 'A_Wv': _A_in['Wv'], 'A_Wo': _A_in['Wo'], 'A_seg_len': _A_in['seg_len'], 'B_x': _B_in['x'], 'B_w_gate': _B_in['w_gate'], 'B_w_up': _B_in['w_up'], 'B_w_down': _B_in['w_down'], 'c': _w((lambda *s: torch.randn(*s, dtype=torch.bfloat16) * 0.2)(1, 512) * 8.0), 'w_mod': _w((lambda *s: torch.randn(*s, dtype=torch.bfloat16) * 0.2)(512, 6 * 512) * 512 ** (-0.5) * 8.0)}

def reference(A_x, A_mem0, A_Wq, A_Wk, A_Wv, A_Wo, A_seg_len, B_x, B_w_gate, B_w_up, B_w_down, c, w_mod):

    def _A_ref(x, mem0, Wq, Wk, Wv, Wo, seg_len):
        B, S, Dm = x.shape
        H, Dh = (Wq.shape[1], Wq.shape[2])
        M = mem0.shape[1]
        scale = Dh ** (-0.5)
        n_seg = S // seg_len
        L = M + seg_len
        idx = torch.arange(L)
        mask = (idx[:, None] < M) | (idx[:, None] >= idx[None, :])
        mem = mem0
        outs = []
        for s in range(n_seg):
            xs = x[:, s * seg_len:(s + 1) * seg_len, :].clone()
            h = torch.concatenate([mem, xs], axis=1)
            q = torch.einsum('btd,dhe->bhte', h, Wq)
            k = torch.einsum('btd,dhe->bhte', h, Wk)
            v = torch.einsum('btd,dhe->bhte', h, Wv)
            scores = torch.einsum('bhqe,bhke->bhqk', q, k) * scale
            scores = torch.where(mask[None, None], scores, -1000000000.0)
            p = _softmax(scores, axis=-1)
            o = torch.einsum('bhqk,bhke->bhqe', p, v)
            o = torch.einsum('bhte,hed->btd', o, Wo)
            mem = o[:, :M, :].clone()
            outs.append(o[:, M:, :])
        return torch.concatenate(outs, axis=1)

    def _B_ref(x, w_gate, w_up, w_down):
        g = torch.einsum('bsd,df->bsf', x, w_gate)
        u = torch.einsum('bsd,df->bsf', x, w_up)
        h = _gelu(g) * u
        return torch.einsum('bsf,fd->bsd', h, w_down)
    x = A_x
    mod = (_silu(c) @ w_mod).reshape(c.shape[0], 6, 1, -1)
    sa, ca, ga, sb, cb, gb = (mod[:, 0].clone(), mod[:, 1].clone(), mod[:, 2].clone(), mod[:, 3].clone(), mod[:, 4].clone(), mod[:, 5].clone())
    h = _layernorm(x, axis=-1) * (1 + ca) + sa
    x = x + ga * _A_ref(h, A_mem0, A_Wq, A_Wk, A_Wv, A_Wo, A_seg_len)
    h = _layernorm(x, axis=-1) * (1 + cb) + sb
    x = x + gb * _B_ref(h, B_w_gate, B_w_up, B_w_down)
    return x
```

```asm
; @launch kernel=init_kernel grid=(256,1,1) block=(256,1,1) lds=2048
; @launch kernel=ln1_kernel grid=(128,1,1) block=(256,1,1) lds=0
; @launch kernel=main_kernel grid=(256,1,1) block=(256,1,1) lds=163840
.amdgcn_target "amdgcn-amd-amdhsa--gfx950"
.text
.globl init_kernel
.p2align 8
.type init_kernel,@function
init_kernel:
    s_cmp_ge_u32 s2, 256
    s_cbranch_scc1 L_k0_end
    s_load_dwordx16 s[64:79], s[0:1], 0
    s_load_dwordx16 s[80:95], s[0:1], 64
    s_waitcnt lgkmcnt(0)
    s_mov_b32 s8, s94
    s_and_b32 s9, s95, 0xffff
    s_mov_b32 s10, 0x10000000
    s_mov_b32 s11, 0x20000
    v_lshlrev_b32 v1, 4, v0
    s_lshl_b32 s3, s2, 12
    v_add_u32 v1, s3, v1
    v_mov_b32 v4, -1
    v_mov_b32 v8, 0
    v_mov_b32 v5, -1
    v_mov_b32 v9, 0
    v_mov_b32 v6, -1
    v_mov_b32 v10, 0
    v_mov_b32 v7, -1
    v_mov_b32 v11, 0
    s_mov_b32 s20, 0x100000
    buffer_store_dwordx4 v[4:7], v1, s[8:11], s20 offen
    s_cmp_ge_u32 s2, 144
    s_cbranch_scc1 L_k0_a
    s_mov_b32 s20, 0x10000
    buffer_store_dwordx4 v[4:7], v1, s[8:11], s20 offen
L_k0_a:
    s_cmp_ge_u32 s2, 8
    s_cbranch_scc1 L_k0_b
    buffer_store_dwordx4 v[8:11], v1, s[8:11], 0 offen
L_k0_b:
    s_cmp_ge_u32 s2, 2
    s_cbranch_scc1 L_k0_c
    s_mov_b32 s12, s66
    s_and_b32 s13, s67, 0xffff
    s_mov_b32 s14, 0x2000
    s_mov_b32 s15, 0x20000
    s_lshl_b32 s3, s2, 8
    v_add_u32 v12, s3, v0
    v_lshrrev_b32 v13, 2, v12
    v_lshlrev_b32 v13, 3, v13
    v_and_b32 v14, 3, v12
    v_lshlrev_b32 v14, 11, v14
    v_add_u32 v13, v13, v14
    buffer_load_dwordx2 v[4:5], v13, s[12:15], 0 offen
    buffer_load_dwordx2 v[6:7], v13, s[12:15], 0 offen offset:1024
    s_waitcnt vmcnt(0)
    s_mov_b32 s20, 0x10000
    buffer_store_dwordx4 v[4:7], v1, s[8:11], s20 offen
L_k0_c:
    s_cmp_ge_u32 s2, 96
    s_cbranch_scc1 L_k0_end
    s_mov_b32 s12, s88
    s_and_b32 s13, s89, 0xffff
    s_mov_b32 s14, 0x300000
    s_mov_b32 s15, 0x20000
    s_mov_b32 s16, s86
    s_and_b32 s17, s87, 0xffff
    s_mov_b32 s18, 0x400
    s_mov_b32 s19, 0x20000
    v_lshrrev_b32 v20, 4, v0
    v_and_b32 v21, 15, v0
    v_mul_u32_u24 v22, 196608, v20
    v_lshl_add_u32 v22, v21, 2, v22
    s_lshl_b32 s3, s2, 6
    v_add_u32 v22, s3, v22
    v_lshlrev_b32 v23, 6, v20
    buffer_load_dwordx4 v[24:27], v23, s[16:19], 0 offen offset:0
    buffer_load_dwordx4 v[28:31], v23, s[16:19], 0 offen offset:16
    buffer_load_dwordx4 v[32:35], v23, s[16:19], 0 offen offset:32
    buffer_load_dwordx4 v[36:39], v23, s[16:19], 0 offen offset:48
    s_mov_b32 s20, 0
    buffer_load_dword v64, v22, s[12:15], s20 offen
    s_mov_b32 s20, 0x1800
    buffer_load_dword v65, v22, s[12:15], s20 offen
    s_mov_b32 s20, 0x3000
    buffer_load_dword v66, v22, s[12:15], s20 offen
    s_mov_b32 s20, 0x4800
    buffer_load_dword v67, v22, s[12:15], s20 offen
    s_mov_b32 s20, 0x6000
    buffer_load_dword v68, v22, s[12:15], s20 offen
    s_mov_b32 s20, 0x7800
    buffer_load_dword v69, v22, s[12:15], s20 offen
    s_mov_b32 s20, 0x9000
    buffer_load_dword v70, v22, s[12:15], s20 offen
    s_mov_b32 s20, 0xa800
    buffer_load_dword v71, v22, s[12:15], s20 offen
    s_mov_b32 s20, 0xc000
    buffer_load_dword v72, v22, s[12:15], s20 offen
    s_mov_b32 s20, 0xd800
    buffer_load_dword v73, v22, s[12:15], s20 offen
    s_mov_b32 s20, 0xf000
    buffer_load_dword v74, v22, s[12:15], s20 offen
    s_mov_b32 s20, 0x10800
    buffer_load_dword v75, v22, s[12:15], s20 offen
    s_mov_b32 s20, 0x12000
    buffer_load_dword v76, v22, s[12:15], s20 offen
    s_mov_b32 s20, 0x13800
    buffer_load_dword v77, v22, s[12:15], s20 offen
    s_mov_b32 s20, 0x15000
    buffer_load_dword v78, v22, s[12:15], s20 offen
    s_mov_b32 s20, 0x16800
    buffer_load_dword v79, v22, s[12:15], s20 offen
    s_mov_b32 s20, 0x18000
    buffer_load_dword v80, v22, s[12:15], s20 offen
    s_mov_b32 s20, 0x19800
    buffer_load_dword v81, v22, s[12:15], s20 offen
    s_mov_b32 s20, 0x1b000
    buffer_load_dword v82, v22, s[12:15], s20 offen
    s_mov_b32 s20, 0x1c800
    buffer_load_dword v83, v22, s[12:15], s20 offen
    s_mov_b32 s20, 0x1e000
    buffer_load_dword v84, v22, s[12:15], s20 offen
    s_mov_b32 s20, 0x1f800
    buffer_load_dword v85, v22, s[12:15], s20 offen
    s_mov_b32 s20, 0x21000
    buffer_load_dword v86, v22, s[12:15], s20 offen
    s_mov_b32 s20, 0x22800
    buffer_load_dword v87, v22, s[12:15], s20 offen
    s_mov_b32 s20, 0x24000
    buffer_load_dword v88, v22, s[12:15], s20 offen
    s_mov_b32 s20, 0x25800
    buffer_load_dword v89, v22, s[12:15], s20 offen
    s_mov_b32 s20, 0x27000
    buffer_load_dword v90, v22, s[12:15], s20 offen
    s_mov_b32 s20, 0x28800
    buffer_load_dword v91, v22, s[12:15], s20 offen
    s_mov_b32 s20, 0x2a000
    buffer_load_dword v92, v22, s[12:15], s20 offen
    s_mov_b32 s20, 0x2b800
    buffer_load_dword v93, v22, s[12:15], s20 offen
    s_mov_b32 s20, 0x2d000
    buffer_load_dword v94, v22, s[12:15], s20 offen
    s_mov_b32 s20, 0x2e800
    buffer_load_dword v95, v22, s[12:15], s20 offen
    v_mov_b32 v40, 0
    v_mov_b32 v41, 0
    s_mov_b32 s21, 0xbfb8aa3b
    s_waitcnt vmcnt(32)
    v_lshlrev_b32 v100, 16, v24
    v_mul_f32 v42, s21, v100
    v_exp_f32 v42, v42
    s_nop 0
    v_add_f32 v42, 1.0, v42
    v_rcp_f32 v42, v42
    s_nop 0
    v_mul_f32 v100, v100, v42
    v_cvt_pk_bf16_f32 v100, v100, v100
    v_lshlrev_b32 v100, 16, v100
    v_and_b32 v101, 0xffff0000, v24
    v_mul_f32 v42, s21, v101
    v_exp_f32 v42, v42
    s_nop 0
    v_add_f32 v42, 1.0, v42
    v_rcp_f32 v42, v42
    s_nop 0
    v_mul_f32 v101, v101, v42
    v_cvt_pk_bf16_f32 v101, v101, v101
    v_lshlrev_b32 v101, 16, v101
    v_lshlrev_b32 v102, 16, v25
    v_mul_f32 v42, s21, v102
    v_exp_f32 v42, v42
    s_nop 0
    v_add_f32 v42, 1.0, v42
    v_rcp_f32 v42, v42
    s_nop 0
    v_mul_f32 v102, v102, v42
    v_cvt_pk_bf16_f32 v102, v102, v102
    v_lshlrev_b32 v102, 16, v102
    v_and_b32 v103, 0xffff0000, v25
    v_mul_f32 v42, s21, v103
    v_exp_f32 v42, v42
    s_nop 0
    v_add_f32 v42, 1.0, v42
    v_rcp_f32 v42, v42
    s_nop 0
    v_mul_f32 v103, v103, v42
    v_cvt_pk_bf16_f32 v103, v103, v103
    v_lshlrev_b32 v103, 16, v103
    v_lshlrev_b32 v104, 16, v26
    v_mul_f32 v42, s21, v104
    v_exp_f32 v42, v42
    s_nop 0
    v_add_f32 v42, 1.0, v42
    v_rcp_f32 v42, v42
    s_nop 0
    v_mul_f32 v104, v104, v42
    v_cvt_pk_bf16_f32 v104, v104, v104
    v_lshlrev_b32 v104, 16, v104
    v_and_b32 v105, 0xffff0000, v26
    v_mul_f32 v42, s21, v105
    v_exp_f32 v42, v42
    s_nop 0
    v_add_f32 v42, 1.0, v42
    v_rcp_f32 v42, v42
    s_nop 0
    v_mul_f32 v105, v105, v42
    v_cvt_pk_bf16_f32 v105, v105, v105
    v_lshlrev_b32 v105, 16, v105
    v_lshlrev_b32 v106, 16, v27
    v_mul_f32 v42, s21, v106
    v_exp_f32 v42, v42
    s_nop 0
    v_add_f32 v42, 1.0, v42
    v_rcp_f32 v42, v42
    s_nop 0
    v_mul_f32 v106, v106, v42
    v_cvt_pk_bf16_f32 v106, v106, v106
    v_lshlrev_b32 v106, 16, v106
    v_and_b32 v107, 0xffff0000, v27
    v_mul_f32 v42, s21, v107
    v_exp_f32 v42, v42
    s_nop 0
    v_add_f32 v42, 1.0, v42
    v_rcp_f32 v42, v42
    s_nop 0
    v_mul_f32 v107, v107, v42
    v_cvt_pk_bf16_f32 v107, v107, v107
    v_lshlrev_b32 v107, 16, v107
    v_lshlrev_b32 v108, 16, v28
    v_mul_f32 v42, s21, v108
    v_exp_f32 v42, v42
    s_nop 0
    v_add_f32 v42, 1.0, v42
    v_rcp_f32 v42, v42
    s_nop 0
    v_mul_f32 v108, v108, v42
    v_cvt_pk_bf16_f32 v108, v108, v108
    v_lshlrev_b32 v108, 16, v108
    v_and_b32 v109, 0xffff0000, v28
    v_mul_f32 v42, s21, v109
    v_exp_f32 v42, v42
    s_nop 0
    v_add_f32 v42, 1.0, v42
    v_rcp_f32 v42, v42
    s_nop 0
    v_mul_f32 v109, v109, v42
    v_cvt_pk_bf16_f32 v109, v109, v109
    v_lshlrev_b32 v109, 16, v109
    v_lshlrev_b32 v110, 16, v29
    v_mul_f32 v42, s21, v110
    v_exp_f32 v42, v42
    s_nop 0
    v_add_f32 v42, 1.0, v42
    v_rcp_f32 v42, v42
    s_nop 0
    v_mul_f32 v110, v110, v42
    v_cvt_pk_bf16_f32 v110, v110, v110
    v_lshlrev_b32 v110, 16, v110
    v_and_b32 v111, 0xffff0000, v29
    v_mul_f32 v42, s21, v111
    v_exp_f32 v42, v42
    s_nop 0
    v_add_f32 v42, 1.0, v42
    v_rcp_f32 v42, v42
    s_nop 0
    v_mul_f32 v111, v111, v42
    v_cvt_pk_bf16_f32 v111, v111, v111
    v_lshlrev_b32 v111, 16, v111
    v_lshlrev_b32 v112, 16, v30
    v_mul_f32 v42, s21, v112
    v_exp_f32 v42, v42
    s_nop 0
    v_add_f32 v42, 1.0, v42
    v_rcp_f32 v42, v42
    s_nop 0
    v_mul_f32 v112, v112, v42
    v_cvt_pk_bf16_f32 v112, v112, v112
    v_lshlrev_b32 v112, 16, v112
    v_and_b32 v113, 0xffff0000, v30
    v_mul_f32 v42, s21, v113
    v_exp_f32 v42, v42
    s_nop 0
    v_add_f32 v42, 1.0, v42
    v_rcp_f32 v42, v42
    s_nop 0
    v_mul_f32 v113, v113, v42
    v_cvt_pk_bf16_f32 v113, v113, v113
    v_lshlrev_b32 v113, 16, v113
    v_lshlrev_b32 v114, 16, v31
    v_mul_f32 v42, s21, v114
    v_exp_f32 v42, v42
    s_nop 0
    v_add_f32 v42, 1.0, v42
    v_rcp_f32 v42, v42
    s_nop 0
    v_mul_f32 v114, v114, v42
    v_cvt_pk_bf16_f32 v114, v114, v114
    v_lshlrev_b32 v114, 16, v114
    v_and_b32 v115, 0xffff0000, v31
    v_mul_f32 v42, s21, v115
    v_exp_f32 v42, v42
    s_nop 0
    v_add_f32 v42, 1.0, v42
    v_rcp_f32 v42, v42
    s_nop 0
    v_mul_f32 v115, v115, v42
    v_cvt_pk_bf16_f32 v115, v115, v115
    v_lshlrev_b32 v115, 16, v115
    v_lshlrev_b32 v116, 16, v32
    v_mul_f32 v42, s21, v116
    v_exp_f32 v42, v42
    s_nop 0
    v_add_f32 v42, 1.0, v42
    v_rcp_f32 v42, v42
    s_nop 0
    v_mul_f32 v116, v116, v42
    v_cvt_pk_bf16_f32 v116, v116, v116
    v_lshlrev_b32 v116, 16, v116
    v_and_b32 v117, 0xffff0000, v32
    v_mul_f32 v42, s21, v117
    v_exp_f32 v42, v42
    s_nop 0
    v_add_f32 v42, 1.0, v42
    v_rcp_f32 v42, v42
    s_nop 0
    v_mul_f32 v117, v117, v42
    v_cvt_pk_bf16_f32 v117, v117, v117
    v_lshlrev_b32 v117, 16, v117
    v_lshlrev_b32 v118, 16, v33
    v_mul_f32 v42, s21, v118
    v_exp_f32 v42, v42
    s_nop 0
    v_add_f32 v42, 1.0, v42
    v_rcp_f32 v42, v42
    s_nop 0
    v_mul_f32 v118, v118, v42
    v_cvt_pk_bf16_f32 v118, v118, v118
    v_lshlrev_b32 v118, 16, v118
    v_and_b32 v119, 0xffff0000, v33
    v_mul_f32 v42, s21, v119
    v_exp_f32 v42, v42
    s_nop 0
    v_add_f32 v42, 1.0, v42
    v_rcp_f32 v42, v42
    s_nop 0
    v_mul_f32 v119, v119, v42
    v_cvt_pk_bf16_f32 v119, v119, v119
    v_lshlrev_b32 v119, 16, v119
    v_lshlrev_b32 v120, 16, v34
    v_mul_f32 v42, s21, v120
    v_exp_f32 v42, v42
    s_nop 0
    v_add_f32 v42, 1.0, v42
    v_rcp_f32 v42, v42
    s_nop 0
    v_mul_f32 v120, v120, v42
    v_cvt_pk_bf16_f32 v120, v120, v120
    v_lshlrev_b32 v120, 16, v120
    v_and_b32 v121, 0xffff0000, v34
    v_mul_f32 v42, s21, v121
    v_exp_f32 v42, v42
    s_nop 0
    v_add_f32 v42, 1.0, v42
    v_rcp_f32 v42, v42
    s_nop 0
    v_mul_f32 v121, v121, v42
    v_cvt_pk_bf16_f32 v121, v121, v121
    v_lshlrev_b32 v121, 16, v121
    v_lshlrev_b32 v122, 16, v35
    v_mul_f32 v42, s21, v122
    v_exp_f32 v42, v42
    s_nop 0
    v_add_f32 v42, 1.0, v42
    v_rcp_f32 v42, v42
    s_nop 0
    v_mul_f32 v122, v122, v42
    v_cvt_pk_bf16_f32 v122, v122, v122
    v_lshlrev_b32 v122, 16, v122
    v_and_b32 v123, 0xffff0000, v35
    v_mul_f32 v42, s21, v123
    v_exp_f32 v42, v42
    s_nop 0
    v_add_f32 v42, 1.0, v42
    v_rcp_f32 v42, v42
    s_nop 0
    v_mul_f32 v123, v123, v42
    v_cvt_pk_bf16_f32 v123, v123, v123
    v_lshlrev_b32 v123, 16, v123
    v_lshlrev_b32 v124, 16, v36
    v_mul_f32 v42, s21, v124
    v_exp_f32 v42, v42
    s_nop 0
    v_add_f32 v42, 1.0, v42
    v_rcp_f32 v42, v42
    s_nop 0
    v_mul_f32 v124, v124, v42
    v_cvt_pk_bf16_f32 v124, v124, v124
    v_lshlrev_b32 v124, 16, v124
    v_and_b32 v125, 0xffff0000, v36
    v_mul_f32 v42, s21, v125
    v_exp_f32 v42, v42
    s_nop 0
    v_add_f32 v42, 1.0, v42
    v_rcp_f32 v42, v42
    s_nop 0
    v_mul_f32 v125, v125, v42
    v_cvt_pk_bf16_f32 v125, v125, v125
    v_lshlrev_b32 v125, 16, v125
    v_lshlrev_b32 v126, 16, v37
    v_mul_f32 v42, s21, v126
    v_exp_f32 v42, v42
    s_nop 0
    v_add_f32 v42, 1.0, v42
    v_rcp_f32 v42, v42
    s_nop 0
    v_mul_f32 v126, v126, v42
    v_cvt_pk_bf16_f32 v126, v126, v126
    v_lshlrev_b32 v126, 16, v126
    v_and_b32 v127, 0xffff0000, v37
    v_mul_f32 v42, s21, v127
    v_exp_f32 v42, v42
    s_nop 0
    v_add_f32 v42, 1.0, v42
    v_rcp_f32 v42, v42
    s_nop 0
    v_mul_f32 v127, v127, v42
    v_cvt_pk_bf16_f32 v127, v127, v127
    v_lshlrev_b32 v127, 16, v127
    v_lshlrev_b32 v128, 16, v38
    v_mul_f32 v42, s21, v128
    v_exp_f32 v42, v42
    s_nop 0
    v_add_f32 v42, 1.0, v42
    v_rcp_f32 v42, v42
    s_nop 0
    v_mul_f32 v128, v128, v42
    v_cvt_pk_bf16_f32 v128, v128, v128
    v_lshlrev_b32 v128, 16, v128
    v_and_b32 v129, 0xffff0000, v38
    v_mul_f32 v42, s21, v129
    v_exp_f32 v42, v42
    s_nop 0
    v_add_f32 v42, 1.0, v42
    v_rcp_f32 v42, v42
    s_nop 0
    v_mul_f32 v129, v129, v42
    v_cvt_pk_bf16_f32 v129, v129, v129
    v_lshlrev_b32 v129, 16, v129
    v_lshlrev_b32 v130, 16, v39
    v_mul_f32 v42, s21, v130
    v_exp_f32 v42, v42
    s_nop 0
    v_add_f32 v42, 1.0, v42
    v_rcp_f32 v42, v42
    s_nop 0
    v_mul_f32 v130, v130, v42
    v_cvt_pk_bf16_f32 v130, v130, v130
    v_lshlrev_b32 v130, 16, v130
    v_and_b32 v131, 0xffff0000, v39
    v_mul_f32 v42, s21, v131
    v_exp_f32 v42, v42
    s_nop 0
    v_add_f32 v42, 1.0, v42
    v_rcp_f32 v42, v42
    s_nop 0
    v_mul_f32 v131, v131, v42
    v_cvt_pk_bf16_f32 v131, v131, v131
    v_lshlrev_b32 v131, 16, v131
    s_waitcnt vmcnt(0)
    v_lshlrev_b32 v42, 16, v64
    v_and_b32 v43, 0xffff0000, v64
    v_fmac_f32 v40, v100, v42
    v_fmac_f32 v41, v100, v43
    v_lshlrev_b32 v42, 16, v65
    v_and_b32 v43, 0xffff0000, v65
    v_fmac_f32 v40, v101, v42
    v_fmac_f32 v41, v101, v43
    v_lshlrev_b32 v42, 16, v66
    v_and_b32 v43, 0xffff0000, v66
    v_fmac_f32 v40, v102, v42
    v_fmac_f32 v41, v102, v43
    v_lshlrev_b32 v42, 16, v67
    v_and_b32 v43, 0xffff0000, v67
    v_fmac_f32 v40, v103, v42
    v_fmac_f32 v41, v103, v43
    v_lshlrev_b32 v42, 16, v68
    v_and_b32 v43, 0xffff0000, v68
    v_fmac_f32 v40, v104, v42
    v_fmac_f32 v41, v104, v43
    v_lshlrev_b32 v42, 16, v69
    v_and_b32 v43, 0xffff0000, v69
    v_fmac_f32 v40, v105, v42
    v_fmac_f32 v41, v105, v43
    v_lshlrev_b32 v42, 16, v70
    v_and_b32 v43, 0xffff0000, v70
    v_fmac_f32 v40, v106, v42
    v_fmac_f32 v41, v106, v43
    v_lshlrev_b32 v42, 16, v71
    v_and_b32 v43, 0xffff0000, v71
    v_fmac_f32 v40, v107, v42
    v_fmac_f32 v41, v107, v43
    v_lshlrev_b32 v42, 16, v72
    v_and_b32 v43, 0xffff0000, v72
    v_fmac_f32 v40, v108, v42
    v_fmac_f32 v41, v108, v43
    v_lshlrev_b32 v42, 16, v73
    v_and_b32 v43, 0xffff0000, v73
    v_fmac_f32 v40, v109, v42
    v_fmac_f32 v41, v109, v43
    v_lshlrev_b32 v42, 16, v74
    v_and_b32 v43, 0xffff0000, v74
    v_fmac_f32 v40, v110, v42
    v_fmac_f32 v41, v110, v43
    v_lshlrev_b32 v42, 16, v75
    v_and_b32 v43, 0xffff0000, v75
    v_fmac_f32 v40, v111, v42
    v_fmac_f32 v41, v111, v43
    v_lshlrev_b32 v42, 16, v76
    v_and_b32 v43, 0xffff0000, v76
    v_fmac_f32 v40, v112, v42
    v_fmac_f32 v41, v112, v43
    v_lshlrev_b32 v42, 16, v77
    v_and_b32 v43, 0xffff0000, v77
    v_fmac_f32 v40, v113, v42
    v_fmac_f32 v41, v113, v43
    v_lshlrev_b32 v42, 16, v78
    v_and_b32 v43, 0xffff0000, v78
    v_fmac_f32 v40, v114, v42
    v_fmac_f32 v41, v114, v43
    v_lshlrev_b32 v42, 16, v79
    v_and_b32 v43, 0xffff0000, v79
    v_fmac_f32 v40, v115, v42
    v_fmac_f32 v41, v115, v43
    v_lshlrev_b32 v42, 16, v80
    v_and_b32 v43, 0xffff0000, v80
    v_fmac_f32 v40, v116, v42
    v_fmac_f32 v41, v116, v43
    v_lshlrev_b32 v42, 16, v81
    v_and_b32 v43, 0xffff0000, v81
    v_fmac_f32 v40, v117, v42
    v_fmac_f32 v41, v117, v43
    v_lshlrev_b32 v42, 16, v82
    v_and_b32 v43, 0xffff0000, v82
    v_fmac_f32 v40, v118, v42
    v_fmac_f32 v41, v118, v43
    v_lshlrev_b32 v42, 16, v83
    v_and_b32 v43, 0xffff0000, v83
    v_fmac_f32 v40, v119, v42
    v_fmac_f32 v41, v119, v43
    v_lshlrev_b32 v42, 16, v84
    v_and_b32 v43, 0xffff0000, v84
    v_fmac_f32 v40, v120, v42
    v_fmac_f32 v41, v120, v43
    v_lshlrev_b32 v42, 16, v85
    v_and_b32 v43, 0xffff0000, v85
    v_fmac_f32 v40, v121, v42
    v_fmac_f32 v41, v121, v43
    v_lshlrev_b32 v42, 16, v86
    v_and_b32 v43, 0xffff0000, v86
    v_fmac_f32 v40, v122, v42
    v_fmac_f32 v41, v122, v43
    v_lshlrev_b32 v42, 16, v87
    v_and_b32 v43, 0xffff0000, v87
    v_fmac_f32 v40, v123, v42
    v_fmac_f32 v41, v123, v43
    v_lshlrev_b32 v42, 16, v88
    v_and_b32 v43, 0xffff0000, v88
    v_fmac_f32 v40, v124, v42
    v_fmac_f32 v41, v124, v43
    v_lshlrev_b32 v42, 16, v89
    v_and_b32 v43, 0xffff0000, v89
    v_fmac_f32 v40, v125, v42
    v_fmac_f32 v41, v125, v43
    v_lshlrev_b32 v42, 16, v90
    v_and_b32 v43, 0xffff0000, v90
    v_fmac_f32 v40, v126, v42
    v_fmac_f32 v41, v126, v43
    v_lshlrev_b32 v42, 16, v91
    v_and_b32 v43, 0xffff0000, v91
    v_fmac_f32 v40, v127, v42
    v_fmac_f32 v41, v127, v43
    v_lshlrev_b32 v42, 16, v92
    v_and_b32 v43, 0xffff0000, v92
    v_fmac_f32 v40, v128, v42
    v_fmac_f32 v41, v128, v43
    v_lshlrev_b32 v42, 16, v93
    v_and_b32 v43, 0xffff0000, v93
    v_fmac_f32 v40, v129, v42
    v_fmac_f32 v41, v129, v43
    v_lshlrev_b32 v42, 16, v94
    v_and_b32 v43, 0xffff0000, v94
    v_fmac_f32 v40, v130, v42
    v_fmac_f32 v41, v130, v43
    v_lshlrev_b32 v42, 16, v95
    v_and_b32 v43, 0xffff0000, v95
    v_fmac_f32 v40, v131, v42
    v_fmac_f32 v41, v131, v43
    v_lshlrev_b32 v44, 3, v0
    ds_write_b64 v44, v[40:41]
    s_waitcnt lgkmcnt(0)
    s_barrier
    v_cmp_gt_u32 vcc, 16, v0
    s_and_saveexec_b64 s[22:23], vcc
    s_cbranch_execz L_k0_end
    ds_read_b64 v[64:65], v44 offset:0
    ds_read_b64 v[66:67], v44 offset:128
    ds_read_b64 v[68:69], v44 offset:256
    ds_read_b64 v[70:71], v44 offset:384
    ds_read_b64 v[72:73], v44 offset:512
    ds_read_b64 v[74:75], v44 offset:640
    ds_read_b64 v[76:77], v44 offset:768
    ds_read_b64 v[78:79], v44 offset:896
    ds_read_b64 v[80:81], v44 offset:1024
    ds_read_b64 v[82:83], v44 offset:1152
    ds_read_b64 v[84:85], v44 offset:1280
    ds_read_b64 v[86:87], v44 offset:1408
    ds_read_b64 v[88:89], v44 offset:1536
    ds_read_b64 v[90:91], v44 offset:1664
    ds_read_b64 v[92:93], v44 offset:1792
    ds_read_b64 v[94:95], v44 offset:1920
    s_waitcnt lgkmcnt(0)
    v_add_f32 v64, v64, v66
    v_add_f32 v65, v65, v67
    v_add_f32 v64, v64, v68
    v_add_f32 v65, v65, v69
    v_add_f32 v64, v64, v70
    v_add_f32 v65, v65, v71
    v_add_f32 v64, v64, v72
    v_add_f32 v65, v65, v73
    v_add_f32 v64, v64, v74
    v_add_f32 v65, v65, v75
    v_add_f32 v64, v64, v76
    v_add_f32 v65, v65, v77
    v_add_f32 v64, v64, v78
    v_add_f32 v65, v65, v79
    v_add_f32 v64, v64, v80
    v_add_f32 v65, v65, v81
    v_add_f32 v64, v64, v82
    v_add_f32 v65, v65, v83
    v_add_f32 v64, v64, v84
    v_add_f32 v65, v65, v85
    v_add_f32 v64, v64, v86
    v_add_f32 v65, v65, v87
    v_add_f32 v64, v64, v88
    v_add_f32 v65, v65, v89
    v_add_f32 v64, v64, v90
    v_add_f32 v65, v65, v91
    v_add_f32 v64, v64, v92
    v_add_f32 v65, v65, v93
    v_add_f32 v64, v64, v94
    v_add_f32 v65, v65, v95
    v_cvt_pk_bf16_f32 v64, v64, v64
    v_lshlrev_b32 v64, 16, v64
    v_cvt_pk_bf16_f32 v65, v65, v65
    v_lshlrev_b32 v65, 16, v65
    s_lshl_b32 s3, s2, 7
    v_add_u32 v44, s3, v44
    s_mov_b32 s20, 0x8000
    buffer_store_dwordx2 v[64:65], v44, s[8:11], s20 offen
L_k0_end:
    s_endpgm
.section .rodata,"a"
.p2align 6
.amdhsa_kernel init_kernel
  .amdhsa_next_free_vgpr 136
  .amdhsa_next_free_sgpr 102
  .amdhsa_accum_offset 136
  .amdhsa_group_segment_fixed_size 0
  .amdhsa_kernarg_size 128
  .amdhsa_user_sgpr_count 2
  .amdhsa_user_sgpr_kernarg_segment_ptr 1
  .amdhsa_system_sgpr_workgroup_id_x 1
.end_amdhsa_kernel
.text

.globl ln1_kernel
.p2align 8
.type ln1_kernel,@function
ln1_kernel:
    s_cmp_ge_u32 s2, 128
    s_cbranch_scc1 L_ln1_kernel_end
    s_load_dwordx16 s[64:79], s[0:1], 0
    s_load_dwordx16 s[80:95], s[0:1], 64
    s_waitcnt lgkmcnt(0)
    s_mov_b32 s8, s94
    s_and_b32 s9, s95, 0xffff
    s_mov_b32 s10, 0x10000000
    s_mov_b32 s11, 0x20000
    v_and_b32 v1, 63, v0
    v_and_b32 v2, 15, v0
    v_bfe_u32 v3, v0, 4, 2
    v_lshrrev_b32 v4, 6, v0
    s_nop 0
    v_readfirstlane_b32 s4, v4
    s_nop 3
    s_mov_b32 s61, 0
    s_mov_b32 s5, s2
    s_mov_b32 s16, s64
    s_and_b32 s17, s65, 0xffff
    s_mov_b32 s18, 0x200000
    s_mov_b32 s19, 0x20000
    v_lshlrev_b32 v4, 5, v1
    s_mov_b32 s20, 0x8000
    buffer_load_dwordx4 v[16:19], v4, s[8:11], s20 offen
    buffer_load_dwordx4 v[20:23], v4, s[8:11], s20 offen offset:16
    s_mov_b32 s20, 0x8800
    buffer_load_dwordx4 v[24:27], v4, s[8:11], s20 offen
    buffer_load_dwordx4 v[28:31], v4, s[8:11], s20 offen offset:16
    s_lshl_b32 s32, s5, 4
    s_lshl_b32 s33, s4, 2
    s_add_u32 s32, s32, s33
    s_lshl_b32 s32, s32, 10
    v_lshlrev_b32 v5, 4, v1
    buffer_load_dwordx4 v[32:35], v5, s[16:19], s32 offen offset:0
    buffer_load_dwordx4 v[36:39], v5, s[16:19], s32 offen offset:1024
    buffer_load_dwordx4 v[40:43], v5, s[16:19], s32 offen offset:2048
    buffer_load_dwordx4 v[44:47], v5, s[16:19], s32 offen offset:3072
    s_waitcnt vmcnt(4)
    v_add_f32 v24, 1.0, v24
    v_cvt_pk_bf16_f32 v24, v24, v24
    v_lshlrev_b32 v24, 16, v24
    v_add_f32 v25, 1.0, v25
    v_cvt_pk_bf16_f32 v25, v25, v25
    v_lshlrev_b32 v25, 16, v25
    v_add_f32 v26, 1.0, v26
    v_cvt_pk_bf16_f32 v26, v26, v26
    v_lshlrev_b32 v26, 16, v26
    v_add_f32 v27, 1.0, v27
    v_cvt_pk_bf16_f32 v27, v27, v27
    v_lshlrev_b32 v27, 16, v27
    v_add_f32 v28, 1.0, v28
    v_cvt_pk_bf16_f32 v28, v28, v28
    v_lshlrev_b32 v28, 16, v28
    v_add_f32 v29, 1.0, v29
    v_cvt_pk_bf16_f32 v29, v29, v29
    v_lshlrev_b32 v29, 16, v29
    v_add_f32 v30, 1.0, v30
    v_cvt_pk_bf16_f32 v30, v30, v30
    v_lshlrev_b32 v30, 16, v30
    v_add_f32 v31, 1.0, v31
    v_cvt_pk_bf16_f32 v31, v31, v31
    v_lshlrev_b32 v31, 16, v31
    s_lshl_b32 s33, s5, 14
    s_lshl_b32 s34, s4, 6
    s_add_u32 s33, s33, s34
    s_add_u32 s33, s33, 0x200000
    v_lshrrev_b32 v6, 2, v1
    v_lshlrev_b32 v6, 10, v6
    v_and_b32 v7, 3, v1
    v_lshl_add_u32 v6, v7, 8, v6
    s_waitcnt vmcnt(3)
    s_waitcnt vmcnt(0)
    v_lshlrev_b32 v48, 16, v32
    v_and_b32 v49, 0xffff0000, v32
    v_lshlrev_b32 v50, 16, v33
    v_and_b32 v51, 0xffff0000, v33
    v_lshlrev_b32 v52, 16, v34
    v_and_b32 v53, 0xffff0000, v34
    v_lshlrev_b32 v54, 16, v35
    v_and_b32 v55, 0xffff0000, v35
    v_add_f32 v56, v48, v49
    v_add_f32 v56, v56, v50
    v_add_f32 v56, v56, v51
    v_add_f32 v56, v56, v52
    v_add_f32 v56, v56, v53
    v_add_f32 v56, v56, v54
    v_add_f32 v56, v56, v55
    s_nop 1
    v_add_f32_dpp v56, v56, v56 quad_perm:[1,0,3,2] row_mask:0xf bank_mask:0xf
    s_nop 1
    v_add_f32_dpp v56, v56, v56 quad_perm:[2,3,0,1] row_mask:0xf bank_mask:0xf
    s_nop 1
    v_add_f32_dpp v56, v56, v56 row_half_mirror row_mask:0xf bank_mask:0xf
    s_nop 1
    v_add_f32_dpp v56, v56, v56 row_mirror row_mask:0xf bank_mask:0xf
    v_mov_b32 v57, v56
    s_nop 1
    v_permlane16_swap_b32 v56, v57
    s_nop 1
    v_add_f32 v56, v56, v57
    v_mov_b32 v57, v56
    s_nop 1
    v_permlane32_swap_b32 v56, v57
    s_nop 1
    v_add_f32 v56, v56, v57
    v_mul_f32 v56, 0x3b000000, v56
    v_sub_f32 v48, v48, v56
    v_sub_f32 v49, v49, v56
    v_sub_f32 v50, v50, v56
    v_sub_f32 v51, v51, v56
    v_sub_f32 v52, v52, v56
    v_sub_f32 v53, v53, v56
    v_sub_f32 v54, v54, v56
    v_sub_f32 v55, v55, v56
    v_mul_f32 v56, v48, v48
    v_fmac_f32 v56, v49, v49
    v_fmac_f32 v56, v50, v50
    v_fmac_f32 v56, v51, v51
    v_fmac_f32 v56, v52, v52
    v_fmac_f32 v56, v53, v53
    v_fmac_f32 v56, v54, v54
    v_fmac_f32 v56, v55, v55
    s_nop 1
    v_add_f32_dpp v56, v56, v56 quad_perm:[1,0,3,2] row_mask:0xf bank_mask:0xf
    s_nop 1
    v_add_f32_dpp v56, v56, v56 quad_perm:[2,3,0,1] row_mask:0xf bank_mask:0xf
    s_nop 1
    v_add_f32_dpp v56, v56, v56 row_half_mirror row_mask:0xf bank_mask:0xf
    s_nop 1
    v_add_f32_dpp v56, v56, v56 row_mirror row_mask:0xf bank_mask:0xf
    v_mov_b32 v57, v56
    s_nop 1
    v_permlane16_swap_b32 v56, v57
    s_nop 1
    v_add_f32 v56, v56, v57
    v_mov_b32 v57, v56
    s_nop 1
    v_permlane32_swap_b32 v56, v57
    s_nop 1
    v_add_f32 v56, v56, v57
    v_mov_b32 v57, 0x3727c5ac
    v_fmac_f32 v57, 0x3b000000, v56
    v_rsq_f32 v56, v57
    s_nop 0
    v_mul_f32 v48, v48, v56
    v_fma_f32 v48, v48, v24, v16
    v_mul_f32 v49, v49, v56
    v_fma_f32 v49, v49, v25, v17
    v_mul_f32 v50, v50, v56
    v_fma_f32 v50, v50, v26, v18
    v_mul_f32 v51, v51, v56
    v_fma_f32 v51, v51, v27, v19
    v_mul_f32 v52, v52, v56
    v_fma_f32 v52, v52, v28, v20
    v_mul_f32 v53, v53, v56
    v_fma_f32 v53, v53, v29, v21
    v_mul_f32 v54, v54, v56
    v_fma_f32 v54, v54, v30, v22
    v_mul_f32 v55, v55, v56
    v_fma_f32 v55, v55, v31, v23
    v_cvt_pk_bf16_f32 v60, v48, v49
    v_cvt_pk_bf16_f32 v61, v50, v51
    v_cvt_pk_bf16_f32 v62, v52, v53
    v_cvt_pk_bf16_f32 v63, v54, v55
    buffer_store_dwordx4 v[60:63], v6, s[8:11], s33 offen offset:0
    s_nop 1
    s_nop 0
    v_lshlrev_b32 v48, 16, v36
    v_and_b32 v49, 0xffff0000, v36
    v_lshlrev_b32 v50, 16, v37
    v_and_b32 v51, 0xffff0000, v37
    v_lshlrev_b32 v52, 16, v38
    v_and_b32 v53, 0xffff0000, v38
    v_lshlrev_b32 v54, 16, v39
    v_and_b32 v55, 0xffff0000, v39
    v_add_f32 v56, v48, v49
    v_add_f32 v56, v56, v50
    v_add_f32 v56, v56, v51
    v_add_f32 v56, v56, v52
    v_add_f32 v56, v56, v53
    v_add_f32 v56, v56, v54
    v_add_f32 v56, v56, v55
    s_nop 1
    v_add_f32_dpp v56, v56, v56 quad_perm:[1,0,3,2] row_mask:0xf bank_mask:0xf
    s_nop 1
    v_add_f32_dpp v56, v56, v56 quad_perm:[2,3,0,1] row_mask:0xf bank_mask:0xf
    s_nop 1
    v_add_f32_dpp v56, v56, v56 row_half_mirror row_mask:0xf bank_mask:0xf
    s_nop 1
    v_add_f32_dpp v56, v56, v56 row_mirror row_mask:0xf bank_mask:0xf
    v_mov_b32 v57, v56
    s_nop 1
    v_permlane16_swap_b32 v56, v57
    s_nop 1
    v_add_f32 v56, v56, v57
    v_mov_b32 v57, v56
    s_nop 1
    v_permlane32_swap_b32 v56, v57
    s_nop 1
    v_add_f32 v56, v56, v57
    v_mul_f32 v56, 0x3b000000, v56
    v_sub_f32 v48, v48, v56
    v_sub_f32 v49, v49, v56
    v_sub_f32 v50, v50, v56
    v_sub_f32 v51, v51, v56
    v_sub_f32 v52, v52, v56
    v_sub_f32 v53, v53, v56
    v_sub_f32 v54, v54, v56
    v_sub_f32 v55, v55, v56
    v_mul_f32 v56, v48, v48
    v_fmac_f32 v56, v49, v49
    v_fmac_f32 v56, v50, v50
    v_fmac_f32 v56, v51, v51
    v_fmac_f32 v56, v52, v52
    v_fmac_f32 v56, v53, v53
    v_fmac_f32 v56, v54, v54
    v_fmac_f32 v56, v55, v55
    s_nop 1
    v_add_f32_dpp v56, v56, v56 quad_perm:[1,0,3,2] row_mask:0xf bank_mask:0xf
    s_nop 1
    v_add_f32_dpp v56, v56, v56 quad_perm:[2,3,0,1] row_mask:0xf bank_mask:0xf
    s_nop 1
    v_add_f32_dpp v56, v56, v56 row_half_mirror row_mask:0xf bank_mask:0xf
    s_nop 1
    v_add_f32_dpp v56, v56, v56 row_mirror row_mask:0xf bank_mask:0xf
    v_mov_b32 v57, v56
    s_nop 1
    v_permlane16_swap_b32 v56, v57
    s_nop 1
    v_add_f32 v56, v56, v57
    v_mov_b32 v57, v56
    s_nop 1
    v_permlane32_swap_b32 v56, v57
    s_nop 1
    v_add_f32 v56, v56, v57
    v_mov_b32 v57, 0x3727c5ac
    v_fmac_f32 v57, 0x3b000000, v56
    v_rsq_f32 v56, v57
    s_nop 0
    v_mul_f32 v48, v48, v56
    v_fma_f32 v48, v48, v24, v16
    v_mul_f32 v49, v49, v56
    v_fma_f32 v49, v49, v25, v17
    v_mul_f32 v50, v50, v56
    v_fma_f32 v50, v50, v26, v18
    v_mul_f32 v51, v51, v56
    v_fma_f32 v51, v51, v27, v19
    v_mul_f32 v52, v52, v56
    v_fma_f32 v52, v52, v28, v20
    v_mul_f32 v53, v53, v56
    v_fma_f32 v53, v53, v29, v21
    v_mul_f32 v54, v54, v56
    v_fma_f32 v54, v54, v30, v22
    v_mul_f32 v55, v55, v56
    v_fma_f32 v55, v55, v31, v23
    v_cvt_pk_bf16_f32 v60, v48, v49
    v_cvt_pk_bf16_f32 v61, v50, v51
    v_cvt_pk_bf16_f32 v62, v52, v53
    v_cvt_pk_bf16_f32 v63, v54, v55
    buffer_store_dwordx4 v[60:63], v6, s[8:11], s33 offen offset:16
    s_nop 1
    s_nop 0
    v_lshlrev_b32 v48, 16, v40
    v_and_b32 v49, 0xffff0000, v40
    v_lshlrev_b32 v50, 16, v41
    v_and_b32 v51, 0xffff0000, v41
    v_lshlrev_b32 v52, 16, v42
    v_and_b32 v53, 0xffff0000, v42
    v_lshlrev_b32 v54, 16, v43
    v_and_b32 v55, 0xffff0000, v43
    v_add_f32 v56, v48, v49
    v_add_f32 v56, v56, v50
    v_add_f32 v56, v56, v51
    v_add_f32 v56, v56, v52
    v_add_f32 v56, v56, v53
    v_add_f32 v56, v56, v54
    v_add_f32 v56, v56, v55
    s_nop 1
    v_add_f32_dpp v56, v56, v56 quad_perm:[1,0,3,2] row_mask:0xf bank_mask:0xf
    s_nop 1
    v_add_f32_dpp v56, v56, v56 quad_perm:[2,3,0,1] row_mask:0xf bank_mask:0xf
    s_nop 1
    v_add_f32_dpp v56, v56, v56 row_half_mirror row_mask:0xf bank_mask:0xf
    s_nop 1
    v_add_f32_dpp v56, v56, v56 row_mirror row_mask:0xf bank_mask:0xf
    v_mov_b32 v57, v56
    s_nop 1
    v_permlane16_swap_b32 v56, v57
    s_nop 1
    v_add_f32 v56, v56, v57
    v_mov_b32 v57, v56
    s_nop 1
    v_permlane32_swap_b32 v56, v57
    s_nop 1
    v_add_f32 v56, v56, v57
    v_mul_f32 v56, 0x3b000000, v56
    v_sub_f32 v48, v48, v56
    v_sub_f32 v49, v49, v56
    v_sub_f32 v50, v50, v56
    v_sub_f32 v51, v51, v56
    v_sub_f32 v52, v52, v56
    v_sub_f32 v53, v53, v56
    v_sub_f32 v54, v54, v56
    v_sub_f32 v55, v55, v56
    v_mul_f32 v56, v48, v48
    v_fmac_f32 v56, v49, v49
    v_fmac_f32 v56, v50, v50
    v_fmac_f32 v56, v51, v51
    v_fmac_f32 v56, v52, v52
    v_fmac_f32 v56, v53, v53
    v_fmac_f32 v56, v54, v54
    v_fmac_f32 v56, v55, v55
    s_nop 1
    v_add_f32_dpp v56, v56, v56 quad_perm:[1,0,3,2] row_mask:0xf bank_mask:0xf
    s_nop 1
    v_add_f32_dpp v56, v56, v56 quad_perm:[2,3,0,1] row_mask:0xf bank_mask:0xf
    s_nop 1
    v_add_f32_dpp v56, v56, v56 row_half_mirror row_mask:0xf bank_mask:0xf
    s_nop 1
    v_add_f32_dpp v56, v56, v56 row_mirror row_mask:0xf bank_mask:0xf
    v_mov_b32 v57, v56
    s_nop 1
    v_permlane16_swap_b32 v56, v57
    s_nop 1
    v_add_f32 v56, v56, v57
    v_mov_b32 v57, v56
    s_nop 1
    v_permlane32_swap_b32 v56, v57
    s_nop 1
    v_add_f32 v56, v56, v57
    v_mov_b32 v57, 0x3727c5ac
    v_fmac_f32 v57, 0x3b000000, v56
    v_rsq_f32 v56, v57
    s_nop 0
    v_mul_f32 v48, v48, v56
    v_fma_f32 v48, v48, v24, v16
    v_mul_f32 v49, v49, v56
    v_fma_f32 v49, v49, v25, v17
    v_mul_f32 v50, v50, v56
    v_fma_f32 v50, v50, v26, v18
    v_mul_f32 v51, v51, v56
    v_fma_f32 v51, v51, v27, v19
    v_mul_f32 v52, v52, v56
    v_fma_f32 v52, v52, v28, v20
    v_mul_f32 v53, v53, v56
    v_fma_f32 v53, v53, v29, v21
    v_mul_f32 v54, v54, v56
    v_fma_f32 v54, v54, v30, v22
    v_mul_f32 v55, v55, v56
    v_fma_f32 v55, v55, v31, v23
    v_cvt_pk_bf16_f32 v60, v48, v49
    v_cvt_pk_bf16_f32 v61, v50, v51
    v_cvt_pk_bf16_f32 v62, v52, v53
    v_cvt_pk_bf16_f32 v63, v54, v55
    buffer_store_dwordx4 v[60:63], v6, s[8:11], s33 offen offset:32
    s_nop 1
    s_nop 0
    v_lshlrev_b32 v48, 16, v44
    v_and_b32 v49, 0xffff0000, v44
    v_lshlrev_b32 v50, 16, v45
    v_and_b32 v51, 0xffff0000, v45
    v_lshlrev_b32 v52, 16, v46
    v_and_b32 v53, 0xffff0000, v46
    v_lshlrev_b32 v54, 16, v47
    v_and_b32 v55, 0xffff0000, v47
    v_add_f32 v56, v48, v49
    v_add_f32 v56, v56, v50
    v_add_f32 v56, v56, v51
    v_add_f32 v56, v56, v52
    v_add_f32 v56, v56, v53
    v_add_f32 v56, v56, v54
    v_add_f32 v56, v56, v55
    s_nop 1
    v_add_f32_dpp v56, v56, v56 quad_perm:[1,0,3,2] row_mask:0xf bank_mask:0xf
    s_nop 1
    v_add_f32_dpp v56, v56, v56 quad_perm:[2,3,0,1] row_mask:0xf bank_mask:0xf
    s_nop 1
    v_add_f32_dpp v56, v56, v56 row_half_mirror row_mask:0xf bank_mask:0xf
    s_nop 1
    v_add_f32_dpp v56, v56, v56 row_mirror row_mask:0xf bank_mask:0xf
    v_mov_b32 v57, v56
    s_nop 1
    v_permlane16_swap_b32 v56, v57
    s_nop 1
    v_add_f32 v56, v56, v57
    v_mov_b32 v57, v56
    s_nop 1
    v_permlane32_swap_b32 v56, v57
    s_nop 1
    v_add_f32 v56, v56, v57
    v_mul_f32 v56, 0x3b000000, v56
    v_sub_f32 v48, v48, v56
    v_sub_f32 v49, v49, v56
    v_sub_f32 v50, v50, v56
    v_sub_f32 v51, v51, v56
    v_sub_f32 v52, v52, v56
    v_sub_f32 v53, v53, v56
    v_sub_f32 v54, v54, v56
    v_sub_f32 v55, v55, v56
    v_mul_f32 v56, v48, v48
    v_fmac_f32 v56, v49, v49
    v_fmac_f32 v56, v50, v50
    v_fmac_f32 v56, v51, v51
    v_fmac_f32 v56, v52, v52
    v_fmac_f32 v56, v53, v53
    v_fmac_f32 v56, v54, v54
    v_fmac_f32 v56, v55, v55
    s_nop 1
    v_add_f32_dpp v56, v56, v56 quad_perm:[1,0,3,2] row_mask:0xf bank_mask:0xf
    s_nop 1
    v_add_f32_dpp v56, v56, v56 quad_perm:[2,3,0,1] row_mask:0xf bank_mask:0xf
    s_nop 1
    v_add_f32_dpp v56, v56, v56 row_half_mirror row_mask:0xf bank_mask:0xf
    s_nop 1
    v_add_f32_dpp v56, v56, v56 row_mirror row_mask:0xf bank_mask:0xf
    v_mov_b32 v57, v56
    s_nop 1
    v_permlane16_swap_b32 v56, v57
    s_nop 1
    v_add_f32 v56, v56, v57
    v_mov_b32 v57, v56
    s_nop 1
    v_permlane32_swap_b32 v56, v57
    s_nop 1
    v_add_f32 v56, v56, v57
    v_mov_b32 v57, 0x3727c5ac
    v_fmac_f32 v57, 0x3b000000, v56
    v_rsq_f32 v56, v57
    s_nop 0
    v_mul_f32 v48, v48, v56
    v_fma_f32 v48, v48, v24, v16
    v_mul_f32 v49, v49, v56
    v_fma_f32 v49, v49, v25, v17
    v_mul_f32 v50, v50, v56
    v_fma_f32 v50, v50, v26, v18
    v_mul_f32 v51, v51, v56
    v_fma_f32 v51, v51, v27, v19
    v_mul_f32 v52, v52, v56
    v_fma_f32 v52, v52, v28, v20
    v_mul_f32 v53, v53, v56
    v_fma_f32 v53, v53, v29, v21
    v_mul_f32 v54, v54, v56
    v_fma_f32 v54, v54, v30, v22
    v_mul_f32 v55, v55, v56
    v_fma_f32 v55, v55, v31, v23
    v_cvt_pk_bf16_f32 v60, v48, v49
    v_cvt_pk_bf16_f32 v61, v50, v51
    v_cvt_pk_bf16_f32 v62, v52, v53
    v_cvt_pk_bf16_f32 v63, v54, v55
    buffer_store_dwordx4 v[60:63], v6, s[8:11], s33 offen offset:48
    s_nop 1
L_ln1_kernel_end:
    s_endpgm
.section .rodata,"a"
.p2align 6
.amdhsa_kernel ln1_kernel
  .amdhsa_next_free_vgpr 512
  .amdhsa_next_free_sgpr 102
  .amdhsa_accum_offset 256
  .amdhsa_group_segment_fixed_size 0
  .amdhsa_kernarg_size 128
  .amdhsa_user_sgpr_count 2
  .amdhsa_user_sgpr_kernarg_segment_ptr 1
  .amdhsa_system_sgpr_workgroup_id_x 1
.end_amdhsa_kernel
.text

.globl main_kernel
.p2align 8
.type main_kernel,@function
main_kernel:
    s_cmp_ge_u32 s2, 256
    s_cbranch_scc1 L_main_kernel_end
    s_load_dwordx16 s[64:79], s[0:1], 0
    s_load_dwordx16 s[80:95], s[0:1], 64
    s_waitcnt lgkmcnt(0)
    s_mov_b32 s8, s94
    s_and_b32 s9, s95, 0xffff
    s_mov_b32 s10, 0x10000000
    s_mov_b32 s11, 0x20000
    v_and_b32 v1, 63, v0
    v_and_b32 v2, 15, v0
    v_bfe_u32 v3, v0, 4, 2
    v_lshrrev_b32 v4, 6, v0
    s_nop 0
    v_readfirstlane_b32 s4, v4
    s_nop 3
    s_mov_b32 s61, 0
    s_getreg_b32 s6, hwreg(HW_REG_XCC_ID)
    s_and_b32 s6, s6, 7
    s_cmp_lg_u32 s4, 0
    s_cbranch_scc1 Lrw_4
    v_mov_b32 v5, 0
    v_mov_b32 v6, 1
    s_mov_b64 exec, 1
    s_lshl_b32 s34, s6, 8
    s_add_u32 s34, s34, 20480
    buffer_atomic_add v6, v5, s[8:11], s34 offen sc0 sc1
    s_waitcnt vmcnt(0)
    v_readfirstlane_b32 s7, v6
    s_nop 3
    s_lshl_b32 s35, s6, 5
    s_cmp_lt_u32 s7, 32
    s_cselect_b32 s36, 1, 0
    s_add_u32 s7, s7, s35
    s_cmp_eq_u32 s36, 1
    s_cbranch_scc1 Lr2_5
    v_mov_b32 v6, 1
    s_mov_b32 s34, 22528
    buffer_atomic_add v6, v5, s[8:11], s34 offen sc0 sc1
    s_waitcnt vmcnt(0)
    v_readfirstlane_b32 s37, v6
    s_mov_b64 exec, -1
Lrp_6:
    v_lshlrev_b32 v120, 8, v1
    s_mov_b32 s34, 20480
    buffer_load_dword v121, v120, s[8:11], s34 offen sc1
    s_waitcnt vmcnt(0)
    v_readlane_b32 s40, v121, 0
    v_readlane_b32 s41, v121, 1
    v_readlane_b32 s42, v121, 2
    v_readlane_b32 s43, v121, 3
    v_readlane_b32 s44, v121, 4
    v_readlane_b32 s45, v121, 5
    v_readlane_b32 s46, v121, 6
    v_readlane_b32 s47, v121, 7
    s_nop 3
    s_mov_b32 s48, 0
    s_add_u32 s48, s48, s40
    s_add_u32 s48, s48, s41
    s_add_u32 s48, s48, s42
    s_add_u32 s48, s48, s43
    s_add_u32 s48, s48, s44
    s_add_u32 s48, s48, s45
    s_add_u32 s48, s48, s46
    s_add_u32 s48, s48, s47
    s_add_u32 s61, s61, 1
    s_cmp_gt_u32 s61, 0x40000
    s_cbranch_scc1 Lrq_7
    s_cmp_lt_u32 s48, 256
    s_cbranch_scc1 Lrp_6
Lrq_7:
    s_mov_b32 s7, 0
    s_min_u32 s49, s40, 32
    s_sub_u32 s50, 32, s49
    s_cmp_lt_u32 s37, s50
    s_cbranch_scc0 Lrs_8
    s_add_u32 s7, s49, s37
    s_add_u32 s7, s7, 0
    s_branch Lr2_5
Lrs_8:
    s_sub_u32 s37, s37, s50
    s_min_u32 s49, s41, 32
    s_sub_u32 s50, 32, s49
    s_cmp_lt_u32 s37, s50
    s_cbranch_scc0 Lrs_9
    s_add_u32 s7, s49, s37
    s_add_u32 s7, s7, 32
    s_branch Lr2_5
Lrs_9:
    s_sub_u32 s37, s37, s50
    s_min_u32 s49, s42, 32
    s_sub_u32 s50, 32, s49
    s_cmp_lt_u32 s37, s50
    s_cbranch_scc0 Lrs_10
    s_add_u32 s7, s49, s37
    s_add_u32 s7, s7, 64
    s_branch Lr2_5
Lrs_10:
    s_sub_u32 s37, s37, s50
    s_min_u32 s49, s43, 32
    s_sub_u32 s50, 32, s49
    s_cmp_lt_u32 s37, s50
    s_cbranch_scc0 Lrs_11
    s_add_u32 s7, s49, s37
    s_add_u32 s7, s7, 96
    s_branch Lr2_5
Lrs_11:
    s_sub_u32 s37, s37, s50
    s_min_u32 s49, s44, 32
    s_sub_u32 s50, 32, s49
    s_cmp_lt_u32 s37, s50
    s_cbranch_scc0 Lrs_12
    s_add_u32 s7, s49, s37
    s_add_u32 s7, s7, 128
    s_branch Lr2_5
Lrs_12:
    s_sub_u32 s37, s37, s50
    s_min_u32 s49, s45, 32
    s_sub_u32 s50, 32, s49
    s_cmp_lt_u32 s37, s50
    s_cbranch_scc0 Lrs_13
    s_add_u32 s7, s49, s37
    s_add_u32 s7, s7, 160
    s_branch Lr2_5
Lrs_13:
    s_sub_u32 s37, s37, s50
    s_min_u32 s49, s46, 32
    s_sub_u32 s50, 32, s49
    s_cmp_lt_u32 s37, s50
    s_cbranch_scc0 Lrs_14
    s_add_u32 s7, s49, s37
    s_add_u32 s7, s7, 192
    s_branch Lr2_5
Lrs_14:
    s_sub_u32 s37, s37, s50
    s_min_u32 s49, s47, 32
    s_sub_u32 s50, 32, s49
    s_cmp_lt_u32 s37, s50
    s_cbranch_scc0 Lrs_15
    s_add_u32 s7, s49, s37
    s_add_u32 s7, s7, 224
    s_branch Lr2_5
Lrs_15:
    s_sub_u32 s37, s37, s50
Lr2_5:
    s_mov_b64 exec, 1
    v_mov_b32 v5, 0
    v_mov_b32 v6, s7
    ds_write_b32 v5, v6
    s_mov_b64 exec, -1
Lrw_4:
    s_waitcnt lgkmcnt(0)
    s_barrier
    v_mov_b32 v5, 0
    ds_read_b32 v6, v5
    s_waitcnt lgkmcnt(0)
    v_readfirstlane_b32 s5, v6
    s_nop 3
    s_barrier
    s_cmp_lt_u32 s5, 32
    s_cbranch_scc1 Lrc_16
    s_sub_u32 s5, s5, 32
    s_branch Lworker_1
Lrc_16:
Lmd_19:
    v_lshlrev_b32 v120, 8, v1
    s_mov_b32 s34, 20480
    buffer_load_dword v121, v120, s[8:11], s34 offen sc1
    s_waitcnt vmcnt(0)
    v_readlane_b32 s40, v121, 0
    v_readlane_b32 s41, v121, 1
    v_readlane_b32 s42, v121, 2
    v_readlane_b32 s43, v121, 3
    v_readlane_b32 s44, v121, 4
    v_readlane_b32 s45, v121, 5
    v_readlane_b32 s46, v121, 6
    v_readlane_b32 s47, v121, 7
    s_nop 3
    s_mov_b32 s48, 0
    s_add_u32 s48, s48, s40
    s_add_u32 s48, s48, s41
    s_add_u32 s48, s48, s42
    s_add_u32 s48, s48, s43
    s_add_u32 s48, s48, s44
    s_add_u32 s48, s48, s45
    s_add_u32 s48, s48, s46
    s_add_u32 s48, s48, s47
    s_cmp_ge_u32 s40, 32
    s_cbranch_scc1 Lfast2_18
    s_cmp_ge_u32 s48, 256
    s_cbranch_scc1 Lslow2_17
    s_add_u32 s61, s61, 1
    s_cmp_gt_u32 s61, 0x40000
    s_cbranch_scc1 Lslow2_17
    s_sleep 1
    s_branch Lmd_19
Lfast2_18:
    s_mov_b32 s59, 1
    s_branch Lgo_20
Lslow2_17:
    s_mov_b32 s59, 0
Lgo_20:
    v_cmp_gt_u32 vcc, 8, v2
    v_mov_b32 v120, 0xeeee
    v_mov_b32 v121, 0x4444
    v_cndmask_b32 v4, v120, v121, vcc
    s_mov_b32 s40, -1
    s_mov_b32 s41, 0
    s_mov_b32 s42, 0
    s_mov_b32 s43, -1
    s_mov_b32 s21, 0x5040100
    s_mov_b32 s22, 0x7060302
    v_lshrrev_b32 v120, 1, v3
    v_and_b32 v121, 1, v3
    v_lshlrev_b32 v122, 17, v120
    v_lshl_add_u32 v122, v121, 15, v122
    v_lshl_add_u32 v122, v2, 2, v122
    s_lshl_b32 s32, s5, 8
    s_lshl_b32 s33, s4, 6
    s_add_u32 s32, s32, s33
    v_add_u32 v122, s32, v122
    s_lshl_b32 s33, s4, 15
    v_lshlrev_b32 v15, 4, v1
    v_add_u32 v15, s33, v15
    s_mov_b32 s12, s68
    s_and_b32 s13, s69, 0xffff
    s_mov_b32 s14, 0x400000
    s_mov_b32 s15, 0x20000
    s_mov_b32 s34, 0
    buffer_load_dword v16, v122, s[12:15], s34 offen
    s_mov_b32 s34, 0x2000
    buffer_load_dword v17, v122, s[12:15], s34 offen
    s_mov_b32 s34, 0x10000
    buffer_load_dword v18, v122, s[12:15], s34 offen
    s_mov_b32 s34, 0x12000
    buffer_load_dword v19, v122, s[12:15], s34 offen
    s_mov_b32 s34, 0x4000
    buffer_load_dword v20, v122, s[12:15], s34 offen
    s_mov_b32 s34, 0x6000
    buffer_load_dword v21, v122, s[12:15], s34 offen
    s_mov_b32 s34, 0x14000
    buffer_load_dword v22, v122, s[12:15], s34 offen
    s_mov_b32 s34, 0x16000
    buffer_load_dword v23, v122, s[12:15], s34 offen
    s_mov_b32 s34, 0x40000
    buffer_load_dword v24, v122, s[12:15], s34 offen
    s_mov_b32 s34, 0x42000
    buffer_load_dword v25, v122, s[12:15], s34 offen
    s_mov_b32 s34, 0x50000
    buffer_load_dword v26, v122, s[12:15], s34 offen
    s_mov_b32 s34, 0x52000
    buffer_load_dword v27, v122, s[12:15], s34 offen
    s_mov_b32 s34, 0x44000
    buffer_load_dword v28, v122, s[12:15], s34 offen
    s_mov_b32 s34, 0x46000
    buffer_load_dword v29, v122, s[12:15], s34 offen
    s_mov_b32 s34, 0x54000
    buffer_load_dword v30, v122, s[12:15], s34 offen
    s_mov_b32 s34, 0x56000
    buffer_load_dword v31, v122, s[12:15], s34 offen
    s_mov_b32 s34, 0x80000
    buffer_load_dword v32, v122, s[12:15], s34 offen
    s_mov_b32 s34, 0x82000
    buffer_load_dword v33, v122, s[12:15], s34 offen
    s_mov_b32 s34, 0x90000
    buffer_load_dword v34, v122, s[12:15], s34 offen
    s_mov_b32 s34, 0x92000
    buffer_load_dword v35, v122, s[12:15], s34 offen
    s_mov_b32 s34, 0x84000
    buffer_load_dword v36, v122, s[12:15], s34 offen
    s_mov_b32 s34, 0x86000
    buffer_load_dword v37, v122, s[12:15], s34 offen
    s_mov_b32 s34, 0x94000
    buffer_load_dword v38, v122, s[12:15], s34 offen
    s_mov_b32 s34, 0x96000
    buffer_load_dword v39, v122, s[12:15], s34 offen
    s_mov_b32 s34, 0xc0000
    buffer_load_dword v40, v122, s[12:15], s34 offen
    s_mov_b32 s34, 0xc2000
    buffer_load_dword v41, v122, s[12:15], s34 offen
    s_mov_b32 s34, 0xd0000
    buffer_load_dword v42, v122, s[12:15], s34 offen
    s_mov_b32 s34, 0xd2000
    buffer_load_dword v43, v122, s[12:15], s34 offen
    s_mov_b32 s34, 0xc4000
    buffer_load_dword v44, v122, s[12:15], s34 offen
    s_mov_b32 s34, 0xc6000
    buffer_load_dword v45, v122, s[12:15], s34 offen
    s_mov_b32 s34, 0xd4000
    buffer_load_dword v46, v122, s[12:15], s34 offen
    s_mov_b32 s34, 0xd6000
    buffer_load_dword v47, v122, s[12:15], s34 offen
    s_mov_b32 s34, 0x100000
    buffer_load_dword v48, v122, s[12:15], s34 offen
    s_mov_b32 s34, 0x102000
    buffer_load_dword v49, v122, s[12:15], s34 offen
    s_mov_b32 s34, 0x110000
    buffer_load_dword v50, v122, s[12:15], s34 offen
    s_mov_b32 s34, 0x112000
    buffer_load_dword v51, v122, s[12:15], s34 offen
    s_mov_b32 s34, 0x104000
    buffer_load_dword v52, v122, s[12:15], s34 offen
    s_mov_b32 s34, 0x106000
    buffer_load_dword v53, v122, s[12:15], s34 offen
    s_mov_b32 s34, 0x114000
    buffer_load_dword v54, v122, s[12:15], s34 offen
    s_mov_b32 s34, 0x116000
    buffer_load_dword v55, v122, s[12:15], s34 offen
    s_mov_b32 s34, 0x140000
    buffer_load_dword v56, v122, s[12:15], s34 offen
    s_mov_b32 s34, 0x142000
    buffer_load_dword v57, v122, s[12:15], s34 offen
    s_mov_b32 s34, 0x150000
    buffer_load_dword v58, v122, s[12:15], s34 offen
    s_mov_b32 s34, 0x152000
    buffer_load_dword v59, v122, s[12:15], s34 offen
    s_mov_b32 s34, 0x144000
    buffer_load_dword v60, v122, s[12:15], s34 offen
    s_mov_b32 s34, 0x146000
    buffer_load_dword v61, v122, s[12:15], s34 offen
    s_mov_b32 s34, 0x154000
    buffer_load_dword v62, v122, s[12:15], s34 offen
    s_mov_b32 s34, 0x156000
    buffer_load_dword v63, v122, s[12:15], s34 offen
    s_mov_b32 s34, 0x180000
    buffer_load_dword v64, v122, s[12:15], s34 offen
    s_mov_b32 s34, 0x182000
    buffer_load_dword v65, v122, s[12:15], s34 offen
    s_mov_b32 s34, 0x190000
    buffer_load_dword v66, v122, s[12:15], s34 offen
    s_mov_b32 s34, 0x192000
    buffer_load_dword v67, v122, s[12:15], s34 offen
    s_mov_b32 s34, 0x184000
    buffer_load_dword v68, v122, s[12:15], s34 offen
    s_mov_b32 s34, 0x186000
    buffer_load_dword v69, v122, s[12:15], s34 offen
    s_mov_b32 s34, 0x194000
    buffer_load_dword v70, v122, s[12:15], s34 offen
    s_mov_b32 s34, 0x196000
    buffer_load_dword v71, v122, s[12:15], s34 offen
    s_mov_b32 s34, 0x1c0000
    buffer_load_dword v72, v122, s[12:15], s34 offen
    s_mov_b32 s34, 0x1c2000
    buffer_load_dword v73, v122, s[12:15], s34 offen
    s_mov_b32 s34, 0x1d0000
    buffer_load_dword v74, v122, s[12:15], s34 offen
    s_mov_b32 s34, 0x1d2000
    buffer_load_dword v75, v122, s[12:15], s34 offen
    s_mov_b32 s34, 0x1c4000
    buffer_load_dword v76, v122, s[12:15], s34 offen
    s_mov_b32 s34, 0x1c6000
    buffer_load_dword v77, v122, s[12:15], s34 offen
    s_mov_b32 s34, 0x1d4000
    buffer_load_dword v78, v122, s[12:15], s34 offen
    s_mov_b32 s34, 0x1d6000
    buffer_load_dword v79, v122, s[12:15], s34 offen
    s_waitcnt vmcnt(48)
    v_perm_b32 v80, v17, v16, s21
    v_perm_b32 v81, v19, v18, s21
    v_perm_b32 v82, v21, v20, s21
    v_perm_b32 v83, v23, v22, s21
    v_perm_b32 v84, v25, v24, s21
    v_perm_b32 v85, v27, v26, s21
    v_perm_b32 v86, v29, v28, s21
    v_perm_b32 v87, v31, v30, s21
    v_perm_b32 v88, v17, v16, s22
    v_perm_b32 v89, v19, v18, s22
    v_perm_b32 v90, v21, v20, s22
    v_perm_b32 v91, v23, v22, s22
    v_perm_b32 v92, v25, v24, s22
    v_perm_b32 v93, v27, v26, s22
    v_perm_b32 v94, v29, v28, s22
    v_perm_b32 v95, v31, v30, s22
    v_accvgpr_write_b32 a0, v80
    v_accvgpr_write_b32 a1, v81
    v_accvgpr_write_b32 a2, v82
    v_accvgpr_write_b32 a3, v83
    v_accvgpr_write_b32 a4, v84
    v_accvgpr_write_b32 a5, v85
    v_accvgpr_write_b32 a6, v86
    v_accvgpr_write_b32 a7, v87
    v_accvgpr_write_b32 a8, v88
    v_accvgpr_write_b32 a9, v89
    v_accvgpr_write_b32 a10, v90
    v_accvgpr_write_b32 a11, v91
    v_accvgpr_write_b32 a12, v92
    v_accvgpr_write_b32 a13, v93
    v_accvgpr_write_b32 a14, v94
    v_accvgpr_write_b32 a15, v95
    s_mov_b32 s34, 0x200000
    buffer_load_dword v16, v122, s[12:15], s34 offen
    s_mov_b32 s34, 0x202000
    buffer_load_dword v17, v122, s[12:15], s34 offen
    s_mov_b32 s34, 0x210000
    buffer_load_dword v18, v122, s[12:15], s34 offen
    s_mov_b32 s34, 0x212000
    buffer_load_dword v19, v122, s[12:15], s34 offen
    s_mov_b32 s34, 0x204000
    buffer_load_dword v20, v122, s[12:15], s34 offen
    s_mov_b32 s34, 0x206000
    buffer_load_dword v21, v122, s[12:15], s34 offen
    s_mov_b32 s34, 0x214000
    buffer_load_dword v22, v122, s[12:15], s34 offen
    s_mov_b32 s34, 0x216000
    buffer_load_dword v23, v122, s[12:15], s34 offen
    s_mov_b32 s34, 0x240000
    buffer_load_dword v24, v122, s[12:15], s34 offen
    s_mov_b32 s34, 0x242000
    buffer_load_dword v25, v122, s[12:15], s34 offen
    s_mov_b32 s34, 0x250000
    buffer_load_dword v26, v122, s[12:15], s34 offen
    s_mov_b32 s34, 0x252000
    buffer_load_dword v27, v122, s[12:15], s34 offen
    s_mov_b32 s34, 0x244000
    buffer_load_dword v28, v122, s[12:15], s34 offen
    s_mov_b32 s34, 0x246000
    buffer_load_dword v29, v122, s[12:15], s34 offen
    s_mov_b32 s34, 0x254000
    buffer_load_dword v30, v122, s[12:15], s34 offen
    s_mov_b32 s34, 0x256000
    buffer_load_dword v31, v122, s[12:15], s34 offen
    s_waitcnt vmcnt(48)
    v_perm_b32 v80, v33, v32, s21
    v_perm_b32 v81, v35, v34, s21
    v_perm_b32 v82, v37, v36, s21
    v_perm_b32 v83, v39, v38, s21
    v_perm_b32 v84, v41, v40, s21
    v_perm_b32 v85, v43, v42, s21
    v_perm_b32 v86, v45, v44, s21
    v_perm_b32 v87, v47, v46, s21
    v_perm_b32 v88, v33, v32, s22
    v_perm_b32 v89, v35, v34, s22
    v_perm_b32 v90, v37, v36, s22
    v_perm_b32 v91, v39, v38, s22
    v_perm_b32 v92, v41, v40, s22
    v_perm_b32 v93, v43, v42, s22
    v_perm_b32 v94, v45, v44, s22
    v_perm_b32 v95, v47, v46, s22
    v_accvgpr_write_b32 a16, v80
    v_accvgpr_write_b32 a17, v81
    v_accvgpr_write_b32 a18, v82
    v_accvgpr_write_b32 a19, v83
    v_accvgpr_write_b32 a20, v84
    v_accvgpr_write_b32 a21, v85
    v_accvgpr_write_b32 a22, v86
    v_accvgpr_write_b32 a23, v87
    v_accvgpr_write_b32 a24, v88
    v_accvgpr_write_b32 a25, v89
    v_accvgpr_write_b32 a26, v90
    v_accvgpr_write_b32 a27, v91
    v_accvgpr_write_b32 a28, v92
    v_accvgpr_write_b32 a29, v93
    v_accvgpr_write_b32 a30, v94
    v_accvgpr_write_b32 a31, v95
    s_mov_b32 s34, 0x280000
    buffer_load_dword v32, v122, s[12:15], s34 offen
    s_mov_b32 s34, 0x282000
    buffer_load_dword v33, v122, s[12:15], s34 offen
    s_mov_b32 s34, 0x290000
    buffer_load_dword v34, v122, s[12:15], s34 offen
    s_mov_b32 s34, 0x292000
    buffer_load_dword v35, v122, s[12:15], s34 offen
    s_mov_b32 s34, 0x284000
    buffer_load_dword v36, v122, s[12:15], s34 offen
    s_mov_b32 s34, 0x286000
    buffer_load_dword v37, v122, s[12:15], s34 offen
    s_mov_b32 s34, 0x294000
    buffer_load_dword v38, v122, s[12:15], s34 offen
    s_mov_b32 s34, 0x296000
    buffer_load_dword v39, v122, s[12:15], s34 offen
    s_mov_b32 s34, 0x2c0000
    buffer_load_dword v40, v122, s[12:15], s34 offen
    s_mov_b32 s34, 0x2c2000
    buffer_load_dword v41, v122, s[12:15], s34 offen
    s_mov_b32 s34, 0x2d0000
    buffer_load_dword v42, v122, s[12:15], s34 offen
    s_mov_b32 s34, 0x2d2000
    buffer_load_dword v43, v122, s[12:15], s34 offen
    s_mov_b32 s34, 0x2c4000
    buffer_load_dword v44, v122, s[12:15], s34 offen
    s_mov_b32 s34, 0x2c6000
    buffer_load_dword v45, v122, s[12:15], s34 offen
    s_mov_b32 s34, 0x2d4000
    buffer_load_dword v46, v122, s[12:15], s34 offen
    s_mov_b32 s34, 0x2d6000
    buffer_load_dword v47, v122, s[12:15], s34 offen
    s_waitcnt vmcnt(48)
    v_perm_b32 v80, v49, v48, s21
    v_perm_b32 v81, v51, v50, s21
    v_perm_b32 v82, v53, v52, s21
    v_perm_b32 v83, v55, v54, s21
    v_perm_b32 v84, v57, v56, s21
    v_perm_b32 v85, v59, v58, s21
    v_perm_b32 v86, v61, v60, s21
    v_perm_b32 v87, v63, v62, s21
    v_perm_b32 v88, v49, v48, s22
    v_perm_b32 v89, v51, v50, s22
    v_perm_b32 v90, v53, v52, s22
    v_perm_b32 v91, v55, v54, s22
    v_perm_b32 v92, v57, v56, s22
    v_perm_b32 v93, v59, v58, s22
    v_perm_b32 v94, v61, v60, s22
    v_perm_b32 v95, v63, v62, s22
    v_accvgpr_write_b32 a32, v80
    v_accvgpr_write_b32 a33, v81
    v_accvgpr_write_b32 a34, v82
    v_accvgpr_write_b32 a35, v83
    v_accvgpr_write_b32 a36, v84
    v_accvgpr_write_b32 a37, v85
    v_accvgpr_write_b32 a38, v86
    v_accvgpr_write_b32 a39, v87
    v_accvgpr_write_b32 a40, v88
    v_accvgpr_write_b32 a41, v89
    v_accvgpr_write_b32 a42, v90
    v_accvgpr_write_b32 a43, v91
    v_accvgpr_write_b32 a44, v92
    v_accvgpr_write_b32 a45, v93
    v_accvgpr_write_b32 a46, v94
    v_accvgpr_write_b32 a47, v95
    s_mov_b32 s34, 0x300000
    buffer_load_dword v48, v122, s[12:15], s34 offen
    s_mov_b32 s34, 0x302000
    buffer_load_dword v49, v122, s[12:15], s34 offen
    s_mov_b32 s34, 0x310000
    buffer_load_dword v50, v122, s[12:15], s34 offen
    s_mov_b32 s34, 0x312000
    buffer_load_dword v51, v122, s[12:15], s34 offen
    s_mov_b32 s34, 0x304000
    buffer_load_dword v52, v122, s[12:15], s34 offen
    s_mov_b32 s34, 0x306000
    buffer_load_dword v53, v122, s[12:15], s34 offen
    s_mov_b32 s34, 0x314000
    buffer_load_dword v54, v122, s[12:15], s34 offen
    s_mov_b32 s34, 0x316000
    buffer_load_dword v55, v122, s[12:15], s34 offen
    s_mov_b32 s34, 0x340000
    buffer_load_dword v56, v122, s[12:15], s34 offen
    s_mov_b32 s34, 0x342000
    buffer_load_dword v57, v122, s[12:15], s34 offen
    s_mov_b32 s34, 0x350000
    buffer_load_dword v58, v122, s[12:15], s34 offen
    s_mov_b32 s34, 0x352000
    buffer_load_dword v59, v122, s[12:15], s34 offen
    s_mov_b32 s34, 0x344000
    buffer_load_dword v60, v122, s[12:15], s34 offen
    s_mov_b32 s34, 0x346000
    buffer_load_dword v61, v122, s[12:15], s34 offen
    s_mov_b32 s34, 0x354000
    buffer_load_dword v62, v122, s[12:15], s34 offen
    s_mov_b32 s34, 0x356000
    buffer_load_dword v63, v122, s[12:15], s34 offen
    s_waitcnt vmcnt(48)
    v_perm_b32 v80, v65, v64, s21
    v_perm_b32 v81, v67, v66, s21
    v_perm_b32 v82, v69, v68, s21
    v_perm_b32 v83, v71, v70, s21
    v_perm_b32 v84, v73, v72, s21
    v_perm_b32 v85, v75, v74, s21
    v_perm_b32 v86, v77, v76, s21
    v_perm_b32 v87, v79, v78, s21
    v_perm_b32 v88, v65, v64, s22
    v_perm_b32 v89, v67, v66, s22
    v_perm_b32 v90, v69, v68, s22
    v_perm_b32 v91, v71, v70, s22
    v_perm_b32 v92, v73, v72, s22
    v_perm_b32 v93, v75, v74, s22
    v_perm_b32 v94, v77, v76, s22
    v_perm_b32 v95, v79, v78, s22
    v_accvgpr_write_b32 a48, v80
    v_accvgpr_write_b32 a49, v81
    v_accvgpr_write_b32 a50, v82
    v_accvgpr_write_b32 a51, v83
    v_accvgpr_write_b32 a52, v84
    v_accvgpr_write_b32 a53, v85
    v_accvgpr_write_b32 a54, v86
    v_accvgpr_write_b32 a55, v87
    v_accvgpr_write_b32 a56, v88
    v_accvgpr_write_b32 a57, v89
    v_accvgpr_write_b32 a58, v90
    v_accvgpr_write_b32 a59, v91
    v_accvgpr_write_b32 a60, v92
    v_accvgpr_write_b32 a61, v93
    v_accvgpr_write_b32 a62, v94
    v_accvgpr_write_b32 a63, v95
    s_mov_b32 s34, 0x380000
    buffer_load_dword v64, v122, s[12:15], s34 offen
    s_mov_b32 s34, 0x382000
    buffer_load_dword v65, v122, s[12:15], s34 offen
    s_mov_b32 s34, 0x390000
    buffer_load_dword v66, v122, s[12:15], s34 offen
    s_mov_b32 s34, 0x392000
    buffer_load_dword v67, v122, s[12:15], s34 offen
    s_mov_b32 s34, 0x384000
    buffer_load_dword v68, v122, s[12:15], s34 offen
    s_mov_b32 s34, 0x386000
    buffer_load_dword v69, v122, s[12:15], s34 offen
    s_mov_b32 s34, 0x394000
    buffer_load_dword v70, v122, s[12:15], s34 offen
    s_mov_b32 s34, 0x396000
    buffer_load_dword v71, v122, s[12:15], s34 offen
    s_mov_b32 s34, 0x3c0000
    buffer_load_dword v72, v122, s[12:15], s34 offen
    s_mov_b32 s34, 0x3c2000
    buffer_load_dword v73, v122, s[12:15], s34 offen
    s_mov_b32 s34, 0x3d0000
    buffer_load_dword v74, v122, s[12:15], s34 offen
    s_mov_b32 s34, 0x3d2000
    buffer_load_dword v75, v122, s[12:15], s34 offen
    s_mov_b32 s34, 0x3c4000
    buffer_load_dword v76, v122, s[12:15], s34 offen
    s_mov_b32 s34, 0x3c6000
    buffer_load_dword v77, v122, s[12:15], s34 offen
    s_mov_b32 s34, 0x3d4000
    buffer_load_dword v78, v122, s[12:15], s34 offen
    s_mov_b32 s34, 0x3d6000
    buffer_load_dword v79, v122, s[12:15], s34 offen
    s_waitcnt vmcnt(48)
    v_perm_b32 v80, v17, v16, s21
    v_perm_b32 v81, v19, v18, s21
    v_perm_b32 v82, v21, v20, s21
    v_perm_b32 v83, v23, v22, s21
    v_perm_b32 v84, v25, v24, s21
    v_perm_b32 v85, v27, v26, s21
    v_perm_b32 v86, v29, v28, s21
    v_perm_b32 v87, v31, v30, s21
    v_perm_b32 v88, v17, v16, s22
    v_perm_b32 v89, v19, v18, s22
    v_perm_b32 v90, v21, v20, s22
    v_perm_b32 v91, v23, v22, s22
    v_perm_b32 v92, v25, v24, s22
    v_perm_b32 v93, v27, v26, s22
    v_perm_b32 v94, v29, v28, s22
    v_perm_b32 v95, v31, v30, s22
    v_accvgpr_write_b32 a64, v80
    v_accvgpr_write_b32 a65, v81
    v_accvgpr_write_b32 a66, v82
    v_accvgpr_write_b32 a67, v83
    v_accvgpr_write_b32 a68, v84
    v_accvgpr_write_b32 a69, v85
    v_accvgpr_write_b32 a70, v86
    v_accvgpr_write_b32 a71, v87
    v_accvgpr_write_b32 a72, v88
    v_accvgpr_write_b32 a73, v89
    v_accvgpr_write_b32 a74, v90
    v_accvgpr_write_b32 a75, v91
    v_accvgpr_write_b32 a76, v92
    v_accvgpr_write_b32 a77, v93
    v_accvgpr_write_b32 a78, v94
    v_accvgpr_write_b32 a79, v95
    s_mov_b32 s16, s70
    s_and_b32 s17, s71, 0xffff
    s_mov_b32 s18, 0x400000
    s_mov_b32 s19, 0x20000
    s_mov_b32 s34, 0
    buffer_load_dword v16, v122, s[16:19], s34 offen
    s_mov_b32 s34, 0x2000
    buffer_load_dword v17, v122, s[16:19], s34 offen
    s_mov_b32 s34, 0x10000
    buffer_load_dword v18, v122, s[16:19], s34 offen
    s_mov_b32 s34, 0x12000
    buffer_load_dword v19, v122, s[16:19], s34 offen
    s_mov_b32 s34, 0x4000
    buffer_load_dword v20, v122, s[16:19], s34 offen
    s_mov_b32 s34, 0x6000
    buffer_load_dword v21, v122, s[16:19], s34 offen
    s_mov_b32 s34, 0x14000
    buffer_load_dword v22, v122, s[16:19], s34 offen
    s_mov_b32 s34, 0x16000
    buffer_load_dword v23, v122, s[16:19], s34 offen
    s_mov_b32 s34, 0x40000
    buffer_load_dword v24, v122, s[16:19], s34 offen
    s_mov_b32 s34, 0x42000
    buffer_load_dword v25, v122, s[16:19], s34 offen
    s_mov_b32 s34, 0x50000
    buffer_load_dword v26, v122, s[16:19], s34 offen
    s_mov_b32 s34, 0x52000
    buffer_load_dword v27, v122, s[16:19], s34 offen
    s_mov_b32 s34, 0x44000
    buffer_load_dword v28, v122, s[16:19], s34 offen
    s_mov_b32 s34, 0x46000
    buffer_load_dword v29, v122, s[16:19], s34 offen
    s_mov_b32 s34, 0x54000
    buffer_load_dword v30, v122, s[16:19], s34 offen
    s_mov_b32 s34, 0x56000
    buffer_load_dword v31, v122, s[16:19], s34 offen
    s_waitcnt vmcnt(48)
    v_perm_b32 v80, v33, v32, s21
    v_perm_b32 v81, v35, v34, s21
    v_perm_b32 v82, v37, v36, s21
    v_perm_b32 v83, v39, v38, s21
    v_perm_b32 v84, v41, v40, s21
    v_perm_b32 v85, v43, v42, s21
    v_perm_b32 v86, v45, v44, s21
    v_perm_b32 v87, v47, v46, s21
    v_perm_b32 v88, v33, v32, s22
    v_perm_b32 v89, v35, v34, s22
    v_perm_b32 v90, v37, v36, s22
    v_perm_b32 v91, v39, v38, s22
    v_perm_b32 v92, v41, v40, s22
    v_perm_b32 v93, v43, v42, s22
    v_perm_b32 v94, v45, v44, s22
    v_perm_b32 v95, v47, v46, s22
    v_accvgpr_write_b32 a80, v80
    v_accvgpr_write_b32 a81, v81
    v_accvgpr_write_b32 a82, v82
    v_accvgpr_write_b32 a83, v83
    v_accvgpr_write_b32 a84, v84
    v_accvgpr_write_b32 a85, v85
    v_accvgpr_write_b32 a86, v86
    v_accvgpr_write_b32 a87, v87
    v_accvgpr_write_b32 a88, v88
    v_accvgpr_write_b32 a89, v89
    v_accvgpr_write_b32 a90, v90
    v_accvgpr_write_b32 a91, v91
    v_accvgpr_write_b32 a92, v92
    v_accvgpr_write_b32 a93, v93
    v_accvgpr_write_b32 a94, v94
    v_accvgpr_write_b32 a95, v95
    s_mov_b32 s34, 0x80000
    buffer_load_dword v32, v122, s[16:19], s34 offen
    s_mov_b32 s34, 0x82000
    buffer_load_dword v33, v122, s[16:19], s34 offen
    s_mov_b32 s34, 0x90000
    buffer_load_dword v34, v122, s[16:19], s34 offen
    s_mov_b32 s34, 0x92000
    buffer_load_dword v35, v122, s[16:19], s34 offen
    s_mov_b32 s34, 0x84000
    buffer_load_dword v36, v122, s[16:19], s34 offen
    s_mov_b32 s34, 0x86000
    buffer_load_dword v37, v122, s[16:19], s34 offen
    s_mov_b32 s34, 0x94000
    buffer_load_dword v38, v122, s[16:19], s34 offen
    s_mov_b32 s34, 0x96000
    buffer_load_dword v39, v122, s[16:19], s34 offen
    s_mov_b32 s34, 0xc0000
    buffer_load_dword v40, v122, s[16:19], s34 offen
    s_mov_b32 s34, 0xc2000
    buffer_load_dword v41, v122, s[16:19], s34 offen
    s_mov_b32 s34, 0xd0000
    buffer_load_dword v42, v122, s[16:19], s34 offen
    s_mov_b32 s34, 0xd2000
    buffer_load_dword v43, v122, s[16:19], s34 offen
    s_mov_b32 s34, 0xc4000
    buffer_load_dword v44, v122, s[16:19], s34 offen
    s_mov_b32 s34, 0xc6000
    buffer_load_dword v45, v122, s[16:19], s34 offen
    s_mov_b32 s34, 0xd4000
    buffer_load_dword v46, v122, s[16:19], s34 offen
    s_mov_b32 s34, 0xd6000
    buffer_load_dword v47, v122, s[16:19], s34 offen
    s_waitcnt vmcnt(48)
    v_perm_b32 v80, v49, v48, s21
    v_perm_b32 v81, v51, v50, s21
    v_perm_b32 v82, v53, v52, s21
    v_perm_b32 v83, v55, v54, s21
    v_perm_b32 v84, v57, v56, s21
    v_perm_b32 v85, v59, v58, s21
    v_perm_b32 v86, v61, v60, s21
    v_perm_b32 v87, v63, v62, s21
    v_perm_b32 v88, v49, v48, s22
    v_perm_b32 v89, v51, v50, s22
    v_perm_b32 v90, v53, v52, s22
    v_perm_b32 v91, v55, v54, s22
    v_perm_b32 v92, v57, v56, s22
    v_perm_b32 v93, v59, v58, s22
    v_perm_b32 v94, v61, v60, s22
    v_perm_b32 v95, v63, v62, s22
    v_accvgpr_write_b32 a96, v80
    v_accvgpr_write_b32 a97, v81
    v_accvgpr_write_b32 a98, v82
    v_accvgpr_write_b32 a99, v83
    v_accvgpr_write_b32 a100, v84
    v_accvgpr_write_b32 a101, v85
    v_accvgpr_write_b32 a102, v86
    v_accvgpr_write_b32 a103, v87
    v_accvgpr_write_b32 a104, v88
    v_accvgpr_write_b32 a105, v89
    v_accvgpr_write_b32 a106, v90
    v_accvgpr_write_b32 a107, v91
    v_accvgpr_write_b32 a108, v92
    v_accvgpr_write_b32 a109, v93
    v_accvgpr_write_b32 a110, v94
    v_accvgpr_write_b32 a111, v95
    s_mov_b32 s34, 0x100000
    buffer_load_dword v48, v122, s[16:19], s34 offen
    s_mov_b32 s34, 0x102000
    buffer_load_dword v49, v122, s[16:19], s34 offen
    s_mov_b32 s34, 0x110000
    buffer_load_dword v50, v122, s[16:19], s34 offen
    s_mov_b32 s34, 0x112000
    buffer_load_dword v51, v122, s[16:19], s34 offen
    s_mov_b32 s34, 0x104000
    buffer_load_dword v52, v122, s[16:19], s34 offen
    s_mov_b32 s34, 0x106000
    buffer_load_dword v53, v122, s[16:19], s34 offen
    s_mov_b32 s34, 0x114000
    buffer_load_dword v54, v122, s[16:19], s34 offen
    s_mov_b32 s34, 0x116000
    buffer_load_dword v55, v122, s[16:19], s34 offen
    s_mov_b32 s34, 0x140000
    buffer_load_dword v56, v122, s[16:19], s34 offen
    s_mov_b32 s34, 0x142000
    buffer_load_dword v57, v122, s[16:19], s34 offen
    s_mov_b32 s34, 0x150000
    buffer_load_dword v58, v122, s[16:19], s34 offen
    s_mov_b32 s34, 0x152000
    buffer_load_dword v59, v122, s[16:19], s34 offen
    s_mov_b32 s34, 0x144000
    buffer_load_dword v60, v122, s[16:19], s34 offen
    s_mov_b32 s34, 0x146000
    buffer_load_dword v61, v122, s[16:19], s34 offen
    s_mov_b32 s34, 0x154000
    buffer_load_dword v62, v122, s[16:19], s34 offen
    s_mov_b32 s34, 0x156000
    buffer_load_dword v63, v122, s[16:19], s34 offen
    s_waitcnt vmcnt(48)
    v_perm_b32 v80, v65, v64, s21
    v_perm_b32 v81, v67, v66, s21
    v_perm_b32 v82, v69, v68, s21
    v_perm_b32 v83, v71, v70, s21
    v_perm_b32 v84, v73, v72, s21
    v_perm_b32 v85, v75, v74, s21
    v_perm_b32 v86, v77, v76, s21
    v_perm_b32 v87, v79, v78, s21
    v_perm_b32 v88, v65, v64, s22
    v_perm_b32 v89, v67, v66, s22
    v_perm_b32 v90, v69, v68, s22
    v_perm_b32 v91, v71, v70, s22
    v_perm_b32 v92, v73, v72, s22
    v_perm_b32 v93, v75, v74, s22
    v_perm_b32 v94, v77, v76, s22
    v_perm_b32 v95, v79, v78, s22
    v_accvgpr_write_b32 a112, v80
    v_accvgpr_write_b32 a113, v81
    v_accvgpr_write_b32 a114, v82
    v_accvgpr_write_b32 a115, v83
    v_accvgpr_write_b32 a116, v84
    v_accvgpr_write_b32 a117, v85
    v_accvgpr_write_b32 a118, v86
    v_accvgpr_write_b32 a119, v87
    v_accvgpr_write_b32 a120, v88
    v_accvgpr_write_b32 a121, v89
    v_accvgpr_write_b32 a122, v90
    v_accvgpr_write_b32 a123, v91
    v_accvgpr_write_b32 a124, v92
    v_accvgpr_write_b32 a125, v93
    v_accvgpr_write_b32 a126, v94
    v_accvgpr_write_b32 a127, v95
    s_mov_b32 s34, 0x180000
    buffer_load_dword v64, v122, s[16:19], s34 offen
    s_mov_b32 s34, 0x182000
    buffer_load_dword v65, v122, s[16:19], s34 offen
    s_mov_b32 s34, 0x190000
    buffer_load_dword v66, v122, s[16:19], s34 offen
    s_mov_b32 s34, 0x192000
    buffer_load_dword v67, v122, s[16:19], s34 offen
    s_mov_b32 s34, 0x184000
    buffer_load_dword v68, v122, s[16:19], s34 offen
    s_mov_b32 s34, 0x186000
    buffer_load_dword v69, v122, s[16:19], s34 offen
    s_mov_b32 s34, 0x194000
    buffer_load_dword v70, v122, s[16:19], s34 offen
    s_mov_b32 s34, 0x196000
    buffer_load_dword v71, v122, s[16:19], s34 offen
    s_mov_b32 s34, 0x1c0000
    buffer_load_dword v72, v122, s[16:19], s34 offen
    s_mov_b32 s34, 0x1c2000
    buffer_load_dword v73, v122, s[16:19], s34 offen
    s_mov_b32 s34, 0x1d0000
    buffer_load_dword v74, v122, s[16:19], s34 offen
    s_mov_b32 s34, 0x1d2000
    buffer_load_dword v75, v122, s[16:19], s34 offen
    s_mov_b32 s34, 0x1c4000
    buffer_load_dword v76, v122, s[16:19], s34 offen
    s_mov_b32 s34, 0x1c6000
    buffer_load_dword v77, v122, s[16:19], s34 offen
    s_mov_b32 s34, 0x1d4000
    buffer_load_dword v78, v122, s[16:19], s34 offen
    s_mov_b32 s34, 0x1d6000
    buffer_load_dword v79, v122, s[16:19], s34 offen
    s_waitcnt vmcnt(48)
    v_perm_b32 v80, v17, v16, s21
    v_perm_b32 v81, v19, v18, s21
    v_perm_b32 v82, v21, v20, s21
    v_perm_b32 v83, v23, v22, s21
    v_perm_b32 v84, v25, v24, s21
    v_perm_b32 v85, v27, v26, s21
    v_perm_b32 v86, v29, v28, s21
    v_perm_b32 v87, v31, v30, s21
    v_perm_b32 v88, v17, v16, s22
    v_perm_b32 v89, v19, v18, s22
    v_perm_b32 v90, v21, v20, s22
    v_perm_b32 v91, v23, v22, s22
    v_perm_b32 v92, v25, v24, s22
    v_perm_b32 v93, v27, v26, s22
    v_perm_b32 v94, v29, v28, s22
    v_perm_b32 v95, v31, v30, s22
    v_accvgpr_write_b32 a128, v80
    v_accvgpr_write_b32 a129, v81
    v_accvgpr_write_b32 a130, v82
    v_accvgpr_write_b32 a131, v83
    v_accvgpr_write_b32 a132, v84
    v_accvgpr_write_b32 a133, v85
    v_accvgpr_write_b32 a134, v86
    v_accvgpr_write_b32 a135, v87
    v_accvgpr_write_b32 a136, v88
    v_accvgpr_write_b32 a137, v89
    v_accvgpr_write_b32 a138, v90
    v_accvgpr_write_b32 a139, v91
    v_accvgpr_write_b32 a140, v92
    v_accvgpr_write_b32 a141, v93
    v_accvgpr_write_b32 a142, v94
    v_accvgpr_write_b32 a143, v95
    s_mov_b32 s34, 0x200000
    buffer_load_dword v16, v122, s[16:19], s34 offen
    s_mov_b32 s34, 0x202000
    buffer_load_dword v17, v122, s[16:19], s34 offen
    s_mov_b32 s34, 0x210000
    buffer_load_dword v18, v122, s[16:19], s34 offen
    s_mov_b32 s34, 0x212000
    buffer_load_dword v19, v122, s[16:19], s34 offen
    s_mov_b32 s34, 0x204000
    buffer_load_dword v20, v122, s[16:19], s34 offen
    s_mov_b32 s34, 0x206000
    buffer_load_dword v21, v122, s[16:19], s34 offen
    s_mov_b32 s34, 0x214000
    buffer_load_dword v22, v122, s[16:19], s34 offen
    s_mov_b32 s34, 0x216000
    buffer_load_dword v23, v122, s[16:19], s34 offen
    s_mov_b32 s34, 0x240000
    buffer_load_dword v24, v122, s[16:19], s34 offen
    s_mov_b32 s34, 0x242000
    buffer_load_dword v25, v122, s[16:19], s34 offen
    s_mov_b32 s34, 0x250000
    buffer_load_dword v26, v122, s[16:19], s34 offen
    s_mov_b32 s34, 0x252000
    buffer_load_dword v27, v122, s[16:19], s34 offen
    s_mov_b32 s34, 0x244000
    buffer_load_dword v28, v122, s[16:19], s34 offen
    s_mov_b32 s34, 0x246000
    buffer_load_dword v29, v122, s[16:19], s34 offen
    s_mov_b32 s34, 0x254000
    buffer_load_dword v30, v122, s[16:19], s34 offen
    s_mov_b32 s34, 0x256000
    buffer_load_dword v31, v122, s[16:19], s34 offen
    s_waitcnt vmcnt(48)
    v_perm_b32 v80, v33, v32, s21
    v_perm_b32 v81, v35, v34, s21
    v_perm_b32 v82, v37, v36, s21
    v_perm_b32 v83, v39, v38, s21
    v_perm_b32 v84, v41, v40, s21
    v_perm_b32 v85, v43, v42, s21
    v_perm_b32 v86, v45, v44, s21
    v_perm_b32 v87, v47, v46, s21
    v_perm_b32 v88, v33, v32, s22
    v_perm_b32 v89, v35, v34, s22
    v_perm_b32 v90, v37, v36, s22
    v_perm_b32 v91, v39, v38, s22
    v_perm_b32 v92, v41, v40, s22
    v_perm_b32 v93, v43, v42, s22
    v_perm_b32 v94, v45, v44, s22
    v_perm_b32 v95, v47, v46, s22
    v_accvgpr_write_b32 a144, v80
    v_accvgpr_write_b32 a145, v81
    v_accvgpr_write_b32 a146, v82
    v_accvgpr_write_b32 a147, v83
    v_accvgpr_write_b32 a148, v84
    v_accvgpr_write_b32 a149, v85
    v_accvgpr_write_b32 a150, v86
    v_accvgpr_write_b32 a151, v87
    v_accvgpr_write_b32 a152, v88
    v_accvgpr_write_b32 a153, v89
    v_accvgpr_write_b32 a154, v90
    v_accvgpr_write_b32 a155, v91
    v_accvgpr_write_b32 a156, v92
    v_accvgpr_write_b32 a157, v93
    v_accvgpr_write_b32 a158, v94
    v_accvgpr_write_b32 a159, v95
    s_mov_b32 s34, 0x280000
    buffer_load_dword v32, v122, s[16:19], s34 offen
    s_mov_b32 s34, 0x282000
    buffer_load_dword v33, v122, s[16:19], s34 offen
    s_mov_b32 s34, 0x290000
    buffer_load_dword v34, v122, s[16:19], s34 offen
    s_mov_b32 s34, 0x292000
    buffer_load_dword v35, v122, s[16:19], s34 offen
    s_mov_b32 s34, 0x284000
    buffer_load_dword v36, v122, s[16:19], s34 offen
    s_mov_b32 s34, 0x286000
    buffer_load_dword v37, v122, s[16:19], s34 offen
    s_mov_b32 s34, 0x294000
    buffer_load_dword v38, v122, s[16:19], s34 offen
    s_mov_b32 s34, 0x296000
    buffer_load_dword v39, v122, s[16:19], s34 offen
    s_mov_b32 s34, 0x2c0000
    buffer_load_dword v40, v122, s[16:19], s34 offen
    s_mov_b32 s34, 0x2c2000
    buffer_load_dword v41, v122, s[16:19], s34 offen
    s_mov_b32 s34, 0x2d0000
    buffer_load_dword v42, v122, s[16:19], s34 offen
    s_mov_b32 s34, 0x2d2000
    buffer_load_dword v43, v122, s[16:19], s34 offen
    s_mov_b32 s34, 0x2c4000
    buffer_load_dword v44, v122, s[16:19], s34 offen
    s_mov_b32 s34, 0x2c6000
    buffer_load_dword v45, v122, s[16:19], s34 offen
    s_mov_b32 s34, 0x2d4000
    buffer_load_dword v46, v122, s[16:19], s34 offen
    s_mov_b32 s34, 0x2d6000
    buffer_load_dword v47, v122, s[16:19], s34 offen
    s_waitcnt vmcnt(48)
    v_perm_b32 v80, v49, v48, s21
    v_perm_b32 v81, v51, v50, s21
    v_perm_b32 v82, v53, v52, s21
    v_perm_b32 v83, v55, v54, s21
    v_perm_b32 v84, v57, v56, s21
    v_perm_b32 v85, v59, v58, s21
    v_perm_b32 v86, v61, v60, s21
    v_perm_b32 v87, v63, v62, s21
    v_perm_b32 v88, v49, v48, s22
    v_perm_b32 v89, v51, v50, s22
    v_perm_b32 v90, v53, v52, s22
    v_perm_b32 v91, v55, v54, s22
    v_perm_b32 v92, v57, v56, s22
    v_perm_b32 v93, v59, v58, s22
    v_perm_b32 v94, v61, v60, s22
    v_perm_b32 v95, v63, v62, s22
    v_accvgpr_write_b32 a160, v80
    v_accvgpr_write_b32 a161, v81
    v_accvgpr_write_b32 a162, v82
    v_accvgpr_write_b32 a163, v83
    v_accvgpr_write_b32 a164, v84
    v_accvgpr_write_b32 a165, v85
    v_accvgpr_write_b32 a166, v86
    v_accvgpr_write_b32 a167, v87
    v_accvgpr_write_b32 a168, v88
    v_accvgpr_write_b32 a169, v89
    v_accvgpr_write_b32 a170, v90
    v_accvgpr_write_b32 a171, v91
    v_accvgpr_write_b32 a172, v92
    v_accvgpr_write_b32 a173, v93
    v_accvgpr_write_b32 a174, v94
    v_accvgpr_write_b32 a175, v95
    s_mov_b32 s34, 0x300000
    buffer_load_dword v48, v122, s[16:19], s34 offen
    s_mov_b32 s34, 0x302000
    buffer_load_dword v49, v122, s[16:19], s34 offen
    s_mov_b32 s34, 0x310000
    buffer_load_dword v50, v122, s[16:19], s34 offen
    s_mov_b32 s34, 0x312000
    buffer_load_dword v51, v122, s[16:19], s34 offen
    s_mov_b32 s34, 0x304000
    buffer_load_dword v52, v122, s[16:19], s34 offen
    s_mov_b32 s34, 0x306000
    buffer_load_dword v53, v122, s[16:19], s34 offen
    s_mov_b32 s34, 0x314000
    buffer_load_dword v54, v122, s[16:19], s34 offen
    s_mov_b32 s34, 0x316000
    buffer_load_dword v55, v122, s[16:19], s34 offen
    s_mov_b32 s34, 0x340000
    buffer_load_dword v56, v122, s[16:19], s34 offen
    s_mov_b32 s34, 0x342000
    buffer_load_dword v57, v122, s[16:19], s34 offen
    s_mov_b32 s34, 0x350000
    buffer_load_dword v58, v122, s[16:19], s34 offen
    s_mov_b32 s34, 0x352000
    buffer_load_dword v59, v122, s[16:19], s34 offen
    s_mov_b32 s34, 0x344000
    buffer_load_dword v60, v122, s[16:19], s34 offen
    s_mov_b32 s34, 0x346000
    buffer_load_dword v61, v122, s[16:19], s34 offen
    s_mov_b32 s34, 0x354000
    buffer_load_dword v62, v122, s[16:19], s34 offen
    s_mov_b32 s34, 0x356000
    buffer_load_dword v63, v122, s[16:19], s34 offen
    s_waitcnt vmcnt(48)
    v_perm_b32 v80, v65, v64, s21
    v_perm_b32 v81, v67, v66, s21
    v_perm_b32 v82, v69, v68, s21
    v_perm_b32 v83, v71, v70, s21
    v_perm_b32 v84, v73, v72, s21
    v_perm_b32 v85, v75, v74, s21
    v_perm_b32 v86, v77, v76, s21
    v_perm_b32 v87, v79, v78, s21
    v_perm_b32 v88, v65, v64, s22
    v_perm_b32 v89, v67, v66, s22
    v_perm_b32 v90, v69, v68, s22
    v_perm_b32 v91, v71, v70, s22
    v_perm_b32 v92, v73, v72, s22
    v_perm_b32 v93, v75, v74, s22
    v_perm_b32 v94, v77, v76, s22
    v_perm_b32 v95, v79, v78, s22
    v_accvgpr_write_b32 a176, v80
    v_accvgpr_write_b32 a177, v81
    v_accvgpr_write_b32 a178, v82
    v_accvgpr_write_b32 a179, v83
    v_accvgpr_write_b32 a180, v84
    v_accvgpr_write_b32 a181, v85
    v_accvgpr_write_b32 a182, v86
    v_accvgpr_write_b32 a183, v87
    v_accvgpr_write_b32 a184, v88
    v_accvgpr_write_b32 a185, v89
    v_accvgpr_write_b32 a186, v90
    v_accvgpr_write_b32 a187, v91
    v_accvgpr_write_b32 a188, v92
    v_accvgpr_write_b32 a189, v93
    v_accvgpr_write_b32 a190, v94
    v_accvgpr_write_b32 a191, v95
    s_mov_b32 s34, 0x380000
    buffer_load_dword v64, v122, s[16:19], s34 offen
    s_mov_b32 s34, 0x382000
    buffer_load_dword v65, v122, s[16:19], s34 offen
    s_mov_b32 s34, 0x390000
    buffer_load_dword v66, v122, s[16:19], s34 offen
    s_mov_b32 s34, 0x392000
    buffer_load_dword v67, v122, s[16:19], s34 offen
    s_mov_b32 s34, 0x384000
    buffer_load_dword v68, v122, s[16:19], s34 offen
    s_mov_b32 s34, 0x386000
    buffer_load_dword v69, v122, s[16:19], s34 offen
    s_mov_b32 s34, 0x394000
    buffer_load_dword v70, v122, s[16:19], s34 offen
    s_mov_b32 s34, 0x396000
    buffer_load_dword v71, v122, s[16:19], s34 offen
    s_mov_b32 s34, 0x3c0000
    buffer_load_dword v72, v122, s[16:19], s34 offen
    s_mov_b32 s34, 0x3c2000
    buffer_load_dword v73, v122, s[16:19], s34 offen
    s_mov_b32 s34, 0x3d0000
    buffer_load_dword v74, v122, s[16:19], s34 offen
    s_mov_b32 s34, 0x3d2000
    buffer_load_dword v75, v122, s[16:19], s34 offen
    s_mov_b32 s34, 0x3c4000
    buffer_load_dword v76, v122, s[16:19], s34 offen
    s_mov_b32 s34, 0x3c6000
    buffer_load_dword v77, v122, s[16:19], s34 offen
    s_mov_b32 s34, 0x3d4000
    buffer_load_dword v78, v122, s[16:19], s34 offen
    s_mov_b32 s34, 0x3d6000
    buffer_load_dword v79, v122, s[16:19], s34 offen
    s_waitcnt vmcnt(48)
    v_perm_b32 v80, v17, v16, s21
    v_perm_b32 v81, v19, v18, s21
    v_perm_b32 v82, v21, v20, s21
    v_perm_b32 v83, v23, v22, s21
    v_perm_b32 v84, v25, v24, s21
    v_perm_b32 v85, v27, v26, s21
    v_perm_b32 v86, v29, v28, s21
    v_perm_b32 v87, v31, v30, s21
    v_perm_b32 v88, v17, v16, s22
    v_perm_b32 v89, v19, v18, s22
    v_perm_b32 v90, v21, v20, s22
    v_perm_b32 v91, v23, v22, s22
    v_perm_b32 v92, v25, v24, s22
    v_perm_b32 v93, v27, v26, s22
    v_perm_b32 v94, v29, v28, s22
    v_perm_b32 v95, v31, v30, s22
    v_accvgpr_write_b32 a192, v80
    v_accvgpr_write_b32 a193, v81
    v_accvgpr_write_b32 a194, v82
    v_accvgpr_write_b32 a195, v83
    v_accvgpr_write_b32 a196, v84
    v_accvgpr_write_b32 a197, v85
    v_accvgpr_write_b32 a198, v86
    v_accvgpr_write_b32 a199, v87
    v_accvgpr_write_b32 a200, v88
    v_accvgpr_write_b32 a201, v89
    v_accvgpr_write_b32 a202, v90
    v_accvgpr_write_b32 a203, v91
    v_accvgpr_write_b32 a204, v92
    v_accvgpr_write_b32 a205, v93
    v_accvgpr_write_b32 a206, v94
    v_accvgpr_write_b32 a207, v95
    s_mov_b32 s12, s72
    s_and_b32 s13, s73, 0xffff
    s_mov_b32 s14, 0x400000
    s_mov_b32 s15, 0x20000
    s_mov_b32 s34, 0
    buffer_load_dword v16, v122, s[12:15], s34 offen
    s_mov_b32 s34, 0x2000
    buffer_load_dword v17, v122, s[12:15], s34 offen
    s_mov_b32 s34, 0x10000
    buffer_load_dword v18, v122, s[12:15], s34 offen
    s_mov_b32 s34, 0x12000
    buffer_load_dword v19, v122, s[12:15], s34 offen
    s_mov_b32 s34, 0x4000
    buffer_load_dword v20, v122, s[12:15], s34 offen
    s_mov_b32 s34, 0x6000
    buffer_load_dword v21, v122, s[12:15], s34 offen
    s_mov_b32 s34, 0x14000
    buffer_load_dword v22, v122, s[12:15], s34 offen
    s_mov_b32 s34, 0x16000
    buffer_load_dword v23, v122, s[12:15], s34 offen
    s_mov_b32 s34, 0x40000
    buffer_load_dword v24, v122, s[12:15], s34 offen
    s_mov_b32 s34, 0x42000
    buffer_load_dword v25, v122, s[12:15], s34 offen
    s_mov_b32 s34, 0x50000
    buffer_load_dword v26, v122, s[12:15], s34 offen
    s_mov_b32 s34, 0x52000
    buffer_load_dword v27, v122, s[12:15], s34 offen
    s_mov_b32 s34, 0x44000
    buffer_load_dword v28, v122, s[12:15], s34 offen
    s_mov_b32 s34, 0x46000
    buffer_load_dword v29, v122, s[12:15], s34 offen
    s_mov_b32 s34, 0x54000
    buffer_load_dword v30, v122, s[12:15], s34 offen
    s_mov_b32 s34, 0x56000
    buffer_load_dword v31, v122, s[12:15], s34 offen
    s_waitcnt vmcnt(48)
    v_perm_b32 v80, v33, v32, s21
    v_perm_b32 v81, v35, v34, s21
    v_perm_b32 v82, v37, v36, s21
    v_perm_b32 v83, v39, v38, s21
    v_perm_b32 v84, v41, v40, s21
    v_perm_b32 v85, v43, v42, s21
    v_perm_b32 v86, v45, v44, s21
    v_perm_b32 v87, v47, v46, s21
    v_perm_b32 v88, v33, v32, s22
    v_perm_b32 v89, v35, v34, s22
    v_perm_b32 v90, v37, v36, s22
    v_perm_b32 v91, v39, v38, s22
    v_perm_b32 v92, v41, v40, s22
    v_perm_b32 v93, v43, v42, s22
    v_perm_b32 v94, v45, v44, s22
    v_perm_b32 v95, v47, v46, s22
    v_accvgpr_write_b32 a208, v80
    v_accvgpr_write_b32 a209, v81
    v_accvgpr_write_b32 a210, v82
    v_accvgpr_write_b32 a211, v83
    v_accvgpr_write_b32 a212, v84
    v_accvgpr_write_b32 a213, v85
    v_accvgpr_write_b32 a214, v86
    v_accvgpr_write_b32 a215, v87
    v_accvgpr_write_b32 a216, v88
    v_accvgpr_write_b32 a217, v89
    v_accvgpr_write_b32 a218, v90
    v_accvgpr_write_b32 a219, v91
    v_accvgpr_write_b32 a220, v92
    v_accvgpr_write_b32 a221, v93
    v_accvgpr_write_b32 a222, v94
    v_accvgpr_write_b32 a223, v95
    s_mov_b32 s34, 0x80000
    buffer_load_dword v32, v122, s[12:15], s34 offen
    s_mov_b32 s34, 0x82000
    buffer_load_dword v33, v122, s[12:15], s34 offen
    s_mov_b32 s34, 0x90000
    buffer_load_dword v34, v122, s[12:15], s34 offen
    s_mov_b32 s34, 0x92000
    buffer_load_dword v35, v122, s[12:15], s34 offen
    s_mov_b32 s34, 0x84000
    buffer_load_dword v36, v122, s[12:15], s34 offen
    s_mov_b32 s34, 0x86000
    buffer_load_dword v37, v122, s[12:15], s34 offen
    s_mov_b32 s34, 0x94000
    buffer_load_dword v38, v122, s[12:15], s34 offen
    s_mov_b32 s34, 0x96000
    buffer_load_dword v39, v122, s[12:15], s34 offen
    s_mov_b32 s34, 0xc0000
    buffer_load_dword v40, v122, s[12:15], s34 offen
    s_mov_b32 s34, 0xc2000
    buffer_load_dword v41, v122, s[12:15], s34 offen
    s_mov_b32 s34, 0xd0000
    buffer_load_dword v42, v122, s[12:15], s34 offen
    s_mov_b32 s34, 0xd2000
    buffer_load_dword v43, v122, s[12:15], s34 offen
    s_mov_b32 s34, 0xc4000
    buffer_load_dword v44, v122, s[12:15], s34 offen
    s_mov_b32 s34, 0xc6000
    buffer_load_dword v45, v122, s[12:15], s34 offen
    s_mov_b32 s34, 0xd4000
    buffer_load_dword v46, v122, s[12:15], s34 offen
    s_mov_b32 s34, 0xd6000
    buffer_load_dword v47, v122, s[12:15], s34 offen
    s_waitcnt vmcnt(48)
    v_perm_b32 v80, v49, v48, s21
    v_perm_b32 v81, v51, v50, s21
    v_perm_b32 v82, v53, v52, s21
    v_perm_b32 v83, v55, v54, s21
    v_perm_b32 v84, v57, v56, s21
    v_perm_b32 v85, v59, v58, s21
    v_perm_b32 v86, v61, v60, s21
    v_perm_b32 v87, v63, v62, s21
    v_perm_b32 v88, v49, v48, s22
    v_perm_b32 v89, v51, v50, s22
    v_perm_b32 v90, v53, v52, s22
    v_perm_b32 v91, v55, v54, s22
    v_perm_b32 v92, v57, v56, s22
    v_perm_b32 v93, v59, v58, s22
    v_perm_b32 v94, v61, v60, s22
    v_perm_b32 v95, v63, v62, s22
    v_accvgpr_write_b32 a224, v80
    v_accvgpr_write_b32 a225, v81
    v_accvgpr_write_b32 a226, v82
    v_accvgpr_write_b32 a227, v83
    v_accvgpr_write_b32 a228, v84
    v_accvgpr_write_b32 a229, v85
    v_accvgpr_write_b32 a230, v86
    v_accvgpr_write_b32 a231, v87
    v_accvgpr_write_b32 a232, v88
    v_accvgpr_write_b32 a233, v89
    v_accvgpr_write_b32 a234, v90
    v_accvgpr_write_b32 a235, v91
    v_accvgpr_write_b32 a236, v92
    v_accvgpr_write_b32 a237, v93
    v_accvgpr_write_b32 a238, v94
    v_accvgpr_write_b32 a239, v95
    s_mov_b32 s34, 0x100000
    buffer_load_dword v48, v122, s[12:15], s34 offen
    s_mov_b32 s34, 0x102000
    buffer_load_dword v49, v122, s[12:15], s34 offen
    s_mov_b32 s34, 0x110000
    buffer_load_dword v50, v122, s[12:15], s34 offen
    s_mov_b32 s34, 0x112000
    buffer_load_dword v51, v122, s[12:15], s34 offen
    s_mov_b32 s34, 0x104000
    buffer_load_dword v52, v122, s[12:15], s34 offen
    s_mov_b32 s34, 0x106000
    buffer_load_dword v53, v122, s[12:15], s34 offen
    s_mov_b32 s34, 0x114000
    buffer_load_dword v54, v122, s[12:15], s34 offen
    s_mov_b32 s34, 0x116000
    buffer_load_dword v55, v122, s[12:15], s34 offen
    s_mov_b32 s34, 0x140000
    buffer_load_dword v56, v122, s[12:15], s34 offen
    s_mov_b32 s34, 0x142000
    buffer_load_dword v57, v122, s[12:15], s34 offen
    s_mov_b32 s34, 0x150000
    buffer_load_dword v58, v122, s[12:15], s34 offen
    s_mov_b32 s34, 0x152000
    buffer_load_dword v59, v122, s[12:15], s34 offen
    s_mov_b32 s34, 0x144000
    buffer_load_dword v60, v122, s[12:15], s34 offen
    s_mov_b32 s34, 0x146000
    buffer_load_dword v61, v122, s[12:15], s34 offen
    s_mov_b32 s34, 0x154000
    buffer_load_dword v62, v122, s[12:15], s34 offen
    s_mov_b32 s34, 0x156000
    buffer_load_dword v63, v122, s[12:15], s34 offen
    s_waitcnt vmcnt(48)
    v_perm_b32 v80, v65, v64, s21
    v_perm_b32 v81, v67, v66, s21
    v_perm_b32 v82, v69, v68, s21
    v_perm_b32 v83, v71, v70, s21
    v_perm_b32 v84, v73, v72, s21
    v_perm_b32 v85, v75, v74, s21
    v_perm_b32 v86, v77, v76, s21
    v_perm_b32 v87, v79, v78, s21
    v_perm_b32 v88, v65, v64, s22
    v_perm_b32 v89, v67, v66, s22
    v_perm_b32 v90, v69, v68, s22
    v_perm_b32 v91, v71, v70, s22
    v_perm_b32 v92, v73, v72, s22
    v_perm_b32 v93, v75, v74, s22
    v_perm_b32 v94, v77, v76, s22
    v_perm_b32 v95, v79, v78, s22
    v_accvgpr_write_b32 a240, v80
    v_accvgpr_write_b32 a241, v81
    v_accvgpr_write_b32 a242, v82
    v_accvgpr_write_b32 a243, v83
    v_accvgpr_write_b32 a244, v84
    v_accvgpr_write_b32 a245, v85
    v_accvgpr_write_b32 a246, v86
    v_accvgpr_write_b32 a247, v87
    v_accvgpr_write_b32 a248, v88
    v_accvgpr_write_b32 a249, v89
    v_accvgpr_write_b32 a250, v90
    v_accvgpr_write_b32 a251, v91
    v_accvgpr_write_b32 a252, v92
    v_accvgpr_write_b32 a253, v93
    v_accvgpr_write_b32 a254, v94
    v_accvgpr_write_b32 a255, v95
    s_mov_b32 s34, 0x180000
    buffer_load_dword v64, v122, s[12:15], s34 offen
    s_mov_b32 s34, 0x182000
    buffer_load_dword v65, v122, s[12:15], s34 offen
    s_mov_b32 s34, 0x190000
    buffer_load_dword v66, v122, s[12:15], s34 offen
    s_mov_b32 s34, 0x192000
    buffer_load_dword v67, v122, s[12:15], s34 offen
    s_mov_b32 s34, 0x184000
    buffer_load_dword v68, v122, s[12:15], s34 offen
    s_mov_b32 s34, 0x186000
    buffer_load_dword v69, v122, s[12:15], s34 offen
    s_mov_b32 s34, 0x194000
    buffer_load_dword v70, v122, s[12:15], s34 offen
    s_mov_b32 s34, 0x196000
    buffer_load_dword v71, v122, s[12:15], s34 offen
    s_mov_b32 s34, 0x1c0000
    buffer_load_dword v72, v122, s[12:15], s34 offen
    s_mov_b32 s34, 0x1c2000
    buffer_load_dword v73, v122, s[12:15], s34 offen
    s_mov_b32 s34, 0x1d0000
    buffer_load_dword v74, v122, s[12:15], s34 offen
    s_mov_b32 s34, 0x1d2000
    buffer_load_dword v75, v122, s[12:15], s34 offen
    s_mov_b32 s34, 0x1c4000
    buffer_load_dword v76, v122, s[12:15], s34 offen
    s_mov_b32 s34, 0x1c6000
    buffer_load_dword v77, v122, s[12:15], s34 offen
    s_mov_b32 s34, 0x1d4000
    buffer_load_dword v78, v122, s[12:15], s34 offen
    s_mov_b32 s34, 0x1d6000
    buffer_load_dword v79, v122, s[12:15], s34 offen
    s_waitcnt vmcnt(48)
    v_perm_b32 v80, v17, v16, s21
    v_perm_b32 v81, v19, v18, s21
    v_perm_b32 v82, v21, v20, s21
    v_perm_b32 v83, v23, v22, s21
    v_perm_b32 v84, v25, v24, s21
    v_perm_b32 v85, v27, v26, s21
    v_perm_b32 v86, v29, v28, s21
    v_perm_b32 v87, v31, v30, s21
    v_perm_b32 v88, v17, v16, s22
    v_perm_b32 v89, v19, v18, s22
    v_perm_b32 v90, v21, v20, s22
    v_perm_b32 v91, v23, v22, s22
    v_perm_b32 v92, v25, v24, s22
    v_perm_b32 v93, v27, v26, s22
    v_perm_b32 v94, v29, v28, s22
    v_perm_b32 v95, v31, v30, s22
    ds_write_b128 v15, v[80:83] offset:0
    ds_write_b128 v15, v[84:87] offset:1024
    ds_write_b128 v15, v[88:91] offset:2048
    ds_write_b128 v15, v[92:95] offset:3072
    s_nop 1
    s_mov_b32 s34, 0x200000
    buffer_load_dword v16, v122, s[12:15], s34 offen
    s_mov_b32 s34, 0x202000
    buffer_load_dword v17, v122, s[12:15], s34 offen
    s_mov_b32 s34, 0x210000
    buffer_load_dword v18, v122, s[12:15], s34 offen
    s_mov_b32 s34, 0x212000
    buffer_load_dword v19, v122, s[12:15], s34 offen
    s_mov_b32 s34, 0x204000
    buffer_load_dword v20, v122, s[12:15], s34 offen
    s_mov_b32 s34, 0x206000
    buffer_load_dword v21, v122, s[12:15], s34 offen
    s_mov_b32 s34, 0x214000
    buffer_load_dword v22, v122, s[12:15], s34 offen
    s_mov_b32 s34, 0x216000
    buffer_load_dword v23, v122, s[12:15], s34 offen
    s_mov_b32 s34, 0x240000
    buffer_load_dword v24, v122, s[12:15], s34 offen
    s_mov_b32 s34, 0x242000
    buffer_load_dword v25, v122, s[12:15], s34 offen
    s_mov_b32 s34, 0x250000
    buffer_load_dword v26, v122, s[12:15], s34 offen
    s_mov_b32 s34, 0x252000
    buffer_load_dword v27, v122, s[12:15], s34 offen
    s_mov_b32 s34, 0x244000
    buffer_load_dword v28, v122, s[12:15], s34 offen
    s_mov_b32 s34, 0x246000
    buffer_load_dword v29, v122, s[12:15], s34 offen
    s_mov_b32 s34, 0x254000
    buffer_load_dword v30, v122, s[12:15], s34 offen
    s_mov_b32 s34, 0x256000
    buffer_load_dword v31, v122, s[12:15], s34 offen
    s_waitcnt vmcnt(48)
    v_perm_b32 v80, v33, v32, s21
    v_perm_b32 v81, v35, v34, s21
    v_perm_b32 v82, v37, v36, s21
    v_perm_b32 v83, v39, v38, s21
    v_perm_b32 v84, v41, v40, s21
    v_perm_b32 v85, v43, v42, s21
    v_perm_b32 v86, v45, v44, s21
    v_perm_b32 v87, v47, v46, s21
    v_perm_b32 v88, v33, v32, s22
    v_perm_b32 v89, v35, v34, s22
    v_perm_b32 v90, v37, v36, s22
    v_perm_b32 v91, v39, v38, s22
    v_perm_b32 v92, v41, v40, s22
    v_perm_b32 v93, v43, v42, s22
    v_perm_b32 v94, v45, v44, s22
    v_perm_b32 v95, v47, v46, s22
    ds_write_b128 v15, v[80:83] offset:4096
    ds_write_b128 v15, v[84:87] offset:5120
    ds_write_b128 v15, v[88:91] offset:6144
    ds_write_b128 v15, v[92:95] offset:7168
    s_nop 1
    s_mov_b32 s34, 0x280000
    buffer_load_dword v32, v122, s[12:15], s34 offen
    s_mov_b32 s34, 0x282000
    buffer_load_dword v33, v122, s[12:15], s34 offen
    s_mov_b32 s34, 0x290000
    buffer_load_dword v34, v122, s[12:15], s34 offen
    s_mov_b32 s34, 0x292000
    buffer_load_dword v35, v122, s[12:15], s34 offen
    s_mov_b32 s34, 0x284000
    buffer_load_dword v36, v122, s[12:15], s34 offen
    s_mov_b32 s34, 0x286000
    buffer_load_dword v37, v122, s[12:15], s34 offen
    s_mov_b32 s34, 0x294000
    buffer_load_dword v38, v122, s[12:15], s34 offen
    s_mov_b32 s34, 0x296000
    buffer_load_dword v39, v122, s[12:15], s34 offen
    s_mov_b32 s34, 0x2c0000
    buffer_load_dword v40, v122, s[12:15], s34 offen
    s_mov_b32 s34, 0x2c2000
    buffer_load_dword v41, v122, s[12:15], s34 offen
    s_mov_b32 s34, 0x2d0000
    buffer_load_dword v42, v122, s[12:15], s34 offen
    s_mov_b32 s34, 0x2d2000
    buffer_load_dword v43, v122, s[12:15], s34 offen
    s_mov_b32 s34, 0x2c4000
    buffer_load_dword v44, v122, s[12:15], s34 offen
    s_mov_b32 s34, 0x2c6000
    buffer_load_dword v45, v122, s[12:15], s34 offen
    s_mov_b32 s34, 0x2d4000
    buffer_load_dword v46, v122, s[12:15], s34 offen
    s_mov_b32 s34, 0x2d6000
    buffer_load_dword v47, v122, s[12:15], s34 offen
    s_waitcnt vmcnt(48)
    v_perm_b32 v80, v49, v48, s21
    v_perm_b32 v81, v51, v50, s21
    v_perm_b32 v82, v53, v52, s21
    v_perm_b32 v83, v55, v54, s21
    v_perm_b32 v84, v57, v56, s21
    v_perm_b32 v85, v59, v58, s21
    v_perm_b32 v86, v61, v60, s21
    v_perm_b32 v87, v63, v62, s21
    v_perm_b32 v88, v49, v48, s22
    v_perm_b32 v89, v51, v50, s22
    v_perm_b32 v90, v53, v52, s22
    v_perm_b32 v91, v55, v54, s22
    v_perm_b32 v92, v57, v56, s22
    v_perm_b32 v93, v59, v58, s22
    v_perm_b32 v94, v61, v60, s22
    v_perm_b32 v95, v63, v62, s22
    ds_write_b128 v15, v[80:83] offset:8192
    ds_write_b128 v15, v[84:87] offset:9216
    ds_write_b128 v15, v[88:91] offset:10240
    ds_write_b128 v15, v[92:95] offset:11264
    s_nop 1
    s_mov_b32 s34, 0x300000
    buffer_load_dword v48, v122, s[12:15], s34 offen
    s_mov_b32 s34, 0x302000
    buffer_load_dword v49, v122, s[12:15], s34 offen
    s_mov_b32 s34, 0x310000
    buffer_load_dword v50, v122, s[12:15], s34 offen
    s_mov_b32 s34, 0x312000
    buffer_load_dword v51, v122, s[12:15], s34 offen
    s_mov_b32 s34, 0x304000
    buffer_load_dword v52, v122, s[12:15], s34 offen
    s_mov_b32 s34, 0x306000
    buffer_load_dword v53, v122, s[12:15], s34 offen
    s_mov_b32 s34, 0x314000
    buffer_load_dword v54, v122, s[12:15], s34 offen
    s_mov_b32 s34, 0x316000
    buffer_load_dword v55, v122, s[12:15], s34 offen
    s_mov_b32 s34, 0x340000
    buffer_load_dword v56, v122, s[12:15], s34 offen
    s_mov_b32 s34, 0x342000
    buffer_load_dword v57, v122, s[12:15], s34 offen
    s_mov_b32 s34, 0x350000
    buffer_load_dword v58, v122, s[12:15], s34 offen
    s_mov_b32 s34, 0x352000
    buffer_load_dword v59, v122, s[12:15], s34 offen
    s_mov_b32 s34, 0x344000
    buffer_load_dword v60, v122, s[12:15], s34 offen
    s_mov_b32 s34, 0x346000
    buffer_load_dword v61, v122, s[12:15], s34 offen
    s_mov_b32 s34, 0x354000
    buffer_load_dword v62, v122, s[12:15], s34 offen
    s_mov_b32 s34, 0x356000
    buffer_load_dword v63, v122, s[12:15], s34 offen
    s_waitcnt vmcnt(48)
    v_perm_b32 v80, v65, v64, s21
    v_perm_b32 v81, v67, v66, s21
    v_perm_b32 v82, v69, v68, s21
    v_perm_b32 v83, v71, v70, s21
    v_perm_b32 v84, v73, v72, s21
    v_perm_b32 v85, v75, v74, s21
    v_perm_b32 v86, v77, v76, s21
    v_perm_b32 v87, v79, v78, s21
    v_perm_b32 v88, v65, v64, s22
    v_perm_b32 v89, v67, v66, s22
    v_perm_b32 v90, v69, v68, s22
    v_perm_b32 v91, v71, v70, s22
    v_perm_b32 v92, v73, v72, s22
    v_perm_b32 v93, v75, v74, s22
    v_perm_b32 v94, v77, v76, s22
    v_perm_b32 v95, v79, v78, s22
    ds_write_b128 v15, v[80:83] offset:12288
    ds_write_b128 v15, v[84:87] offset:13312
    ds_write_b128 v15, v[88:91] offset:14336
    ds_write_b128 v15, v[92:95] offset:15360
    s_nop 1
    s_mov_b32 s34, 0x380000
    buffer_load_dword v64, v122, s[12:15], s34 offen
    s_mov_b32 s34, 0x382000
    buffer_load_dword v65, v122, s[12:15], s34 offen
    s_mov_b32 s34, 0x390000
    buffer_load_dword v66, v122, s[12:15], s34 offen
    s_mov_b32 s34, 0x392000
    buffer_load_dword v67, v122, s[12:15], s34 offen
    s_mov_b32 s34, 0x384000
    buffer_load_dword v68, v122, s[12:15], s34 offen
    s_mov_b32 s34, 0x386000
    buffer_load_dword v69, v122, s[12:15], s34 offen
    s_mov_b32 s34, 0x394000
    buffer_load_dword v70, v122, s[12:15], s34 offen
    s_mov_b32 s34, 0x396000
    buffer_load_dword v71, v122, s[12:15], s34 offen
    s_mov_b32 s34, 0x3c0000
    buffer_load_dword v72, v122, s[12:15], s34 offen
    s_mov_b32 s34, 0x3c2000
    buffer_load_dword v73, v122, s[12:15], s34 offen
    s_mov_b32 s34, 0x3d0000
    buffer_load_dword v74, v122, s[12:15], s34 offen
    s_mov_b32 s34, 0x3d2000
    buffer_load_dword v75, v122, s[12:15], s34 offen
    s_mov_b32 s34, 0x3c4000
    buffer_load_dword v76, v122, s[12:15], s34 offen
    s_mov_b32 s34, 0x3c6000
    buffer_load_dword v77, v122, s[12:15], s34 offen
    s_mov_b32 s34, 0x3d4000
    buffer_load_dword v78, v122, s[12:15], s34 offen
    s_mov_b32 s34, 0x3d6000
    buffer_load_dword v79, v122, s[12:15], s34 offen
    s_waitcnt vmcnt(48)
    v_perm_b32 v80, v17, v16, s21
    v_perm_b32 v81, v19, v18, s21
    v_perm_b32 v82, v21, v20, s21
    v_perm_b32 v83, v23, v22, s21
    v_perm_b32 v84, v25, v24, s21
    v_perm_b32 v85, v27, v26, s21
    v_perm_b32 v86, v29, v28, s21
    v_perm_b32 v87, v31, v30, s21
    v_perm_b32 v88, v17, v16, s22
    v_perm_b32 v89, v19, v18, s22
    v_perm_b32 v90, v21, v20, s22
    v_perm_b32 v91, v23, v22, s22
    v_perm_b32 v92, v25, v24, s22
    v_perm_b32 v93, v27, v26, s22
    v_perm_b32 v94, v29, v28, s22
    v_perm_b32 v95, v31, v30, s22
    ds_write_b128 v15, v[80:83] offset:16384
    ds_write_b128 v15, v[84:87] offset:17408
    ds_write_b128 v15, v[88:91] offset:18432
    ds_write_b128 v15, v[92:95] offset:19456
    s_nop 1
    s_waitcnt vmcnt(32)
    v_perm_b32 v80, v33, v32, s21
    v_perm_b32 v81, v35, v34, s21
    v_perm_b32 v82, v37, v36, s21
    v_perm_b32 v83, v39, v38, s21
    v_perm_b32 v84, v41, v40, s21
    v_perm_b32 v85, v43, v42, s21
    v_perm_b32 v86, v45, v44, s21
    v_perm_b32 v87, v47, v46, s21
    v_perm_b32 v88, v33, v32, s22
    v_perm_b32 v89, v35, v34, s22
    v_perm_b32 v90, v37, v36, s22
    v_perm_b32 v91, v39, v38, s22
    v_perm_b32 v92, v41, v40, s22
    v_perm_b32 v93, v43, v42, s22
    v_perm_b32 v94, v45, v44, s22
    v_perm_b32 v95, v47, v46, s22
    ds_write_b128 v15, v[80:83] offset:20480
    ds_write_b128 v15, v[84:87] offset:21504
    ds_write_b128 v15, v[88:91] offset:22528
    ds_write_b128 v15, v[92:95] offset:23552
    s_nop 1
    s_waitcnt vmcnt(16)
    v_perm_b32 v80, v49, v48, s21
    v_perm_b32 v81, v51, v50, s21
    v_perm_b32 v82, v53, v52, s21
    v_perm_b32 v83, v55, v54, s21
    v_perm_b32 v84, v57, v56, s21
    v_perm_b32 v85, v59, v58, s21
    v_perm_b32 v86, v61, v60, s21
    v_perm_b32 v87, v63, v62, s21
    v_perm_b32 v88, v49, v48, s22
    v_perm_b32 v89, v51, v50, s22
    v_perm_b32 v90, v53, v52, s22
    v_perm_b32 v91, v55, v54, s22
    v_perm_b32 v92, v57, v56, s22
    v_perm_b32 v93, v59, v58, s22
    v_perm_b32 v94, v61, v60, s22
    v_perm_b32 v95, v63, v62, s22
    ds_write_b128 v15, v[80:83] offset:24576
    ds_write_b128 v15, v[84:87] offset:25600
    ds_write_b128 v15, v[88:91] offset:26624
    ds_write_b128 v15, v[92:95] offset:27648
    s_nop 1
    s_waitcnt vmcnt(0)
    v_perm_b32 v80, v65, v64, s21
    v_perm_b32 v81, v67, v66, s21
    v_perm_b32 v82, v69, v68, s21
    v_perm_b32 v83, v71, v70, s21
    v_perm_b32 v84, v73, v72, s21
    v_perm_b32 v85, v75, v74, s21
    v_perm_b32 v86, v77, v76, s21
    v_perm_b32 v87, v79, v78, s21
    v_perm_b32 v88, v65, v64, s22
    v_perm_b32 v89, v67, v66, s22
    v_perm_b32 v90, v69, v68, s22
    v_perm_b32 v91, v71, v70, s22
    v_perm_b32 v92, v73, v72, s22
    v_perm_b32 v93, v75, v74, s22
    v_perm_b32 v94, v77, v76, s22
    v_perm_b32 v95, v79, v78, s22
    ds_write_b128 v15, v[80:83] offset:28672
    ds_write_b128 v15, v[84:87] offset:29696
    ds_write_b128 v15, v[88:91] offset:30720
    ds_write_b128 v15, v[92:95] offset:31744
    s_nop 1
    s_mov_b32 s12, s74
    s_and_b32 s13, s75, 0xffff
    s_mov_b32 s14, 0x400000
    s_mov_b32 s15, 0x20000
    v_lshlrev_b32 v122, 13, v120
    v_lshl_add_u32 v122, v121, 12, v122
    v_lshl_add_u32 v122, v2, 2, v122
    s_lshl_b32 s32, s5, 17
    s_lshl_b32 s33, s4, 8
    s_add_u32 s32, s32, s33
    v_add_u32 v122, s32, v122
    s_mov_b32 s34, 0
    buffer_load_dword v16, v122, s[12:15], s34 offen
    s_mov_b32 s34, 0x400
    buffer_load_dword v17, v122, s[12:15], s34 offen
    s_mov_b32 s34, 0x800
    buffer_load_dword v18, v122, s[12:15], s34 offen
    s_mov_b32 s34, 0xc00
    buffer_load_dword v19, v122, s[12:15], s34 offen
    s_mov_b32 s34, 0x4000
    buffer_load_dword v20, v122, s[12:15], s34 offen
    s_mov_b32 s34, 0x4400
    buffer_load_dword v21, v122, s[12:15], s34 offen
    s_mov_b32 s34, 0x4800
    buffer_load_dword v22, v122, s[12:15], s34 offen
    s_mov_b32 s34, 0x4c00
    buffer_load_dword v23, v122, s[12:15], s34 offen
    s_mov_b32 s34, 0x8000
    buffer_load_dword v24, v122, s[12:15], s34 offen
    s_mov_b32 s34, 0x8400
    buffer_load_dword v25, v122, s[12:15], s34 offen
    s_mov_b32 s34, 0x8800
    buffer_load_dword v26, v122, s[12:15], s34 offen
    s_mov_b32 s34, 0x8c00
    buffer_load_dword v27, v122, s[12:15], s34 offen
    s_mov_b32 s34, 0xc000
    buffer_load_dword v28, v122, s[12:15], s34 offen
    s_mov_b32 s34, 0xc400
    buffer_load_dword v29, v122, s[12:15], s34 offen
    s_mov_b32 s34, 0xc800
    buffer_load_dword v30, v122, s[12:15], s34 offen
    s_mov_b32 s34, 0xcc00
    buffer_load_dword v31, v122, s[12:15], s34 offen
    s_mov_b32 s34, 0x10000
    buffer_load_dword v32, v122, s[12:15], s34 offen
    s_mov_b32 s34, 0x10400
    buffer_load_dword v33, v122, s[12:15], s34 offen
    s_mov_b32 s34, 0x10800
    buffer_load_dword v34, v122, s[12:15], s34 offen
    s_mov_b32 s34, 0x10c00
    buffer_load_dword v35, v122, s[12:15], s34 offen
    s_mov_b32 s34, 0x14000
    buffer_load_dword v36, v122, s[12:15], s34 offen
    s_mov_b32 s34, 0x14400
    buffer_load_dword v37, v122, s[12:15], s34 offen
    s_mov_b32 s34, 0x14800
    buffer_load_dword v38, v122, s[12:15], s34 offen
    s_mov_b32 s34, 0x14c00
    buffer_load_dword v39, v122, s[12:15], s34 offen
    s_mov_b32 s34, 0x18000
    buffer_load_dword v40, v122, s[12:15], s34 offen
    s_mov_b32 s34, 0x18400
    buffer_load_dword v41, v122, s[12:15], s34 offen
    s_mov_b32 s34, 0x18800
    buffer_load_dword v42, v122, s[12:15], s34 offen
    s_mov_b32 s34, 0x18c00
    buffer_load_dword v43, v122, s[12:15], s34 offen
    s_mov_b32 s34, 0x1c000
    buffer_load_dword v44, v122, s[12:15], s34 offen
    s_mov_b32 s34, 0x1c400
    buffer_load_dword v45, v122, s[12:15], s34 offen
    s_mov_b32 s34, 0x1c800
    buffer_load_dword v46, v122, s[12:15], s34 offen
    s_mov_b32 s34, 0x1cc00
    buffer_load_dword v47, v122, s[12:15], s34 offen
    s_mov_b32 s34, 64
    buffer_load_dword v48, v122, s[12:15], s34 offen
    s_mov_b32 s34, 0x440
    buffer_load_dword v49, v122, s[12:15], s34 offen
    s_mov_b32 s34, 0x840
    buffer_load_dword v50, v122, s[12:15], s34 offen
    s_mov_b32 s34, 0xc40
    buffer_load_dword v51, v122, s[12:15], s34 offen
    s_mov_b32 s34, 0x4040
    buffer_load_dword v52, v122, s[12:15], s34 offen
    s_mov_b32 s34, 0x4440
    buffer_load_dword v53, v122, s[12:15], s34 offen
    s_mov_b32 s34, 0x4840
    buffer_load_dword v54, v122, s[12:15], s34 offen
    s_mov_b32 s34, 0x4c40
    buffer_load_dword v55, v122, s[12:15], s34 offen
    s_mov_b32 s34, 0x8040
    buffer_load_dword v56, v122, s[12:15], s34 offen
    s_mov_b32 s34, 0x8440
    buffer_load_dword v57, v122, s[12:15], s34 offen
    s_mov_b32 s34, 0x8840
    buffer_load_dword v58, v122, s[12:15], s34 offen
    s_mov_b32 s34, 0x8c40
    buffer_load_dword v59, v122, s[12:15], s34 offen
    s_mov_b32 s34, 0xc040
    buffer_load_dword v60, v122, s[12:15], s34 offen
    s_mov_b32 s34, 0xc440
    buffer_load_dword v61, v122, s[12:15], s34 offen
    s_mov_b32 s34, 0xc840
    buffer_load_dword v62, v122, s[12:15], s34 offen
    s_mov_b32 s34, 0xcc40
    buffer_load_dword v63, v122, s[12:15], s34 offen
    s_mov_b32 s34, 0x10040
    buffer_load_dword v64, v122, s[12:15], s34 offen
    s_mov_b32 s34, 0x10440
    buffer_load_dword v65, v122, s[12:15], s34 offen
    s_mov_b32 s34, 0x10840
    buffer_load_dword v66, v122, s[12:15], s34 offen
    s_mov_b32 s34, 0x10c40
    buffer_load_dword v67, v122, s[12:15], s34 offen
    s_mov_b32 s34, 0x14040
    buffer_load_dword v68, v122, s[12:15], s34 offen
    s_mov_b32 s34, 0x14440
    buffer_load_dword v69, v122, s[12:15], s34 offen
    s_mov_b32 s34, 0x14840
    buffer_load_dword v70, v122, s[12:15], s34 offen
    s_mov_b32 s34, 0x14c40
    buffer_load_dword v71, v122, s[12:15], s34 offen
    s_mov_b32 s34, 0x18040
    buffer_load_dword v72, v122, s[12:15], s34 offen
    s_mov_b32 s34, 0x18440
    buffer_load_dword v73, v122, s[12:15], s34 offen
    s_mov_b32 s34, 0x18840
    buffer_load_dword v74, v122, s[12:15], s34 offen
    s_mov_b32 s34, 0x18c40
    buffer_load_dword v75, v122, s[12:15], s34 offen
    s_mov_b32 s34, 0x1c040
    buffer_load_dword v76, v122, s[12:15], s34 offen
    s_mov_b32 s34, 0x1c440
    buffer_load_dword v77, v122, s[12:15], s34 offen
    s_mov_b32 s34, 0x1c840
    buffer_load_dword v78, v122, s[12:15], s34 offen
    s_mov_b32 s34, 0x1cc40
    buffer_load_dword v79, v122, s[12:15], s34 offen
    s_waitcnt vmcnt(56)
    v_perm_b32 v128, v17, v16, s21
    v_perm_b32 v129, v17, v16, s22
    v_perm_b32 v130, v19, v18, s21
    v_perm_b32 v131, v19, v18, s22
    v_perm_b32 v132, v21, v20, s21
    v_perm_b32 v133, v21, v20, s22
    v_perm_b32 v134, v23, v22, s21
    v_perm_b32 v135, v23, v22, s22
    s_mov_b32 s34, 0x80
    buffer_load_dword v16, v122, s[12:15], s34 offen
    s_mov_b32 s34, 0x480
    buffer_load_dword v17, v122, s[12:15], s34 offen
    s_mov_b32 s34, 0x880
    buffer_load_dword v18, v122, s[12:15], s34 offen
    s_mov_b32 s34, 0xc80
    buffer_load_dword v19, v122, s[12:15], s34 offen
    s_mov_b32 s34, 0x4080
    buffer_load_dword v20, v122, s[12:15], s34 offen
    s_mov_b32 s34, 0x4480
    buffer_load_dword v21, v122, s[12:15], s34 offen
    s_mov_b32 s34, 0x4880
    buffer_load_dword v22, v122, s[12:15], s34 offen
    s_mov_b32 s34, 0x4c80
    buffer_load_dword v23, v122, s[12:15], s34 offen
    s_waitcnt vmcnt(56)
    v_perm_b32 v136, v25, v24, s21
    v_perm_b32 v137, v25, v24, s22
    v_perm_b32 v138, v27, v26, s21
    v_perm_b32 v139, v27, v26, s22
    v_perm_b32 v140, v29, v28, s21
    v_perm_b32 v141, v29, v28, s22
    v_perm_b32 v142, v31, v30, s21
    v_perm_b32 v143, v31, v30, s22
    s_mov_b32 s34, 0x8080
    buffer_load_dword v24, v122, s[12:15], s34 offen
    s_mov_b32 s34, 0x8480
    buffer_load_dword v25, v122, s[12:15], s34 offen
    s_mov_b32 s34, 0x8880
    buffer_load_dword v26, v122, s[12:15], s34 offen
    s_mov_b32 s34, 0x8c80
    buffer_load_dword v27, v122, s[12:15], s34 offen
    s_mov_b32 s34, 0xc080
    buffer_load_dword v28, v122, s[12:15], s34 offen
    s_mov_b32 s34, 0xc480
    buffer_load_dword v29, v122, s[12:15], s34 offen
    s_mov_b32 s34, 0xc880
    buffer_load_dword v30, v122, s[12:15], s34 offen
    s_mov_b32 s34, 0xcc80
    buffer_load_dword v31, v122, s[12:15], s34 offen
    s_waitcnt vmcnt(56)
    v_perm_b32 v144, v33, v32, s21
    v_perm_b32 v145, v33, v32, s22
    v_perm_b32 v146, v35, v34, s21
    v_perm_b32 v147, v35, v34, s22
    v_perm_b32 v148, v37, v36, s21
    v_perm_b32 v149, v37, v36, s22
    v_perm_b32 v150, v39, v38, s21
    v_perm_b32 v151, v39, v38, s22
    s_mov_b32 s34, 0x10080
    buffer_load_dword v32, v122, s[12:15], s34 offen
    s_mov_b32 s34, 0x10480
    buffer_load_dword v33, v122, s[12:15], s34 offen
    s_mov_b32 s34, 0x10880
    buffer_load_dword v34, v122, s[12:15], s34 offen
    s_mov_b32 s34, 0x10c80
    buffer_load_dword v35, v122, s[12:15], s34 offen
    s_mov_b32 s34, 0x14080
    buffer_load_dword v36, v122, s[12:15], s34 offen
    s_mov_b32 s34, 0x14480
    buffer_load_dword v37, v122, s[12:15], s34 offen
    s_mov_b32 s34, 0x14880
    buffer_load_dword v38, v122, s[12:15], s34 offen
    s_mov_b32 s34, 0x14c80
    buffer_load_dword v39, v122, s[12:15], s34 offen
    s_waitcnt vmcnt(56)
    v_perm_b32 v152, v41, v40, s21
    v_perm_b32 v153, v41, v40, s22
    v_perm_b32 v154, v43, v42, s21
    v_perm_b32 v155, v43, v42, s22
    v_perm_b32 v156, v45, v44, s21
    v_perm_b32 v157, v45, v44, s22
    v_perm_b32 v158, v47, v46, s21
    v_perm_b32 v159, v47, v46, s22
    s_mov_b32 s34, 0x18080
    buffer_load_dword v40, v122, s[12:15], s34 offen
    s_mov_b32 s34, 0x18480
    buffer_load_dword v41, v122, s[12:15], s34 offen
    s_mov_b32 s34, 0x18880
    buffer_load_dword v42, v122, s[12:15], s34 offen
    s_mov_b32 s34, 0x18c80
    buffer_load_dword v43, v122, s[12:15], s34 offen
    s_mov_b32 s34, 0x1c080
    buffer_load_dword v44, v122, s[12:15], s34 offen
    s_mov_b32 s34, 0x1c480
    buffer_load_dword v45, v122, s[12:15], s34 offen
    s_mov_b32 s34, 0x1c880
    buffer_load_dword v46, v122, s[12:15], s34 offen
    s_mov_b32 s34, 0x1cc80
    buffer_load_dword v47, v122, s[12:15], s34 offen
    s_waitcnt vmcnt(56)
    v_perm_b32 v160, v49, v48, s21
    v_perm_b32 v161, v49, v48, s22
    v_perm_b32 v162, v51, v50, s21
    v_perm_b32 v163, v51, v50, s22
    v_perm_b32 v164, v53, v52, s21
    v_perm_b32 v165, v53, v52, s22
    v_perm_b32 v166, v55, v54, s21
    v_perm_b32 v167, v55, v54, s22
    s_mov_b32 s34, 0xc0
    buffer_load_dword v48, v122, s[12:15], s34 offen
    s_mov_b32 s34, 0x4c0
    buffer_load_dword v49, v122, s[12:15], s34 offen
    s_mov_b32 s34, 0x8c0
    buffer_load_dword v50, v122, s[12:15], s34 offen
    s_mov_b32 s34, 0xcc0
    buffer_load_dword v51, v122, s[12:15], s34 offen
    s_mov_b32 s34, 0x40c0
    buffer_load_dword v52, v122, s[12:15], s34 offen
    s_mov_b32 s34, 0x44c0
    buffer_load_dword v53, v122, s[12:15], s34 offen
    s_mov_b32 s34, 0x48c0
    buffer_load_dword v54, v122, s[12:15], s34 offen
    s_mov_b32 s34, 0x4cc0
    buffer_load_dword v55, v122, s[12:15], s34 offen
    s_waitcnt vmcnt(56)
    v_perm_b32 v168, v57, v56, s21
    v_perm_b32 v169, v57, v56, s22
    v_perm_b32 v170, v59, v58, s21
    v_perm_b32 v171, v59, v58, s22
    v_perm_b32 v172, v61, v60, s21
    v_perm_b32 v173, v61, v60, s22
    v_perm_b32 v174, v63, v62, s21
    v_perm_b32 v175, v63, v62, s22
    s_mov_b32 s34, 0x80c0
    buffer_load_dword v56, v122, s[12:15], s34 offen
    s_mov_b32 s34, 0x84c0
    buffer_load_dword v57, v122, s[12:15], s34 offen
    s_mov_b32 s34, 0x88c0
    buffer_load_dword v58, v122, s[12:15], s34 offen
    s_mov_b32 s34, 0x8cc0
    buffer_load_dword v59, v122, s[12:15], s34 offen
    s_mov_b32 s34, 0xc0c0
    buffer_load_dword v60, v122, s[12:15], s34 offen
    s_mov_b32 s34, 0xc4c0
    buffer_load_dword v61, v122, s[12:15], s34 offen
    s_mov_b32 s34, 0xc8c0
    buffer_load_dword v62, v122, s[12:15], s34 offen
    s_mov_b32 s34, 0xccc0
    buffer_load_dword v63, v122, s[12:15], s34 offen
    s_waitcnt vmcnt(56)
    v_perm_b32 v176, v65, v64, s21
    v_perm_b32 v177, v65, v64, s22
    v_perm_b32 v178, v67, v66, s21
    v_perm_b32 v179, v67, v66, s22
    v_perm_b32 v180, v69, v68, s21
    v_perm_b32 v181, v69, v68, s22
    v_perm_b32 v182, v71, v70, s21
    v_perm_b32 v183, v71, v70, s22
    s_mov_b32 s34, 0x100c0
    buffer_load_dword v64, v122, s[12:15], s34 offen
    s_mov_b32 s34, 0x104c0
    buffer_load_dword v65, v122, s[12:15], s34 offen
    s_mov_b32 s34, 0x108c0
    buffer_load_dword v66, v122, s[12:15], s34 offen
    s_mov_b32 s34, 0x10cc0
    buffer_load_dword v67, v122, s[12:15], s34 offen
    s_mov_b32 s34, 0x140c0
    buffer_load_dword v68, v122, s[12:15], s34 offen
    s_mov_b32 s34, 0x144c0
    buffer_load_dword v69, v122, s[12:15], s34 offen
    s_mov_b32 s34, 0x148c0
    buffer_load_dword v70, v122, s[12:15], s34 offen
    s_mov_b32 s34, 0x14cc0
    buffer_load_dword v71, v122, s[12:15], s34 offen
    s_waitcnt vmcnt(56)
    v_perm_b32 v184, v73, v72, s21
    v_perm_b32 v185, v73, v72, s22
    v_perm_b32 v186, v75, v74, s21
    v_perm_b32 v187, v75, v74, s22
    v_perm_b32 v188, v77, v76, s21
    v_perm_b32 v189, v77, v76, s22
    v_perm_b32 v190, v79, v78, s21
    v_perm_b32 v191, v79, v78, s22
    s_mov_b32 s34, 0x180c0
    buffer_load_dword v72, v122, s[12:15], s34 offen
    s_mov_b32 s34, 0x184c0
    buffer_load_dword v73, v122, s[12:15], s34 offen
    s_mov_b32 s34, 0x188c0
    buffer_load_dword v74, v122, s[12:15], s34 offen
    s_mov_b32 s34, 0x18cc0
    buffer_load_dword v75, v122, s[12:15], s34 offen
    s_mov_b32 s34, 0x1c0c0
    buffer_load_dword v76, v122, s[12:15], s34 offen
    s_mov_b32 s34, 0x1c4c0
    buffer_load_dword v77, v122, s[12:15], s34 offen
    s_mov_b32 s34, 0x1c8c0
    buffer_load_dword v78, v122, s[12:15], s34 offen
    s_mov_b32 s34, 0x1ccc0
    buffer_load_dword v79, v122, s[12:15], s34 offen
    s_waitcnt vmcnt(56)
    v_perm_b32 v192, v17, v16, s21
    v_perm_b32 v193, v17, v16, s22
    v_perm_b32 v194, v19, v18, s21
    v_perm_b32 v195, v19, v18, s22
    v_perm_b32 v196, v21, v20, s21
    v_perm_b32 v197, v21, v20, s22
    v_perm_b32 v198, v23, v22, s21
    v_perm_b32 v199, v23, v22, s22
    s_waitcnt vmcnt(48)
    v_perm_b32 v200, v25, v24, s21
    v_perm_b32 v201, v25, v24, s22
    v_perm_b32 v202, v27, v26, s21
    v_perm_b32 v203, v27, v26, s22
    v_perm_b32 v204, v29, v28, s21
    v_perm_b32 v205, v29, v28, s22
    v_perm_b32 v206, v31, v30, s21
    v_perm_b32 v207, v31, v30, s22
    s_waitcnt vmcnt(40)
    v_perm_b32 v208, v33, v32, s21
    v_perm_b32 v209, v33, v32, s22
    v_perm_b32 v210, v35, v34, s21
    v_perm_b32 v211, v35, v34, s22
    v_perm_b32 v212, v37, v36, s21
    v_perm_b32 v213, v37, v36, s22
    v_perm_b32 v214, v39, v38, s21
    v_perm_b32 v215, v39, v38, s22
    s_waitcnt vmcnt(32)
    v_perm_b32 v216, v41, v40, s21
    v_perm_b32 v217, v41, v40, s22
    v_perm_b32 v218, v43, v42, s21
    v_perm_b32 v219, v43, v42, s22
    v_perm_b32 v220, v45, v44, s21
    v_perm_b32 v221, v45, v44, s22
    v_perm_b32 v222, v47, v46, s21
    v_perm_b32 v223, v47, v46, s22
    s_waitcnt vmcnt(24)
    v_perm_b32 v224, v49, v48, s21
    v_perm_b32 v225, v49, v48, s22
    v_perm_b32 v226, v51, v50, s21
    v_perm_b32 v227, v51, v50, s22
    v_perm_b32 v228, v53, v52, s21
    v_perm_b32 v229, v53, v52, s22
    v_perm_b32 v230, v55, v54, s21
    v_perm_b32 v231, v55, v54, s22
    s_waitcnt vmcnt(16)
    v_perm_b32 v232, v57, v56, s21
    v_perm_b32 v233, v57, v56, s22
    v_perm_b32 v234, v59, v58, s21
    v_perm_b32 v235, v59, v58, s22
    v_perm_b32 v236, v61, v60, s21
    v_perm_b32 v237, v61, v60, s22
    v_perm_b32 v238, v63, v62, s21
    v_perm_b32 v239, v63, v62, s22
    s_waitcnt vmcnt(8)
    v_perm_b32 v240, v65, v64, s21
    v_perm_b32 v241, v65, v64, s22
    v_perm_b32 v242, v67, v66, s21
    v_perm_b32 v243, v67, v66, s22
    v_perm_b32 v244, v69, v68, s21
    v_perm_b32 v245, v69, v68, s22
    v_perm_b32 v246, v71, v70, s21
    v_perm_b32 v247, v71, v70, s22
    s_waitcnt vmcnt(0)
    v_perm_b32 v248, v73, v72, s21
    v_perm_b32 v249, v73, v72, s22
    v_perm_b32 v250, v75, v74, s21
    v_perm_b32 v251, v75, v74, s22
    v_perm_b32 v252, v77, v76, s21
    v_perm_b32 v253, v77, v76, s22
    v_perm_b32 v254, v79, v78, s21
    v_perm_b32 v255, v79, v78, s22
    s_lshl_b32 s33, s4, 7
    v_add_u32 v120, s33, v1
    v_lshrrev_b32 v121, 2, v120
    v_and_b32 v122, 3, v120
    v_lshlrev_b32 v122, 5, v122
    v_lshrrev_b32 v123, 4, v121
    v_lshl_add_u32 v122, v123, 10, v122
    v_bfe_u32 v123, v121, 2, 2
    v_lshl_add_u32 v122, v123, 8, v122
    v_bfe_u32 v123, v121, 1, 1
    v_lshl_add_u32 v122, v123, 7, v122
    v_and_b32 v123, 1, v121
    v_lshl_add_u32 v122, v123, 3, v122
    v_add_u32 v5, 139264, v122
    s_lshl_b32 s33, s4, 11
    v_lshlrev_b32 v6, 4, v1
    v_add_u32 v6, s33, v6
    v_lshlrev_b32 v7, 4, v1
    v_add_u32 v0, 131072, v7
    v_and_b32 v120, 1, v3
    v_mul_u32_u24 v120, 1088, v120
    v_lshl_add_u32 v120, v2, 2, v120
    v_lshrrev_b32 v121, 1, v3
    v_lshl_add_u32 v120, v121, 1, v120
    s_lshl_b32 s33, s4, 6
    s_add_u32 s33, s33, 147456
    v_add_u32 v8, s33, v120
    v_and_b32 v120, 7, v2
    v_mul_u32_u24 v120, 272, v120
    v_lshl_add_u32 v120, v3, 4, v120
    v_add_u32 v9, 147456, v120
    s_lshl_b32 s33, s4, 6
    s_add_u32 s33, s33, 152064
    v_add_u32 v13, s33, v120
    v_lshrrev_b32 v120, 1, v2
    v_lshlrev_b32 v120, 12, v120
    v_and_b32 v121, 1, v2
    v_lshl_add_u32 v120, v121, 6, v120
    v_lshrrev_b32 v121, 1, v3
    v_lshl_add_u32 v120, v121, 5, v120
    v_and_b32 v121, 1, v3
    v_lshl_add_u32 v120, v121, 4, v120
    s_lshl_b32 s33, s4, 17
    s_lshl_b32 s34, s5, 7
    s_add_u32 s33, s33, s34
    v_add_u32 v10, s33, v120
    s_lshl_b32 s33, s5, 2
    s_add_u32 s33, s33, s4
    s_lshl_b32 s34, s33, 12
    v_add_u32 v11, s34, v7
    v_and_b32 v120, 1, v1
    v_lshlrev_b32 v120, 5, v120
    v_bfe_u32 v121, v1, 4, 1
    v_lshl_add_u32 v120, v121, 4, v120
    v_bfe_u32 v121, v1, 5, 1
    v_lshl_add_u32 v120, v121, 3, v120
    v_bfe_u32 v121, v1, 2, 1
    v_lshl_add_u32 v120, v121, 2, v120
    s_lshl_b32 s34, s33, 6
    v_add_u32 v12, s34, v120
    s_mov_b32 s44, 0x00330033
    s_mov_b32 s45, 0x00330033
    v_mov_b32 v14, v6
    s_mov_b32 s46, 0x3e0293ee
    s_cmp_eq_u32 s59, 0
    s_cbranch_scc1 Lslow_3
Lfast_2:
    s_mov_b32 s50, 0
    s_mov_b32 s35, 2048
Lw_24:
    buffer_load_dword v121, off, s[8:11], s35 sc1
    s_add_u32 s61, s61, 1
    s_cmp_gt_u32 s61, 0x40000
    s_cbranch_scc1 Lwd_25
    s_waitcnt vmcnt(0)
    v_readfirstlane_b32 s60, v121
    s_nop 3
    s_cmp_ge_u32 s60, 16
    s_cbranch_scc1 Lwd_25
    s_sleep 2
    s_branch Lw_24
Lwd_25:
    s_lshl_b32 s34, s50, 5
    s_add_u32 s34, s34, s5
    s_lshl_b32 s34, s34, 13
    s_add_u32 s35, s34, 0x3000000
    s_add_u32 s57, s34, 0x4000000
    s_lshl_b32 s37, s4, 11
    s_add_u32 s37, s37, 131072
    s_mov_b32 m0, s37
    s_nop 0
    buffer_load_dwordx4 v6, s[8:11], s35 offen sc1 lds
    buffer_load_dwordx4 v6, s[8:11], s35 offen offset:1024 sc1 lds
    buffer_load_dwordx4 v[72:75], v14, s[8:11], s57 offen sc1
    buffer_load_dwordx4 v[76:79], v14, s[8:11], s57 offen offset:1024 sc1
Lctop_21:
    s_add_u32 s54, s50, 1
    s_lshr_b32 s58, s54, 2
    s_add_u32 s58, s58, 32
    s_lshl_b32 s58, s58, 6
    buffer_load_dword v123, off, s[8:11], s58 sc1
    ds_read_b128 v[80:83], v15 offset:0
    ds_read_b128 v[84:87], v15 offset:1024
    ds_read_b128 v[88:91], v15 offset:2048
    ds_read_b128 v[92:95], v15 offset:3072
    ds_read_b128 v[96:99], v15 offset:4096
    ds_read_b128 v[100:103], v15 offset:5120
    ds_read_b128 v[104:107], v15 offset:6144
    ds_read_b128 v[108:111], v15 offset:7168
    ds_read_b128 v[112:115], v15 offset:8192
    ds_read_b128 v[116:119], v15 offset:9216
    v_mov_b32 v48, 0
    v_mov_b32 v49, 0
    v_mov_b32 v50, 0
    v_mov_b32 v51, 0
    v_mov_b32 v52, 0
    v_mov_b32 v53, 0
    v_mov_b32 v54, 0
    v_mov_b32 v55, 0
    v_mov_b32 v56, 0
    v_mov_b32 v57, 0
    v_mov_b32 v58, 0
    v_mov_b32 v59, 0
    v_mov_b32 v60, 0
    v_mov_b32 v61, 0
    v_mov_b32 v62, 0
    v_mov_b32 v63, 0
    v_mov_b32 v64, 0
    v_mov_b32 v65, 0
    v_mov_b32 v66, 0
    v_mov_b32 v67, 0
    v_mov_b32 v68, 0
    v_mov_b32 v69, 0
    v_mov_b32 v70, 0
    v_mov_b32 v71, 0
    s_lshl_b32 s51, s50, 13
    s_add_u32 s51, s51, 0x10000
Lpm_26:
    buffer_load_dwordx4 v[16:19], v6, s[8:11], s51 offen sc1
    buffer_load_dwordx4 v[20:23], v6, s[8:11], s51 offen offset:1024 sc1
    s_add_u32 s61, s61, 1
    s_cmp_gt_u32 s61, 0x40000
    s_cbranch_scc1 Lpmd_27
    s_waitcnt vmcnt(0)
    v_max3_u32 v24, v16, v17, v18
    v_max3_u32 v25, v19, v20, v21
    v_max3_u32 v24, v22, v23, v24
    v_max_u32 v24, v24, v25
    v_cmp_eq_u32 vcc, -1, v24
    s_cbranch_vccnz Lpm_26
Lpmd_27:
    ds_write_b64 v5, v[16:17]
    ds_write_b64 v5, v[18:19] offset:16
    ds_write_b64 v5, v[20:21] offset:1024
    ds_write_b64 v5, v[22:23] offset:1040
    s_waitcnt lgkmcnt(0)
    s_barrier
    ds_read_b128 v[16:19], v0 offset:8192
    ds_read_b128 v[20:23], v0 offset:9216
    ds_read_b128 v[24:27], v0 offset:10240
    ds_read_b128 v[28:31], v0 offset:11264
    ds_read_b128 v[32:35], v0 offset:12288
    ds_read_b128 v[36:39], v0 offset:13312
    ds_read_b128 v[40:43], v0 offset:14336
    ds_read_b128 v[44:47], v0 offset:15360
    s_cmp_eq_u32 s50, 0
    s_cbranch_scc1 Lsk_28
    s_cmp_lg_u32 s4, 0
    s_cbranch_scc1 Lsk_28
    s_add_u32 s34, s50, 63
    s_lshl_b32 s34, s34, 6
    v_mov_b32 v120, 0
    v_mov_b32 v121, 1
    s_mov_b64 exec, 1
    buffer_atomic_add v121, v120, s[8:11], s34 offen sc1
    s_mov_b64 exec, -1
Lsk_28:
    s_waitcnt lgkmcnt(7)
    v_smfmac_f32_16x16x64_bf16 v[48:51], v[16:19], a[0:7], v4
    v_smfmac_f32_16x16x64_bf16 v[52:55], v[16:19], a[8:15], v4
    v_smfmac_f32_16x16x64_bf16 v[56:59], v[16:19], a[128:135], v4
    v_smfmac_f32_16x16x64_bf16 v[60:63], v[16:19], a[136:143], v4
    v_smfmac_f32_16x16x64_bf16 v[64:67], v[16:19], v[80:87], v4
    ds_read_b128 v[80:83], v15 offset:10240
    ds_read_b128 v[84:87], v15 offset:11264
    v_smfmac_f32_16x16x64_bf16 v[68:71], v[16:19], v[88:95], v4
    ds_read_b128 v[88:91], v15 offset:12288
    ds_read_b128 v[92:95], v15 offset:13312
    s_waitcnt lgkmcnt(10)
    v_smfmac_f32_16x16x64_bf16 v[48:51], v[20:23], a[16:23], v4
    v_smfmac_f32_16x16x64_bf16 v[52:55], v[20:23], a[24:31], v4
    v_smfmac_f32_16x16x64_bf16 v[56:59], v[20:23], a[144:151], v4
    v_smfmac_f32_16x16x64_bf16 v[60:63], v[20:23], a[152:159], v4
    v_smfmac_f32_16x16x64_bf16 v[64:67], v[20:23], v[96:103], v4
    ds_read_b128 v[96:99], v15 offset:14336
    ds_read_b128 v[100:103], v15 offset:15360
    v_smfmac_f32_16x16x64_bf16 v[68:71], v[20:23], v[104:111], v4
    ds_read_b128 v[104:107], v15 offset:16384
    ds_read_b128 v[108:111], v15 offset:17408
    s_waitcnt lgkmcnt(13)
    v_smfmac_f32_16x16x64_bf16 v[48:51], v[24:27], a[32:39], v4
    v_smfmac_f32_16x16x64_bf16 v[52:55], v[24:27], a[40:47], v4
    v_smfmac_f32_16x16x64_bf16 v[56:59], v[24:27], a[160:167], v4
    v_smfmac_f32_16x16x64_bf16 v[60:63], v[24:27], a[168:175], v4
    v_smfmac_f32_16x16x64_bf16 v[64:67], v[24:27], v[112:119], v4
    ds_read_b128 v[112:115], v15 offset:18432
    ds_read_b128 v[116:119], v15 offset:19456
    s_waitcnt lgkmcnt(8)
    v_smfmac_f32_16x16x64_bf16 v[68:71], v[24:27], v[80:87], v4
    ds_read_b128 v[80:83], v15 offset:20480
    ds_read_b128 v[84:87], v15 offset:21504
    v_smfmac_f32_16x16x64_bf16 v[48:51], v[28:31], a[48:55], v4
    v_smfmac_f32_16x16x64_bf16 v[52:55], v[28:31], a[56:63], v4
    v_smfmac_f32_16x16x64_bf16 v[56:59], v[28:31], a[176:183], v4
    v_smfmac_f32_16x16x64_bf16 v[60:63], v[28:31], a[184:191], v4
    s_waitcnt lgkmcnt(8)
    v_smfmac_f32_16x16x64_bf16 v[64:67], v[28:31], v[88:95], v4
    ds_read_b128 v[88:91], v15 offset:22528
    ds_read_b128 v[92:95], v15 offset:23552
    s_waitcnt lgkmcnt(8)
    v_smfmac_f32_16x16x64_bf16 v[68:71], v[28:31], v[96:103], v4
    ds_read_b128 v[96:99], v15 offset:24576
    ds_read_b128 v[100:103], v15 offset:25600
    v_smfmac_f32_16x16x64_bf16 v[48:51], v[32:35], a[64:71], v4
    v_smfmac_f32_16x16x64_bf16 v[52:55], v[32:35], a[72:79], v4
    v_smfmac_f32_16x16x64_bf16 v[56:59], v[32:35], a[192:199], v4
    v_smfmac_f32_16x16x64_bf16 v[60:63], v[32:35], a[200:207], v4
    s_waitcnt lgkmcnt(8)
    v_smfmac_f32_16x16x64_bf16 v[64:67], v[32:35], v[104:111], v4
    ds_read_b128 v[104:107], v15 offset:26624
    ds_read_b128 v[108:111], v15 offset:27648
    s_waitcnt lgkmcnt(8)
    v_smfmac_f32_16x16x64_bf16 v[68:71], v[32:35], v[112:119], v4
    ds_read_b128 v[112:115], v15 offset:28672
    ds_read_b128 v[116:119], v15 offset:29696
    v_smfmac_f32_16x16x64_bf16 v[48:51], v[36:39], a[80:87], v4
    v_smfmac_f32_16x16x64_bf16 v[52:55], v[36:39], a[88:95], v4
    v_smfmac_f32_16x16x64_bf16 v[56:59], v[36:39], a[208:215], v4
    v_smfmac_f32_16x16x64_bf16 v[60:63], v[36:39], a[216:223], v4
    s_waitcnt lgkmcnt(8)
    v_smfmac_f32_16x16x64_bf16 v[64:67], v[36:39], v[80:87], v4
    ds_read_b128 v[80:83], v15 offset:30720
    ds_read_b128 v[84:87], v15 offset:31744
    s_waitcnt lgkmcnt(8)
    v_smfmac_f32_16x16x64_bf16 v[68:71], v[36:39], v[88:95], v4
    v_smfmac_f32_16x16x64_bf16 v[48:51], v[40:43], a[96:103], v4
    v_smfmac_f32_16x16x64_bf16 v[52:55], v[40:43], a[104:111], v4
    v_smfmac_f32_16x16x64_bf16 v[56:59], v[40:43], a[224:231], v4
    v_smfmac_f32_16x16x64_bf16 v[60:63], v[40:43], a[232:239], v4
    s_waitcnt lgkmcnt(6)
    v_smfmac_f32_16x16x64_bf16 v[64:67], v[40:43], v[96:103], v4
    s_waitcnt lgkmcnt(4)
    v_smfmac_f32_16x16x64_bf16 v[68:71], v[40:43], v[104:111], v4
    v_smfmac_f32_16x16x64_bf16 v[48:51], v[44:47], a[112:119], v4
    v_smfmac_f32_16x16x64_bf16 v[52:55], v[44:47], a[120:127], v4
    v_smfmac_f32_16x16x64_bf16 v[56:59], v[44:47], a[240:247], v4
    v_smfmac_f32_16x16x64_bf16 v[60:63], v[44:47], a[248:255], v4
    s_waitcnt lgkmcnt(2)
    v_smfmac_f32_16x16x64_bf16 v[64:67], v[44:47], v[112:119], v4
    s_waitcnt lgkmcnt(0)
    v_smfmac_f32_16x16x64_bf16 v[68:71], v[44:47], v[80:87], v4
    ds_read_b128 v[16:19], v0 offset:0
    ds_read_b128 v[20:23], v0 offset:1024
    ds_read_b128 v[24:27], v0 offset:2048
    ds_read_b128 v[28:31], v0 offset:3072
    ds_read_b128 v[32:35], v0 offset:4096
    ds_read_b128 v[36:39], v0 offset:5120
    ds_read_b128 v[40:43], v0 offset:6144
    ds_read_b128 v[44:47], v0 offset:7168
    s_nop 7
    v_permlane32_swap_b32 v48, v52
    v_permlane32_swap_b32 v49, v53
    v_permlane32_swap_b32 v50, v54
    v_permlane32_swap_b32 v51, v55
    s_nop 0
    v_add_f32 v48, v48, v52
    v_add_f32 v49, v49, v53
    v_add_f32 v50, v50, v54
    v_add_f32 v51, v51, v55
    v_cvt_pk_bf16_f32 v52, v48, v49
    v_cvt_pk_bf16_f32 v53, v50, v51
    ds_write_b16 v8, v52 offset:0
    ds_write_b16_d16_hi v8, v52 offset:272
    ds_write_b16 v8, v53 offset:544
    ds_write_b16_d16_hi v8, v53 offset:816
    v_permlane32_swap_b32 v56, v60
    v_permlane32_swap_b32 v57, v61
    v_permlane32_swap_b32 v58, v62
    v_permlane32_swap_b32 v59, v63
    s_nop 0
    v_add_f32 v56, v56, v60
    v_add_f32 v57, v57, v61
    v_add_f32 v58, v58, v62
    v_add_f32 v59, v59, v63
    v_cvt_pk_bf16_f32 v60, v56, v57
    v_cvt_pk_bf16_f32 v61, v58, v59
    ds_write_b16 v8, v60 offset:2304
    ds_write_b16_d16_hi v8, v60 offset:2576
    ds_write_b16 v8, v61 offset:2848
    ds_write_b16_d16_hi v8, v61 offset:3120
    v_permlane32_swap_b32 v64, v68
    v_permlane32_swap_b32 v65, v69
    v_permlane32_swap_b32 v66, v70
    v_permlane32_swap_b32 v67, v71
    s_nop 0
    v_add_f32 v64, v64, v68
    v_add_f32 v65, v65, v69
    v_add_f32 v66, v66, v70
    v_add_f32 v67, v67, v71
    v_cvt_pk_bf16_f32 v68, v64, v65
    v_cvt_pk_bf16_f32 v69, v66, v67
    s_lshl_b32 s52, s50, 5
    s_add_u32 s52, s52, s5
    s_lshl_b32 s52, s52, 11
    s_lshl_b32 s53, s4, 9
    s_add_u32 s53, s53, s52
    s_add_u32 s53, s53, 0x1400000
    v_lshrrev_b32 v120, 1, v7
    buffer_store_dwordx2 v[68:69], v120, s[8:11], s53 offen sc1
    s_waitcnt lgkmcnt(0)
    s_barrier
    s_cmp_eq_u32 s50, 63
    s_cbranch_scc1 Lpk_29
    v_readfirstlane_b32 s60, v123
    s_nop 3
    s_cmp_ge_u32 s60, 16
    s_cbranch_scc1 Lpk2_30
Lw_31:
    buffer_load_dword v121, off, s[8:11], s58 sc1
    s_add_u32 s61, s61, 1
    s_cmp_gt_u32 s61, 0x40000
    s_cbranch_scc1 Lwd_32
    s_waitcnt vmcnt(0)
    v_readfirstlane_b32 s60, v121
    s_nop 3
    s_cmp_ge_u32 s60, 16
    s_cbranch_scc1 Lwd_32
    s_sleep 2
    s_branch Lw_31
Lwd_32:
Lpk2_30:
    s_lshl_b32 s34, s54, 5
    s_add_u32 s34, s34, s5
    s_lshl_b32 s34, s34, 13
    s_add_u32 s35, s34, 0x3000000
    s_add_u32 s57, s34, 0x4000000
    s_lshl_b32 s37, s4, 11
    s_add_u32 s37, s37, 131072
    s_mov_b32 m0, s37
    s_nop 0
    buffer_load_dwordx4 v6, s[8:11], s35 offen sc1 lds
    buffer_load_dwordx4 v6, s[8:11], s35 offen offset:1024 sc1 lds
Lpk_29:
    ds_read_b128 v[48:51], v9 offset:0
    ds_read_b128 v[52:55], v9 offset:64
    ds_read_b128 v[56:59], v9 offset:128
    ds_read_b128 v[60:63], v9 offset:192
    ds_read_b128 v[80:83], v9 offset:2304
    ds_read_b128 v[84:87], v9 offset:2368
    ds_read_b128 v[88:91], v9 offset:2432
    ds_read_b128 v[92:95], v9 offset:2496
    v_and_b32 v120, 7, v2
    v_lshlrev_b32 v120, 8, v120
    v_lshl_add_u32 v120, v3, 4, v120
    s_lshl_b32 s34, s4, 6
    v_add_u32 v120, s34, v120
    s_add_u32 s53, s52, 0x1000000
    v_add_u32 v121, -2304, v13
    ds_read_b128 v[112:115], v121
    s_waitcnt lgkmcnt(8)
    v_mfma_f32_16x16x32_bf16 v[100:103], v[16:19], v[48:51], 0
    v_mfma_f32_16x16x32_bf16 v[104:107], v[32:35], v[48:51], 0
    s_waitcnt lgkmcnt(7)
    v_mfma_f32_16x16x32_bf16 v[100:103], v[20:23], v[52:55], v[100:103]
    v_mfma_f32_16x16x32_bf16 v[104:107], v[36:39], v[52:55], v[104:107]
    s_waitcnt lgkmcnt(6)
    v_mfma_f32_16x16x32_bf16 v[100:103], v[24:27], v[56:59], v[100:103]
    v_mfma_f32_16x16x32_bf16 v[104:107], v[40:43], v[56:59], v[104:107]
    s_waitcnt lgkmcnt(5)
    v_mfma_f32_16x16x32_bf16 v[100:103], v[28:31], v[60:63], v[100:103]
    v_mfma_f32_16x16x32_bf16 v[104:107], v[44:47], v[60:63], v[104:107]
    s_waitcnt lgkmcnt(0)
    buffer_store_dwordx4 v[112:115], v120, s[8:11], s53 offen sc1
    s_cmp_eq_u32 s50, 63
    s_cbranch_scc1 Lcfin_22
    v_mfma_f32_16x16x32_bf16 v[96:99], v[80:83], v[48:51], 0
    v_mfma_f32_16x16x32_bf16 v[96:99], v[84:87], v[52:55], v[96:99]
    v_mfma_f32_16x16x32_bf16 v[96:99], v[88:91], v[56:59], v[96:99]
    v_mfma_f32_16x16x32_bf16 v[96:99], v[92:95], v[60:63], v[96:99]
    s_nop 7
    v_max3_f32 v116, v100, v101, v102
    v_max3_f32 v117, v103, v104, v105
    v_max3_f32 v116, v106, v107, v116
    v_max3_f32 v117, v96, v97, v117
    v_max3_f32 v116, v98, v99, v116
    v_max_f32 v116, v116, v117
    v_mov_b32 v117, v116
    s_nop 1
    v_permlane16_swap_b32 v116, v117
    s_nop 1
    v_max_f32 v116, v116, v117
    v_mov_b32 v117, v116
    s_nop 1
    v_permlane32_swap_b32 v116, v117
    s_nop 1
    v_max_f32 v116, v116, v117
    v_mul_f32 v116, s46, v116
    v_fma_f32 v100, v100, s46, -v116
    v_fma_f32 v101, v101, s46, -v116
    v_fma_f32 v102, v102, s46, -v116
    v_fma_f32 v103, v103, s46, -v116
    v_fma_f32 v104, v104, s46, -v116
    v_fma_f32 v105, v105, s46, -v116
    v_fma_f32 v106, v106, s46, -v116
    v_fma_f32 v107, v107, s46, -v116
    v_fma_f32 v96, v96, s46, -v116
    v_fma_f32 v97, v97, s46, -v116
    v_fma_f32 v98, v98, s46, -v116
    v_fma_f32 v99, v99, s46, -v116
    v_exp_f32 v100, v100
    v_exp_f32 v101, v101
    v_exp_f32 v102, v102
    v_exp_f32 v103, v103
    v_exp_f32 v104, v104
    v_exp_f32 v105, v105
    v_exp_f32 v106, v106
    v_exp_f32 v107, v107
    v_exp_f32 v96, v96
    v_exp_f32 v97, v97
    v_exp_f32 v98, v98
    v_exp_f32 v99, v99
    s_nop 0
    v_cvt_pk_bf16_f32 v48, v100, v101
    v_cvt_pk_bf16_f32 v49, v102, v103
    v_cvt_pk_bf16_f32 v50, v104, v105
    v_cvt_pk_bf16_f32 v51, v106, v107
    v_cvt_pk_bf16_f32 v52, v96, v97
    v_cvt_pk_bf16_f32 v53, v98, v99
    v_mfma_f32_16x16x32_bf16 v[60:63], v[72:75], v[48:51], 0
    v_mfma_f32_16x16x32_bf16 v[112:115], v[76:79], v[48:51], 0
    v_cndmask_b32 v54, 0, v52, s[40:41]
    v_cndmask_b32 v56, 0, v52, s[42:43]
    v_cndmask_b32 v55, 0, v53, s[40:41]
    v_cndmask_b32 v57, 0, v53, s[42:43]
    s_nop 1
    v_mfma_f32_16x16x16_bf16 v[60:63], v[68:69], v[54:55], v[60:63]
    v_mfma_f32_16x16x16_bf16 v[112:115], v[68:69], v[56:57], v[112:115]
    v_add_f32 v116, v96, v97
    v_add_f32 v117, v98, v99
    v_add_f32 v116, v116, v117
    v_cndmask_b32 v116, 0, v116, s[40:41]
    v_add_f32 v117, v100, v101
    v_add_f32 v118, v102, v103
    v_add_f32 v119, v104, v105
    v_add_f32 v116, v116, v106
    v_add_f32 v117, v117, v107
    v_add_f32 v118, v118, v119
    v_add_f32 v116, v116, v117
    v_add_f32 v116, v116, v118
    v_mov_b32 v117, v116
    s_nop 1
    v_permlane16_swap_b32 v116, v117
    s_nop 1
    v_add_f32 v116, v116, v117
    v_mov_b32 v117, v116
    s_nop 1
    v_permlane32_swap_b32 v116, v117
    s_nop 1
    v_add_f32 v116, v116, v117
    v_rcp_f32 v116, v116
    s_nop 4
    v_mul_f32 v60, v60, v116
    v_mul_f32 v112, v112, v116
    v_mul_f32 v61, v61, v116
    v_mul_f32 v113, v113, v116
    v_mul_f32 v62, v62, v116
    v_mul_f32 v114, v114, v116
    v_mul_f32 v63, v63, v116
    v_mul_f32 v115, v115, v116
    v_cvt_pk_bf16_f32 v96, v60, v112
    v_cvt_pk_bf16_f32 v97, v61, v113
    v_cvt_pk_bf16_f32 v98, v62, v114
    v_cvt_pk_bf16_f32 v99, v63, v115
    ds_write_b128 v13, v[96:99]
    buffer_load_dwordx4 v[72:75], v14, s[8:11], s57 offen sc1
    buffer_load_dwordx4 v[76:79], v14, s[8:11], s57 offen offset:1024 sc1
    v_mov_b32 v16, 0
    v_mov_b32 v17, 0
    v_mov_b32 v18, 0
    v_mov_b32 v19, 0
    v_mov_b32 v20, 0
    v_mov_b32 v21, 0
    v_mov_b32 v22, 0
    v_mov_b32 v23, 0
    v_mov_b32 v24, 0
    v_mov_b32 v25, 0
    v_mov_b32 v26, 0
    v_mov_b32 v27, 0
    v_mov_b32 v28, 0
    v_mov_b32 v29, 0
    v_mov_b32 v30, 0
    v_mov_b32 v31, 0
    s_waitcnt lgkmcnt(0)
    s_barrier
    v_add_u32 v120, 4608, v9
    ds_read_b128 v[48:51], v120 offset:0
    ds_read_b128 v[52:55], v120 offset:64
    ds_read_b128 v[56:59], v120 offset:128
    ds_read_b128 v[60:63], v120 offset:192
    s_waitcnt lgkmcnt(3)
    v_smfmac_f32_16x16x64_bf16 v[16:19], v[48:51], v[128:135], v4
    v_smfmac_f32_16x16x64_bf16 v[20:23], v[48:51], v[160:167], v4
    v_smfmac_f32_16x16x64_bf16 v[24:27], v[48:51], v[192:199], v4
    v_smfmac_f32_16x16x64_bf16 v[28:31], v[48:51], v[224:231], v4
    s_waitcnt lgkmcnt(2)
    v_smfmac_f32_16x16x64_bf16 v[16:19], v[52:55], v[136:143], v4
    v_smfmac_f32_16x16x64_bf16 v[20:23], v[52:55], v[168:175], v4
    v_smfmac_f32_16x16x64_bf16 v[24:27], v[52:55], v[200:207], v4
    v_smfmac_f32_16x16x64_bf16 v[28:31], v[52:55], v[232:239], v4
    s_waitcnt lgkmcnt(1)
    v_smfmac_f32_16x16x64_bf16 v[16:19], v[56:59], v[144:151], v4
    v_smfmac_f32_16x16x64_bf16 v[20:23], v[56:59], v[176:183], v4
    v_smfmac_f32_16x16x64_bf16 v[24:27], v[56:59], v[208:215], v4
    v_smfmac_f32_16x16x64_bf16 v[28:31], v[56:59], v[240:247], v4
    s_waitcnt lgkmcnt(0)
    v_smfmac_f32_16x16x64_bf16 v[16:19], v[60:63], v[152:159], v4
    v_smfmac_f32_16x16x64_bf16 v[20:23], v[60:63], v[184:191], v4
    v_smfmac_f32_16x16x64_bf16 v[24:27], v[60:63], v[216:223], v4
    v_smfmac_f32_16x16x64_bf16 v[28:31], v[60:63], v[248:255], v4
    s_and_b32 s34, s50, 1
    s_lshl_b32 s34, s34, 19
    s_add_u32 s55, s34, 0x100000
    s_mov_b32 s56, s55
    s_nop 4
    buffer_store_dwordx4 v[16:19], v10, s[8:11], s56 offen
    s_add_u32 s56, s56, 0x8000
    buffer_store_dwordx4 v[20:23], v10, s[8:11], s56 offen
    s_add_u32 s56, s56, 0x8000
    buffer_store_dwordx4 v[24:27], v10, s[8:11], s56 offen
    s_add_u32 s56, s56, 0x8000
    buffer_store_dwordx4 v[28:31], v10, s[8:11], s56 offen
    s_add_u32 s56, s56, 0x8000
Lpr_33:
    buffer_load_dwordx4 v[96:99], v11, s[8:11], s55 offen offset:0 sc1
    buffer_load_dwordx4 v[100:103], v11, s[8:11], s55 offen offset:1024 sc1
    buffer_load_dwordx4 v[104:107], v11, s[8:11], s55 offen offset:2048 sc1
    buffer_load_dwordx4 v[108:111], v11, s[8:11], s55 offen offset:3072 sc1
    s_add_u32 s61, s61, 1
    s_cmp_gt_u32 s61, 0x40000
    s_cbranch_scc1 Lprd_34
    s_waitcnt vmcnt(0)
    v_max3_u32 v112, v96, v100, v104
    v_max_u32 v112, v112, v108
    v_cmp_eq_u32 vcc, -1, v112
    s_cbranch_vccnz Lpr_33
Lprd_34:
    v_add_f32 v96, v96, v100
    v_add_f32 v104, v104, v108
    v_add_f32 v97, v97, v101
    v_add_f32 v105, v105, v109
    v_add_f32 v98, v98, v102
    v_add_f32 v106, v106, v110
    v_add_f32 v99, v99, v103
    v_add_f32 v107, v107, v111
    v_add_f32 v96, v96, v104
    v_add_f32 v97, v97, v105
    v_add_f32 v98, v98, v106
    v_add_f32 v99, v99, v107
    s_nop 1
    v_add_f32_dpp v96, v96, v96 row_ror:8 row_mask:0xf bank_mask:0xf
    v_add_f32_dpp v97, v97, v97 row_ror:8 row_mask:0xf bank_mask:0xf
    v_add_f32_dpp v98, v98, v98 row_ror:8 row_mask:0xf bank_mask:0xf
    v_add_f32_dpp v99, v99, v99 row_ror:8 row_mask:0xf bank_mask:0xf
    s_nop 1
    v_permlane32_swap_b32 v96, v97
    v_permlane32_swap_b32 v98, v99
    s_nop 1
    v_add_f32 v96, v96, v97
    v_add_f32 v98, v98, v99
    s_nop 1
    v_permlane16_swap_b32 v96, v98
    s_nop 1
    v_add_f32 v96, v96, v98
    s_nop 1
    v_mov_b32_dpp v97, v96 quad_perm:[2,3,0,1] row_mask:0xf bank_mask:0xf
    s_nop 0
    v_cvt_pk_bf16_f32 v96, v96, v97
    s_add_u32 s34, s51, 0x2000
    s_mov_b64 exec, s[44:45]
    buffer_store_dword v96, v12, s[8:11], s34 offen
    s_mov_b64 exec, -1
    v_mov_b32 v100, -1
    v_mov_b32 v101, -1
    v_mov_b32 v102, -1
    v_mov_b32 v103, -1
    buffer_store_dwordx4 v[100:103], v11, s[8:11], s55 offen offset:0
    buffer_store_dwordx4 v[100:103], v11, s[8:11], s55 offen offset:1024
    buffer_store_dwordx4 v[100:103], v11, s[8:11], s55 offen offset:2048
    buffer_store_dwordx4 v[100:103], v11, s[8:11], s55 offen offset:3072
    s_add_u32 s50, s50, 1
    s_branch Lctop_21
Lcfin_22:
    s_mov_b32 s34, 8128
    s_waitcnt vmcnt(0) lgkmcnt(0)
    s_barrier
    s_cmp_lg_u32 s4, 0
    s_cbranch_scc1 Lsg_35
    v_mov_b32 v121, 1
    s_mov_b64 exec, 1
    buffer_atomic_add v121, off, s[8:11], s34 sc1
    s_mov_b64 exec, -1
Lsg_35:
    s_endpgm
Lslow_3:
    s_mov_b32 s50, 0
    s_mov_b32 s35, 2048
Lw_39:
    buffer_load_dword v121, off, s[8:11], s35 sc1
    s_add_u32 s61, s61, 1
    s_cmp_gt_u32 s61, 0x40000
    s_cbranch_scc1 Lwd_40
    s_waitcnt vmcnt(0)
    v_readfirstlane_b32 s60, v121
    s_nop 3
    s_cmp_ge_u32 s60, 16
    s_cbranch_scc1 Lwd_40
    s_sleep 2
    s_branch Lw_39
Lwd_40:
    s_lshl_b32 s34, s50, 5
    s_add_u32 s34, s34, s5
    s_lshl_b32 s34, s34, 13
    s_add_u32 s35, s34, 0x3000000
    s_add_u32 s57, s34, 0x4000000
    s_lshl_b32 s37, s4, 11
    s_add_u32 s37, s37, 131072
    s_mov_b32 m0, s37
    s_nop 0
    buffer_load_dwordx4 v6, s[8:11], s35 offen sc1 lds
    buffer_load_dwordx4 v6, s[8:11], s35 offen offset:1024 sc1 lds
    buffer_load_dwordx4 v[72:75], v14, s[8:11], s57 offen sc1
    buffer_load_dwordx4 v[76:79], v14, s[8:11], s57 offen offset:1024 sc1
Lctop_36:
    s_add_u32 s54, s50, 1
    s_lshr_b32 s58, s54, 2
    s_add_u32 s58, s58, 32
    s_lshl_b32 s58, s58, 6
    buffer_load_dword v123, off, s[8:11], s58 sc1
    ds_read_b128 v[80:83], v15 offset:0
    ds_read_b128 v[84:87], v15 offset:1024
    ds_read_b128 v[88:91], v15 offset:2048
    ds_read_b128 v[92:95], v15 offset:3072
    ds_read_b128 v[96:99], v15 offset:4096
    ds_read_b128 v[100:103], v15 offset:5120
    ds_read_b128 v[104:107], v15 offset:6144
    ds_read_b128 v[108:111], v15 offset:7168
    ds_read_b128 v[112:115], v15 offset:8192
    ds_read_b128 v[116:119], v15 offset:9216
    v_mov_b32 v48, 0
    v_mov_b32 v49, 0
    v_mov_b32 v50, 0
    v_mov_b32 v51, 0
    v_mov_b32 v52, 0
    v_mov_b32 v53, 0
    v_mov_b32 v54, 0
    v_mov_b32 v55, 0
    v_mov_b32 v56, 0
    v_mov_b32 v57, 0
    v_mov_b32 v58, 0
    v_mov_b32 v59, 0
    v_mov_b32 v60, 0
    v_mov_b32 v61, 0
    v_mov_b32 v62, 0
    v_mov_b32 v63, 0
    v_mov_b32 v64, 0
    v_mov_b32 v65, 0
    v_mov_b32 v66, 0
    v_mov_b32 v67, 0
    v_mov_b32 v68, 0
    v_mov_b32 v69, 0
    v_mov_b32 v70, 0
    v_mov_b32 v71, 0
    s_lshl_b32 s51, s50, 13
    s_add_u32 s51, s51, 0x10000
Lpm_41:
    buffer_load_dwordx4 v[16:19], v6, s[8:11], s51 offen sc1
    buffer_load_dwordx4 v[20:23], v6, s[8:11], s51 offen offset:1024 sc1
    s_add_u32 s61, s61, 1
    s_cmp_gt_u32 s61, 0x40000
    s_cbranch_scc1 Lpmd_42
    s_waitcnt vmcnt(0)
    v_max3_u32 v24, v16, v17, v18
    v_max3_u32 v25, v19, v20, v21
    v_max3_u32 v24, v22, v23, v24
    v_max_u32 v24, v24, v25
    v_cmp_eq_u32 vcc, -1, v24
    s_cbranch_vccnz Lpm_41
Lpmd_42:
    ds_write_b64 v5, v[16:17]
    ds_write_b64 v5, v[18:19] offset:16
    ds_write_b64 v5, v[20:21] offset:1024
    ds_write_b64 v5, v[22:23] offset:1040
    s_waitcnt lgkmcnt(0)
    s_barrier
    ds_read_b128 v[16:19], v0 offset:8192
    ds_read_b128 v[20:23], v0 offset:9216
    ds_read_b128 v[24:27], v0 offset:10240
    ds_read_b128 v[28:31], v0 offset:11264
    ds_read_b128 v[32:35], v0 offset:12288
    ds_read_b128 v[36:39], v0 offset:13312
    ds_read_b128 v[40:43], v0 offset:14336
    ds_read_b128 v[44:47], v0 offset:15360
    s_cmp_eq_u32 s50, 0
    s_cbranch_scc1 Lsk_43
    s_cmp_lg_u32 s4, 0
    s_cbranch_scc1 Lsk_43
    s_add_u32 s34, s50, 63
    s_lshl_b32 s34, s34, 6
    v_mov_b32 v120, 0
    v_mov_b32 v121, 1
    s_mov_b64 exec, 1
    buffer_atomic_add v121, v120, s[8:11], s34 offen sc1
    s_mov_b64 exec, -1
Lsk_43:
    s_waitcnt lgkmcnt(7)
    v_smfmac_f32_16x16x64_bf16 v[48:51], v[16:19], a[0:7], v4
    v_smfmac_f32_16x16x64_bf16 v[52:55], v[16:19], a[8:15], v4
    v_smfmac_f32_16x16x64_bf16 v[56:59], v[16:19], a[128:135], v4
    v_smfmac_f32_16x16x64_bf16 v[60:63], v[16:19], a[136:143], v4
    v_smfmac_f32_16x16x64_bf16 v[64:67], v[16:19], v[80:87], v4
    ds_read_b128 v[80:83], v15 offset:10240
    ds_read_b128 v[84:87], v15 offset:11264
    v_smfmac_f32_16x16x64_bf16 v[68:71], v[16:19], v[88:95], v4
    ds_read_b128 v[88:91], v15 offset:12288
    ds_read_b128 v[92:95], v15 offset:13312
    s_waitcnt lgkmcnt(10)
    v_smfmac_f32_16x16x64_bf16 v[48:51], v[20:23], a[16:23], v4
    v_smfmac_f32_16x16x64_bf16 v[52:55], v[20:23], a[24:31], v4
    v_smfmac_f32_16x16x64_bf16 v[56:59], v[20:23], a[144:151], v4
    v_smfmac_f32_16x16x64_bf16 v[60:63], v[20:23], a[152:159], v4
    v_smfmac_f32_16x16x64_bf16 v[64:67], v[20:23], v[96:103], v4
    ds_read_b128 v[96:99], v15 offset:14336
    ds_read_b128 v[100:103], v15 offset:15360
    v_smfmac_f32_16x16x64_bf16 v[68:71], v[20:23], v[104:111], v4
    ds_read_b128 v[104:107], v15 offset:16384
    ds_read_b128 v[108:111], v15 offset:17408
    s_waitcnt lgkmcnt(13)
    v_smfmac_f32_16x16x64_bf16 v[48:51], v[24:27], a[32:39], v4
    v_smfmac_f32_16x16x64_bf16 v[52:55], v[24:27], a[40:47], v4
    v_smfmac_f32_16x16x64_bf16 v[56:59], v[24:27], a[160:167], v4
    v_smfmac_f32_16x16x64_bf16 v[60:63], v[24:27], a[168:175], v4
    v_smfmac_f32_16x16x64_bf16 v[64:67], v[24:27], v[112:119], v4
    ds_read_b128 v[112:115], v15 offset:18432
    ds_read_b128 v[116:119], v15 offset:19456
    s_waitcnt lgkmcnt(8)
    v_smfmac_f32_16x16x64_bf16 v[68:71], v[24:27], v[80:87], v4
    ds_read_b128 v[80:83], v15 offset:20480
    ds_read_b128 v[84:87], v15 offset:21504
    v_smfmac_f32_16x16x64_bf16 v[48:51], v[28:31], a[48:55], v4
    v_smfmac_f32_16x16x64_bf16 v[52:55], v[28:31], a[56:63], v4
    v_smfmac_f32_16x16x64_bf16 v[56:59], v[28:31], a[176:183], v4
    v_smfmac_f32_16x16x64_bf16 v[60:63], v[28:31], a[184:191], v4
    s_waitcnt lgkmcnt(8)
    v_smfmac_f32_16x16x64_bf16 v[64:67], v[28:31], v[88:95], v4
    ds_read_b128 v[88:91], v15 offset:22528
    ds_read_b128 v[92:95], v15 offset:23552
    s_waitcnt lgkmcnt(8)
    v_smfmac_f32_16x16x64_bf16 v[68:71], v[28:31], v[96:103], v4
    ds_read_b128 v[96:99], v15 offset:24576
    ds_read_b128 v[100:103], v15 offset:25600
    v_smfmac_f32_16x16x64_bf16 v[48:51], v[32:35], a[64:71], v4
    v_smfmac_f32_16x16x64_bf16 v[52:55], v[32:35], a[72:79], v4
    v_smfmac_f32_16x16x64_bf16 v[56:59], v[32:35], a[192:199], v4
    v_smfmac_f32_16x16x64_bf16 v[60:63], v[32:35], a[200:207], v4
    s_waitcnt lgkmcnt(8)
    v_smfmac_f32_16x16x64_bf16 v[64:67], v[32:35], v[104:111], v4
    ds_read_b128 v[104:107], v15 offset:26624
    ds_read_b128 v[108:111], v15 offset:27648
    s_waitcnt lgkmcnt(8)
    v_smfmac_f32_16x16x64_bf16 v[68:71], v[32:35], v[112:119], v4
    ds_read_b128 v[112:115], v15 offset:28672
    ds_read_b128 v[116:119], v15 offset:29696
    v_smfmac_f32_16x16x64_bf16 v[48:51], v[36:39], a[80:87], v4
    v_smfmac_f32_16x16x64_bf16 v[52:55], v[36:39], a[88:95], v4
    v_smfmac_f32_16x16x64_bf16 v[56:59], v[36:39], a[208:215], v4
    v_smfmac_f32_16x16x64_bf16 v[60:63], v[36:39], a[216:223], v4
    s_waitcnt lgkmcnt(8)
    v_smfmac_f32_16x16x64_bf16 v[64:67], v[36:39], v[80:87], v4
    ds_read_b128 v[80:83], v15 offset:30720
    ds_read_b128 v[84:87], v15 offset:31744
    s_waitcnt lgkmcnt(8)
    v_smfmac_f32_16x16x64_bf16 v[68:71], v[36:39], v[88:95], v4
    v_smfmac_f32_16x16x64_bf16 v[48:51], v[40:43], a[96:103], v4
    v_smfmac_f32_16x16x64_bf16 v[52:55], v[40:43], a[104:111], v4
    v_smfmac_f32_16x16x64_bf16 v[56:59], v[40:43], a[224:231], v4
    v_smfmac_f32_16x16x64_bf16 v[60:63], v[40:43], a[232:239], v4
    s_waitcnt lgkmcnt(6)
    v_smfmac_f32_16x16x64_bf16 v[64:67], v[40:43], v[96:103], v4
    s_waitcnt lgkmcnt(4)
    v_smfmac_f32_16x16x64_bf16 v[68:71], v[40:43], v[104:111], v4
    v_smfmac_f32_16x16x64_bf16 v[48:51], v[44:47], a[112:119], v4
    v_smfmac_f32_16x16x64_bf16 v[52:55], v[44:47], a[120:127], v4
    v_smfmac_f32_16x16x64_bf16 v[56:59], v[44:47], a[240:247], v4
    v_smfmac_f32_16x16x64_bf16 v[60:63], v[44:47], a[248:255], v4
    s_waitcnt lgkmcnt(2)
    v_smfmac_f32_16x16x64_bf16 v[64:67], v[44:47], v[112:119], v4
    s_waitcnt lgkmcnt(0)
    v_smfmac_f32_16x16x64_bf16 v[68:71], v[44:47], v[80:87], v4
    ds_read_b128 v[16:19], v0 offset:0
    ds_read_b128 v[20:23], v0 offset:1024
    ds_read_b128 v[24:27], v0 offset:2048
    ds_read_b128 v[28:31], v0 offset:3072
    ds_read_b128 v[32:35], v0 offset:4096
    ds_read_b128 v[36:39], v0 offset:5120
    ds_read_b128 v[40:43], v0 offset:6144
    ds_read_b128 v[44:47], v0 offset:7168
    s_nop 7
    v_permlane32_swap_b32 v48, v52
    v_permlane32_swap_b32 v49, v53
    v_permlane32_swap_b32 v50, v54
    v_permlane32_swap_b32 v51, v55
    s_nop 0
    v_add_f32 v48, v48, v52
    v_add_f32 v49, v49, v53
    v_add_f32 v50, v50, v54
    v_add_f32 v51, v51, v55
    v_cvt_pk_bf16_f32 v52, v48, v49
    v_cvt_pk_bf16_f32 v53, v50, v51
    ds_write_b16 v8, v52 offset:0
    ds_write_b16_d16_hi v8, v52 offset:272
    ds_write_b16 v8, v53 offset:544
    ds_write_b16_d16_hi v8, v53 offset:816
    v_permlane32_swap_b32 v56, v60
    v_permlane32_swap_b32 v57, v61
    v_permlane32_swap_b32 v58, v62
    v_permlane32_swap_b32 v59, v63
    s_nop 0
    v_add_f32 v56, v56, v60
    v_add_f32 v57, v57, v61
    v_add_f32 v58, v58, v62
    v_add_f32 v59, v59, v63
    v_cvt_pk_bf16_f32 v60, v56, v57
    v_cvt_pk_bf16_f32 v61, v58, v59
    ds_write_b16 v8, v60 offset:2304
    ds_write_b16_d16_hi v8, v60 offset:2576
    ds_write_b16 v8, v61 offset:2848
    ds_write_b16_d16_hi v8, v61 offset:3120
    v_permlane32_swap_b32 v64, v68
    v_permlane32_swap_b32 v65, v69
    v_permlane32_swap_b32 v66, v70
    v_permlane32_swap_b32 v67, v71
    s_nop 0
    v_add_f32 v64, v64, v68
    v_add_f32 v65, v65, v69
    v_add_f32 v66, v66, v70
    v_add_f32 v67, v67, v71
    v_cvt_pk_bf16_f32 v68, v64, v65
    v_cvt_pk_bf16_f32 v69, v66, v67
    s_lshl_b32 s52, s50, 5
    s_add_u32 s52, s52, s5
    s_lshl_b32 s52, s52, 11
    s_lshl_b32 s53, s4, 9
    s_add_u32 s53, s53, s52
    s_add_u32 s53, s53, 0x1400000
    v_lshrrev_b32 v120, 1, v7
    buffer_store_dwordx2 v[68:69], v120, s[8:11], s53 offen sc1
    s_waitcnt lgkmcnt(0)
    s_barrier
    s_cmp_eq_u32 s50, 63
    s_cbranch_scc1 Lpk_44
    v_readfirstlane_b32 s60, v123
    s_nop 3
    s_cmp_ge_u32 s60, 16
    s_cbranch_scc1 Lpk2_45
Lw_46:
    buffer_load_dword v121, off, s[8:11], s58 sc1
    s_add_u32 s61, s61, 1
    s_cmp_gt_u32 s61, 0x40000
    s_cbranch_scc1 Lwd_47
    s_waitcnt vmcnt(0)
    v_readfirstlane_b32 s60, v121
    s_nop 3
    s_cmp_ge_u32 s60, 16
    s_cbranch_scc1 Lwd_47
    s_sleep 2
    s_branch Lw_46
Lwd_47:
Lpk2_45:
    s_lshl_b32 s34, s54, 5
    s_add_u32 s34, s34, s5
    s_lshl_b32 s34, s34, 13
    s_add_u32 s35, s34, 0x3000000
    s_add_u32 s57, s34, 0x4000000
    s_lshl_b32 s37, s4, 11
    s_add_u32 s37, s37, 131072
    s_mov_b32 m0, s37
    s_nop 0
    buffer_load_dwordx4 v6, s[8:11], s35 offen sc1 lds
    buffer_load_dwordx4 v6, s[8:11], s35 offen offset:1024 sc1 lds
Lpk_44:
    ds_read_b128 v[48:51], v9 offset:0
    ds_read_b128 v[52:55], v9 offset:64
    ds_read_b128 v[56:59], v9 offset:128
    ds_read_b128 v[60:63], v9 offset:192
    ds_read_b128 v[80:83], v9 offset:2304
    ds_read_b128 v[84:87], v9 offset:2368
    ds_read_b128 v[88:91], v9 offset:2432
    ds_read_b128 v[92:95], v9 offset:2496
    v_and_b32 v120, 7, v2
    v_lshlrev_b32 v120, 8, v120
    v_lshl_add_u32 v120, v3, 4, v120
    s_lshl_b32 s34, s4, 6
    v_add_u32 v120, s34, v120
    s_add_u32 s53, s52, 0x1000000
    v_add_u32 v121, -2304, v13
    ds_read_b128 v[112:115], v121
    s_waitcnt lgkmcnt(8)
    v_mfma_f32_16x16x32_bf16 v[100:103], v[16:19], v[48:51], 0
    v_mfma_f32_16x16x32_bf16 v[104:107], v[32:35], v[48:51], 0
    s_waitcnt lgkmcnt(7)
    v_mfma_f32_16x16x32_bf16 v[100:103], v[20:23], v[52:55], v[100:103]
    v_mfma_f32_16x16x32_bf16 v[104:107], v[36:39], v[52:55], v[104:107]
    s_waitcnt lgkmcnt(6)
    v_mfma_f32_16x16x32_bf16 v[100:103], v[24:27], v[56:59], v[100:103]
    v_mfma_f32_16x16x32_bf16 v[104:107], v[40:43], v[56:59], v[104:107]
    s_waitcnt lgkmcnt(5)
    v_mfma_f32_16x16x32_bf16 v[100:103], v[28:31], v[60:63], v[100:103]
    v_mfma_f32_16x16x32_bf16 v[104:107], v[44:47], v[60:63], v[104:107]
    s_waitcnt lgkmcnt(0)
    buffer_store_dwordx4 v[112:115], v120, s[8:11], s53 offen sc1
    s_cmp_eq_u32 s50, 63
    s_cbranch_scc1 Lcfin_37
    v_mfma_f32_16x16x32_bf16 v[96:99], v[80:83], v[48:51], 0
    v_mfma_f32_16x16x32_bf16 v[96:99], v[84:87], v[52:55], v[96:99]
    v_mfma_f32_16x16x32_bf16 v[96:99], v[88:91], v[56:59], v[96:99]
    v_mfma_f32_16x16x32_bf16 v[96:99], v[92:95], v[60:63], v[96:99]
    s_nop 7
    v_max3_f32 v116, v100, v101, v102
    v_max3_f32 v117, v103, v104, v105
    v_max3_f32 v116, v106, v107, v116
    v_max3_f32 v117, v96, v97, v117
    v_max3_f32 v116, v98, v99, v116
    v_max_f32 v116, v116, v117
    v_mov_b32 v117, v116
    s_nop 1
    v_permlane16_swap_b32 v116, v117
    s_nop 1
    v_max_f32 v116, v116, v117
    v_mov_b32 v117, v116
    s_nop 1
    v_permlane32_swap_b32 v116, v117
    s_nop 1
    v_max_f32 v116, v116, v117
    v_mul_f32 v116, s46, v116
    v_fma_f32 v100, v100, s46, -v116
    v_fma_f32 v101, v101, s46, -v116
    v_fma_f32 v102, v102, s46, -v116
    v_fma_f32 v103, v103, s46, -v116
    v_fma_f32 v104, v104, s46, -v116
    v_fma_f32 v105, v105, s46, -v116
    v_fma_f32 v106, v106, s46, -v116
    v_fma_f32 v107, v107, s46, -v116
    v_fma_f32 v96, v96, s46, -v116
    v_fma_f32 v97, v97, s46, -v116
    v_fma_f32 v98, v98, s46, -v116
    v_fma_f32 v99, v99, s46, -v116
    v_exp_f32 v100, v100
    v_exp_f32 v101, v101
    v_exp_f32 v102, v102
    v_exp_f32 v103, v103
    v_exp_f32 v104, v104
    v_exp_f32 v105, v105
    v_exp_f32 v106, v106
    v_exp_f32 v107, v107
    v_exp_f32 v96, v96
    v_exp_f32 v97, v97
    v_exp_f32 v98, v98
    v_exp_f32 v99, v99
    s_nop 0
    v_cvt_pk_bf16_f32 v48, v100, v101
    v_cvt_pk_bf16_f32 v49, v102, v103
    v_cvt_pk_bf16_f32 v50, v104, v105
    v_cvt_pk_bf16_f32 v51, v106, v107
    v_cvt_pk_bf16_f32 v52, v96, v97
    v_cvt_pk_bf16_f32 v53, v98, v99
    v_mfma_f32_16x16x32_bf16 v[60:63], v[72:75], v[48:51], 0
    v_mfma_f32_16x16x32_bf16 v[112:115], v[76:79], v[48:51], 0
    v_cndmask_b32 v54, 0, v52, s[40:41]
    v_cndmask_b32 v56, 0, v52, s[42:43]
    v_cndmask_b32 v55, 0, v53, s[40:41]
    v_cndmask_b32 v57, 0, v53, s[42:43]
    s_nop 1
    v_mfma_f32_16x16x16_bf16 v[60:63], v[68:69], v[54:55], v[60:63]
    v_mfma_f32_16x16x16_bf16 v[112:115], v[68:69], v[56:57], v[112:115]
    v_add_f32 v116, v96, v97
    v_add_f32 v117, v98, v99
    v_add_f32 v116, v116, v117
    v_cndmask_b32 v116, 0, v116, s[40:41]
    v_add_f32 v117, v100, v101
    v_add_f32 v118, v102, v103
    v_add_f32 v119, v104, v105
    v_add_f32 v116, v116, v106
    v_add_f32 v117, v117, v107
    v_add_f32 v118, v118, v119
    v_add_f32 v116, v116, v117
    v_add_f32 v116, v116, v118
    v_mov_b32 v117, v116
    s_nop 1
    v_permlane16_swap_b32 v116, v117
    s_nop 1
    v_add_f32 v116, v116, v117
    v_mov_b32 v117, v116
    s_nop 1
    v_permlane32_swap_b32 v116, v117
    s_nop 1
    v_add_f32 v116, v116, v117
    v_rcp_f32 v116, v116
    s_nop 4
    v_mul_f32 v60, v60, v116
    v_mul_f32 v112, v112, v116
    v_mul_f32 v61, v61, v116
    v_mul_f32 v113, v113, v116
    v_mul_f32 v62, v62, v116
    v_mul_f32 v114, v114, v116
    v_mul_f32 v63, v63, v116
    v_mul_f32 v115, v115, v116
    v_cvt_pk_bf16_f32 v96, v60, v112
    v_cvt_pk_bf16_f32 v97, v61, v113
    v_cvt_pk_bf16_f32 v98, v62, v114
    v_cvt_pk_bf16_f32 v99, v63, v115
    ds_write_b128 v13, v[96:99]
    buffer_load_dwordx4 v[72:75], v14, s[8:11], s57 offen sc1
    buffer_load_dwordx4 v[76:79], v14, s[8:11], s57 offen offset:1024 sc1
    v_mov_b32 v16, 0
    v_mov_b32 v17, 0
    v_mov_b32 v18, 0
    v_mov_b32 v19, 0
    v_mov_b32 v20, 0
    v_mov_b32 v21, 0
    v_mov_b32 v22, 0
    v_mov_b32 v23, 0
    v_mov_b32 v24, 0
    v_mov_b32 v25, 0
    v_mov_b32 v26, 0
    v_mov_b32 v27, 0
    v_mov_b32 v28, 0
    v_mov_b32 v29, 0
    v_mov_b32 v30, 0
    v_mov_b32 v31, 0
    s_waitcnt lgkmcnt(0)
    s_barrier
    v_add_u32 v120, 4608, v9
    ds_read_b128 v[48:51], v120 offset:0
    ds_read_b128 v[52:55], v120 offset:64
    ds_read_b128 v[56:59], v120 offset:128
    ds_read_b128 v[60:63], v120 offset:192
    s_waitcnt lgkmcnt(3)
    v_smfmac_f32_16x16x64_bf16 v[16:19], v[48:51], v[128:135], v4
    v_smfmac_f32_16x16x64_bf16 v[20:23], v[48:51], v[160:167], v4
    v_smfmac_f32_16x16x64_bf16 v[24:27], v[48:51], v[192:199], v4
    v_smfmac_f32_16x16x64_bf16 v[28:31], v[48:51], v[224:231], v4
    s_waitcnt lgkmcnt(2)
    v_smfmac_f32_16x16x64_bf16 v[16:19], v[52:55], v[136:143], v4
    v_smfmac_f32_16x16x64_bf16 v[20:23], v[52:55], v[168:175], v4
    v_smfmac_f32_16x16x64_bf16 v[24:27], v[52:55], v[200:207], v4
    v_smfmac_f32_16x16x64_bf16 v[28:31], v[52:55], v[232:239], v4
    s_waitcnt lgkmcnt(1)
    v_smfmac_f32_16x16x64_bf16 v[16:19], v[56:59], v[144:151], v4
    v_smfmac_f32_16x16x64_bf16 v[20:23], v[56:59], v[176:183], v4
    v_smfmac_f32_16x16x64_bf16 v[24:27], v[56:59], v[208:215], v4
    v_smfmac_f32_16x16x64_bf16 v[28:31], v[56:59], v[240:247], v4
    s_waitcnt lgkmcnt(0)
    v_smfmac_f32_16x16x64_bf16 v[16:19], v[60:63], v[152:159], v4
    v_smfmac_f32_16x16x64_bf16 v[20:23], v[60:63], v[184:191], v4
    v_smfmac_f32_16x16x64_bf16 v[24:27], v[60:63], v[216:223], v4
    v_smfmac_f32_16x16x64_bf16 v[28:31], v[60:63], v[248:255], v4
    s_and_b32 s34, s50, 1
    s_lshl_b32 s34, s34, 19
    s_add_u32 s55, s34, 0x100000
    s_mov_b32 s56, s55
    s_nop 4
    buffer_store_dwordx4 v[16:19], v10, s[8:11], s56 offen sc1
    s_add_u32 s56, s56, 0x8000
    buffer_store_dwordx4 v[20:23], v10, s[8:11], s56 offen sc1
    s_add_u32 s56, s56, 0x8000
    buffer_store_dwordx4 v[24:27], v10, s[8:11], s56 offen sc1
    s_add_u32 s56, s56, 0x8000
    buffer_store_dwordx4 v[28:31], v10, s[8:11], s56 offen sc1
    s_add_u32 s56, s56, 0x8000
Lpr_48:
    buffer_load_dwordx4 v[96:99], v11, s[8:11], s55 offen offset:0 sc1
    buffer_load_dwordx4 v[100:103], v11, s[8:11], s55 offen offset:1024 sc1
    buffer_load_dwordx4 v[104:107], v11, s[8:11], s55 offen offset:2048 sc1
    buffer_load_dwordx4 v[108:111], v11, s[8:11], s55 offen offset:3072 sc1
    s_add_u32 s61, s61, 1
    s_cmp_gt_u32 s61, 0x40000
    s_cbranch_scc1 Lprd_49
    s_waitcnt vmcnt(0)
    v_max3_u32 v112, v96, v100, v104
    v_max_u32 v112, v112, v108
    v_cmp_eq_u32 vcc, -1, v112
    s_cbranch_vccnz Lpr_48
Lprd_49:
    v_add_f32 v96, v96, v100
    v_add_f32 v104, v104, v108
    v_add_f32 v97, v97, v101
    v_add_f32 v105, v105, v109
    v_add_f32 v98, v98, v102
    v_add_f32 v106, v106, v110
    v_add_f32 v99, v99, v103
    v_add_f32 v107, v107, v111
    v_add_f32 v96, v96, v104
    v_add_f32 v97, v97, v105
    v_add_f32 v98, v98, v106
    v_add_f32 v99, v99, v107
    s_nop 1
    v_add_f32_dpp v96, v96, v96 row_ror:8 row_mask:0xf bank_mask:0xf
    v_add_f32_dpp v97, v97, v97 row_ror:8 row_mask:0xf bank_mask:0xf
    v_add_f32_dpp v98, v98, v98 row_ror:8 row_mask:0xf bank_mask:0xf
    v_add_f32_dpp v99, v99, v99 row_ror:8 row_mask:0xf bank_mask:0xf
    s_nop 1
    v_permlane32_swap_b32 v96, v97
    v_permlane32_swap_b32 v98, v99
    s_nop 1
    v_add_f32 v96, v96, v97
    v_add_f32 v98, v98, v99
    s_nop 1
    v_permlane16_swap_b32 v96, v98
    s_nop 1
    v_add_f32 v96, v96, v98
    s_nop 1
    v_mov_b32_dpp v97, v96 quad_perm:[2,3,0,1] row_mask:0xf bank_mask:0xf
    s_nop 0
    v_cvt_pk_bf16_f32 v96, v96, v97
    s_add_u32 s34, s51, 0x2000
    s_mov_b64 exec, s[44:45]
    buffer_store_dword v96, v12, s[8:11], s34 offen sc1
    s_mov_b64 exec, -1
    v_mov_b32 v100, -1
    v_mov_b32 v101, -1
    v_mov_b32 v102, -1
    v_mov_b32 v103, -1
    buffer_store_dwordx4 v[100:103], v11, s[8:11], s55 offen offset:0 sc1
    buffer_store_dwordx4 v[100:103], v11, s[8:11], s55 offen offset:1024 sc1
    buffer_store_dwordx4 v[100:103], v11, s[8:11], s55 offen offset:2048 sc1
    buffer_store_dwordx4 v[100:103], v11, s[8:11], s55 offen offset:3072 sc1
    s_add_u32 s50, s50, 1
    s_branch Lctop_36
Lcfin_37:
    s_mov_b32 s34, 8128
    s_waitcnt vmcnt(0) lgkmcnt(0)
    s_barrier
    s_cmp_lg_u32 s4, 0
    s_cbranch_scc1 Lsg_50
    v_mov_b32 v121, 1
    s_mov_b64 exec, 1
    buffer_atomic_add v121, off, s[8:11], s34 sc1
    s_mov_b64 exec, -1
Lsg_50:
    s_endpgm
Lworker_1:
    s_mul_hi_u32 s34, s5, 0x12492493
    s_mul_i32 s33, s34, 14
    s_sub_u32 s33, s5, s33
    s_add_u32 s34, s34, 8
    s_mov_b32 s62, 1
    s_mov_b32 s63, 0
Lq2_51:
    s_cmp_eq_u32 s62, 0
    s_cbranch_scc1 Lna_53
    v_lshlrev_b32 v5, 4, v1
    s_lshl_b32 s39, s33, 17
    s_lshl_b32 s38, s4, 15
    s_add_u32 s39, s39, s38
    s_add_u32 s39, s39, 0x200000
    s_mov_b32 m0, s38
    s_nop 0
    buffer_load_dwordx4 v5, s[8:11], s39 offen offset:0 lds
    buffer_load_dwordx4 v5, s[8:11], s39 offen offset:1024 lds
    buffer_load_dwordx4 v5, s[8:11], s39 offen offset:2048 lds
    buffer_load_dwordx4 v5, s[8:11], s39 offen offset:3072 lds
    s_add_u32 s38, s38, 4096
    s_add_u32 s39, s39, 4096
    s_mov_b32 m0, s38
    s_nop 0
    buffer_load_dwordx4 v5, s[8:11], s39 offen offset:0 lds
    buffer_load_dwordx4 v5, s[8:11], s39 offen offset:1024 lds
    buffer_load_dwordx4 v5, s[8:11], s39 offen offset:2048 lds
    buffer_load_dwordx4 v5, s[8:11], s39 offen offset:3072 lds
    s_add_u32 s38, s38, 4096
    s_add_u32 s39, s39, 4096
    s_mov_b32 m0, s38
    s_nop 0
    buffer_load_dwordx4 v5, s[8:11], s39 offen offset:0 lds
    buffer_load_dwordx4 v5, s[8:11], s39 offen offset:1024 lds
    buffer_load_dwordx4 v5, s[8:11], s39 offen offset:2048 lds
    buffer_load_dwordx4 v5, s[8:11], s39 offen offset:3072 lds
    s_add_u32 s38, s38, 4096
    s_add_u32 s39, s39, 4096
    s_mov_b32 m0, s38
    s_nop 0
    buffer_load_dwordx4 v5, s[8:11], s39 offen offset:0 lds
    buffer_load_dwordx4 v5, s[8:11], s39 offen offset:1024 lds
    buffer_load_dwordx4 v5, s[8:11], s39 offen offset:2048 lds
    buffer_load_dwordx4 v5, s[8:11], s39 offen offset:3072 lds
    s_add_u32 s38, s38, 4096
    s_add_u32 s39, s39, 4096
    s_mov_b32 m0, s38
    s_nop 0
    buffer_load_dwordx4 v5, s[8:11], s39 offen offset:0 lds
    buffer_load_dwordx4 v5, s[8:11], s39 offen offset:1024 lds
    buffer_load_dwordx4 v5, s[8:11], s39 offen offset:2048 lds
    buffer_load_dwordx4 v5, s[8:11], s39 offen offset:3072 lds
    s_add_u32 s38, s38, 4096
    s_add_u32 s39, s39, 4096
    s_mov_b32 m0, s38
    s_nop 0
    buffer_load_dwordx4 v5, s[8:11], s39 offen offset:0 lds
    buffer_load_dwordx4 v5, s[8:11], s39 offen offset:1024 lds
    buffer_load_dwordx4 v5, s[8:11], s39 offen offset:2048 lds
    buffer_load_dwordx4 v5, s[8:11], s39 offen offset:3072 lds
    s_add_u32 s38, s38, 4096
    s_add_u32 s39, s39, 4096
    s_mov_b32 m0, s38
    s_nop 0
    buffer_load_dwordx4 v5, s[8:11], s39 offen offset:0 lds
    buffer_load_dwordx4 v5, s[8:11], s39 offen offset:1024 lds
    buffer_load_dwordx4 v5, s[8:11], s39 offen offset:2048 lds
    buffer_load_dwordx4 v5, s[8:11], s39 offen offset:3072 lds
    s_add_u32 s38, s38, 4096
    s_add_u32 s39, s39, 4096
    s_mov_b32 m0, s38
    s_nop 0
    buffer_load_dwordx4 v5, s[8:11], s39 offen offset:0 lds
    buffer_load_dwordx4 v5, s[8:11], s39 offen offset:1024 lds
    buffer_load_dwordx4 v5, s[8:11], s39 offen offset:2048 lds
    buffer_load_dwordx4 v5, s[8:11], s39 offen offset:3072 lds
    s_add_u32 s38, s38, 4096
    s_add_u32 s39, s39, 4096
Lna_53:
    s_mov_b32 s42, s34
    s_lshl_b32 s34, s34, 2
    s_add_u32 s34, s34, s4
    s_lshr_b32 s36, s34, 5
    s_and_b32 s37, s34, 31
    s_mov_b32 s12, s68
    s_and_b32 s13, s69, 0xffff
    s_mov_b32 s14, 0x400000
    s_mov_b32 s15, 0x20000
    s_cmp_lg_u32 s36, 1
    s_cbranch_scc1 Lm_54
    s_mov_b32 s12, s70
    s_and_b32 s13, s71, 0xffff
    s_mov_b32 s14, 0x400000
    s_mov_b32 s15, 0x20000
Lm_54:
    s_cmp_lg_u32 s36, 2
    s_cbranch_scc1 Lm_55
    s_mov_b32 s12, s72
    s_and_b32 s13, s73, 0xffff
    s_mov_b32 s14, 0x400000
    s_mov_b32 s15, 0x20000
Lm_55:
    v_lshlrev_b32 v4, 16, v3
    v_lshl_add_u32 v4, v2, 4, v4
    s_lshl_b32 s38, s37, 8
    v_add_u32 v4, s38, v4
    v_lshlrev_b32 v5, 4, v1
    v_add_u32 v6, 0x10000, v5
    s_waitcnt vmcnt(0)
    s_barrier
    s_mov_b32 s21, 0x5040100
    s_mov_b32 s22, 0x7060302
    s_mov_b32 s23, 0x40000
    s_mov_b32 s24, 0
    s_mov_b32 s25, 0x2000
    s_mov_b32 s26, 0x4000
    s_mov_b32 s27, 0x6000
    s_mov_b32 s28, 0x8000
    s_mov_b32 s29, 0xa000
    s_mov_b32 s30, 0xc000
    s_mov_b32 s31, 0xe000
    buffer_load_dwordx4 v[16:19], v4, s[12:15], s24 offen
    buffer_load_dwordx4 v[20:23], v4, s[12:15], s25 offen
    buffer_load_dwordx4 v[24:27], v4, s[12:15], s26 offen
    buffer_load_dwordx4 v[28:31], v4, s[12:15], s27 offen
    buffer_load_dwordx4 v[32:35], v4, s[12:15], s28 offen
    buffer_load_dwordx4 v[36:39], v4, s[12:15], s29 offen
    buffer_load_dwordx4 v[40:43], v4, s[12:15], s30 offen
    buffer_load_dwordx4 v[44:47], v4, s[12:15], s31 offen
    v_add_u32 v4, s23, v4
    buffer_load_dwordx4 v[48:51], v4, s[12:15], s24 offen
    buffer_load_dwordx4 v[52:55], v4, s[12:15], s25 offen
    buffer_load_dwordx4 v[56:59], v4, s[12:15], s26 offen
    buffer_load_dwordx4 v[60:63], v4, s[12:15], s27 offen
    buffer_load_dwordx4 v[64:67], v4, s[12:15], s28 offen
    buffer_load_dwordx4 v[68:71], v4, s[12:15], s29 offen
    buffer_load_dwordx4 v[72:75], v4, s[12:15], s30 offen
    buffer_load_dwordx4 v[76:79], v4, s[12:15], s31 offen
    v_add_u32 v4, s23, v4
    buffer_load_dwordx4 v[80:83], v4, s[12:15], s24 offen
    buffer_load_dwordx4 v[84:87], v4, s[12:15], s25 offen
    buffer_load_dwordx4 v[88:91], v4, s[12:15], s26 offen
    buffer_load_dwordx4 v[92:95], v4, s[12:15], s27 offen
    buffer_load_dwordx4 v[96:99], v4, s[12:15], s28 offen
    buffer_load_dwordx4 v[100:103], v4, s[12:15], s29 offen
    buffer_load_dwordx4 v[104:107], v4, s[12:15], s30 offen
    buffer_load_dwordx4 v[108:111], v4, s[12:15], s31 offen
    v_add_u32 v4, s23, v4
    s_waitcnt vmcnt(16)
    v_perm_b32 v112, v20, v16, s21
    v_perm_b32 v113, v28, v24, s21
    v_perm_b32 v114, v36, v32, s21
    v_perm_b32 v115, v44, v40, s21
    v_perm_b32 v116, v20, v16, s22
    v_perm_b32 v117, v28, v24, s22
    v_perm_b32 v118, v36, v32, s22
    v_perm_b32 v119, v44, v40, s22
    v_perm_b32 v120, v21, v17, s21
    v_perm_b32 v121, v29, v25, s21
    v_perm_b32 v122, v37, v33, s21
    v_perm_b32 v123, v45, v41, s21
    v_perm_b32 v124, v21, v17, s22
    v_perm_b32 v125, v29, v25, s22
    v_perm_b32 v126, v37, v33, s22
    v_perm_b32 v127, v45, v41, s22
    v_perm_b32 v128, v22, v18, s21
    v_perm_b32 v129, v30, v26, s21
    v_perm_b32 v130, v38, v34, s21
    v_perm_b32 v131, v46, v42, s21
    v_perm_b32 v132, v22, v18, s22
    v_perm_b32 v133, v30, v26, s22
    v_perm_b32 v134, v38, v34, s22
    v_perm_b32 v135, v46, v42, s22
    v_perm_b32 v136, v23, v19, s21
    v_perm_b32 v137, v31, v27, s21
    v_perm_b32 v138, v39, v35, s21
    v_perm_b32 v139, v47, v43, s21
    v_perm_b32 v140, v23, v19, s22
    v_perm_b32 v141, v31, v27, s22
    v_perm_b32 v142, v39, v35, s22
    v_perm_b32 v143, v47, v43, s22
    ds_read_b128 v[176:179], v5 offset:0
    ds_read_b128 v[180:183], v5 offset:16384
    ds_read_b128 v[184:187], v5 offset:32768
    ds_read_b128 v[188:191], v5 offset:49152
    ds_read_b128 v[192:195], v6 offset:0
    ds_read_b128 v[196:199], v6 offset:16384
    ds_read_b128 v[200:203], v6 offset:32768
    ds_read_b128 v[204:207], v6 offset:49152
    s_waitcnt vmcnt(8) lgkmcnt(0)
    s_nop 1
    v_mfma_f32_16x16x32_bf16 a[0:3], v[176:179], v[112:115], 0
    buffer_load_dwordx4 v[16:19], v4, s[12:15], s24 offen
    v_mfma_f32_16x16x32_bf16 a[32:35], v[180:183], v[112:115], 0
    buffer_load_dwordx4 v[20:23], v4, s[12:15], s25 offen
    v_mfma_f32_16x16x32_bf16 a[64:67], v[184:187], v[112:115], 0
    buffer_load_dwordx4 v[24:27], v4, s[12:15], s26 offen
    v_mfma_f32_16x16x32_bf16 a[96:99], v[188:191], v[112:115], 0
    buffer_load_dwordx4 v[28:31], v4, s[12:15], s27 offen
    v_mfma_f32_16x16x32_bf16 a[128:131], v[192:195], v[112:115], 0
    v_mfma_f32_16x16x32_bf16 a[160:163], v[196:199], v[112:115], 0
    buffer_load_dwordx4 v[32:35], v4, s[12:15], s28 offen
    v_mfma_f32_16x16x32_bf16 a[192:195], v[200:203], v[112:115], 0
    buffer_load_dwordx4 v[36:39], v4, s[12:15], s29 offen
    v_mfma_f32_16x16x32_bf16 a[224:227], v[204:207], v[112:115], 0
    buffer_load_dwordx4 v[40:43], v4, s[12:15], s30 offen
    v_mfma_f32_16x16x32_bf16 a[4:7], v[176:179], v[116:119], 0
    v_mfma_f32_16x16x32_bf16 a[36:39], v[180:183], v[116:119], 0
    buffer_load_dwordx4 v[44:47], v4, s[12:15], s31 offen
    v_mfma_f32_16x16x32_bf16 a[68:71], v[184:187], v[116:119], 0
    v_add_u32 v4, s23, v4
    v_mfma_f32_16x16x32_bf16 a[100:103], v[188:191], v[116:119], 0
    ds_read_b128 v[208:211], v5 offset:1024
    v_mfma_f32_16x16x32_bf16 a[132:135], v[192:195], v[116:119], 0
    v_mfma_f32_16x16x32_bf16 a[164:167], v[196:199], v[116:119], 0
    ds_read_b128 v[212:215], v5 offset:17408
    v_mfma_f32_16x16x32_bf16 a[196:199], v[200:203], v[116:119], 0
    ds_read_b128 v[216:219], v5 offset:33792
    v_mfma_f32_16x16x32_bf16 a[228:231], v[204:207], v[116:119], 0
    ds_read_b128 v[220:223], v5 offset:50176
    v_mfma_f32_16x16x32_bf16 a[8:11], v[176:179], v[120:123], 0
    ds_read_b128 v[224:227], v6 offset:1024
    v_mfma_f32_16x16x32_bf16 a[40:43], v[180:183], v[120:123], 0
    v_mfma_f32_16x16x32_bf16 a[72:75], v[184:187], v[120:123], 0
    ds_read_b128 v[228:231], v6 offset:17408
    v_mfma_f32_16x16x32_bf16 a[104:107], v[188:191], v[120:123], 0
    ds_read_b128 v[232:235], v6 offset:33792
    v_mfma_f32_16x16x32_bf16 a[136:139], v[192:195], v[120:123], 0
    ds_read_b128 v[236:239], v6 offset:50176
    v_mfma_f32_16x16x32_bf16 a[168:171], v[196:199], v[120:123], 0
    v_mfma_f32_16x16x32_bf16 a[200:203], v[200:203], v[120:123], 0
    v_perm_b32 v144, v52, v48, s21
    v_mfma_f32_16x16x32_bf16 a[232:235], v[204:207], v[120:123], 0
    v_perm_b32 v145, v60, v56, s21
    v_mfma_f32_16x16x32_bf16 a[12:15], v[176:179], v[124:127], 0
    v_perm_b32 v146, v68, v64, s21
    v_mfma_f32_16x16x32_bf16 a[44:47], v[180:183], v[124:127], 0
    v_mfma_f32_16x16x32_bf16 a[76:79], v[184:187], v[124:127], 0
    v_perm_b32 v147, v76, v72, s21
    v_mfma_f32_16x16x32_bf16 a[108:111], v[188:191], v[124:127], 0
    v_perm_b32 v148, v52, v48, s22
    v_mfma_f32_16x16x32_bf16 a[140:143], v[192:195], v[124:127], 0
    v_perm_b32 v149, v60, v56, s22
    v_mfma_f32_16x16x32_bf16 a[172:175], v[196:199], v[124:127], 0
    v_mfma_f32_16x16x32_bf16 a[204:207], v[200:203], v[124:127], 0
    v_perm_b32 v150, v68, v64, s22
    v_mfma_f32_16x16x32_bf16 a[236:239], v[204:207], v[124:127], 0
    v_perm_b32 v151, v76, v72, s22
    v_mfma_f32_16x16x32_bf16 a[16:19], v[176:179], v[128:131], 0
    v_perm_b32 v152, v53, v49, s21
    v_mfma_f32_16x16x32_bf16 a[48:51], v[180:183], v[128:131], 0
    v_perm_b32 v153, v61, v57, s21
    v_mfma_f32_16x16x32_bf16 a[80:83], v[184:187], v[128:131], 0
    v_mfma_f32_16x16x32_bf16 a[112:115], v[188:191], v[128:131], 0
    v_perm_b32 v154, v69, v65, s21
    v_mfma_f32_16x16x32_bf16 a[144:147], v[192:195], v[128:131], 0
    v_perm_b32 v155, v77, v73, s21
    v_mfma_f32_16x16x32_bf16 a[176:179], v[196:199], v[128:131], 0
    v_perm_b32 v156, v53, v49, s22
    v_mfma_f32_16x16x32_bf16 a[208:211], v[200:203], v[128:131], 0
    v_mfma_f32_16x16x32_bf16 a[240:243], v[204:207], v[128:131], 0
    v_perm_b32 v157, v61, v57, s22
    v_mfma_f32_16x16x32_bf16 a[20:23], v[176:179], v[132:135], 0
    v_perm_b32 v158, v69, v65, s22
    v_mfma_f32_16x16x32_bf16 a[52:55], v[180:183], v[132:135], 0
    v_perm_b32 v159, v77, v73, s22
    v_mfma_f32_16x16x32_bf16 a[84:87], v[184:187], v[132:135], 0
    v_mfma_f32_16x16x32_bf16 a[116:119], v[188:191], v[132:135], 0
    v_perm_b32 v160, v54, v50, s21
    v_mfma_f32_16x16x32_bf16 a[148:151], v[192:195], v[132:135], 0
    v_perm_b32 v161, v62, v58, s21
    v_mfma_f32_16x16x32_bf16 a[180:183], v[196:199], v[132:135], 0
    v_perm_b32 v162, v70, v66, s21
    v_mfma_f32_16x16x32_bf16 a[212:215], v[200:203], v[132:135], 0
    v_mfma_f32_16x16x32_bf16 a[244:247], v[204:207], v[132:135], 0
    v_perm_b32 v163, v78, v74, s21
    v_mfma_f32_16x16x32_bf16 a[24:27], v[176:179], v[136:139], 0
    v_perm_b32 v164, v54, v50, s22
    v_mfma_f32_16x16x32_bf16 a[56:59], v[180:183], v[136:139], 0
    v_perm_b32 v165, v62, v58, s22
    v_mfma_f32_16x16x32_bf16 a[88:91], v[184:187], v[136:139], 0
    v_perm_b32 v166, v70, v66, s22
    v_mfma_f32_16x16x32_bf16 a[120:123], v[188:191], v[136:139], 0
    v_mfma_f32_16x16x32_bf16 a[152:155], v[192:195], v[136:139], 0
    v_perm_b32 v167, v78, v74, s22
    v_mfma_f32_16x16x32_bf16 a[184:187], v[196:199], v[136:139], 0
    v_perm_b32 v168, v55, v51, s21
    v_mfma_f32_16x16x32_bf16 a[216:219], v[200:203], v[136:139], 0
    v_perm_b32 v169, v63, v59, s21
    v_mfma_f32_16x16x32_bf16 a[248:251], v[204:207], v[136:139], 0
    v_mfma_f32_16x16x32_bf16 a[28:31], v[176:179], v[140:143], 0
    v_perm_b32 v170, v71, v67, s21
    v_mfma_f32_16x16x32_bf16 a[60:63], v[180:183], v[140:143], 0
    v_perm_b32 v171, v79, v75, s21
    v_mfma_f32_16x16x32_bf16 a[92:95], v[184:187], v[140:143], 0
    v_perm_b32 v172, v55, v51, s22
    v_mfma_f32_16x16x32_bf16 a[124:127], v[188:191], v[140:143], 0
    v_mfma_f32_16x16x32_bf16 a[156:159], v[192:195], v[140:143], 0
    v_perm_b32 v173, v63, v59, s22
    v_mfma_f32_16x16x32_bf16 a[188:191], v[196:199], v[140:143], 0
    v_perm_b32 v174, v71, v67, s22
    v_mfma_f32_16x16x32_bf16 a[220:223], v[200:203], v[140:143], 0
    v_perm_b32 v175, v79, v75, s22
    v_mfma_f32_16x16x32_bf16 a[252:255], v[204:207], v[140:143], 0
    s_waitcnt vmcnt(8) lgkmcnt(0)
    s_nop 1
    v_mfma_f32_16x16x32_bf16 a[0:3], v[208:211], v[144:147], a[0:3]
    buffer_load_dwordx4 v[48:51], v4, s[12:15], s24 offen
    v_mfma_f32_16x16x32_bf16 a[32:35], v[212:215], v[144:147], a[32:35]
    buffer_load_dwordx4 v[52:55], v4, s[12:15], s25 offen
    v_mfma_f32_16x16x32_bf16 a[64:67], v[216:219], v[144:147], a[64:67]
    buffer_load_dwordx4 v[56:59], v4, s[12:15], s26 offen
    v_mfma_f32_16x16x32_bf16 a[96:99], v[220:223], v[144:147], a[96:99]
    buffer_load_dwordx4 v[60:63], v4, s[12:15], s27 offen
    v_mfma_f32_16x16x32_bf16 a[128:131], v[224:227], v[144:147], a[128:131]
    v_mfma_f32_16x16x32_bf16 a[160:163], v[228:231], v[144:147], a[160:163]
    buffer_load_dwordx4 v[64:67], v4, s[12:15], s28 offen
    v_mfma_f32_16x16x32_bf16 a[192:195], v[232:235], v[144:147], a[192:195]
    buffer_load_dwordx4 v[68:71], v4, s[12:15], s29 offen
    v_mfma_f32_16x16x32_bf16 a[224:227], v[236:239], v[144:147], a[224:227]
    buffer_load_dwordx4 v[72:75], v4, s[12:15], s30 offen
    v_mfma_f32_16x16x32_bf16 a[4:7], v[208:211], v[148:151], a[4:7]
    v_mfma_f32_16x16x32_bf16 a[36:39], v[212:215], v[148:151], a[36:39]
    buffer_load_dwordx4 v[76:79], v4, s[12:15], s31 offen
    v_mfma_f32_16x16x32_bf16 a[68:71], v[216:219], v[148:151], a[68:71]
    v_add_u32 v4, s23, v4
    v_mfma_f32_16x16x32_bf16 a[100:103], v[220:223], v[148:151], a[100:103]
    ds_read_b128 v[176:179], v5 offset:2048
    v_mfma_f32_16x16x32_bf16 a[132:135], v[224:227], v[148:151], a[132:135]
    v_mfma_f32_16x16x32_bf16 a[164:167], v[228:231], v[148:151], a[164:167]
    ds_read_b128 v[180:183], v5 offset:18432
    v_mfma_f32_16x16x32_bf16 a[196:199], v[232:235], v[148:151], a[196:199]
    ds_read_b128 v[184:187], v5 offset:34816
    v_mfma_f32_16x16x32_bf16 a[228:231], v[236:239], v[148:151], a[228:231]
    ds_read_b128 v[188:191], v5 offset:51200
    v_mfma_f32_16x16x32_bf16 a[8:11], v[208:211], v[152:155], a[8:11]
    ds_read_b128 v[192:195], v6 offset:2048
    v_mfma_f32_16x16x32_bf16 a[40:43], v[212:215], v[152:155], a[40:43]
    v_mfma_f32_16x16x32_bf16 a[72:75], v[216:219], v[152:155], a[72:75]
    ds_read_b128 v[196:199], v6 offset:18432
    v_mfma_f32_16x16x32_bf16 a[104:107], v[220:223], v[152:155], a[104:107]
    ds_read_b128 v[200:203], v6 offset:34816
    v_mfma_f32_16x16x32_bf16 a[136:139], v[224:227], v[152:155], a[136:139]
    ds_read_b128 v[204:207], v6 offset:51200
    v_mfma_f32_16x16x32_bf16 a[168:171], v[228:231], v[152:155], a[168:171]
    v_mfma_f32_16x16x32_bf16 a[200:203], v[232:235], v[152:155], a[200:203]
    v_perm_b32 v112, v84, v80, s21
    v_mfma_f32_16x16x32_bf16 a[232:235], v[236:239], v[152:155], a[232:235]
    v_perm_b32 v113, v92, v88, s21
    v_mfma_f32_16x16x32_bf16 a[12:15], v[208:211], v[156:159], a[12:15]
    v_perm_b32 v114, v100, v96, s21
    v_mfma_f32_16x16x32_bf16 a[44:47], v[212:215], v[156:159], a[44:47]
    v_mfma_f32_16x16x32_bf16 a[76:79], v[216:219], v[156:159], a[76:79]
    v_perm_b32 v115, v108, v104, s21
    v_mfma_f32_16x16x32_bf16 a[108:111], v[220:223], v[156:159], a[108:111]
    v_perm_b32 v116, v84, v80, s22
    v_mfma_f32_16x16x32_bf16 a[140:143], v[224:227], v[156:159], a[140:143]
    v_perm_b32 v117, v92, v88, s22
    v_mfma_f32_16x16x32_bf16 a[172:175], v[228:231], v[156:159], a[172:175]
    v_mfma_f32_16x16x32_bf16 a[204:207], v[232:235], v[156:159], a[204:207]
    v_perm_b32 v118, v100, v96, s22
    v_mfma_f32_16x16x32_bf16 a[236:239], v[236:239], v[156:159], a[236:239]
    v_perm_b32 v119, v108, v104, s22
    v_mfma_f32_16x16x32_bf16 a[16:19], v[208:211], v[160:163], a[16:19]
    v_perm_b32 v120, v85, v81, s21
    v_mfma_f32_16x16x32_bf16 a[48:51], v[212:215], v[160:163], a[48:51]
    v_perm_b32 v121, v93, v89, s21
    v_mfma_f32_16x16x32_bf16 a[80:83], v[216:219], v[160:163], a[80:83]
    v_mfma_f32_16x16x32_bf16 a[112:115], v[220:223], v[160:163], a[112:115]
    v_perm_b32 v122, v101, v97, s21
    v_mfma_f32_16x16x32_bf16 a[144:147], v[224:227], v[160:163], a[144:147]
    v_perm_b32 v123, v109, v105, s21
    v_mfma_f32_16x16x32_bf16 a[176:179], v[228:231], v[160:163], a[176:179]
    v_perm_b32 v124, v85, v81, s22
    v_mfma_f32_16x16x32_bf16 a[208:211], v[232:235], v[160:163], a[208:211]
    v_mfma_f32_16x16x32_bf16 a[240:243], v[236:239], v[160:163], a[240:243]
    v_perm_b32 v125, v93, v89, s22
    v_mfma_f32_16x16x32_bf16 a[20:23], v[208:211], v[164:167], a[20:23]
    v_perm_b32 v126, v101, v97, s22
    v_mfma_f32_16x16x32_bf16 a[52:55], v[212:215], v[164:167], a[52:55]
    v_perm_b32 v127, v109, v105, s22
    v_mfma_f32_16x16x32_bf16 a[84:87], v[216:219], v[164:167], a[84:87]
    v_mfma_f32_16x16x32_bf16 a[116:119], v[220:223], v[164:167], a[116:119]
    v_perm_b32 v128, v86, v82, s21
    v_mfma_f32_16x16x32_bf16 a[148:151], v[224:227], v[164:167], a[148:151]
    v_perm_b32 v129, v94, v90, s21
    v_mfma_f32_16x16x32_bf16 a[180:183], v[228:231], v[164:167], a[180:183]
    v_perm_b32 v130, v102, v98, s21
    v_mfma_f32_16x16x32_bf16 a[212:215], v[232:235], v[164:167], a[212:215]
    v_mfma_f32_16x16x32_bf16 a[244:247], v[236:239], v[164:167], a[244:247]
    v_perm_b32 v131, v110, v106, s21
    v_mfma_f32_16x16x32_bf16 a[24:27], v[208:211], v[168:171], a[24:27]
    v_perm_b32 v132, v86, v82, s22
    v_mfma_f32_16x16x32_bf16 a[56:59], v[212:215], v[168:171], a[56:59]
    v_perm_b32 v133, v94, v90, s22
    v_mfma_f32_16x16x32_bf16 a[88:91], v[216:219], v[168:171], a[88:91]
    v_perm_b32 v134, v102, v98, s22
    v_mfma_f32_16x16x32_bf16 a[120:123], v[220:223], v[168:171], a[120:123]
    v_mfma_f32_16x16x32_bf16 a[152:155], v[224:227], v[168:171], a[152:155]
    v_perm_b32 v135, v110, v106, s22
    v_mfma_f32_16x16x32_bf16 a[184:187], v[228:231], v[168:171], a[184:187]
    v_perm_b32 v136, v87, v83, s21
    v_mfma_f32_16x16x32_bf16 a[216:219], v[232:235], v[168:171], a[216:219]
    v_perm_b32 v137, v95, v91, s21
    v_mfma_f32_16x16x32_bf16 a[248:251], v[236:239], v[168:171], a[248:251]
    v_mfma_f32_16x16x32_bf16 a[28:31], v[208:211], v[172:175], a[28:31]
    v_perm_b32 v138, v103, v99, s21
    v_mfma_f32_16x16x32_bf16 a[60:63], v[212:215], v[172:175], a[60:63]
    v_perm_b32 v139, v111, v107, s21
    v_mfma_f32_16x16x32_bf16 a[92:95], v[216:219], v[172:175], a[92:95]
    v_perm_b32 v140, v87, v83, s22
    v_mfma_f32_16x16x32_bf16 a[124:127], v[220:223], v[172:175], a[124:127]
    v_mfma_f32_16x16x32_bf16 a[156:159], v[224:227], v[172:175], a[156:159]
    v_perm_b32 v141, v95, v91, s22
    v_mfma_f32_16x16x32_bf16 a[188:191], v[228:231], v[172:175], a[188:191]
    v_perm_b32 v142, v103, v99, s22
    v_mfma_f32_16x16x32_bf16 a[220:223], v[232:235], v[172:175], a[220:223]
    v_perm_b32 v143, v111, v107, s22
    v_mfma_f32_16x16x32_bf16 a[252:255], v[236:239], v[172:175], a[252:255]
    s_waitcnt vmcnt(8) lgkmcnt(0)
    s_nop 1
    v_mfma_f32_16x16x32_bf16 a[0:3], v[176:179], v[112:115], a[0:3]
    buffer_load_dwordx4 v[80:83], v4, s[12:15], s24 offen
    v_mfma_f32_16x16x32_bf16 a[32:35], v[180:183], v[112:115], a[32:35]
    buffer_load_dwordx4 v[84:87], v4, s[12:15], s25 offen
    v_mfma_f32_16x16x32_bf16 a[64:67], v[184:187], v[112:115], a[64:67]
    buffer_load_dwordx4 v[88:91], v4, s[12:15], s26 offen
    v_mfma_f32_16x16x32_bf16 a[96:99], v[188:191], v[112:115], a[96:99]
    buffer_load_dwordx4 v[92:95], v4, s[12:15], s27 offen
    v_mfma_f32_16x16x32_bf16 a[128:131], v[192:195], v[112:115], a[128:131]
    v_mfma_f32_16x16x32_bf16 a[160:163], v[196:199], v[112:115], a[160:163]
    buffer_load_dwordx4 v[96:99], v4, s[12:15], s28 offen
    v_mfma_f32_16x16x32_bf16 a[192:195], v[200:203], v[112:115], a[192:195]
    buffer_load_dwordx4 v[100:103], v4, s[12:15], s29 offen
    v_mfma_f32_16x16x32_bf16 a[224:227], v[204:207], v[112:115], a[224:227]
    buffer_load_dwordx4 v[104:107], v4, s[12:15], s30 offen
    v_mfma_f32_16x16x32_bf16 a[4:7], v[176:179], v[116:119], a[4:7]
    v_mfma_f32_16x16x32_bf16 a[36:39], v[180:183], v[116:119], a[36:39]
    buffer_load_dwordx4 v[108:111], v4, s[12:15], s31 offen
    v_mfma_f32_16x16x32_bf16 a[68:71], v[184:187], v[116:119], a[68:71]
    v_add_u32 v4, s23, v4
    v_mfma_f32_16x16x32_bf16 a[100:103], v[188:191], v[116:119], a[100:103]
    ds_read_b128 v[208:211], v5 offset:3072
    v_mfma_f32_16x16x32_bf16 a[132:135], v[192:195], v[116:119], a[132:135]
    v_mfma_f32_16x16x32_bf16 a[164:167], v[196:199], v[116:119], a[164:167]
    ds_read_b128 v[212:215], v5 offset:19456
    v_mfma_f32_16x16x32_bf16 a[196:199], v[200:203], v[116:119], a[196:199]
    ds_read_b128 v[216:219], v5 offset:35840
    v_mfma_f32_16x16x32_bf16 a[228:231], v[204:207], v[116:119], a[228:231]
    ds_read_b128 v[220:223], v5 offset:52224
    v_mfma_f32_16x16x32_bf16 a[8:11], v[176:179], v[120:123], a[8:11]
    ds_read_b128 v[224:227], v6 offset:3072
    v_mfma_f32_16x16x32_bf16 a[40:43], v[180:183], v[120:123], a[40:43]
    v_mfma_f32_16x16x32_bf16 a[72:75], v[184:187], v[120:123], a[72:75]
    ds_read_b128 v[228:231], v6 offset:19456
    v_mfma_f32_16x16x32_bf16 a[104:107], v[188:191], v[120:123], a[104:107]
    ds_read_b128 v[232:235], v6 offset:35840
    v_mfma_f32_16x16x32_bf16 a[136:139], v[192:195], v[120:123], a[136:139]
    ds_read_b128 v[236:239], v6 offset:52224
    v_mfma_f32_16x16x32_bf16 a[168:171], v[196:199], v[120:123], a[168:171]
    v_mfma_f32_16x16x32_bf16 a[200:203], v[200:203], v[120:123], a[200:203]
    v_perm_b32 v144, v20, v16, s21
    v_mfma_f32_16x16x32_bf16 a[232:235], v[204:207], v[120:123], a[232:235]
    v_perm_b32 v145, v28, v24, s21
    v_mfma_f32_16x16x32_bf16 a[12:15], v[176:179], v[124:127], a[12:15]
    v_perm_b32 v146, v36, v32, s21
    v_mfma_f32_16x16x32_bf16 a[44:47], v[180:183], v[124:127], a[44:47]
    v_mfma_f32_16x16x32_bf16 a[76:79], v[184:187], v[124:127], a[76:79]
    v_perm_b32 v147, v44, v40, s21
    v_mfma_f32_16x16x32_bf16 a[108:111], v[188:191], v[124:127], a[108:111]
    v_perm_b32 v148, v20, v16, s22
    v_mfma_f32_16x16x32_bf16 a[140:143], v[192:195], v[124:127], a[140:143]
    v_perm_b32 v149, v28, v24, s22
    v_mfma_f32_16x16x32_bf16 a[172:175], v[196:199], v[124:127], a[172:175]
    v_mfma_f32_16x16x32_bf16 a[204:207], v[200:203], v[124:127], a[204:207]
    v_perm_b32 v150, v36, v32, s22
    v_mfma_f32_16x16x32_bf16 a[236:239], v[204:207], v[124:127], a[236:239]
    v_perm_b32 v151, v44, v40, s22
    v_mfma_f32_16x16x32_bf16 a[16:19], v[176:179], v[128:131], a[16:19]
    v_perm_b32 v152, v21, v17, s21
    v_mfma_f32_16x16x32_bf16 a[48:51], v[180:183], v[128:131], a[48:51]
    v_perm_b32 v153, v29, v25, s21
    v_mfma_f32_16x16x32_bf16 a[80:83], v[184:187], v[128:131], a[80:83]
    v_mfma_f32_16x16x32_bf16 a[112:115], v[188:191], v[128:131], a[112:115]
    v_perm_b32 v154, v37, v33, s21
    v_mfma_f32_16x16x32_bf16 a[144:147], v[192:195], v[128:131], a[144:147]
    v_perm_b32 v155, v45, v41, s21
    v_mfma_f32_16x16x32_bf16 a[176:179], v[196:199], v[128:131], a[176:179]
    v_perm_b32 v156, v21, v17, s22
    v_mfma_f32_16x16x32_bf16 a[208:211], v[200:203], v[128:131], a[208:211]
    v_mfma_f32_16x16x32_bf16 a[240:243], v[204:207], v[128:131], a[240:243]
    v_perm_b32 v157, v29, v25, s22
    v_mfma_f32_16x16x32_bf16 a[20:23], v[176:179], v[132:135], a[20:23]
    v_perm_b32 v158, v37, v33, s22
    v_mfma_f32_16x16x32_bf16 a[52:55], v[180:183], v[132:135], a[52:55]
    v_perm_b32 v159, v45, v41, s22
    v_mfma_f32_16x16x32_bf16 a[84:87], v[184:187], v[132:135], a[84:87]
    v_mfma_f32_16x16x32_bf16 a[116:119], v[188:191], v[132:135], a[116:119]
    v_perm_b32 v160, v22, v18, s21
    v_mfma_f32_16x16x32_bf16 a[148:151], v[192:195], v[132:135], a[148:151]
    v_perm_b32 v161, v30, v26, s21
    v_mfma_f32_16x16x32_bf16 a[180:183], v[196:199], v[132:135], a[180:183]
    v_perm_b32 v162, v38, v34, s21
    v_mfma_f32_16x16x32_bf16 a[212:215], v[200:203], v[132:135], a[212:215]
    v_mfma_f32_16x16x32_bf16 a[244:247], v[204:207], v[132:135], a[244:247]
    v_perm_b32 v163, v46, v42, s21
    v_mfma_f32_16x16x32_bf16 a[24:27], v[176:179], v[136:139], a[24:27]
    v_perm_b32 v164, v22, v18, s22
    v_mfma_f32_16x16x32_bf16 a[56:59], v[180:183], v[136:139], a[56:59]
    v_perm_b32 v165, v30, v26, s22
    v_mfma_f32_16x16x32_bf16 a[88:91], v[184:187], v[136:139], a[88:91]
    v_perm_b32 v166, v38, v34, s22
    v_mfma_f32_16x16x32_bf16 a[120:123], v[188:191], v[136:139], a[120:123]
    v_mfma_f32_16x16x32_bf16 a[152:155], v[192:195], v[136:139], a[152:155]
    v_perm_b32 v167, v46, v42, s22
    v_mfma_f32_16x16x32_bf16 a[184:187], v[196:199], v[136:139], a[184:187]
    v_perm_b32 v168, v23, v19, s21
    v_mfma_f32_16x16x32_bf16 a[216:219], v[200:203], v[136:139], a[216:219]
    v_perm_b32 v169, v31, v27, s21
    v_mfma_f32_16x16x32_bf16 a[248:251], v[204:207], v[136:139], a[248:251]
    v_mfma_f32_16x16x32_bf16 a[28:31], v[176:179], v[140:143], a[28:31]
    v_perm_b32 v170, v39, v35, s21
    v_mfma_f32_16x16x32_bf16 a[60:63], v[180:183], v[140:143], a[60:63]
    v_perm_b32 v171, v47, v43, s21
    v_mfma_f32_16x16x32_bf16 a[92:95], v[184:187], v[140:143], a[92:95]
    v_perm_b32 v172, v23, v19, s22
    v_mfma_f32_16x16x32_bf16 a[124:127], v[188:191], v[140:143], a[124:127]
    v_mfma_f32_16x16x32_bf16 a[156:159], v[192:195], v[140:143], a[156:159]
    v_perm_b32 v173, v31, v27, s22
    v_mfma_f32_16x16x32_bf16 a[188:191], v[196:199], v[140:143], a[188:191]
    v_perm_b32 v174, v39, v35, s22
    v_mfma_f32_16x16x32_bf16 a[220:223], v[200:203], v[140:143], a[220:223]
    v_perm_b32 v175, v47, v43, s22
    v_mfma_f32_16x16x32_bf16 a[252:255], v[204:207], v[140:143], a[252:255]
    s_waitcnt vmcnt(8) lgkmcnt(0)
    s_nop 1
    v_mfma_f32_16x16x32_bf16 a[0:3], v[208:211], v[144:147], a[0:3]
    buffer_load_dwordx4 v[16:19], v4, s[12:15], s24 offen
    v_mfma_f32_16x16x32_bf16 a[32:35], v[212:215], v[144:147], a[32:35]
    buffer_load_dwordx4 v[20:23], v4, s[12:15], s25 offen
    v_mfma_f32_16x16x32_bf16 a[64:67], v[216:219], v[144:147], a[64:67]
    buffer_load_dwordx4 v[24:27], v4, s[12:15], s26 offen
    v_mfma_f32_16x16x32_bf16 a[96:99], v[220:223], v[144:147], a[96:99]
    buffer_load_dwordx4 v[28:31], v4, s[12:15], s27 offen
    v_mfma_f32_16x16x32_bf16 a[128:131], v[224:227], v[144:147], a[128:131]
    v_mfma_f32_16x16x32_bf16 a[160:163], v[228:231], v[144:147], a[160:163]
    buffer_load_dwordx4 v[32:35], v4, s[12:15], s28 offen
    v_mfma_f32_16x16x32_bf16 a[192:195], v[232:235], v[144:147], a[192:195]
    buffer_load_dwordx4 v[36:39], v4, s[12:15], s29 offen
    v_mfma_f32_16x16x32_bf16 a[224:227], v[236:239], v[144:147], a[224:227]
    buffer_load_dwordx4 v[40:43], v4, s[12:15], s30 offen
    v_mfma_f32_16x16x32_bf16 a[4:7], v[208:211], v[148:151], a[4:7]
    v_mfma_f32_16x16x32_bf16 a[36:39], v[212:215], v[148:151], a[36:39]
    buffer_load_dwordx4 v[44:47], v4, s[12:15], s31 offen
    v_mfma_f32_16x16x32_bf16 a[68:71], v[216:219], v[148:151], a[68:71]
    v_add_u32 v4, s23, v4
    v_mfma_f32_16x16x32_bf16 a[100:103], v[220:223], v[148:151], a[100:103]
    ds_read_b128 v[176:179], v5 offset:4096
    v_mfma_f32_16x16x32_bf16 a[132:135], v[224:227], v[148:151], a[132:135]
    v_mfma_f32_16x16x32_bf16 a[164:167], v[228:231], v[148:151], a[164:167]
    ds_read_b128 v[180:183], v5 offset:20480
    v_mfma_f32_16x16x32_bf16 a[196:199], v[232:235], v[148:151], a[196:199]
    ds_read_b128 v[184:187], v5 offset:36864
    v_mfma_f32_16x16x32_bf16 a[228:231], v[236:239], v[148:151], a[228:231]
    ds_read_b128 v[188:191], v5 offset:53248
    v_mfma_f32_16x16x32_bf16 a[8:11], v[208:211], v[152:155], a[8:11]
    ds_read_b128 v[192:195], v6 offset:4096
    v_mfma_f32_16x16x32_bf16 a[40:43], v[212:215], v[152:155], a[40:43]
    v_mfma_f32_16x16x32_bf16 a[72:75], v[216:219], v[152:155], a[72:75]
    ds_read_b128 v[196:199], v6 offset:20480
    v_mfma_f32_16x16x32_bf16 a[104:107], v[220:223], v[152:155], a[104:107]
    ds_read_b128 v[200:203], v6 offset:36864
    v_mfma_f32_16x16x32_bf16 a[136:139], v[224:227], v[152:155], a[136:139]
    ds_read_b128 v[204:207], v6 offset:53248
    v_mfma_f32_16x16x32_bf16 a[168:171], v[228:231], v[152:155], a[168:171]
    v_mfma_f32_16x16x32_bf16 a[200:203], v[232:235], v[152:155], a[200:203]
    v_perm_b32 v112, v52, v48, s21
    v_mfma_f32_16x16x32_bf16 a[232:235], v[236:239], v[152:155], a[232:235]
    v_perm_b32 v113, v60, v56, s21
    v_mfma_f32_16x16x32_bf16 a[12:15], v[208:211], v[156:159], a[12:15]
    v_perm_b32 v114, v68, v64, s21
    v_mfma_f32_16x16x32_bf16 a[44:47], v[212:215], v[156:159], a[44:47]
    v_mfma_f32_16x16x32_bf16 a[76:79], v[216:219], v[156:159], a[76:79]
    v_perm_b32 v115, v76, v72, s21
    v_mfma_f32_16x16x32_bf16 a[108:111], v[220:223], v[156:159], a[108:111]
    v_perm_b32 v116, v52, v48, s22
    v_mfma_f32_16x16x32_bf16 a[140:143], v[224:227], v[156:159], a[140:143]
    v_perm_b32 v117, v60, v56, s22
    v_mfma_f32_16x16x32_bf16 a[172:175], v[228:231], v[156:159], a[172:175]
    v_mfma_f32_16x16x32_bf16 a[204:207], v[232:235], v[156:159], a[204:207]
    v_perm_b32 v118, v68, v64, s22
    v_mfma_f32_16x16x32_bf16 a[236:239], v[236:239], v[156:159], a[236:239]
    v_perm_b32 v119, v76, v72, s22
    v_mfma_f32_16x16x32_bf16 a[16:19], v[208:211], v[160:163], a[16:19]
    v_perm_b32 v120, v53, v49, s21
    v_mfma_f32_16x16x32_bf16 a[48:51], v[212:215], v[160:163], a[48:51]
    v_perm_b32 v121, v61, v57, s21
    v_mfma_f32_16x16x32_bf16 a[80:83], v[216:219], v[160:163], a[80:83]
    v_mfma_f32_16x16x32_bf16 a[112:115], v[220:223], v[160:163], a[112:115]
    v_perm_b32 v122, v69, v65, s21
    v_mfma_f32_16x16x32_bf16 a[144:147], v[224:227], v[160:163], a[144:147]
    v_perm_b32 v123, v77, v73, s21
    v_mfma_f32_16x16x32_bf16 a[176:179], v[228:231], v[160:163], a[176:179]
    v_perm_b32 v124, v53, v49, s22
    v_mfma_f32_16x16x32_bf16 a[208:211], v[232:235], v[160:163], a[208:211]
    v_mfma_f32_16x16x32_bf16 a[240:243], v[236:239], v[160:163], a[240:243]
    v_perm_b32 v125, v61, v57, s22
    v_mfma_f32_16x16x32_bf16 a[20:23], v[208:211], v[164:167], a[20:23]
    v_perm_b32 v126, v69, v65, s22
    v_mfma_f32_16x16x32_bf16 a[52:55], v[212:215], v[164:167], a[52:55]
    v_perm_b32 v127, v77, v73, s22
    v_mfma_f32_16x16x32_bf16 a[84:87], v[216:219], v[164:167], a[84:87]
    v_mfma_f32_16x16x32_bf16 a[116:119], v[220:223], v[164:167], a[116:119]
    v_perm_b32 v128, v54, v50, s21
    v_mfma_f32_16x16x32_bf16 a[148:151], v[224:227], v[164:167], a[148:151]
    v_perm_b32 v129, v62, v58, s21
    v_mfma_f32_16x16x32_bf16 a[180:183], v[228:231], v[164:167], a[180:183]
    v_perm_b32 v130, v70, v66, s21
    v_mfma_f32_16x16x32_bf16 a[212:215], v[232:235], v[164:167], a[212:215]
    v_mfma_f32_16x16x32_bf16 a[244:247], v[236:239], v[164:167], a[244:247]
    v_perm_b32 v131, v78, v74, s21
    v_mfma_f32_16x16x32_bf16 a[24:27], v[208:211], v[168:171], a[24:27]
    v_perm_b32 v132, v54, v50, s22
    v_mfma_f32_16x16x32_bf16 a[56:59], v[212:215], v[168:171], a[56:59]
    v_perm_b32 v133, v62, v58, s22
    v_mfma_f32_16x16x32_bf16 a[88:91], v[216:219], v[168:171], a[88:91]
    v_perm_b32 v134, v70, v66, s22
    v_mfma_f32_16x16x32_bf16 a[120:123], v[220:223], v[168:171], a[120:123]
    v_mfma_f32_16x16x32_bf16 a[152:155], v[224:227], v[168:171], a[152:155]
    v_perm_b32 v135, v78, v74, s22
    v_mfma_f32_16x16x32_bf16 a[184:187], v[228:231], v[168:171], a[184:187]
    v_perm_b32 v136, v55, v51, s21
    v_mfma_f32_16x16x32_bf16 a[216:219], v[232:235], v[168:171], a[216:219]
    v_perm_b32 v137, v63, v59, s21
    v_mfma_f32_16x16x32_bf16 a[248:251], v[236:239], v[168:171], a[248:251]
    v_mfma_f32_16x16x32_bf16 a[28:31], v[208:211], v[172:175], a[28:31]
    v_perm_b32 v138, v71, v67, s21
    v_mfma_f32_16x16x32_bf16 a[60:63], v[212:215], v[172:175], a[60:63]
    v_perm_b32 v139, v79, v75, s21
    v_mfma_f32_16x16x32_bf16 a[92:95], v[216:219], v[172:175], a[92:95]
    v_perm_b32 v140, v55, v51, s22
    v_mfma_f32_16x16x32_bf16 a[124:127], v[220:223], v[172:175], a[124:127]
    v_mfma_f32_16x16x32_bf16 a[156:159], v[224:227], v[172:175], a[156:159]
    v_perm_b32 v141, v63, v59, s22
    v_mfma_f32_16x16x32_bf16 a[188:191], v[228:231], v[172:175], a[188:191]
    v_perm_b32 v142, v71, v67, s22
    v_mfma_f32_16x16x32_bf16 a[220:223], v[232:235], v[172:175], a[220:223]
    v_perm_b32 v143, v79, v75, s22
    v_mfma_f32_16x16x32_bf16 a[252:255], v[236:239], v[172:175], a[252:255]
    s_waitcnt vmcnt(8) lgkmcnt(0)
    s_nop 1
    v_mfma_f32_16x16x32_bf16 a[0:3], v[176:179], v[112:115], a[0:3]
    buffer_load_dwordx4 v[48:51], v4, s[12:15], s24 offen
    v_mfma_f32_16x16x32_bf16 a[32:35], v[180:183], v[112:115], a[32:35]
    buffer_load_dwordx4 v[52:55], v4, s[12:15], s25 offen
    v_mfma_f32_16x16x32_bf16 a[64:67], v[184:187], v[112:115], a[64:67]
    buffer_load_dwordx4 v[56:59], v4, s[12:15], s26 offen
    v_mfma_f32_16x16x32_bf16 a[96:99], v[188:191], v[112:115], a[96:99]
    buffer_load_dwordx4 v[60:63], v4, s[12:15], s27 offen
    v_mfma_f32_16x16x32_bf16 a[128:131], v[192:195], v[112:115], a[128:131]
    v_mfma_f32_16x16x32_bf16 a[160:163], v[196:199], v[112:115], a[160:163]
    buffer_load_dwordx4 v[64:67], v4, s[12:15], s28 offen
    v_mfma_f32_16x16x32_bf16 a[192:195], v[200:203], v[112:115], a[192:195]
    buffer_load_dwordx4 v[68:71], v4, s[12:15], s29 offen
    v_mfma_f32_16x16x32_bf16 a[224:227], v[204:207], v[112:115], a[224:227]
    buffer_load_dwordx4 v[72:75], v4, s[12:15], s30 offen
    v_mfma_f32_16x16x32_bf16 a[4:7], v[176:179], v[116:119], a[4:7]
    v_mfma_f32_16x16x32_bf16 a[36:39], v[180:183], v[116:119], a[36:39]
    buffer_load_dwordx4 v[76:79], v4, s[12:15], s31 offen
    v_mfma_f32_16x16x32_bf16 a[68:71], v[184:187], v[116:119], a[68:71]
    v_add_u32 v4, s23, v4
    v_mfma_f32_16x16x32_bf16 a[100:103], v[188:191], v[116:119], a[100:103]
    ds_read_b128 v[208:211], v5 offset:5120
    v_mfma_f32_16x16x32_bf16 a[132:135], v[192:195], v[116:119], a[132:135]
    v_mfma_f32_16x16x32_bf16 a[164:167], v[196:199], v[116:119], a[164:167]
    ds_read_b128 v[212:215], v5 offset:21504
    v_mfma_f32_16x16x32_bf16 a[196:199], v[200:203], v[116:119], a[196:199]
    ds_read_b128 v[216:219], v5 offset:37888
    v_mfma_f32_16x16x32_bf16 a[228:231], v[204:207], v[116:119], a[228:231]
    ds_read_b128 v[220:223], v5 offset:54272
    v_mfma_f32_16x16x32_bf16 a[8:11], v[176:179], v[120:123], a[8:11]
    ds_read_b128 v[224:227], v6 offset:5120
    v_mfma_f32_16x16x32_bf16 a[40:43], v[180:183], v[120:123], a[40:43]
    v_mfma_f32_16x16x32_bf16 a[72:75], v[184:187], v[120:123], a[72:75]
    ds_read_b128 v[228:231], v6 offset:21504
    v_mfma_f32_16x16x32_bf16 a[104:107], v[188:191], v[120:123], a[104:107]
    ds_read_b128 v[232:235], v6 offset:37888
    v_mfma_f32_16x16x32_bf16 a[136:139], v[192:195], v[120:123], a[136:139]
    ds_read_b128 v[236:239], v6 offset:54272
    v_mfma_f32_16x16x32_bf16 a[168:171], v[196:199], v[120:123], a[168:171]
    v_mfma_f32_16x16x32_bf16 a[200:203], v[200:203], v[120:123], a[200:203]
    v_perm_b32 v144, v84, v80, s21
    v_mfma_f32_16x16x32_bf16 a[232:235], v[204:207], v[120:123], a[232:235]
    v_perm_b32 v145, v92, v88, s21
    v_mfma_f32_16x16x32_bf16 a[12:15], v[176:179], v[124:127], a[12:15]
    v_perm_b32 v146, v100, v96, s21
    v_mfma_f32_16x16x32_bf16 a[44:47], v[180:183], v[124:127], a[44:47]
    v_mfma_f32_16x16x32_bf16 a[76:79], v[184:187], v[124:127], a[76:79]
    v_perm_b32 v147, v108, v104, s21
    v_mfma_f32_16x16x32_bf16 a[108:111], v[188:191], v[124:127], a[108:111]
    v_perm_b32 v148, v84, v80, s22
    v_mfma_f32_16x16x32_bf16 a[140:143], v[192:195], v[124:127], a[140:143]
    v_perm_b32 v149, v92, v88, s22
    v_mfma_f32_16x16x32_bf16 a[172:175], v[196:199], v[124:127], a[172:175]
    v_mfma_f32_16x16x32_bf16 a[204:207], v[200:203], v[124:127], a[204:207]
    v_perm_b32 v150, v100, v96, s22
    v_mfma_f32_16x16x32_bf16 a[236:239], v[204:207], v[124:127], a[236:239]
    v_perm_b32 v151, v108, v104, s22
    v_mfma_f32_16x16x32_bf16 a[16:19], v[176:179], v[128:131], a[16:19]
    v_perm_b32 v152, v85, v81, s21
    v_mfma_f32_16x16x32_bf16 a[48:51], v[180:183], v[128:131], a[48:51]
    v_perm_b32 v153, v93, v89, s21
    v_mfma_f32_16x16x32_bf16 a[80:83], v[184:187], v[128:131], a[80:83]
    v_mfma_f32_16x16x32_bf16 a[112:115], v[188:191], v[128:131], a[112:115]
    v_perm_b32 v154, v101, v97, s21
    v_mfma_f32_16x16x32_bf16 a[144:147], v[192:195], v[128:131], a[144:147]
    v_perm_b32 v155, v109, v105, s21
    v_mfma_f32_16x16x32_bf16 a[176:179], v[196:199], v[128:131], a[176:179]
    v_perm_b32 v156, v85, v81, s22
    v_mfma_f32_16x16x32_bf16 a[208:211], v[200:203], v[128:131], a[208:211]
    v_mfma_f32_16x16x32_bf16 a[240:243], v[204:207], v[128:131], a[240:243]
    v_perm_b32 v157, v93, v89, s22
    v_mfma_f32_16x16x32_bf16 a[20:23], v[176:179], v[132:135], a[20:23]
    v_perm_b32 v158, v101, v97, s22
    v_mfma_f32_16x16x32_bf16 a[52:55], v[180:183], v[132:135], a[52:55]
    v_perm_b32 v159, v109, v105, s22
    v_mfma_f32_16x16x32_bf16 a[84:87], v[184:187], v[132:135], a[84:87]
    v_mfma_f32_16x16x32_bf16 a[116:119], v[188:191], v[132:135], a[116:119]
    v_perm_b32 v160, v86, v82, s21
    v_mfma_f32_16x16x32_bf16 a[148:151], v[192:195], v[132:135], a[148:151]
    v_perm_b32 v161, v94, v90, s21
    v_mfma_f32_16x16x32_bf16 a[180:183], v[196:199], v[132:135], a[180:183]
    v_perm_b32 v162, v102, v98, s21
    v_mfma_f32_16x16x32_bf16 a[212:215], v[200:203], v[132:135], a[212:215]
    v_mfma_f32_16x16x32_bf16 a[244:247], v[204:207], v[132:135], a[244:247]
    v_perm_b32 v163, v110, v106, s21
    v_mfma_f32_16x16x32_bf16 a[24:27], v[176:179], v[136:139], a[24:27]
    v_perm_b32 v164, v86, v82, s22
    v_mfma_f32_16x16x32_bf16 a[56:59], v[180:183], v[136:139], a[56:59]
    v_perm_b32 v165, v94, v90, s22
    v_mfma_f32_16x16x32_bf16 a[88:91], v[184:187], v[136:139], a[88:91]
    v_perm_b32 v166, v102, v98, s22
    v_mfma_f32_16x16x32_bf16 a[120:123], v[188:191], v[136:139], a[120:123]
    v_mfma_f32_16x16x32_bf16 a[152:155], v[192:195], v[136:139], a[152:155]
    v_perm_b32 v167, v110, v106, s22
    v_mfma_f32_16x16x32_bf16 a[184:187], v[196:199], v[136:139], a[184:187]
    v_perm_b32 v168, v87, v83, s21
    v_mfma_f32_16x16x32_bf16 a[216:219], v[200:203], v[136:139], a[216:219]
    v_perm_b32 v169, v95, v91, s21
    v_mfma_f32_16x16x32_bf16 a[248:251], v[204:207], v[136:139], a[248:251]
    v_mfma_f32_16x16x32_bf16 a[28:31], v[176:179], v[140:143], a[28:31]
    v_perm_b32 v170, v103, v99, s21
    v_mfma_f32_16x16x32_bf16 a[60:63], v[180:183], v[140:143], a[60:63]
    v_perm_b32 v171, v111, v107, s21
    v_mfma_f32_16x16x32_bf16 a[92:95], v[184:187], v[140:143], a[92:95]
    v_perm_b32 v172, v87, v83, s22
    v_mfma_f32_16x16x32_bf16 a[124:127], v[188:191], v[140:143], a[124:127]
    v_mfma_f32_16x16x32_bf16 a[156:159], v[192:195], v[140:143], a[156:159]
    v_perm_b32 v173, v95, v91, s22
    v_mfma_f32_16x16x32_bf16 a[188:191], v[196:199], v[140:143], a[188:191]
    v_perm_b32 v174, v103, v99, s22
    v_mfma_f32_16x16x32_bf16 a[220:223], v[200:203], v[140:143], a[220:223]
    v_perm_b32 v175, v111, v107, s22
    v_mfma_f32_16x16x32_bf16 a[252:255], v[204:207], v[140:143], a[252:255]
    s_waitcnt vmcnt(8) lgkmcnt(0)
    s_nop 1
    v_mfma_f32_16x16x32_bf16 a[0:3], v[208:211], v[144:147], a[0:3]
    buffer_load_dwordx4 v[80:83], v4, s[12:15], s24 offen
    v_mfma_f32_16x16x32_bf16 a[32:35], v[212:215], v[144:147], a[32:35]
    buffer_load_dwordx4 v[84:87], v4, s[12:15], s25 offen
    v_mfma_f32_16x16x32_bf16 a[64:67], v[216:219], v[144:147], a[64:67]
    buffer_load_dwordx4 v[88:91], v4, s[12:15], s26 offen
    v_mfma_f32_16x16x32_bf16 a[96:99], v[220:223], v[144:147], a[96:99]
    buffer_load_dwordx4 v[92:95], v4, s[12:15], s27 offen
    v_mfma_f32_16x16x32_bf16 a[128:131], v[224:227], v[144:147], a[128:131]
    v_mfma_f32_16x16x32_bf16 a[160:163], v[228:231], v[144:147], a[160:163]
    buffer_load_dwordx4 v[96:99], v4, s[12:15], s28 offen
    v_mfma_f32_16x16x32_bf16 a[192:195], v[232:235], v[144:147], a[192:195]
    buffer_load_dwordx4 v[100:103], v4, s[12:15], s29 offen
    v_mfma_f32_16x16x32_bf16 a[224:227], v[236:239], v[144:147], a[224:227]
    buffer_load_dwordx4 v[104:107], v4, s[12:15], s30 offen
    v_mfma_f32_16x16x32_bf16 a[4:7], v[208:211], v[148:151], a[4:7]
    v_mfma_f32_16x16x32_bf16 a[36:39], v[212:215], v[148:151], a[36:39]
    buffer_load_dwordx4 v[108:111], v4, s[12:15], s31 offen
    v_mfma_f32_16x16x32_bf16 a[68:71], v[216:219], v[148:151], a[68:71]
    v_add_u32 v4, s23, v4
    v_mfma_f32_16x16x32_bf16 a[100:103], v[220:223], v[148:151], a[100:103]
    ds_read_b128 v[176:179], v5 offset:6144
    v_mfma_f32_16x16x32_bf16 a[132:135], v[224:227], v[148:151], a[132:135]
    v_mfma_f32_16x16x32_bf16 a[164:167], v[228:231], v[148:151], a[164:167]
    ds_read_b128 v[180:183], v5 offset:22528
    v_mfma_f32_16x16x32_bf16 a[196:199], v[232:235], v[148:151], a[196:199]
    ds_read_b128 v[184:187], v5 offset:38912
    v_mfma_f32_16x16x32_bf16 a[228:231], v[236:239], v[148:151], a[228:231]
    ds_read_b128 v[188:191], v5 offset:55296
    v_mfma_f32_16x16x32_bf16 a[8:11], v[208:211], v[152:155], a[8:11]
    ds_read_b128 v[192:195], v6 offset:6144
    v_mfma_f32_16x16x32_bf16 a[40:43], v[212:215], v[152:155], a[40:43]
    v_mfma_f32_16x16x32_bf16 a[72:75], v[216:219], v[152:155], a[72:75]
    ds_read_b128 v[196:199], v6 offset:22528
    v_mfma_f32_16x16x32_bf16 a[104:107], v[220:223], v[152:155], a[104:107]
    ds_read_b128 v[200:203], v6 offset:38912
    v_mfma_f32_16x16x32_bf16 a[136:139], v[224:227], v[152:155], a[136:139]
    ds_read_b128 v[204:207], v6 offset:55296
    v_mfma_f32_16x16x32_bf16 a[168:171], v[228:231], v[152:155], a[168:171]
    v_mfma_f32_16x16x32_bf16 a[200:203], v[232:235], v[152:155], a[200:203]
    v_perm_b32 v112, v20, v16, s21
    v_mfma_f32_16x16x32_bf16 a[232:235], v[236:239], v[152:155], a[232:235]
    v_perm_b32 v113, v28, v24, s21
    v_mfma_f32_16x16x32_bf16 a[12:15], v[208:211], v[156:159], a[12:15]
    v_perm_b32 v114, v36, v32, s21
    v_mfma_f32_16x16x32_bf16 a[44:47], v[212:215], v[156:159], a[44:47]
    v_mfma_f32_16x16x32_bf16 a[76:79], v[216:219], v[156:159], a[76:79]
    v_perm_b32 v115, v44, v40, s21
    v_mfma_f32_16x16x32_bf16 a[108:111], v[220:223], v[156:159], a[108:111]
    v_perm_b32 v116, v20, v16, s22
    v_mfma_f32_16x16x32_bf16 a[140:143], v[224:227], v[156:159], a[140:143]
    v_perm_b32 v117, v28, v24, s22
    v_mfma_f32_16x16x32_bf16 a[172:175], v[228:231], v[156:159], a[172:175]
    v_mfma_f32_16x16x32_bf16 a[204:207], v[232:235], v[156:159], a[204:207]
    v_perm_b32 v118, v36, v32, s22
    v_mfma_f32_16x16x32_bf16 a[236:239], v[236:239], v[156:159], a[236:239]
    v_perm_b32 v119, v44, v40, s22
    v_mfma_f32_16x16x32_bf16 a[16:19], v[208:211], v[160:163], a[16:19]
    v_perm_b32 v120, v21, v17, s21
    v_mfma_f32_16x16x32_bf16 a[48:51], v[212:215], v[160:163], a[48:51]
    v_perm_b32 v121, v29, v25, s21
    v_mfma_f32_16x16x32_bf16 a[80:83], v[216:219], v[160:163], a[80:83]
    v_mfma_f32_16x16x32_bf16 a[112:115], v[220:223], v[160:163], a[112:115]
    v_perm_b32 v122, v37, v33, s21
    v_mfma_f32_16x16x32_bf16 a[144:147], v[224:227], v[160:163], a[144:147]
    v_perm_b32 v123, v45, v41, s21
    v_mfma_f32_16x16x32_bf16 a[176:179], v[228:231], v[160:163], a[176:179]
    v_perm_b32 v124, v21, v17, s22
    v_mfma_f32_16x16x32_bf16 a[208:211], v[232:235], v[160:163], a[208:211]
    v_mfma_f32_16x16x32_bf16 a[240:243], v[236:239], v[160:163], a[240:243]
    v_perm_b32 v125, v29, v25, s22
    v_mfma_f32_16x16x32_bf16 a[20:23], v[208:211], v[164:167], a[20:23]
    v_perm_b32 v126, v37, v33, s22
    v_mfma_f32_16x16x32_bf16 a[52:55], v[212:215], v[164:167], a[52:55]
    v_perm_b32 v127, v45, v41, s22
    v_mfma_f32_16x16x32_bf16 a[84:87], v[216:219], v[164:167], a[84:87]
    v_mfma_f32_16x16x32_bf16 a[116:119], v[220:223], v[164:167], a[116:119]
    v_perm_b32 v128, v22, v18, s21
    v_mfma_f32_16x16x32_bf16 a[148:151], v[224:227], v[164:167], a[148:151]
    v_perm_b32 v129, v30, v26, s21
    v_mfma_f32_16x16x32_bf16 a[180:183], v[228:231], v[164:167], a[180:183]
    v_perm_b32 v130, v38, v34, s21
    v_mfma_f32_16x16x32_bf16 a[212:215], v[232:235], v[164:167], a[212:215]
    v_mfma_f32_16x16x32_bf16 a[244:247], v[236:239], v[164:167], a[244:247]
    v_perm_b32 v131, v46, v42, s21
    v_mfma_f32_16x16x32_bf16 a[24:27], v[208:211], v[168:171], a[24:27]
    v_perm_b32 v132, v22, v18, s22
    v_mfma_f32_16x16x32_bf16 a[56:59], v[212:215], v[168:171], a[56:59]
    v_perm_b32 v133, v30, v26, s22
    v_mfma_f32_16x16x32_bf16 a[88:91], v[216:219], v[168:171], a[88:91]
    v_perm_b32 v134, v38, v34, s22
    v_mfma_f32_16x16x32_bf16 a[120:123], v[220:223], v[168:171], a[120:123]
    v_mfma_f32_16x16x32_bf16 a[152:155], v[224:227], v[168:171], a[152:155]
    v_perm_b32 v135, v46, v42, s22
    v_mfma_f32_16x16x32_bf16 a[184:187], v[228:231], v[168:171], a[184:187]
    v_perm_b32 v136, v23, v19, s21
    v_mfma_f32_16x16x32_bf16 a[216:219], v[232:235], v[168:171], a[216:219]
    v_perm_b32 v137, v31, v27, s21
    v_mfma_f32_16x16x32_bf16 a[248:251], v[236:239], v[168:171], a[248:251]
    v_mfma_f32_16x16x32_bf16 a[28:31], v[208:211], v[172:175], a[28:31]
    v_perm_b32 v138, v39, v35, s21
    v_mfma_f32_16x16x32_bf16 a[60:63], v[212:215], v[172:175], a[60:63]
    v_perm_b32 v139, v47, v43, s21
    v_mfma_f32_16x16x32_bf16 a[92:95], v[216:219], v[172:175], a[92:95]
    v_perm_b32 v140, v23, v19, s22
    v_mfma_f32_16x16x32_bf16 a[124:127], v[220:223], v[172:175], a[124:127]
    v_mfma_f32_16x16x32_bf16 a[156:159], v[224:227], v[172:175], a[156:159]
    v_perm_b32 v141, v31, v27, s22
    v_mfma_f32_16x16x32_bf16 a[188:191], v[228:231], v[172:175], a[188:191]
    v_perm_b32 v142, v39, v35, s22
    v_mfma_f32_16x16x32_bf16 a[220:223], v[232:235], v[172:175], a[220:223]
    v_perm_b32 v143, v47, v43, s22
    v_mfma_f32_16x16x32_bf16 a[252:255], v[236:239], v[172:175], a[252:255]
    s_waitcnt vmcnt(8) lgkmcnt(0)
    s_nop 1
    v_mfma_f32_16x16x32_bf16 a[0:3], v[176:179], v[112:115], a[0:3]
    buffer_load_dwordx4 v[16:19], v4, s[12:15], s24 offen
    v_mfma_f32_16x16x32_bf16 a[32:35], v[180:183], v[112:115], a[32:35]
    buffer_load_dwordx4 v[20:23], v4, s[12:15], s25 offen
    v_mfma_f32_16x16x32_bf16 a[64:67], v[184:187], v[112:115], a[64:67]
    buffer_load_dwordx4 v[24:27], v4, s[12:15], s26 offen
    v_mfma_f32_16x16x32_bf16 a[96:99], v[188:191], v[112:115], a[96:99]
    buffer_load_dwordx4 v[28:31], v4, s[12:15], s27 offen
    v_mfma_f32_16x16x32_bf16 a[128:131], v[192:195], v[112:115], a[128:131]
    v_mfma_f32_16x16x32_bf16 a[160:163], v[196:199], v[112:115], a[160:163]
    buffer_load_dwordx4 v[32:35], v4, s[12:15], s28 offen
    v_mfma_f32_16x16x32_bf16 a[192:195], v[200:203], v[112:115], a[192:195]
    buffer_load_dwordx4 v[36:39], v4, s[12:15], s29 offen
    v_mfma_f32_16x16x32_bf16 a[224:227], v[204:207], v[112:115], a[224:227]
    buffer_load_dwordx4 v[40:43], v4, s[12:15], s30 offen
    v_mfma_f32_16x16x32_bf16 a[4:7], v[176:179], v[116:119], a[4:7]
    v_mfma_f32_16x16x32_bf16 a[36:39], v[180:183], v[116:119], a[36:39]
    buffer_load_dwordx4 v[44:47], v4, s[12:15], s31 offen
    v_mfma_f32_16x16x32_bf16 a[68:71], v[184:187], v[116:119], a[68:71]
    v_add_u32 v4, s23, v4
    v_mfma_f32_16x16x32_bf16 a[100:103], v[188:191], v[116:119], a[100:103]
    ds_read_b128 v[208:211], v5 offset:7168
    v_mfma_f32_16x16x32_bf16 a[132:135], v[192:195], v[116:119], a[132:135]
    v_mfma_f32_16x16x32_bf16 a[164:167], v[196:199], v[116:119], a[164:167]
    ds_read_b128 v[212:215], v5 offset:23552
    v_mfma_f32_16x16x32_bf16 a[196:199], v[200:203], v[116:119], a[196:199]
    ds_read_b128 v[216:219], v5 offset:39936
    v_mfma_f32_16x16x32_bf16 a[228:231], v[204:207], v[116:119], a[228:231]
    ds_read_b128 v[220:223], v5 offset:56320
    v_mfma_f32_16x16x32_bf16 a[8:11], v[176:179], v[120:123], a[8:11]
    ds_read_b128 v[224:227], v6 offset:7168
    v_mfma_f32_16x16x32_bf16 a[40:43], v[180:183], v[120:123], a[40:43]
    v_mfma_f32_16x16x32_bf16 a[72:75], v[184:187], v[120:123], a[72:75]
    ds_read_b128 v[228:231], v6 offset:23552
    v_mfma_f32_16x16x32_bf16 a[104:107], v[188:191], v[120:123], a[104:107]
    ds_read_b128 v[232:235], v6 offset:39936
    v_mfma_f32_16x16x32_bf16 a[136:139], v[192:195], v[120:123], a[136:139]
    ds_read_b128 v[236:239], v6 offset:56320
    v_mfma_f32_16x16x32_bf16 a[168:171], v[196:199], v[120:123], a[168:171]
    v_mfma_f32_16x16x32_bf16 a[200:203], v[200:203], v[120:123], a[200:203]
    v_perm_b32 v144, v52, v48, s21
    v_mfma_f32_16x16x32_bf16 a[232:235], v[204:207], v[120:123], a[232:235]
    v_perm_b32 v145, v60, v56, s21
    v_mfma_f32_16x16x32_bf16 a[12:15], v[176:179], v[124:127], a[12:15]
    v_perm_b32 v146, v68, v64, s21
    v_mfma_f32_16x16x32_bf16 a[44:47], v[180:183], v[124:127], a[44:47]
    v_mfma_f32_16x16x32_bf16 a[76:79], v[184:187], v[124:127], a[76:79]
    v_perm_b32 v147, v76, v72, s21
    v_mfma_f32_16x16x32_bf16 a[108:111], v[188:191], v[124:127], a[108:111]
    v_perm_b32 v148, v52, v48, s22
    v_mfma_f32_16x16x32_bf16 a[140:143], v[192:195], v[124:127], a[140:143]
    v_perm_b32 v149, v60, v56, s22
    v_mfma_f32_16x16x32_bf16 a[172:175], v[196:199], v[124:127], a[172:175]
    v_mfma_f32_16x16x32_bf16 a[204:207], v[200:203], v[124:127], a[204:207]
    v_perm_b32 v150, v68, v64, s22
    v_mfma_f32_16x16x32_bf16 a[236:239], v[204:207], v[124:127], a[236:239]
    v_perm_b32 v151, v76, v72, s22
    v_mfma_f32_16x16x32_bf16 a[16:19], v[176:179], v[128:131], a[16:19]
    v_perm_b32 v152, v53, v49, s21
    v_mfma_f32_16x16x32_bf16 a[48:51], v[180:183], v[128:131], a[48:51]
    v_perm_b32 v153, v61, v57, s21
    v_mfma_f32_16x16x32_bf16 a[80:83], v[184:187], v[128:131], a[80:83]
    v_mfma_f32_16x16x32_bf16 a[112:115], v[188:191], v[128:131], a[112:115]
    v_perm_b32 v154, v69, v65, s21
    v_mfma_f32_16x16x32_bf16 a[144:147], v[192:195], v[128:131], a[144:147]
    v_perm_b32 v155, v77, v73, s21
    v_mfma_f32_16x16x32_bf16 a[176:179], v[196:199], v[128:131], a[176:179]
    v_perm_b32 v156, v53, v49, s22
    v_mfma_f32_16x16x32_bf16 a[208:211], v[200:203], v[128:131], a[208:211]
    v_mfma_f32_16x16x32_bf16 a[240:243], v[204:207], v[128:131], a[240:243]
    v_perm_b32 v157, v61, v57, s22
    v_mfma_f32_16x16x32_bf16 a[20:23], v[176:179], v[132:135], a[20:23]
    v_perm_b32 v158, v69, v65, s22
    v_mfma_f32_16x16x32_bf16 a[52:55], v[180:183], v[132:135], a[52:55]
    v_perm_b32 v159, v77, v73, s22
    v_mfma_f32_16x16x32_bf16 a[84:87], v[184:187], v[132:135], a[84:87]
    v_mfma_f32_16x16x32_bf16 a[116:119], v[188:191], v[132:135], a[116:119]
    v_perm_b32 v160, v54, v50, s21
    v_mfma_f32_16x16x32_bf16 a[148:151], v[192:195], v[132:135], a[148:151]
    v_perm_b32 v161, v62, v58, s21
    v_mfma_f32_16x16x32_bf16 a[180:183], v[196:199], v[132:135], a[180:183]
    v_perm_b32 v162, v70, v66, s21
    v_mfma_f32_16x16x32_bf16 a[212:215], v[200:203], v[132:135], a[212:215]
    v_mfma_f32_16x16x32_bf16 a[244:247], v[204:207], v[132:135], a[244:247]
    v_perm_b32 v163, v78, v74, s21
    v_mfma_f32_16x16x32_bf16 a[24:27], v[176:179], v[136:139], a[24:27]
    v_perm_b32 v164, v54, v50, s22
    v_mfma_f32_16x16x32_bf16 a[56:59], v[180:183], v[136:139], a[56:59]
    v_perm_b32 v165, v62, v58, s22
    v_mfma_f32_16x16x32_bf16 a[88:91], v[184:187], v[136:139], a[88:91]
    v_perm_b32 v166, v70, v66, s22
    v_mfma_f32_16x16x32_bf16 a[120:123], v[188:191], v[136:139], a[120:123]
    v_mfma_f32_16x16x32_bf16 a[152:155], v[192:195], v[136:139], a[152:155]
    v_perm_b32 v167, v78, v74, s22
    v_mfma_f32_16x16x32_bf16 a[184:187], v[196:199], v[136:139], a[184:187]
    v_perm_b32 v168, v55, v51, s21
    v_mfma_f32_16x16x32_bf16 a[216:219], v[200:203], v[136:139], a[216:219]
    v_perm_b32 v169, v63, v59, s21
    v_mfma_f32_16x16x32_bf16 a[248:251], v[204:207], v[136:139], a[248:251]
    v_mfma_f32_16x16x32_bf16 a[28:31], v[176:179], v[140:143], a[28:31]
    v_perm_b32 v170, v71, v67, s21
    v_mfma_f32_16x16x32_bf16 a[60:63], v[180:183], v[140:143], a[60:63]
    v_perm_b32 v171, v79, v75, s21
    v_mfma_f32_16x16x32_bf16 a[92:95], v[184:187], v[140:143], a[92:95]
    v_perm_b32 v172, v55, v51, s22
    v_mfma_f32_16x16x32_bf16 a[124:127], v[188:191], v[140:143], a[124:127]
    v_mfma_f32_16x16x32_bf16 a[156:159], v[192:195], v[140:143], a[156:159]
    v_perm_b32 v173, v63, v59, s22
    v_mfma_f32_16x16x32_bf16 a[188:191], v[196:199], v[140:143], a[188:191]
    v_perm_b32 v174, v71, v67, s22
    v_mfma_f32_16x16x32_bf16 a[220:223], v[200:203], v[140:143], a[220:223]
    v_perm_b32 v175, v79, v75, s22
    v_mfma_f32_16x16x32_bf16 a[252:255], v[204:207], v[140:143], a[252:255]
    s_waitcnt vmcnt(8) lgkmcnt(0)
    s_nop 1
    v_mfma_f32_16x16x32_bf16 a[0:3], v[208:211], v[144:147], a[0:3]
    buffer_load_dwordx4 v[48:51], v4, s[12:15], s24 offen
    v_mfma_f32_16x16x32_bf16 a[32:35], v[212:215], v[144:147], a[32:35]
    buffer_load_dwordx4 v[52:55], v4, s[12:15], s25 offen
    v_mfma_f32_16x16x32_bf16 a[64:67], v[216:219], v[144:147], a[64:67]
    buffer_load_dwordx4 v[56:59], v4, s[12:15], s26 offen
    v_mfma_f32_16x16x32_bf16 a[96:99], v[220:223], v[144:147], a[96:99]
    buffer_load_dwordx4 v[60:63], v4, s[12:15], s27 offen
    v_mfma_f32_16x16x32_bf16 a[128:131], v[224:227], v[144:147], a[128:131]
    v_mfma_f32_16x16x32_bf16 a[160:163], v[228:231], v[144:147], a[160:163]
    buffer_load_dwordx4 v[64:67], v4, s[12:15], s28 offen
    v_mfma_f32_16x16x32_bf16 a[192:195], v[232:235], v[144:147], a[192:195]
    buffer_load_dwordx4 v[68:71], v4, s[12:15], s29 offen
    v_mfma_f32_16x16x32_bf16 a[224:227], v[236:239], v[144:147], a[224:227]
    buffer_load_dwordx4 v[72:75], v4, s[12:15], s30 offen
    v_mfma_f32_16x16x32_bf16 a[4:7], v[208:211], v[148:151], a[4:7]
    v_mfma_f32_16x16x32_bf16 a[36:39], v[212:215], v[148:151], a[36:39]
    buffer_load_dwordx4 v[76:79], v4, s[12:15], s31 offen
    v_mfma_f32_16x16x32_bf16 a[68:71], v[216:219], v[148:151], a[68:71]
    v_add_u32 v4, s23, v4
    v_mfma_f32_16x16x32_bf16 a[100:103], v[220:223], v[148:151], a[100:103]
    ds_read_b128 v[176:179], v5 offset:8192
    v_mfma_f32_16x16x32_bf16 a[132:135], v[224:227], v[148:151], a[132:135]
    v_mfma_f32_16x16x32_bf16 a[164:167], v[228:231], v[148:151], a[164:167]
    ds_read_b128 v[180:183], v5 offset:24576
    v_mfma_f32_16x16x32_bf16 a[196:199], v[232:235], v[148:151], a[196:199]
    ds_read_b128 v[184:187], v5 offset:40960
    v_mfma_f32_16x16x32_bf16 a[228:231], v[236:239], v[148:151], a[228:231]
    ds_read_b128 v[188:191], v5 offset:57344
    v_mfma_f32_16x16x32_bf16 a[8:11], v[208:211], v[152:155], a[8:11]
    ds_read_b128 v[192:195], v6 offset:8192
    v_mfma_f32_16x16x32_bf16 a[40:43], v[212:215], v[152:155], a[40:43]
    v_mfma_f32_16x16x32_bf16 a[72:75], v[216:219], v[152:155], a[72:75]
    ds_read_b128 v[196:199], v6 offset:24576
    v_mfma_f32_16x16x32_bf16 a[104:107], v[220:223], v[152:155], a[104:107]
    ds_read_b128 v[200:203], v6 offset:40960
    v_mfma_f32_16x16x32_bf16 a[136:139], v[224:227], v[152:155], a[136:139]
    ds_read_b128 v[204:207], v6 offset:57344
    v_mfma_f32_16x16x32_bf16 a[168:171], v[228:231], v[152:155], a[168:171]
    v_mfma_f32_16x16x32_bf16 a[200:203], v[232:235], v[152:155], a[200:203]
    v_perm_b32 v112, v84, v80, s21
    v_mfma_f32_16x16x32_bf16 a[232:235], v[236:239], v[152:155], a[232:235]
    v_perm_b32 v113, v92, v88, s21
    v_mfma_f32_16x16x32_bf16 a[12:15], v[208:211], v[156:159], a[12:15]
    v_perm_b32 v114, v100, v96, s21
    v_mfma_f32_16x16x32_bf16 a[44:47], v[212:215], v[156:159], a[44:47]
    v_mfma_f32_16x16x32_bf16 a[76:79], v[216:219], v[156:159], a[76:79]
    v_perm_b32 v115, v108, v104, s21
    v_mfma_f32_16x16x32_bf16 a[108:111], v[220:223], v[156:159], a[108:111]
    v_perm_b32 v116, v84, v80, s22
    v_mfma_f32_16x16x32_bf16 a[140:143], v[224:227], v[156:159], a[140:143]
    v_perm_b32 v117, v92, v88, s22
    v_mfma_f32_16x16x32_bf16 a[172:175], v[228:231], v[156:159], a[172:175]
    v_mfma_f32_16x16x32_bf16 a[204:207], v[232:235], v[156:159], a[204:207]
    v_perm_b32 v118, v100, v96, s22
    v_mfma_f32_16x16x32_bf16 a[236:239], v[236:239], v[156:159], a[236:239]
    v_perm_b32 v119, v108, v104, s22
    v_mfma_f32_16x16x32_bf16 a[16:19], v[208:211], v[160:163], a[16:19]
    v_perm_b32 v120, v85, v81, s21
    v_mfma_f32_16x16x32_bf16 a[48:51], v[212:215], v[160:163], a[48:51]
    v_perm_b32 v121, v93, v89, s21
    v_mfma_f32_16x16x32_bf16 a[80:83], v[216:219], v[160:163], a[80:83]
    v_mfma_f32_16x16x32_bf16 a[112:115], v[220:223], v[160:163], a[112:115]
    v_perm_b32 v122, v101, v97, s21
    v_mfma_f32_16x16x32_bf16 a[144:147], v[224:227], v[160:163], a[144:147]
    v_perm_b32 v123, v109, v105, s21
    v_mfma_f32_16x16x32_bf16 a[176:179], v[228:231], v[160:163], a[176:179]
    v_perm_b32 v124, v85, v81, s22
    v_mfma_f32_16x16x32_bf16 a[208:211], v[232:235], v[160:163], a[208:211]
    v_mfma_f32_16x16x32_bf16 a[240:243], v[236:239], v[160:163], a[240:243]
    v_perm_b32 v125, v93, v89, s22
    v_mfma_f32_16x16x32_bf16 a[20:23], v[208:211], v[164:167], a[20:23]
    v_perm_b32 v126, v101, v97, s22
    v_mfma_f32_16x16x32_bf16 a[52:55], v[212:215], v[164:167], a[52:55]
    v_perm_b32 v127, v109, v105, s22
    v_mfma_f32_16x16x32_bf16 a[84:87], v[216:219], v[164:167], a[84:87]
    v_mfma_f32_16x16x32_bf16 a[116:119], v[220:223], v[164:167], a[116:119]
    v_perm_b32 v128, v86, v82, s21
    v_mfma_f32_16x16x32_bf16 a[148:151], v[224:227], v[164:167], a[148:151]
    v_perm_b32 v129, v94, v90, s21
    v_mfma_f32_16x16x32_bf16 a[180:183], v[228:231], v[164:167], a[180:183]
    v_perm_b32 v130, v102, v98, s21
    v_mfma_f32_16x16x32_bf16 a[212:215], v[232:235], v[164:167], a[212:215]
    v_mfma_f32_16x16x32_bf16 a[244:247], v[236:239], v[164:167], a[244:247]
    v_perm_b32 v131, v110, v106, s21
    v_mfma_f32_16x16x32_bf16 a[24:27], v[208:211], v[168:171], a[24:27]
    v_perm_b32 v132, v86, v82, s22
    v_mfma_f32_16x16x32_bf16 a[56:59], v[212:215], v[168:171], a[56:59]
    v_perm_b32 v133, v94, v90, s22
    v_mfma_f32_16x16x32_bf16 a[88:91], v[216:219], v[168:171], a[88:91]
    v_perm_b32 v134, v102, v98, s22
    v_mfma_f32_16x16x32_bf16 a[120:123], v[220:223], v[168:171], a[120:123]
    v_mfma_f32_16x16x32_bf16 a[152:155], v[224:227], v[168:171], a[152:155]
    v_perm_b32 v135, v110, v106, s22
    v_mfma_f32_16x16x32_bf16 a[184:187], v[228:231], v[168:171], a[184:187]
    v_perm_b32 v136, v87, v83, s21
    v_mfma_f32_16x16x32_bf16 a[216:219], v[232:235], v[168:171], a[216:219]
    v_perm_b32 v137, v95, v91, s21
    v_mfma_f32_16x16x32_bf16 a[248:251], v[236:239], v[168:171], a[248:251]
    v_mfma_f32_16x16x32_bf16 a[28:31], v[208:211], v[172:175], a[28:31]
    v_perm_b32 v138, v103, v99, s21
    v_mfma_f32_16x16x32_bf16 a[60:63], v[212:215], v[172:175], a[60:63]
    v_perm_b32 v139, v111, v107, s21
    v_mfma_f32_16x16x32_bf16 a[92:95], v[216:219], v[172:175], a[92:95]
    v_perm_b32 v140, v87, v83, s22
    v_mfma_f32_16x16x32_bf16 a[124:127], v[220:223], v[172:175], a[124:127]
    v_mfma_f32_16x16x32_bf16 a[156:159], v[224:227], v[172:175], a[156:159]
    v_perm_b32 v141, v95, v91, s22
    v_mfma_f32_16x16x32_bf16 a[188:191], v[228:231], v[172:175], a[188:191]
    v_perm_b32 v142, v103, v99, s22
    v_mfma_f32_16x16x32_bf16 a[220:223], v[232:235], v[172:175], a[220:223]
    v_perm_b32 v143, v111, v107, s22
    v_mfma_f32_16x16x32_bf16 a[252:255], v[236:239], v[172:175], a[252:255]
    s_waitcnt vmcnt(8) lgkmcnt(0)
    s_nop 1
    v_mfma_f32_16x16x32_bf16 a[0:3], v[176:179], v[112:115], a[0:3]
    buffer_load_dwordx4 v[80:83], v4, s[12:15], s24 offen
    v_mfma_f32_16x16x32_bf16 a[32:35], v[180:183], v[112:115], a[32:35]
    buffer_load_dwordx4 v[84:87], v4, s[12:15], s25 offen
    v_mfma_f32_16x16x32_bf16 a[64:67], v[184:187], v[112:115], a[64:67]
    buffer_load_dwordx4 v[88:91], v4, s[12:15], s26 offen
    v_mfma_f32_16x16x32_bf16 a[96:99], v[188:191], v[112:115], a[96:99]
    buffer_load_dwordx4 v[92:95], v4, s[12:15], s27 offen
    v_mfma_f32_16x16x32_bf16 a[128:131], v[192:195], v[112:115], a[128:131]
    v_mfma_f32_16x16x32_bf16 a[160:163], v[196:199], v[112:115], a[160:163]
    buffer_load_dwordx4 v[96:99], v4, s[12:15], s28 offen
    v_mfma_f32_16x16x32_bf16 a[192:195], v[200:203], v[112:115], a[192:195]
    buffer_load_dwordx4 v[100:103], v4, s[12:15], s29 offen
    v_mfma_f32_16x16x32_bf16 a[224:227], v[204:207], v[112:115], a[224:227]
    buffer_load_dwordx4 v[104:107], v4, s[12:15], s30 offen
    v_mfma_f32_16x16x32_bf16 a[4:7], v[176:179], v[116:119], a[4:7]
    v_mfma_f32_16x16x32_bf16 a[36:39], v[180:183], v[116:119], a[36:39]
    buffer_load_dwordx4 v[108:111], v4, s[12:15], s31 offen
    v_mfma_f32_16x16x32_bf16 a[68:71], v[184:187], v[116:119], a[68:71]
    v_add_u32 v4, s23, v4
    v_mfma_f32_16x16x32_bf16 a[100:103], v[188:191], v[116:119], a[100:103]
    ds_read_b128 v[208:211], v5 offset:9216
    v_mfma_f32_16x16x32_bf16 a[132:135], v[192:195], v[116:119], a[132:135]
    v_mfma_f32_16x16x32_bf16 a[164:167], v[196:199], v[116:119], a[164:167]
    ds_read_b128 v[212:215], v5 offset:25600
    v_mfma_f32_16x16x32_bf16 a[196:199], v[200:203], v[116:119], a[196:199]
    ds_read_b128 v[216:219], v5 offset:41984
    v_mfma_f32_16x16x32_bf16 a[228:231], v[204:207], v[116:119], a[228:231]
    ds_read_b128 v[220:223], v5 offset:58368
    v_mfma_f32_16x16x32_bf16 a[8:11], v[176:179], v[120:123], a[8:11]
    ds_read_b128 v[224:227], v6 offset:9216
    v_mfma_f32_16x16x32_bf16 a[40:43], v[180:183], v[120:123], a[40:43]
    v_mfma_f32_16x16x32_bf16 a[72:75], v[184:187], v[120:123], a[72:75]
    ds_read_b128 v[228:231], v6 offset:25600
    v_mfma_f32_16x16x32_bf16 a[104:107], v[188:191], v[120:123], a[104:107]
    ds_read_b128 v[232:235], v6 offset:41984
    v_mfma_f32_16x16x32_bf16 a[136:139], v[192:195], v[120:123], a[136:139]
    ds_read_b128 v[236:239], v6 offset:58368
    v_mfma_f32_16x16x32_bf16 a[168:171], v[196:199], v[120:123], a[168:171]
    v_mfma_f32_16x16x32_bf16 a[200:203], v[200:203], v[120:123], a[200:203]
    v_perm_b32 v144, v20, v16, s21
    v_mfma_f32_16x16x32_bf16 a[232:235], v[204:207], v[120:123], a[232:235]
    v_perm_b32 v145, v28, v24, s21
    v_mfma_f32_16x16x32_bf16 a[12:15], v[176:179], v[124:127], a[12:15]
    v_perm_b32 v146, v36, v32, s21
    v_mfma_f32_16x16x32_bf16 a[44:47], v[180:183], v[124:127], a[44:47]
    v_mfma_f32_16x16x32_bf16 a[76:79], v[184:187], v[124:127], a[76:79]
    v_perm_b32 v147, v44, v40, s21
    v_mfma_f32_16x16x32_bf16 a[108:111], v[188:191], v[124:127], a[108:111]
    v_perm_b32 v148, v20, v16, s22
    v_mfma_f32_16x16x32_bf16 a[140:143], v[192:195], v[124:127], a[140:143]
    v_perm_b32 v149, v28, v24, s22
    v_mfma_f32_16x16x32_bf16 a[172:175], v[196:199], v[124:127], a[172:175]
    v_mfma_f32_16x16x32_bf16 a[204:207], v[200:203], v[124:127], a[204:207]
    v_perm_b32 v150, v36, v32, s22
    v_mfma_f32_16x16x32_bf16 a[236:239], v[204:207], v[124:127], a[236:239]
    v_perm_b32 v151, v44, v40, s22
    v_mfma_f32_16x16x32_bf16 a[16:19], v[176:179], v[128:131], a[16:19]
    v_perm_b32 v152, v21, v17, s21
    v_mfma_f32_16x16x32_bf16 a[48:51], v[180:183], v[128:131], a[48:51]
    v_perm_b32 v153, v29, v25, s21
    v_mfma_f32_16x16x32_bf16 a[80:83], v[184:187], v[128:131], a[80:83]
    v_mfma_f32_16x16x32_bf16 a[112:115], v[188:191], v[128:131], a[112:115]
    v_perm_b32 v154, v37, v33, s21
    v_mfma_f32_16x16x32_bf16 a[144:147], v[192:195], v[128:131], a[144:147]
    v_perm_b32 v155, v45, v41, s21
    v_mfma_f32_16x16x32_bf16 a[176:179], v[196:199], v[128:131], a[176:179]
    v_perm_b32 v156, v21, v17, s22
    v_mfma_f32_16x16x32_bf16 a[208:211], v[200:203], v[128:131], a[208:211]
    v_mfma_f32_16x16x32_bf16 a[240:243], v[204:207], v[128:131], a[240:243]
    v_perm_b32 v157, v29, v25, s22
    v_mfma_f32_16x16x32_bf16 a[20:23], v[176:179], v[132:135], a[20:23]
    v_perm_b32 v158, v37, v33, s22
    v_mfma_f32_16x16x32_bf16 a[52:55], v[180:183], v[132:135], a[52:55]
    v_perm_b32 v159, v45, v41, s22
    v_mfma_f32_16x16x32_bf16 a[84:87], v[184:187], v[132:135], a[84:87]
    v_mfma_f32_16x16x32_bf16 a[116:119], v[188:191], v[132:135], a[116:119]
    v_perm_b32 v160, v22, v18, s21
    v_mfma_f32_16x16x32_bf16 a[148:151], v[192:195], v[132:135], a[148:151]
    v_perm_b32 v161, v30, v26, s21
    v_mfma_f32_16x16x32_bf16 a[180:183], v[196:199], v[132:135], a[180:183]
    v_perm_b32 v162, v38, v34, s21
    v_mfma_f32_16x16x32_bf16 a[212:215], v[200:203], v[132:135], a[212:215]
    v_mfma_f32_16x16x32_bf16 a[244:247], v[204:207], v[132:135], a[244:247]
    v_perm_b32 v163, v46, v42, s21
    v_mfma_f32_16x16x32_bf16 a[24:27], v[176:179], v[136:139], a[24:27]
    v_perm_b32 v164, v22, v18, s22
    v_mfma_f32_16x16x32_bf16 a[56:59], v[180:183], v[136:139], a[56:59]
    v_perm_b32 v165, v30, v26, s22
    v_mfma_f32_16x16x32_bf16 a[88:91], v[184:187], v[136:139], a[88:91]
    v_perm_b32 v166, v38, v34, s22
    v_mfma_f32_16x16x32_bf16 a[120:123], v[188:191], v[136:139], a[120:123]
    v_mfma_f32_16x16x32_bf16 a[152:155], v[192:195], v[136:139], a[152:155]
    v_perm_b32 v167, v46, v42, s22
    v_mfma_f32_16x16x32_bf16 a[184:187], v[196:199], v[136:139], a[184:187]
    v_perm_b32 v168, v23, v19, s21
    v_mfma_f32_16x16x32_bf16 a[216:219], v[200:203], v[136:139], a[216:219]
    v_perm_b32 v169, v31, v27, s21
    v_mfma_f32_16x16x32_bf16 a[248:251], v[204:207], v[136:139], a[248:251]
    v_mfma_f32_16x16x32_bf16 a[28:31], v[176:179], v[140:143], a[28:31]
    v_perm_b32 v170, v39, v35, s21
    v_mfma_f32_16x16x32_bf16 a[60:63], v[180:183], v[140:143], a[60:63]
    v_perm_b32 v171, v47, v43, s21
    v_mfma_f32_16x16x32_bf16 a[92:95], v[184:187], v[140:143], a[92:95]
    v_perm_b32 v172, v23, v19, s22
    v_mfma_f32_16x16x32_bf16 a[124:127], v[188:191], v[140:143], a[124:127]
    v_mfma_f32_16x16x32_bf16 a[156:159], v[192:195], v[140:143], a[156:159]
    v_perm_b32 v173, v31, v27, s22
    v_mfma_f32_16x16x32_bf16 a[188:191], v[196:199], v[140:143], a[188:191]
    v_perm_b32 v174, v39, v35, s22
    v_mfma_f32_16x16x32_bf16 a[220:223], v[200:203], v[140:143], a[220:223]
    v_perm_b32 v175, v47, v43, s22
    v_mfma_f32_16x16x32_bf16 a[252:255], v[204:207], v[140:143], a[252:255]
    s_waitcnt vmcnt(8) lgkmcnt(0)
    s_nop 1
    v_mfma_f32_16x16x32_bf16 a[0:3], v[208:211], v[144:147], a[0:3]
    buffer_load_dwordx4 v[16:19], v4, s[12:15], s24 offen
    v_mfma_f32_16x16x32_bf16 a[32:35], v[212:215], v[144:147], a[32:35]
    buffer_load_dwordx4 v[20:23], v4, s[12:15], s25 offen
    v_mfma_f32_16x16x32_bf16 a[64:67], v[216:219], v[144:147], a[64:67]
    buffer_load_dwordx4 v[24:27], v4, s[12:15], s26 offen
    v_mfma_f32_16x16x32_bf16 a[96:99], v[220:223], v[144:147], a[96:99]
    buffer_load_dwordx4 v[28:31], v4, s[12:15], s27 offen
    v_mfma_f32_16x16x32_bf16 a[128:131], v[224:227], v[144:147], a[128:131]
    v_mfma_f32_16x16x32_bf16 a[160:163], v[228:231], v[144:147], a[160:163]
    buffer_load_dwordx4 v[32:35], v4, s[12:15], s28 offen
    v_mfma_f32_16x16x32_bf16 a[192:195], v[232:235], v[144:147], a[192:195]
    buffer_load_dwordx4 v[36:39], v4, s[12:15], s29 offen
    v_mfma_f32_16x16x32_bf16 a[224:227], v[236:239], v[144:147], a[224:227]
    buffer_load_dwordx4 v[40:43], v4, s[12:15], s30 offen
    v_mfma_f32_16x16x32_bf16 a[4:7], v[208:211], v[148:151], a[4:7]
    v_mfma_f32_16x16x32_bf16 a[36:39], v[212:215], v[148:151], a[36:39]
    buffer_load_dwordx4 v[44:47], v4, s[12:15], s31 offen
    v_mfma_f32_16x16x32_bf16 a[68:71], v[216:219], v[148:151], a[68:71]
    v_add_u32 v4, s23, v4
    v_mfma_f32_16x16x32_bf16 a[100:103], v[220:223], v[148:151], a[100:103]
    ds_read_b128 v[176:179], v5 offset:10240
    v_mfma_f32_16x16x32_bf16 a[132:135], v[224:227], v[148:151], a[132:135]
    v_mfma_f32_16x16x32_bf16 a[164:167], v[228:231], v[148:151], a[164:167]
    ds_read_b128 v[180:183], v5 offset:26624
    v_mfma_f32_16x16x32_bf16 a[196:199], v[232:235], v[148:151], a[196:199]
    ds_read_b128 v[184:187], v5 offset:43008
    v_mfma_f32_16x16x32_bf16 a[228:231], v[236:239], v[148:151], a[228:231]
    ds_read_b128 v[188:191], v5 offset:59392
    v_mfma_f32_16x16x32_bf16 a[8:11], v[208:211], v[152:155], a[8:11]
    ds_read_b128 v[192:195], v6 offset:10240
    v_mfma_f32_16x16x32_bf16 a[40:43], v[212:215], v[152:155], a[40:43]
    v_mfma_f32_16x16x32_bf16 a[72:75], v[216:219], v[152:155], a[72:75]
    ds_read_b128 v[196:199], v6 offset:26624
    v_mfma_f32_16x16x32_bf16 a[104:107], v[220:223], v[152:155], a[104:107]
    ds_read_b128 v[200:203], v6 offset:43008
    v_mfma_f32_16x16x32_bf16 a[136:139], v[224:227], v[152:155], a[136:139]
    ds_read_b128 v[204:207], v6 offset:59392
    v_mfma_f32_16x16x32_bf16 a[168:171], v[228:231], v[152:155], a[168:171]
    v_mfma_f32_16x16x32_bf16 a[200:203], v[232:235], v[152:155], a[200:203]
    v_perm_b32 v112, v52, v48, s21
    v_mfma_f32_16x16x32_bf16 a[232:235], v[236:239], v[152:155], a[232:235]
    v_perm_b32 v113, v60, v56, s21
    v_mfma_f32_16x16x32_bf16 a[12:15], v[208:211], v[156:159], a[12:15]
    v_perm_b32 v114, v68, v64, s21
    v_mfma_f32_16x16x32_bf16 a[44:47], v[212:215], v[156:159], a[44:47]
    v_mfma_f32_16x16x32_bf16 a[76:79], v[216:219], v[156:159], a[76:79]
    v_perm_b32 v115, v76, v72, s21
    v_mfma_f32_16x16x32_bf16 a[108:111], v[220:223], v[156:159], a[108:111]
    v_perm_b32 v116, v52, v48, s22
    v_mfma_f32_16x16x32_bf16 a[140:143], v[224:227], v[156:159], a[140:143]
    v_perm_b32 v117, v60, v56, s22
    v_mfma_f32_16x16x32_bf16 a[172:175], v[228:231], v[156:159], a[172:175]
    v_mfma_f32_16x16x32_bf16 a[204:207], v[232:235], v[156:159], a[204:207]
    v_perm_b32 v118, v68, v64, s22
    v_mfma_f32_16x16x32_bf16 a[236:239], v[236:239], v[156:159], a[236:239]
    v_perm_b32 v119, v76, v72, s22
    v_mfma_f32_16x16x32_bf16 a[16:19], v[208:211], v[160:163], a[16:19]
    v_perm_b32 v120, v53, v49, s21
    v_mfma_f32_16x16x32_bf16 a[48:51], v[212:215], v[160:163], a[48:51]
    v_perm_b32 v121, v61, v57, s21
    v_mfma_f32_16x16x32_bf16 a[80:83], v[216:219], v[160:163], a[80:83]
    v_mfma_f32_16x16x32_bf16 a[112:115], v[220:223], v[160:163], a[112:115]
    v_perm_b32 v122, v69, v65, s21
    v_mfma_f32_16x16x32_bf16 a[144:147], v[224:227], v[160:163], a[144:147]
    v_perm_b32 v123, v77, v73, s21
    v_mfma_f32_16x16x32_bf16 a[176:179], v[228:231], v[160:163], a[176:179]
    v_perm_b32 v124, v53, v49, s22
    v_mfma_f32_16x16x32_bf16 a[208:211], v[232:235], v[160:163], a[208:211]
    v_mfma_f32_16x16x32_bf16 a[240:243], v[236:239], v[160:163], a[240:243]
    v_perm_b32 v125, v61, v57, s22
    v_mfma_f32_16x16x32_bf16 a[20:23], v[208:211], v[164:167], a[20:23]
    v_perm_b32 v126, v69, v65, s22
    v_mfma_f32_16x16x32_bf16 a[52:55], v[212:215], v[164:167], a[52:55]
    v_perm_b32 v127, v77, v73, s22
    v_mfma_f32_16x16x32_bf16 a[84:87], v[216:219], v[164:167], a[84:87]
    v_mfma_f32_16x16x32_bf16 a[116:119], v[220:223], v[164:167], a[116:119]
    v_perm_b32 v128, v54, v50, s21
    v_mfma_f32_16x16x32_bf16 a[148:151], v[224:227], v[164:167], a[148:151]
    v_perm_b32 v129, v62, v58, s21
    v_mfma_f32_16x16x32_bf16 a[180:183], v[228:231], v[164:167], a[180:183]
    v_perm_b32 v130, v70, v66, s21
    v_mfma_f32_16x16x32_bf16 a[212:215], v[232:235], v[164:167], a[212:215]
    v_mfma_f32_16x16x32_bf16 a[244:247], v[236:239], v[164:167], a[244:247]
    v_perm_b32 v131, v78, v74, s21
    v_mfma_f32_16x16x32_bf16 a[24:27], v[208:211], v[168:171], a[24:27]
    v_perm_b32 v132, v54, v50, s22
    v_mfma_f32_16x16x32_bf16 a[56:59], v[212:215], v[168:171], a[56:59]
    v_perm_b32 v133, v62, v58, s22
    v_mfma_f32_16x16x32_bf16 a[88:91], v[216:219], v[168:171], a[88:91]
    v_perm_b32 v134, v70, v66, s22
    v_mfma_f32_16x16x32_bf16 a[120:123], v[220:223], v[168:171], a[120:123]
    v_mfma_f32_16x16x32_bf16 a[152:155], v[224:227], v[168:171], a[152:155]
    v_perm_b32 v135, v78, v74, s22
    v_mfma_f32_16x16x32_bf16 a[184:187], v[228:231], v[168:171], a[184:187]
    v_perm_b32 v136, v55, v51, s21
    v_mfma_f32_16x16x32_bf16 a[216:219], v[232:235], v[168:171], a[216:219]
    v_perm_b32 v137, v63, v59, s21
    v_mfma_f32_16x16x32_bf16 a[248:251], v[236:239], v[168:171], a[248:251]
    v_mfma_f32_16x16x32_bf16 a[28:31], v[208:211], v[172:175], a[28:31]
    v_perm_b32 v138, v71, v67, s21
    v_mfma_f32_16x16x32_bf16 a[60:63], v[212:215], v[172:175], a[60:63]
    v_perm_b32 v139, v79, v75, s21
    v_mfma_f32_16x16x32_bf16 a[92:95], v[216:219], v[172:175], a[92:95]
    v_perm_b32 v140, v55, v51, s22
    v_mfma_f32_16x16x32_bf16 a[124:127], v[220:223], v[172:175], a[124:127]
    v_mfma_f32_16x16x32_bf16 a[156:159], v[224:227], v[172:175], a[156:159]
    v_perm_b32 v141, v63, v59, s22
    v_mfma_f32_16x16x32_bf16 a[188:191], v[228:231], v[172:175], a[188:191]
    v_perm_b32 v142, v71, v67, s22
    v_mfma_f32_16x16x32_bf16 a[220:223], v[232:235], v[172:175], a[220:223]
    v_perm_b32 v143, v79, v75, s22
    v_mfma_f32_16x16x32_bf16 a[252:255], v[236:239], v[172:175], a[252:255]
    s_waitcnt vmcnt(8) lgkmcnt(0)
    s_nop 1
    v_mfma_f32_16x16x32_bf16 a[0:3], v[176:179], v[112:115], a[0:3]
    buffer_load_dwordx4 v[48:51], v4, s[12:15], s24 offen
    v_mfma_f32_16x16x32_bf16 a[32:35], v[180:183], v[112:115], a[32:35]
    buffer_load_dwordx4 v[52:55], v4, s[12:15], s25 offen
    v_mfma_f32_16x16x32_bf16 a[64:67], v[184:187], v[112:115], a[64:67]
    buffer_load_dwordx4 v[56:59], v4, s[12:15], s26 offen
    v_mfma_f32_16x16x32_bf16 a[96:99], v[188:191], v[112:115], a[96:99]
    buffer_load_dwordx4 v[60:63], v4, s[12:15], s27 offen
    v_mfma_f32_16x16x32_bf16 a[128:131], v[192:195], v[112:115], a[128:131]
    v_mfma_f32_16x16x32_bf16 a[160:163], v[196:199], v[112:115], a[160:163]
    buffer_load_dwordx4 v[64:67], v4, s[12:15], s28 offen
    v_mfma_f32_16x16x32_bf16 a[192:195], v[200:203], v[112:115], a[192:195]
    buffer_load_dwordx4 v[68:71], v4, s[12:15], s29 offen
    v_mfma_f32_16x16x32_bf16 a[224:227], v[204:207], v[112:115], a[224:227]
    buffer_load_dwordx4 v[72:75], v4, s[12:15], s30 offen
    v_mfma_f32_16x16x32_bf16 a[4:7], v[176:179], v[116:119], a[4:7]
    v_mfma_f32_16x16x32_bf16 a[36:39], v[180:183], v[116:119], a[36:39]
    buffer_load_dwordx4 v[76:79], v4, s[12:15], s31 offen
    v_mfma_f32_16x16x32_bf16 a[68:71], v[184:187], v[116:119], a[68:71]
    v_add_u32 v4, s23, v4
    v_mfma_f32_16x16x32_bf16 a[100:103], v[188:191], v[116:119], a[100:103]
    ds_read_b128 v[208:211], v5 offset:11264
    v_mfma_f32_16x16x32_bf16 a[132:135], v[192:195], v[116:119], a[132:135]
    v_mfma_f32_16x16x32_bf16 a[164:167], v[196:199], v[116:119], a[164:167]
    ds_read_b128 v[212:215], v5 offset:27648
    v_mfma_f32_16x16x32_bf16 a[196:199], v[200:203], v[116:119], a[196:199]
    ds_read_b128 v[216:219], v5 offset:44032
    v_mfma_f32_16x16x32_bf16 a[228:231], v[204:207], v[116:119], a[228:231]
    ds_read_b128 v[220:223], v5 offset:60416
    v_mfma_f32_16x16x32_bf16 a[8:11], v[176:179], v[120:123], a[8:11]
    ds_read_b128 v[224:227], v6 offset:11264
    v_mfma_f32_16x16x32_bf16 a[40:43], v[180:183], v[120:123], a[40:43]
    v_mfma_f32_16x16x32_bf16 a[72:75], v[184:187], v[120:123], a[72:75]
    ds_read_b128 v[228:231], v6 offset:27648
    v_mfma_f32_16x16x32_bf16 a[104:107], v[188:191], v[120:123], a[104:107]
    ds_read_b128 v[232:235], v6 offset:44032
    v_mfma_f32_16x16x32_bf16 a[136:139], v[192:195], v[120:123], a[136:139]
    ds_read_b128 v[236:239], v6 offset:60416
    v_mfma_f32_16x16x32_bf16 a[168:171], v[196:199], v[120:123], a[168:171]
    v_mfma_f32_16x16x32_bf16 a[200:203], v[200:203], v[120:123], a[200:203]
    v_perm_b32 v144, v84, v80, s21
    v_mfma_f32_16x16x32_bf16 a[232:235], v[204:207], v[120:123], a[232:235]
    v_perm_b32 v145, v92, v88, s21
    v_mfma_f32_16x16x32_bf16 a[12:15], v[176:179], v[124:127], a[12:15]
    v_perm_b32 v146, v100, v96, s21
    v_mfma_f32_16x16x32_bf16 a[44:47], v[180:183], v[124:127], a[44:47]
    v_mfma_f32_16x16x32_bf16 a[76:79], v[184:187], v[124:127], a[76:79]
    v_perm_b32 v147, v108, v104, s21
    v_mfma_f32_16x16x32_bf16 a[108:111], v[188:191], v[124:127], a[108:111]
    v_perm_b32 v148, v84, v80, s22
    v_mfma_f32_16x16x32_bf16 a[140:143], v[192:195], v[124:127], a[140:143]
    v_perm_b32 v149, v92, v88, s22
    v_mfma_f32_16x16x32_bf16 a[172:175], v[196:199], v[124:127], a[172:175]
    v_mfma_f32_16x16x32_bf16 a[204:207], v[200:203], v[124:127], a[204:207]
    v_perm_b32 v150, v100, v96, s22
    v_mfma_f32_16x16x32_bf16 a[236:239], v[204:207], v[124:127], a[236:239]
    v_perm_b32 v151, v108, v104, s22
    v_mfma_f32_16x16x32_bf16 a[16:19], v[176:179], v[128:131], a[16:19]
    v_perm_b32 v152, v85, v81, s21
    v_mfma_f32_16x16x32_bf16 a[48:51], v[180:183], v[128:131], a[48:51]
    v_perm_b32 v153, v93, v89, s21
    v_mfma_f32_16x16x32_bf16 a[80:83], v[184:187], v[128:131], a[80:83]
    v_mfma_f32_16x16x32_bf16 a[112:115], v[188:191], v[128:131], a[112:115]
    v_perm_b32 v154, v101, v97, s21
    v_mfma_f32_16x16x32_bf16 a[144:147], v[192:195], v[128:131], a[144:147]
    v_perm_b32 v155, v109, v105, s21
    v_mfma_f32_16x16x32_bf16 a[176:179], v[196:199], v[128:131], a[176:179]
    v_perm_b32 v156, v85, v81, s22
    v_mfma_f32_16x16x32_bf16 a[208:211], v[200:203], v[128:131], a[208:211]
    v_mfma_f32_16x16x32_bf16 a[240:243], v[204:207], v[128:131], a[240:243]
    v_perm_b32 v157, v93, v89, s22
    v_mfma_f32_16x16x32_bf16 a[20:23], v[176:179], v[132:135], a[20:23]
    v_perm_b32 v158, v101, v97, s22
    v_mfma_f32_16x16x32_bf16 a[52:55], v[180:183], v[132:135], a[52:55]
    v_perm_b32 v159, v109, v105, s22
    v_mfma_f32_16x16x32_bf16 a[84:87], v[184:187], v[132:135], a[84:87]
    v_mfma_f32_16x16x32_bf16 a[116:119], v[188:191], v[132:135], a[116:119]
    v_perm_b32 v160, v86, v82, s21
    v_mfma_f32_16x16x32_bf16 a[148:151], v[192:195], v[132:135], a[148:151]
    v_perm_b32 v161, v94, v90, s21
    v_mfma_f32_16x16x32_bf16 a[180:183], v[196:199], v[132:135], a[180:183]
    v_perm_b32 v162, v102, v98, s21
    v_mfma_f32_16x16x32_bf16 a[212:215], v[200:203], v[132:135], a[212:215]
    v_mfma_f32_16x16x32_bf16 a[244:247], v[204:207], v[132:135], a[244:247]
    v_perm_b32 v163, v110, v106, s21
    v_mfma_f32_16x16x32_bf16 a[24:27], v[176:179], v[136:139], a[24:27]
    v_perm_b32 v164, v86, v82, s22
    v_mfma_f32_16x16x32_bf16 a[56:59], v[180:183], v[136:139], a[56:59]
    v_perm_b32 v165, v94, v90, s22
    v_mfma_f32_16x16x32_bf16 a[88:91], v[184:187], v[136:139], a[88:91]
    v_perm_b32 v166, v102, v98, s22
    v_mfma_f32_16x16x32_bf16 a[120:123], v[188:191], v[136:139], a[120:123]
    v_mfma_f32_16x16x32_bf16 a[152:155], v[192:195], v[136:139], a[152:155]
    v_perm_b32 v167, v110, v106, s22
    v_mfma_f32_16x16x32_bf16 a[184:187], v[196:199], v[136:139], a[184:187]
    v_perm_b32 v168, v87, v83, s21
    v_mfma_f32_16x16x32_bf16 a[216:219], v[200:203], v[136:139], a[216:219]
    v_perm_b32 v169, v95, v91, s21
    v_mfma_f32_16x16x32_bf16 a[248:251], v[204:207], v[136:139], a[248:251]
    v_mfma_f32_16x16x32_bf16 a[28:31], v[176:179], v[140:143], a[28:31]
    v_perm_b32 v170, v103, v99, s21
    v_mfma_f32_16x16x32_bf16 a[60:63], v[180:183], v[140:143], a[60:63]
    v_perm_b32 v171, v111, v107, s21
    v_mfma_f32_16x16x32_bf16 a[92:95], v[184:187], v[140:143], a[92:95]
    v_perm_b32 v172, v87, v83, s22
    v_mfma_f32_16x16x32_bf16 a[124:127], v[188:191], v[140:143], a[124:127]
    v_mfma_f32_16x16x32_bf16 a[156:159], v[192:195], v[140:143], a[156:159]
    v_perm_b32 v173, v95, v91, s22
    v_mfma_f32_16x16x32_bf16 a[188:191], v[196:199], v[140:143], a[188:191]
    v_perm_b32 v174, v103, v99, s22
    v_mfma_f32_16x16x32_bf16 a[220:223], v[200:203], v[140:143], a[220:223]
    v_perm_b32 v175, v111, v107, s22
    v_mfma_f32_16x16x32_bf16 a[252:255], v[204:207], v[140:143], a[252:255]
    s_waitcnt vmcnt(8) lgkmcnt(0)
    s_nop 1
    v_mfma_f32_16x16x32_bf16 a[0:3], v[208:211], v[144:147], a[0:3]
    buffer_load_dwordx4 v[80:83], v4, s[12:15], s24 offen
    v_mfma_f32_16x16x32_bf16 a[32:35], v[212:215], v[144:147], a[32:35]
    buffer_load_dwordx4 v[84:87], v4, s[12:15], s25 offen
    v_mfma_f32_16x16x32_bf16 a[64:67], v[216:219], v[144:147], a[64:67]
    buffer_load_dwordx4 v[88:91], v4, s[12:15], s26 offen
    v_mfma_f32_16x16x32_bf16 a[96:99], v[220:223], v[144:147], a[96:99]
    buffer_load_dwordx4 v[92:95], v4, s[12:15], s27 offen
    v_mfma_f32_16x16x32_bf16 a[128:131], v[224:227], v[144:147], a[128:131]
    v_mfma_f32_16x16x32_bf16 a[160:163], v[228:231], v[144:147], a[160:163]
    buffer_load_dwordx4 v[96:99], v4, s[12:15], s28 offen
    v_mfma_f32_16x16x32_bf16 a[192:195], v[232:235], v[144:147], a[192:195]
    buffer_load_dwordx4 v[100:103], v4, s[12:15], s29 offen
    v_mfma_f32_16x16x32_bf16 a[224:227], v[236:239], v[144:147], a[224:227]
    buffer_load_dwordx4 v[104:107], v4, s[12:15], s30 offen
    v_mfma_f32_16x16x32_bf16 a[4:7], v[208:211], v[148:151], a[4:7]
    v_mfma_f32_16x16x32_bf16 a[36:39], v[212:215], v[148:151], a[36:39]
    buffer_load_dwordx4 v[108:111], v4, s[12:15], s31 offen
    v_mfma_f32_16x16x32_bf16 a[68:71], v[216:219], v[148:151], a[68:71]
    v_add_u32 v4, s23, v4
    v_mfma_f32_16x16x32_bf16 a[100:103], v[220:223], v[148:151], a[100:103]
    ds_read_b128 v[176:179], v5 offset:12288
    v_mfma_f32_16x16x32_bf16 a[132:135], v[224:227], v[148:151], a[132:135]
    v_mfma_f32_16x16x32_bf16 a[164:167], v[228:231], v[148:151], a[164:167]
    ds_read_b128 v[180:183], v5 offset:28672
    v_mfma_f32_16x16x32_bf16 a[196:199], v[232:235], v[148:151], a[196:199]
    ds_read_b128 v[184:187], v5 offset:45056
    v_mfma_f32_16x16x32_bf16 a[228:231], v[236:239], v[148:151], a[228:231]
    ds_read_b128 v[188:191], v5 offset:61440
    v_mfma_f32_16x16x32_bf16 a[8:11], v[208:211], v[152:155], a[8:11]
    ds_read_b128 v[192:195], v6 offset:12288
    v_mfma_f32_16x16x32_bf16 a[40:43], v[212:215], v[152:155], a[40:43]
    v_mfma_f32_16x16x32_bf16 a[72:75], v[216:219], v[152:155], a[72:75]
    ds_read_b128 v[196:199], v6 offset:28672
    v_mfma_f32_16x16x32_bf16 a[104:107], v[220:223], v[152:155], a[104:107]
    ds_read_b128 v[200:203], v6 offset:45056
    v_mfma_f32_16x16x32_bf16 a[136:139], v[224:227], v[152:155], a[136:139]
    ds_read_b128 v[204:207], v6 offset:61440
    v_mfma_f32_16x16x32_bf16 a[168:171], v[228:231], v[152:155], a[168:171]
    v_mfma_f32_16x16x32_bf16 a[200:203], v[232:235], v[152:155], a[200:203]
    v_perm_b32 v112, v20, v16, s21
    v_mfma_f32_16x16x32_bf16 a[232:235], v[236:239], v[152:155], a[232:235]
    v_perm_b32 v113, v28, v24, s21
    v_mfma_f32_16x16x32_bf16 a[12:15], v[208:211], v[156:159], a[12:15]
    v_perm_b32 v114, v36, v32, s21
    v_mfma_f32_16x16x32_bf16 a[44:47], v[212:215], v[156:159], a[44:47]
    v_mfma_f32_16x16x32_bf16 a[76:79], v[216:219], v[156:159], a[76:79]
    v_perm_b32 v115, v44, v40, s21
    v_mfma_f32_16x16x32_bf16 a[108:111], v[220:223], v[156:159], a[108:111]
    v_perm_b32 v116, v20, v16, s22
    v_mfma_f32_16x16x32_bf16 a[140:143], v[224:227], v[156:159], a[140:143]
    v_perm_b32 v117, v28, v24, s22
    v_mfma_f32_16x16x32_bf16 a[172:175], v[228:231], v[156:159], a[172:175]
    v_mfma_f32_16x16x32_bf16 a[204:207], v[232:235], v[156:159], a[204:207]
    v_perm_b32 v118, v36, v32, s22
    v_mfma_f32_16x16x32_bf16 a[236:239], v[236:239], v[156:159], a[236:239]
    v_perm_b32 v119, v44, v40, s22
    v_mfma_f32_16x16x32_bf16 a[16:19], v[208:211], v[160:163], a[16:19]
    v_perm_b32 v120, v21, v17, s21
    v_mfma_f32_16x16x32_bf16 a[48:51], v[212:215], v[160:163], a[48:51]
    v_perm_b32 v121, v29, v25, s21
    v_mfma_f32_16x16x32_bf16 a[80:83], v[216:219], v[160:163], a[80:83]
    v_mfma_f32_16x16x32_bf16 a[112:115], v[220:223], v[160:163], a[112:115]
    v_perm_b32 v122, v37, v33, s21
    v_mfma_f32_16x16x32_bf16 a[144:147], v[224:227], v[160:163], a[144:147]
    v_perm_b32 v123, v45, v41, s21
    v_mfma_f32_16x16x32_bf16 a[176:179], v[228:231], v[160:163], a[176:179]
    v_perm_b32 v124, v21, v17, s22
    v_mfma_f32_16x16x32_bf16 a[208:211], v[232:235], v[160:163], a[208:211]
    v_mfma_f32_16x16x32_bf16 a[240:243], v[236:239], v[160:163], a[240:243]
    v_perm_b32 v125, v29, v25, s22
    v_mfma_f32_16x16x32_bf16 a[20:23], v[208:211], v[164:167], a[20:23]
    v_perm_b32 v126, v37, v33, s22
    v_mfma_f32_16x16x32_bf16 a[52:55], v[212:215], v[164:167], a[52:55]
    v_perm_b32 v127, v45, v41, s22
    v_mfma_f32_16x16x32_bf16 a[84:87], v[216:219], v[164:167], a[84:87]
    v_mfma_f32_16x16x32_bf16 a[116:119], v[220:223], v[164:167], a[116:119]
    v_perm_b32 v128, v22, v18, s21
    v_mfma_f32_16x16x32_bf16 a[148:151], v[224:227], v[164:167], a[148:151]
    v_perm_b32 v129, v30, v26, s21
    v_mfma_f32_16x16x32_bf16 a[180:183], v[228:231], v[164:167], a[180:183]
    v_perm_b32 v130, v38, v34, s21
    v_mfma_f32_16x16x32_bf16 a[212:215], v[232:235], v[164:167], a[212:215]
    v_mfma_f32_16x16x32_bf16 a[244:247], v[236:239], v[164:167], a[244:247]
    v_perm_b32 v131, v46, v42, s21
    v_mfma_f32_16x16x32_bf16 a[24:27], v[208:211], v[168:171], a[24:27]
    v_perm_b32 v132, v22, v18, s22
    v_mfma_f32_16x16x32_bf16 a[56:59], v[212:215], v[168:171], a[56:59]
    v_perm_b32 v133, v30, v26, s22
    v_mfma_f32_16x16x32_bf16 a[88:91], v[216:219], v[168:171], a[88:91]
    v_perm_b32 v134, v38, v34, s22
    v_mfma_f32_16x16x32_bf16 a[120:123], v[220:223], v[168:171], a[120:123]
    v_mfma_f32_16x16x32_bf16 a[152:155], v[224:227], v[168:171], a[152:155]
    v_perm_b32 v135, v46, v42, s22
    v_mfma_f32_16x16x32_bf16 a[184:187], v[228:231], v[168:171], a[184:187]
    v_perm_b32 v136, v23, v19, s21
    v_mfma_f32_16x16x32_bf16 a[216:219], v[232:235], v[168:171], a[216:219]
    v_perm_b32 v137, v31, v27, s21
    v_mfma_f32_16x16x32_bf16 a[248:251], v[236:239], v[168:171], a[248:251]
    v_mfma_f32_16x16x32_bf16 a[28:31], v[208:211], v[172:175], a[28:31]
    v_perm_b32 v138, v39, v35, s21
    v_mfma_f32_16x16x32_bf16 a[60:63], v[212:215], v[172:175], a[60:63]
    v_perm_b32 v139, v47, v43, s21
    v_mfma_f32_16x16x32_bf16 a[92:95], v[216:219], v[172:175], a[92:95]
    v_perm_b32 v140, v23, v19, s22
    v_mfma_f32_16x16x32_bf16 a[124:127], v[220:223], v[172:175], a[124:127]
    v_mfma_f32_16x16x32_bf16 a[156:159], v[224:227], v[172:175], a[156:159]
    v_perm_b32 v141, v31, v27, s22
    v_mfma_f32_16x16x32_bf16 a[188:191], v[228:231], v[172:175], a[188:191]
    v_perm_b32 v142, v39, v35, s22
    v_mfma_f32_16x16x32_bf16 a[220:223], v[232:235], v[172:175], a[220:223]
    v_perm_b32 v143, v47, v43, s22
    v_mfma_f32_16x16x32_bf16 a[252:255], v[236:239], v[172:175], a[252:255]
    s_waitcnt vmcnt(8) lgkmcnt(0)
    s_nop 1
    v_mfma_f32_16x16x32_bf16 a[0:3], v[176:179], v[112:115], a[0:3]
    buffer_load_dwordx4 v[16:19], v4, s[12:15], s24 offen
    v_mfma_f32_16x16x32_bf16 a[32:35], v[180:183], v[112:115], a[32:35]
    buffer_load_dwordx4 v[20:23], v4, s[12:15], s25 offen
    v_mfma_f32_16x16x32_bf16 a[64:67], v[184:187], v[112:115], a[64:67]
    buffer_load_dwordx4 v[24:27], v4, s[12:15], s26 offen
    v_mfma_f32_16x16x32_bf16 a[96:99], v[188:191], v[112:115], a[96:99]
    buffer_load_dwordx4 v[28:31], v4, s[12:15], s27 offen
    v_mfma_f32_16x16x32_bf16 a[128:131], v[192:195], v[112:115], a[128:131]
    v_mfma_f32_16x16x32_bf16 a[160:163], v[196:199], v[112:115], a[160:163]
    buffer_load_dwordx4 v[32:35], v4, s[12:15], s28 offen
    v_mfma_f32_16x16x32_bf16 a[192:195], v[200:203], v[112:115], a[192:195]
    buffer_load_dwordx4 v[36:39], v4, s[12:15], s29 offen
    v_mfma_f32_16x16x32_bf16 a[224:227], v[204:207], v[112:115], a[224:227]
    buffer_load_dwordx4 v[40:43], v4, s[12:15], s30 offen
    v_mfma_f32_16x16x32_bf16 a[4:7], v[176:179], v[116:119], a[4:7]
    v_mfma_f32_16x16x32_bf16 a[36:39], v[180:183], v[116:119], a[36:39]
    buffer_load_dwordx4 v[44:47], v4, s[12:15], s31 offen
    v_mfma_f32_16x16x32_bf16 a[68:71], v[184:187], v[116:119], a[68:71]
    v_add_u32 v4, s23, v4
    v_mfma_f32_16x16x32_bf16 a[100:103], v[188:191], v[116:119], a[100:103]
    ds_read_b128 v[208:211], v5 offset:13312
    v_mfma_f32_16x16x32_bf16 a[132:135], v[192:195], v[116:119], a[132:135]
    v_mfma_f32_16x16x32_bf16 a[164:167], v[196:199], v[116:119], a[164:167]
    ds_read_b128 v[212:215], v5 offset:29696
    v_mfma_f32_16x16x32_bf16 a[196:199], v[200:203], v[116:119], a[196:199]
    ds_read_b128 v[216:219], v5 offset:46080
    v_mfma_f32_16x16x32_bf16 a[228:231], v[204:207], v[116:119], a[228:231]
    ds_read_b128 v[220:223], v5 offset:62464
    v_mfma_f32_16x16x32_bf16 a[8:11], v[176:179], v[120:123], a[8:11]
    ds_read_b128 v[224:227], v6 offset:13312
    v_mfma_f32_16x16x32_bf16 a[40:43], v[180:183], v[120:123], a[40:43]
    v_mfma_f32_16x16x32_bf16 a[72:75], v[184:187], v[120:123], a[72:75]
    ds_read_b128 v[228:231], v6 offset:29696
    v_mfma_f32_16x16x32_bf16 a[104:107], v[188:191], v[120:123], a[104:107]
    ds_read_b128 v[232:235], v6 offset:46080
    v_mfma_f32_16x16x32_bf16 a[136:139], v[192:195], v[120:123], a[136:139]
    ds_read_b128 v[236:239], v6 offset:62464
    v_mfma_f32_16x16x32_bf16 a[168:171], v[196:199], v[120:123], a[168:171]
    v_mfma_f32_16x16x32_bf16 a[200:203], v[200:203], v[120:123], a[200:203]
    v_perm_b32 v144, v52, v48, s21
    v_mfma_f32_16x16x32_bf16 a[232:235], v[204:207], v[120:123], a[232:235]
    v_perm_b32 v145, v60, v56, s21
    v_mfma_f32_16x16x32_bf16 a[12:15], v[176:179], v[124:127], a[12:15]
    v_perm_b32 v146, v68, v64, s21
    v_mfma_f32_16x16x32_bf16 a[44:47], v[180:183], v[124:127], a[44:47]
    v_mfma_f32_16x16x32_bf16 a[76:79], v[184:187], v[124:127], a[76:79]
    v_perm_b32 v147, v76, v72, s21
    v_mfma_f32_16x16x32_bf16 a[108:111], v[188:191], v[124:127], a[108:111]
    v_perm_b32 v148, v52, v48, s22
    v_mfma_f32_16x16x32_bf16 a[140:143], v[192:195], v[124:127], a[140:143]
    v_perm_b32 v149, v60, v56, s22
    v_mfma_f32_16x16x32_bf16 a[172:175], v[196:199], v[124:127], a[172:175]
    v_mfma_f32_16x16x32_bf16 a[204:207], v[200:203], v[124:127], a[204:207]
    v_perm_b32 v150, v68, v64, s22
    v_mfma_f32_16x16x32_bf16 a[236:239], v[204:207], v[124:127], a[236:239]
    v_perm_b32 v151, v76, v72, s22
    v_mfma_f32_16x16x32_bf16 a[16:19], v[176:179], v[128:131], a[16:19]
    v_perm_b32 v152, v53, v49, s21
    v_mfma_f32_16x16x32_bf16 a[48:51], v[180:183], v[128:131], a[48:51]
    v_perm_b32 v153, v61, v57, s21
    v_mfma_f32_16x16x32_bf16 a[80:83], v[184:187], v[128:131], a[80:83]
    v_mfma_f32_16x16x32_bf16 a[112:115], v[188:191], v[128:131], a[112:115]
    v_perm_b32 v154, v69, v65, s21
    v_mfma_f32_16x16x32_bf16 a[144:147], v[192:195], v[128:131], a[144:147]
    v_perm_b32 v155, v77, v73, s21
    v_mfma_f32_16x16x32_bf16 a[176:179], v[196:199], v[128:131], a[176:179]
    v_perm_b32 v156, v53, v49, s22
    v_mfma_f32_16x16x32_bf16 a[208:211], v[200:203], v[128:131], a[208:211]
    v_mfma_f32_16x16x32_bf16 a[240:243], v[204:207], v[128:131], a[240:243]
    v_perm_b32 v157, v61, v57, s22
    v_mfma_f32_16x16x32_bf16 a[20:23], v[176:179], v[132:135], a[20:23]
    v_perm_b32 v158, v69, v65, s22
    v_mfma_f32_16x16x32_bf16 a[52:55], v[180:183], v[132:135], a[52:55]
    v_perm_b32 v159, v77, v73, s22
    v_mfma_f32_16x16x32_bf16 a[84:87], v[184:187], v[132:135], a[84:87]
    v_mfma_f32_16x16x32_bf16 a[116:119], v[188:191], v[132:135], a[116:119]
    v_perm_b32 v160, v54, v50, s21
    v_mfma_f32_16x16x32_bf16 a[148:151], v[192:195], v[132:135], a[148:151]
    v_perm_b32 v161, v62, v58, s21
    v_mfma_f32_16x16x32_bf16 a[180:183], v[196:199], v[132:135], a[180:183]
    v_perm_b32 v162, v70, v66, s21
    v_mfma_f32_16x16x32_bf16 a[212:215], v[200:203], v[132:135], a[212:215]
    v_mfma_f32_16x16x32_bf16 a[244:247], v[204:207], v[132:135], a[244:247]
    v_perm_b32 v163, v78, v74, s21
    v_mfma_f32_16x16x32_bf16 a[24:27], v[176:179], v[136:139], a[24:27]
    v_perm_b32 v164, v54, v50, s22
    v_mfma_f32_16x16x32_bf16 a[56:59], v[180:183], v[136:139], a[56:59]
    v_perm_b32 v165, v62, v58, s22
    v_mfma_f32_16x16x32_bf16 a[88:91], v[184:187], v[136:139], a[88:91]
    v_perm_b32 v166, v70, v66, s22
    v_mfma_f32_16x16x32_bf16 a[120:123], v[188:191], v[136:139], a[120:123]
    v_mfma_f32_16x16x32_bf16 a[152:155], v[192:195], v[136:139], a[152:155]
    v_perm_b32 v167, v78, v74, s22
    v_mfma_f32_16x16x32_bf16 a[184:187], v[196:199], v[136:139], a[184:187]
    v_perm_b32 v168, v55, v51, s21
    v_mfma_f32_16x16x32_bf16 a[216:219], v[200:203], v[136:139], a[216:219]
    v_perm_b32 v169, v63, v59, s21
    v_mfma_f32_16x16x32_bf16 a[248:251], v[204:207], v[136:139], a[248:251]
    v_mfma_f32_16x16x32_bf16 a[28:31], v[176:179], v[140:143], a[28:31]
    v_perm_b32 v170, v71, v67, s21
    v_mfma_f32_16x16x32_bf16 a[60:63], v[180:183], v[140:143], a[60:63]
    v_perm_b32 v171, v79, v75, s21
    v_mfma_f32_16x16x32_bf16 a[92:95], v[184:187], v[140:143], a[92:95]
    v_perm_b32 v172, v55, v51, s22
    v_mfma_f32_16x16x32_bf16 a[124:127], v[188:191], v[140:143], a[124:127]
    v_mfma_f32_16x16x32_bf16 a[156:159], v[192:195], v[140:143], a[156:159]
    v_perm_b32 v173, v63, v59, s22
    v_mfma_f32_16x16x32_bf16 a[188:191], v[196:199], v[140:143], a[188:191]
    v_perm_b32 v174, v71, v67, s22
    v_mfma_f32_16x16x32_bf16 a[220:223], v[200:203], v[140:143], a[220:223]
    v_perm_b32 v175, v79, v75, s22
    v_mfma_f32_16x16x32_bf16 a[252:255], v[204:207], v[140:143], a[252:255]
    s_waitcnt vmcnt(8) lgkmcnt(0)
    s_nop 1
    v_mfma_f32_16x16x32_bf16 a[0:3], v[208:211], v[144:147], a[0:3]
    ds_read_b128 v[176:179], v5 offset:14336
    v_mfma_f32_16x16x32_bf16 a[32:35], v[212:215], v[144:147], a[32:35]
    ds_read_b128 v[180:183], v5 offset:30720
    v_mfma_f32_16x16x32_bf16 a[64:67], v[216:219], v[144:147], a[64:67]
    v_mfma_f32_16x16x32_bf16 a[96:99], v[220:223], v[144:147], a[96:99]
    ds_read_b128 v[184:187], v5 offset:47104
    v_mfma_f32_16x16x32_bf16 a[128:131], v[224:227], v[144:147], a[128:131]
    ds_read_b128 v[188:191], v5 offset:63488
    v_mfma_f32_16x16x32_bf16 a[160:163], v[228:231], v[144:147], a[160:163]
    v_mfma_f32_16x16x32_bf16 a[192:195], v[232:235], v[144:147], a[192:195]
    ds_read_b128 v[192:195], v6 offset:14336
    v_mfma_f32_16x16x32_bf16 a[224:227], v[236:239], v[144:147], a[224:227]
    v_mfma_f32_16x16x32_bf16 a[4:7], v[208:211], v[148:151], a[4:7]
    ds_read_b128 v[196:199], v6 offset:30720
    v_mfma_f32_16x16x32_bf16 a[36:39], v[212:215], v[148:151], a[36:39]
    ds_read_b128 v[200:203], v6 offset:47104
    v_mfma_f32_16x16x32_bf16 a[68:71], v[216:219], v[148:151], a[68:71]
    v_mfma_f32_16x16x32_bf16 a[100:103], v[220:223], v[148:151], a[100:103]
    ds_read_b128 v[204:207], v6 offset:63488
    v_mfma_f32_16x16x32_bf16 a[132:135], v[224:227], v[148:151], a[132:135]
    v_perm_b32 v112, v84, v80, s21
    v_mfma_f32_16x16x32_bf16 a[164:167], v[228:231], v[148:151], a[164:167]
    v_mfma_f32_16x16x32_bf16 a[196:199], v[232:235], v[148:151], a[196:199]
    v_perm_b32 v113, v92, v88, s21
    v_mfma_f32_16x16x32_bf16 a[228:231], v[236:239], v[148:151], a[228:231]
    v_mfma_f32_16x16x32_bf16 a[8:11], v[208:211], v[152:155], a[8:11]
    v_perm_b32 v114, v100, v96, s21
    v_mfma_f32_16x16x32_bf16 a[40:43], v[212:215], v[152:155], a[40:43]
    v_perm_b32 v115, v108, v104, s21
    v_mfma_f32_16x16x32_bf16 a[72:75], v[216:219], v[152:155], a[72:75]
    v_mfma_f32_16x16x32_bf16 a[104:107], v[220:223], v[152:155], a[104:107]
    v_perm_b32 v116, v84, v80, s22
    v_mfma_f32_16x16x32_bf16 a[136:139], v[224:227], v[152:155], a[136:139]
    v_perm_b32 v117, v92, v88, s22
    v_mfma_f32_16x16x32_bf16 a[168:171], v[228:231], v[152:155], a[168:171]
    v_mfma_f32_16x16x32_bf16 a[200:203], v[232:235], v[152:155], a[200:203]
    v_perm_b32 v118, v100, v96, s22
    v_mfma_f32_16x16x32_bf16 a[232:235], v[236:239], v[152:155], a[232:235]
    v_mfma_f32_16x16x32_bf16 a[12:15], v[208:211], v[156:159], a[12:15]
    v_perm_b32 v119, v108, v104, s22
    v_mfma_f32_16x16x32_bf16 a[44:47], v[212:215], v[156:159], a[44:47]
    v_perm_b32 v120, v85, v81, s21
    v_mfma_f32_16x16x32_bf16 a[76:79], v[216:219], v[156:159], a[76:79]
    v_mfma_f32_16x16x32_bf16 a[108:111], v[220:223], v[156:159], a[108:111]
    v_perm_b32 v121, v93, v89, s21
    v_mfma_f32_16x16x32_bf16 a[140:143], v[224:227], v[156:159], a[140:143]
    v_perm_b32 v122, v101, v97, s21
    v_mfma_f32_16x16x32_bf16 a[172:175], v[228:231], v[156:159], a[172:175]
    v_mfma_f32_16x16x32_bf16 a[204:207], v[232:235], v[156:159], a[204:207]
    v_perm_b32 v123, v109, v105, s21
    v_mfma_f32_16x16x32_bf16 a[236:239], v[236:239], v[156:159], a[236:239]
    v_mfma_f32_16x16x32_bf16 a[16:19], v[208:211], v[160:163], a[16:19]
    v_perm_b32 v124, v85, v81, s22
    v_mfma_f32_16x16x32_bf16 a[48:51], v[212:215], v[160:163], a[48:51]
    v_perm_b32 v125, v93, v89, s22
    v_mfma_f32_16x16x32_bf16 a[80:83], v[216:219], v[160:163], a[80:83]
    v_mfma_f32_16x16x32_bf16 a[112:115], v[220:223], v[160:163], a[112:115]
    v_perm_b32 v126, v101, v97, s22
    v_mfma_f32_16x16x32_bf16 a[144:147], v[224:227], v[160:163], a[144:147]
    v_perm_b32 v127, v109, v105, s22
    v_mfma_f32_16x16x32_bf16 a[176:179], v[228:231], v[160:163], a[176:179]
    v_mfma_f32_16x16x32_bf16 a[208:211], v[232:235], v[160:163], a[208:211]
    v_perm_b32 v128, v86, v82, s21
    v_mfma_f32_16x16x32_bf16 a[240:243], v[236:239], v[160:163], a[240:243]
    v_mfma_f32_16x16x32_bf16 a[20:23], v[208:211], v[164:167], a[20:23]
    v_perm_b32 v129, v94, v90, s21
    v_mfma_f32_16x16x32_bf16 a[52:55], v[212:215], v[164:167], a[52:55]
    v_perm_b32 v130, v102, v98, s21
    v_mfma_f32_16x16x32_bf16 a[84:87], v[216:219], v[164:167], a[84:87]
    v_mfma_f32_16x16x32_bf16 a[116:119], v[220:223], v[164:167], a[116:119]
    v_perm_b32 v131, v110, v106, s21
    v_mfma_f32_16x16x32_bf16 a[148:151], v[224:227], v[164:167], a[148:151]
    v_perm_b32 v132, v86, v82, s22
    v_mfma_f32_16x16x32_bf16 a[180:183], v[228:231], v[164:167], a[180:183]
    v_mfma_f32_16x16x32_bf16 a[212:215], v[232:235], v[164:167], a[212:215]
    v_perm_b32 v133, v94, v90, s22
    v_mfma_f32_16x16x32_bf16 a[244:247], v[236:239], v[164:167], a[244:247]
    v_mfma_f32_16x16x32_bf16 a[24:27], v[208:211], v[168:171], a[24:27]
    v_perm_b32 v134, v102, v98, s22
    v_mfma_f32_16x16x32_bf16 a[56:59], v[212:215], v[168:171], a[56:59]
    v_perm_b32 v135, v110, v106, s22
    v_mfma_f32_16x16x32_bf16 a[88:91], v[216:219], v[168:171], a[88:91]
    v_mfma_f32_16x16x32_bf16 a[120:123], v[220:223], v[168:171], a[120:123]
    v_perm_b32 v136, v87, v83, s21
    v_mfma_f32_16x16x32_bf16 a[152:155], v[224:227], v[168:171], a[152:155]
    v_perm_b32 v137, v95, v91, s21
    v_mfma_f32_16x16x32_bf16 a[184:187], v[228:231], v[168:171], a[184:187]
    v_mfma_f32_16x16x32_bf16 a[216:219], v[232:235], v[168:171], a[216:219]
    v_perm_b32 v138, v103, v99, s21
    v_mfma_f32_16x16x32_bf16 a[248:251], v[236:239], v[168:171], a[248:251]
    v_mfma_f32_16x16x32_bf16 a[28:31], v[208:211], v[172:175], a[28:31]
    v_perm_b32 v139, v111, v107, s21
    v_mfma_f32_16x16x32_bf16 a[60:63], v[212:215], v[172:175], a[60:63]
    v_perm_b32 v140, v87, v83, s22
    v_mfma_f32_16x16x32_bf16 a[92:95], v[216:219], v[172:175], a[92:95]
    v_mfma_f32_16x16x32_bf16 a[124:127], v[220:223], v[172:175], a[124:127]
    v_perm_b32 v141, v95, v91, s22
    v_mfma_f32_16x16x32_bf16 a[156:159], v[224:227], v[172:175], a[156:159]
    v_perm_b32 v142, v103, v99, s22
    v_mfma_f32_16x16x32_bf16 a[188:191], v[228:231], v[172:175], a[188:191]
    v_mfma_f32_16x16x32_bf16 a[220:223], v[232:235], v[172:175], a[220:223]
    v_perm_b32 v143, v111, v107, s22
    v_mfma_f32_16x16x32_bf16 a[252:255], v[236:239], v[172:175], a[252:255]
    s_waitcnt vmcnt(0) lgkmcnt(0)
    s_nop 1
    v_mfma_f32_16x16x32_bf16 a[0:3], v[176:179], v[112:115], a[0:3]
    ds_read_b128 v[208:211], v5 offset:15360
    v_mfma_f32_16x16x32_bf16 a[32:35], v[180:183], v[112:115], a[32:35]
    ds_read_b128 v[212:215], v5 offset:31744
    v_mfma_f32_16x16x32_bf16 a[64:67], v[184:187], v[112:115], a[64:67]
    v_mfma_f32_16x16x32_bf16 a[96:99], v[188:191], v[112:115], a[96:99]
    ds_read_b128 v[216:219], v5 offset:48128
    v_mfma_f32_16x16x32_bf16 a[128:131], v[192:195], v[112:115], a[128:131]
    ds_read_b128 v[220:223], v5 offset:64512
    v_mfma_f32_16x16x32_bf16 a[160:163], v[196:199], v[112:115], a[160:163]
    v_mfma_f32_16x16x32_bf16 a[192:195], v[200:203], v[112:115], a[192:195]
    ds_read_b128 v[224:227], v6 offset:15360
    v_mfma_f32_16x16x32_bf16 a[224:227], v[204:207], v[112:115], a[224:227]
    v_mfma_f32_16x16x32_bf16 a[4:7], v[176:179], v[116:119], a[4:7]
    ds_read_b128 v[228:231], v6 offset:31744
    v_mfma_f32_16x16x32_bf16 a[36:39], v[180:183], v[116:119], a[36:39]
    ds_read_b128 v[232:235], v6 offset:48128
    v_mfma_f32_16x16x32_bf16 a[68:71], v[184:187], v[116:119], a[68:71]
    v_mfma_f32_16x16x32_bf16 a[100:103], v[188:191], v[116:119], a[100:103]
    ds_read_b128 v[236:239], v6 offset:64512
    v_mfma_f32_16x16x32_bf16 a[132:135], v[192:195], v[116:119], a[132:135]
    v_perm_b32 v144, v20, v16, s21
    v_mfma_f32_16x16x32_bf16 a[164:167], v[196:199], v[116:119], a[164:167]
    v_mfma_f32_16x16x32_bf16 a[196:199], v[200:203], v[116:119], a[196:199]
    v_perm_b32 v145, v28, v24, s21
    v_mfma_f32_16x16x32_bf16 a[228:231], v[204:207], v[116:119], a[228:231]
    v_mfma_f32_16x16x32_bf16 a[8:11], v[176:179], v[120:123], a[8:11]
    v_perm_b32 v146, v36, v32, s21
    v_mfma_f32_16x16x32_bf16 a[40:43], v[180:183], v[120:123], a[40:43]
    v_perm_b32 v147, v44, v40, s21
    v_mfma_f32_16x16x32_bf16 a[72:75], v[184:187], v[120:123], a[72:75]
    v_mfma_f32_16x16x32_bf16 a[104:107], v[188:191], v[120:123], a[104:107]
    v_perm_b32 v148, v20, v16, s22
    v_mfma_f32_16x16x32_bf16 a[136:139], v[192:195], v[120:123], a[136:139]
    v_perm_b32 v149, v28, v24, s22
    v_mfma_f32_16x16x32_bf16 a[168:171], v[196:199], v[120:123], a[168:171]
    v_mfma_f32_16x16x32_bf16 a[200:203], v[200:203], v[120:123], a[200:203]
    v_perm_b32 v150, v36, v32, s22
    v_mfma_f32_16x16x32_bf16 a[232:235], v[204:207], v[120:123], a[232:235]
    v_mfma_f32_16x16x32_bf16 a[12:15], v[176:179], v[124:127], a[12:15]
    v_perm_b32 v151, v44, v40, s22
    v_mfma_f32_16x16x32_bf16 a[44:47], v[180:183], v[124:127], a[44:47]
    v_perm_b32 v152, v21, v17, s21
    v_mfma_f32_16x16x32_bf16 a[76:79], v[184:187], v[124:127], a[76:79]
    v_mfma_f32_16x16x32_bf16 a[108:111], v[188:191], v[124:127], a[108:111]
    v_perm_b32 v153, v29, v25, s21
    v_mfma_f32_16x16x32_bf16 a[140:143], v[192:195], v[124:127], a[140:143]
    v_perm_b32 v154, v37, v33, s21
    v_mfma_f32_16x16x32_bf16 a[172:175], v[196:199], v[124:127], a[172:175]
    v_mfma_f32_16x16x32_bf16 a[204:207], v[200:203], v[124:127], a[204:207]
    v_perm_b32 v155, v45, v41, s21
    v_mfma_f32_16x16x32_bf16 a[236:239], v[204:207], v[124:127], a[236:239]
    v_mfma_f32_16x16x32_bf16 a[16:19], v[176:179], v[128:131], a[16:19]
    v_perm_b32 v156, v21, v17, s22
    v_mfma_f32_16x16x32_bf16 a[48:51], v[180:183], v[128:131], a[48:51]
    v_perm_b32 v157, v29, v25, s22
    v_mfma_f32_16x16x32_bf16 a[80:83], v[184:187], v[128:131], a[80:83]
    v_mfma_f32_16x16x32_bf16 a[112:115], v[188:191], v[128:131], a[112:115]
    v_perm_b32 v158, v37, v33, s22
    v_mfma_f32_16x16x32_bf16 a[144:147], v[192:195], v[128:131], a[144:147]
    v_perm_b32 v159, v45, v41, s22
    v_mfma_f32_16x16x32_bf16 a[176:179], v[196:199], v[128:131], a[176:179]
    v_mfma_f32_16x16x32_bf16 a[208:211], v[200:203], v[128:131], a[208:211]
    v_perm_b32 v160, v22, v18, s21
    v_mfma_f32_16x16x32_bf16 a[240:243], v[204:207], v[128:131], a[240:243]
    v_mfma_f32_16x16x32_bf16 a[20:23], v[176:179], v[132:135], a[20:23]
    v_perm_b32 v161, v30, v26, s21
    v_mfma_f32_16x16x32_bf16 a[52:55], v[180:183], v[132:135], a[52:55]
    v_perm_b32 v162, v38, v34, s21
    v_mfma_f32_16x16x32_bf16 a[84:87], v[184:187], v[132:135], a[84:87]
    v_mfma_f32_16x16x32_bf16 a[116:119], v[188:191], v[132:135], a[116:119]
    v_perm_b32 v163, v46, v42, s21
    v_mfma_f32_16x16x32_bf16 a[148:151], v[192:195], v[132:135], a[148:151]
    v_perm_b32 v164, v22, v18, s22
    v_mfma_f32_16x16x32_bf16 a[180:183], v[196:199], v[132:135], a[180:183]
    v_mfma_f32_16x16x32_bf16 a[212:215], v[200:203], v[132:135], a[212:215]
    v_perm_b32 v165, v30, v26, s22
    v_mfma_f32_16x16x32_bf16 a[244:247], v[204:207], v[132:135], a[244:247]
    v_mfma_f32_16x16x32_bf16 a[24:27], v[176:179], v[136:139], a[24:27]
    v_perm_b32 v166, v38, v34, s22
    v_mfma_f32_16x16x32_bf16 a[56:59], v[180:183], v[136:139], a[56:59]
    v_perm_b32 v167, v46, v42, s22
    v_mfma_f32_16x16x32_bf16 a[88:91], v[184:187], v[136:139], a[88:91]
    v_mfma_f32_16x16x32_bf16 a[120:123], v[188:191], v[136:139], a[120:123]
    v_perm_b32 v168, v23, v19, s21
    v_mfma_f32_16x16x32_bf16 a[152:155], v[192:195], v[136:139], a[152:155]
    v_perm_b32 v169, v31, v27, s21
    v_mfma_f32_16x16x32_bf16 a[184:187], v[196:199], v[136:139], a[184:187]
    v_mfma_f32_16x16x32_bf16 a[216:219], v[200:203], v[136:139], a[216:219]
    v_perm_b32 v170, v39, v35, s21
    v_mfma_f32_16x16x32_bf16 a[248:251], v[204:207], v[136:139], a[248:251]
    v_mfma_f32_16x16x32_bf16 a[28:31], v[176:179], v[140:143], a[28:31]
    v_perm_b32 v171, v47, v43, s21
    v_mfma_f32_16x16x32_bf16 a[60:63], v[180:183], v[140:143], a[60:63]
    v_perm_b32 v172, v23, v19, s22
    v_mfma_f32_16x16x32_bf16 a[92:95], v[184:187], v[140:143], a[92:95]
    v_mfma_f32_16x16x32_bf16 a[124:127], v[188:191], v[140:143], a[124:127]
    v_perm_b32 v173, v31, v27, s22
    v_mfma_f32_16x16x32_bf16 a[156:159], v[192:195], v[140:143], a[156:159]
    v_perm_b32 v174, v39, v35, s22
    v_mfma_f32_16x16x32_bf16 a[188:191], v[196:199], v[140:143], a[188:191]
    v_mfma_f32_16x16x32_bf16 a[220:223], v[200:203], v[140:143], a[220:223]
    v_perm_b32 v175, v47, v43, s22
    v_mfma_f32_16x16x32_bf16 a[252:255], v[204:207], v[140:143], a[252:255]
    s_waitcnt vmcnt(0) lgkmcnt(0)
    s_nop 1
    v_mfma_f32_16x16x32_bf16 a[0:3], v[208:211], v[144:147], a[0:3]
    v_mfma_f32_16x16x32_bf16 a[32:35], v[212:215], v[144:147], a[32:35]
    v_mfma_f32_16x16x32_bf16 a[64:67], v[216:219], v[144:147], a[64:67]
    v_mfma_f32_16x16x32_bf16 a[96:99], v[220:223], v[144:147], a[96:99]
    v_mfma_f32_16x16x32_bf16 a[128:131], v[224:227], v[144:147], a[128:131]
    v_mfma_f32_16x16x32_bf16 a[160:163], v[228:231], v[144:147], a[160:163]
    v_mfma_f32_16x16x32_bf16 a[192:195], v[232:235], v[144:147], a[192:195]
    v_mfma_f32_16x16x32_bf16 a[224:227], v[236:239], v[144:147], a[224:227]
    v_mfma_f32_16x16x32_bf16 a[4:7], v[208:211], v[148:151], a[4:7]
    v_mfma_f32_16x16x32_bf16 a[36:39], v[212:215], v[148:151], a[36:39]
    v_mfma_f32_16x16x32_bf16 a[68:71], v[216:219], v[148:151], a[68:71]
    v_mfma_f32_16x16x32_bf16 a[100:103], v[220:223], v[148:151], a[100:103]
    v_mfma_f32_16x16x32_bf16 a[132:135], v[224:227], v[148:151], a[132:135]
    v_mfma_f32_16x16x32_bf16 a[164:167], v[228:231], v[148:151], a[164:167]
    v_mfma_f32_16x16x32_bf16 a[196:199], v[232:235], v[148:151], a[196:199]
    v_mfma_f32_16x16x32_bf16 a[228:231], v[236:239], v[148:151], a[228:231]
    v_mfma_f32_16x16x32_bf16 a[8:11], v[208:211], v[152:155], a[8:11]
    v_mfma_f32_16x16x32_bf16 a[40:43], v[212:215], v[152:155], a[40:43]
    v_mfma_f32_16x16x32_bf16 a[72:75], v[216:219], v[152:155], a[72:75]
    v_mfma_f32_16x16x32_bf16 a[104:107], v[220:223], v[152:155], a[104:107]
    v_mfma_f32_16x16x32_bf16 a[136:139], v[224:227], v[152:155], a[136:139]
    v_mfma_f32_16x16x32_bf16 a[168:171], v[228:231], v[152:155], a[168:171]
    v_mfma_f32_16x16x32_bf16 a[200:203], v[232:235], v[152:155], a[200:203]
    v_mfma_f32_16x16x32_bf16 a[232:235], v[236:239], v[152:155], a[232:235]
    v_mfma_f32_16x16x32_bf16 a[12:15], v[208:211], v[156:159], a[12:15]
    v_mfma_f32_16x16x32_bf16 a[44:47], v[212:215], v[156:159], a[44:47]
    v_mfma_f32_16x16x32_bf16 a[76:79], v[216:219], v[156:159], a[76:79]
    v_mfma_f32_16x16x32_bf16 a[108:111], v[220:223], v[156:159], a[108:111]
    v_mfma_f32_16x16x32_bf16 a[140:143], v[224:227], v[156:159], a[140:143]
    v_mfma_f32_16x16x32_bf16 a[172:175], v[228:231], v[156:159], a[172:175]
    v_mfma_f32_16x16x32_bf16 a[204:207], v[232:235], v[156:159], a[204:207]
    v_mfma_f32_16x16x32_bf16 a[236:239], v[236:239], v[156:159], a[236:239]
    v_mfma_f32_16x16x32_bf16 a[16:19], v[208:211], v[160:163], a[16:19]
    v_mfma_f32_16x16x32_bf16 a[48:51], v[212:215], v[160:163], a[48:51]
    v_mfma_f32_16x16x32_bf16 a[80:83], v[216:219], v[160:163], a[80:83]
    v_mfma_f32_16x16x32_bf16 a[112:115], v[220:223], v[160:163], a[112:115]
    v_mfma_f32_16x16x32_bf16 a[144:147], v[224:227], v[160:163], a[144:147]
    v_mfma_f32_16x16x32_bf16 a[176:179], v[228:231], v[160:163], a[176:179]
    v_mfma_f32_16x16x32_bf16 a[208:211], v[232:235], v[160:163], a[208:211]
    v_mfma_f32_16x16x32_bf16 a[240:243], v[236:239], v[160:163], a[240:243]
    v_mfma_f32_16x16x32_bf16 a[20:23], v[208:211], v[164:167], a[20:23]
    v_mfma_f32_16x16x32_bf16 a[52:55], v[212:215], v[164:167], a[52:55]
    v_mfma_f32_16x16x32_bf16 a[84:87], v[216:219], v[164:167], a[84:87]
    v_mfma_f32_16x16x32_bf16 a[116:119], v[220:223], v[164:167], a[116:119]
    v_mfma_f32_16x16x32_bf16 a[148:151], v[224:227], v[164:167], a[148:151]
    v_mfma_f32_16x16x32_bf16 a[180:183], v[228:231], v[164:167], a[180:183]
    v_mfma_f32_16x16x32_bf16 a[212:215], v[232:235], v[164:167], a[212:215]
    v_mfma_f32_16x16x32_bf16 a[244:247], v[236:239], v[164:167], a[244:247]
    v_mfma_f32_16x16x32_bf16 a[24:27], v[208:211], v[168:171], a[24:27]
    v_mfma_f32_16x16x32_bf16 a[56:59], v[212:215], v[168:171], a[56:59]
    v_mfma_f32_16x16x32_bf16 a[88:91], v[216:219], v[168:171], a[88:91]
    v_mfma_f32_16x16x32_bf16 a[120:123], v[220:223], v[168:171], a[120:123]
    v_mfma_f32_16x16x32_bf16 a[152:155], v[224:227], v[168:171], a[152:155]
    v_mfma_f32_16x16x32_bf16 a[184:187], v[228:231], v[168:171], a[184:187]
    v_mfma_f32_16x16x32_bf16 a[216:219], v[232:235], v[168:171], a[216:219]
    v_mfma_f32_16x16x32_bf16 a[248:251], v[236:239], v[168:171], a[248:251]
    v_mfma_f32_16x16x32_bf16 a[28:31], v[208:211], v[172:175], a[28:31]
    v_mfma_f32_16x16x32_bf16 a[60:63], v[212:215], v[172:175], a[60:63]
    v_mfma_f32_16x16x32_bf16 a[92:95], v[216:219], v[172:175], a[92:95]
    v_mfma_f32_16x16x32_bf16 a[124:127], v[220:223], v[172:175], a[124:127]
    v_mfma_f32_16x16x32_bf16 a[156:159], v[224:227], v[172:175], a[156:159]
    v_mfma_f32_16x16x32_bf16 a[188:191], v[228:231], v[172:175], a[188:191]
    v_mfma_f32_16x16x32_bf16 a[220:223], v[232:235], v[172:175], a[220:223]
    v_mfma_f32_16x16x32_bf16 a[252:255], v[236:239], v[172:175], a[252:255]
    s_nop 7
    s_nop 7
    s_lshl_b32 s40, s33, 7
    s_add_u32 s40, s40, s37
    s_lshl_b32 s40, s40, 13
    s_cmp_eq_u32 s36, 2
    s_cbranch_scc1 Lv_56
    s_lshl_b32 s41, s36, 24
    s_add_u32 s41, s41, 0x2000000
    s_add_u32 s40, s40, s41
    v_lshrrev_b32 v8, 2, v2
    v_lshlrev_b32 v8, 10, v8
    v_and_b32 v9, 3, v2
    v_lshl_add_u32 v8, v9, 8, v8
    v_lshl_add_u32 v8, v3, 6, v8
    s_lshl_b32 s43, s4, 13
    s_add_u32 s43, s43, 0x20000
    v_add_u32 v8, s43, v8
    v_add_u32 v9, s43, v5
    v_accvgpr_read_b32 v16, a0
    v_accvgpr_read_b32 v17, a4
    v_accvgpr_read_b32 v18, a8
    v_accvgpr_read_b32 v19, a12
    v_accvgpr_read_b32 v20, a16
    v_accvgpr_read_b32 v21, a20
    v_accvgpr_read_b32 v22, a24
    v_accvgpr_read_b32 v23, a28
    v_cvt_pk_bf16_f32 v24, v16, v17
    v_cvt_pk_bf16_f32 v25, v18, v19
    v_cvt_pk_bf16_f32 v26, v20, v21
    v_cvt_pk_bf16_f32 v27, v22, v23
    ds_write_b128 v8, v[24:27] offset:0
    v_accvgpr_read_b32 v28, a1
    v_accvgpr_read_b32 v29, a5
    v_accvgpr_read_b32 v30, a9
    v_accvgpr_read_b32 v31, a13
    v_accvgpr_read_b32 v32, a17
    v_accvgpr_read_b32 v33, a21
    v_accvgpr_read_b32 v34, a25
    v_accvgpr_read_b32 v35, a29
    v_cvt_pk_bf16_f32 v36, v28, v29
    v_cvt_pk_bf16_f32 v37, v30, v31
    v_cvt_pk_bf16_f32 v38, v32, v33
    v_cvt_pk_bf16_f32 v39, v34, v35
    ds_write_b128 v8, v[36:39] offset:16
    v_accvgpr_read_b32 v40, a2
    v_accvgpr_read_b32 v41, a6
    v_accvgpr_read_b32 v42, a10
    v_accvgpr_read_b32 v43, a14
    v_accvgpr_read_b32 v44, a18
    v_accvgpr_read_b32 v45, a22
    v_accvgpr_read_b32 v46, a26
    v_accvgpr_read_b32 v47, a30
    v_cvt_pk_bf16_f32 v48, v40, v41
    v_cvt_pk_bf16_f32 v49, v42, v43
    v_cvt_pk_bf16_f32 v50, v44, v45
    v_cvt_pk_bf16_f32 v51, v46, v47
    ds_write_b128 v8, v[48:51] offset:32
    v_accvgpr_read_b32 v52, a3
    v_accvgpr_read_b32 v53, a7
    v_accvgpr_read_b32 v54, a11
    v_accvgpr_read_b32 v55, a15
    v_accvgpr_read_b32 v56, a19
    v_accvgpr_read_b32 v57, a23
    v_accvgpr_read_b32 v58, a27
    v_accvgpr_read_b32 v59, a31
    v_cvt_pk_bf16_f32 v60, v52, v53
    v_cvt_pk_bf16_f32 v61, v54, v55
    v_cvt_pk_bf16_f32 v62, v56, v57
    v_cvt_pk_bf16_f32 v63, v58, v59
    ds_write_b128 v8, v[60:63] offset:48
    v_accvgpr_read_b32 v64, a32
    v_accvgpr_read_b32 v65, a36
    v_accvgpr_read_b32 v66, a40
    v_accvgpr_read_b32 v67, a44
    v_accvgpr_read_b32 v68, a48
    v_accvgpr_read_b32 v69, a52
    v_accvgpr_read_b32 v70, a56
    v_accvgpr_read_b32 v71, a60
    v_cvt_pk_bf16_f32 v72, v64, v65
    v_cvt_pk_bf16_f32 v73, v66, v67
    v_cvt_pk_bf16_f32 v74, v68, v69
    v_cvt_pk_bf16_f32 v75, v70, v71
    ds_write_b128 v8, v[72:75] offset:4096
    v_accvgpr_read_b32 v76, a33
    v_accvgpr_read_b32 v77, a37
    v_accvgpr_read_b32 v78, a41
    v_accvgpr_read_b32 v79, a45
    v_accvgpr_read_b32 v80, a49
    v_accvgpr_read_b32 v81, a53
    v_accvgpr_read_b32 v82, a57
    v_accvgpr_read_b32 v83, a61
    v_cvt_pk_bf16_f32 v84, v76, v77
    v_cvt_pk_bf16_f32 v85, v78, v79
    v_cvt_pk_bf16_f32 v86, v80, v81
    v_cvt_pk_bf16_f32 v87, v82, v83
    ds_write_b128 v8, v[84:87] offset:4112
    v_accvgpr_read_b32 v88, a34
    v_accvgpr_read_b32 v89, a38
    v_accvgpr_read_b32 v90, a42
    v_accvgpr_read_b32 v91, a46
    v_accvgpr_read_b32 v92, a50
    v_accvgpr_read_b32 v93, a54
    v_accvgpr_read_b32 v94, a58
    v_accvgpr_read_b32 v95, a62
    v_cvt_pk_bf16_f32 v96, v88, v89
    v_cvt_pk_bf16_f32 v97, v90, v91
    v_cvt_pk_bf16_f32 v98, v92, v93
    v_cvt_pk_bf16_f32 v99, v94, v95
    ds_write_b128 v8, v[96:99] offset:4128
    v_accvgpr_read_b32 v100, a35
    v_accvgpr_read_b32 v101, a39
    v_accvgpr_read_b32 v102, a43
    v_accvgpr_read_b32 v103, a47
    v_accvgpr_read_b32 v104, a51
    v_accvgpr_read_b32 v105, a55
    v_accvgpr_read_b32 v106, a59
    v_accvgpr_read_b32 v107, a63
    v_cvt_pk_bf16_f32 v108, v100, v101
    v_cvt_pk_bf16_f32 v109, v102, v103
    v_cvt_pk_bf16_f32 v110, v104, v105
    v_cvt_pk_bf16_f32 v111, v106, v107
    ds_write_b128 v8, v[108:111] offset:4144
    s_waitcnt lgkmcnt(0)
    ds_read_b128 v[128:131], v9 offset:0
    ds_read_b128 v[132:135], v9 offset:1024
    ds_read_b128 v[136:139], v9 offset:2048
    ds_read_b128 v[140:143], v9 offset:3072
    ds_read_b128 v[144:147], v9 offset:4096
    ds_read_b128 v[148:151], v9 offset:5120
    ds_read_b128 v[152:155], v9 offset:6144
    ds_read_b128 v[156:159], v9 offset:7168
    s_mov_b32 s41, 0
    s_add_u32 s41, s41, s40
    s_add_u32 s43, s41, 4096
    s_waitcnt lgkmcnt(7)
    buffer_store_dwordx4 v[128:131], v5, s[8:11], s41 offen offset:0 sc1
    s_waitcnt lgkmcnt(6)
    buffer_store_dwordx4 v[132:135], v5, s[8:11], s41 offen offset:1024 sc1
    s_waitcnt lgkmcnt(5)
    buffer_store_dwordx4 v[136:139], v5, s[8:11], s41 offen offset:2048 sc1
    s_waitcnt lgkmcnt(4)
    buffer_store_dwordx4 v[140:143], v5, s[8:11], s41 offen offset:3072 sc1
    s_waitcnt lgkmcnt(3)
    buffer_store_dwordx4 v[144:147], v5, s[8:11], s43 offen offset:0 sc1
    s_waitcnt lgkmcnt(2)
    buffer_store_dwordx4 v[148:151], v5, s[8:11], s43 offen offset:1024 sc1
    s_waitcnt lgkmcnt(1)
    buffer_store_dwordx4 v[152:155], v5, s[8:11], s43 offen offset:2048 sc1
    s_waitcnt lgkmcnt(0)
    buffer_store_dwordx4 v[156:159], v5, s[8:11], s43 offen offset:3072 sc1
    v_accvgpr_read_b32 v16, a64
    v_accvgpr_read_b32 v17, a68
    v_accvgpr_read_b32 v18, a72
    v_accvgpr_read_b32 v19, a76
    v_accvgpr_read_b32 v20, a80
    v_accvgpr_read_b32 v21, a84
    v_accvgpr_read_b32 v22, a88
    v_accvgpr_read_b32 v23, a92
    v_cvt_pk_bf16_f32 v24, v16, v17
    v_cvt_pk_bf16_f32 v25, v18, v19
    v_cvt_pk_bf16_f32 v26, v20, v21
    v_cvt_pk_bf16_f32 v27, v22, v23
    ds_write_b128 v8, v[24:27] offset:0
    v_accvgpr_read_b32 v28, a65
    v_accvgpr_read_b32 v29, a69
    v_accvgpr_read_b32 v30, a73
    v_accvgpr_read_b32 v31, a77
    v_accvgpr_read_b32 v32, a81
    v_accvgpr_read_b32 v33, a85
    v_accvgpr_read_b32 v34, a89
    v_accvgpr_read_b32 v35, a93
    v_cvt_pk_bf16_f32 v36, v28, v29
    v_cvt_pk_bf16_f32 v37, v30, v31
    v_cvt_pk_bf16_f32 v38, v32, v33
    v_cvt_pk_bf16_f32 v39, v34, v35
    ds_write_b128 v8, v[36:39] offset:16
    v_accvgpr_read_b32 v40, a66
    v_accvgpr_read_b32 v41, a70
    v_accvgpr_read_b32 v42, a74
    v_accvgpr_read_b32 v43, a78
    v_accvgpr_read_b32 v44, a82
    v_accvgpr_read_b32 v45, a86
    v_accvgpr_read_b32 v46, a90
    v_accvgpr_read_b32 v47, a94
    v_cvt_pk_bf16_f32 v48, v40, v41
    v_cvt_pk_bf16_f32 v49, v42, v43
    v_cvt_pk_bf16_f32 v50, v44, v45
    v_cvt_pk_bf16_f32 v51, v46, v47
    ds_write_b128 v8, v[48:51] offset:32
    v_accvgpr_read_b32 v52, a67
    v_accvgpr_read_b32 v53, a71
    v_accvgpr_read_b32 v54, a75
    v_accvgpr_read_b32 v55, a79
    v_accvgpr_read_b32 v56, a83
    v_accvgpr_read_b32 v57, a87
    v_accvgpr_read_b32 v58, a91
    v_accvgpr_read_b32 v59, a95
    v_cvt_pk_bf16_f32 v60, v52, v53
    v_cvt_pk_bf16_f32 v61, v54, v55
    v_cvt_pk_bf16_f32 v62, v56, v57
    v_cvt_pk_bf16_f32 v63, v58, v59
    ds_write_b128 v8, v[60:63] offset:48
    v_accvgpr_read_b32 v64, a96
    v_accvgpr_read_b32 v65, a100
    v_accvgpr_read_b32 v66, a104
    v_accvgpr_read_b32 v67, a108
    v_accvgpr_read_b32 v68, a112
    v_accvgpr_read_b32 v69, a116
    v_accvgpr_read_b32 v70, a120
    v_accvgpr_read_b32 v71, a124
    v_cvt_pk_bf16_f32 v72, v64, v65
    v_cvt_pk_bf16_f32 v73, v66, v67
    v_cvt_pk_bf16_f32 v74, v68, v69
    v_cvt_pk_bf16_f32 v75, v70, v71
    ds_write_b128 v8, v[72:75] offset:4096
    v_accvgpr_read_b32 v76, a97
    v_accvgpr_read_b32 v77, a101
    v_accvgpr_read_b32 v78, a105
    v_accvgpr_read_b32 v79, a109
    v_accvgpr_read_b32 v80, a113
    v_accvgpr_read_b32 v81, a117
    v_accvgpr_read_b32 v82, a121
    v_accvgpr_read_b32 v83, a125
    v_cvt_pk_bf16_f32 v84, v76, v77
    v_cvt_pk_bf16_f32 v85, v78, v79
    v_cvt_pk_bf16_f32 v86, v80, v81
    v_cvt_pk_bf16_f32 v87, v82, v83
    ds_write_b128 v8, v[84:87] offset:4112
    v_accvgpr_read_b32 v88, a98
    v_accvgpr_read_b32 v89, a102
    v_accvgpr_read_b32 v90, a106
    v_accvgpr_read_b32 v91, a110
    v_accvgpr_read_b32 v92, a114
    v_accvgpr_read_b32 v93, a118
    v_accvgpr_read_b32 v94, a122
    v_accvgpr_read_b32 v95, a126
    v_cvt_pk_bf16_f32 v96, v88, v89
    v_cvt_pk_bf16_f32 v97, v90, v91
    v_cvt_pk_bf16_f32 v98, v92, v93
    v_cvt_pk_bf16_f32 v99, v94, v95
    ds_write_b128 v8, v[96:99] offset:4128
    v_accvgpr_read_b32 v100, a99
    v_accvgpr_read_b32 v101, a103
    v_accvgpr_read_b32 v102, a107
    v_accvgpr_read_b32 v103, a111
    v_accvgpr_read_b32 v104, a115
    v_accvgpr_read_b32 v105, a119
    v_accvgpr_read_b32 v106, a123
    v_accvgpr_read_b32 v107, a127
    v_cvt_pk_bf16_f32 v108, v100, v101
    v_cvt_pk_bf16_f32 v109, v102, v103
    v_cvt_pk_bf16_f32 v110, v104, v105
    v_cvt_pk_bf16_f32 v111, v106, v107
    ds_write_b128 v8, v[108:111] offset:4144
    s_waitcnt lgkmcnt(0)
    ds_read_b128 v[160:163], v9 offset:0
    ds_read_b128 v[164:167], v9 offset:1024
    ds_read_b128 v[168:171], v9 offset:2048
    ds_read_b128 v[172:175], v9 offset:3072
    ds_read_b128 v[176:179], v9 offset:4096
    ds_read_b128 v[180:183], v9 offset:5120
    ds_read_b128 v[184:187], v9 offset:6144
    ds_read_b128 v[188:191], v9 offset:7168
    s_mov_b32 s41, 0x40000
    s_add_u32 s41, s41, s40
    s_add_u32 s43, s41, 4096
    s_waitcnt lgkmcnt(7)
    buffer_store_dwordx4 v[160:163], v5, s[8:11], s41 offen offset:0 sc1
    s_waitcnt lgkmcnt(6)
    buffer_store_dwordx4 v[164:167], v5, s[8:11], s41 offen offset:1024 sc1
    s_waitcnt lgkmcnt(5)
    buffer_store_dwordx4 v[168:171], v5, s[8:11], s41 offen offset:2048 sc1
    s_waitcnt lgkmcnt(4)
    buffer_store_dwordx4 v[172:175], v5, s[8:11], s41 offen offset:3072 sc1
    s_waitcnt lgkmcnt(3)
    buffer_store_dwordx4 v[176:179], v5, s[8:11], s43 offen offset:0 sc1
    s_waitcnt lgkmcnt(2)
    buffer_store_dwordx4 v[180:183], v5, s[8:11], s43 offen offset:1024 sc1
    s_waitcnt lgkmcnt(1)
    buffer_store_dwordx4 v[184:187], v5, s[8:11], s43 offen offset:2048 sc1
    s_waitcnt lgkmcnt(0)
    buffer_store_dwordx4 v[188:191], v5, s[8:11], s43 offen offset:3072 sc1
    v_accvgpr_read_b32 v16, a128
    v_accvgpr_read_b32 v17, a132
    v_accvgpr_read_b32 v18, a136
    v_accvgpr_read_b32 v19, a140
    v_accvgpr_read_b32 v20, a144
    v_accvgpr_read_b32 v21, a148
    v_accvgpr_read_b32 v22, a152
    v_accvgpr_read_b32 v23, a156
    v_cvt_pk_bf16_f32 v24, v16, v17
    v_cvt_pk_bf16_f32 v25, v18, v19
    v_cvt_pk_bf16_f32 v26, v20, v21
    v_cvt_pk_bf16_f32 v27, v22, v23
    ds_write_b128 v8, v[24:27] offset:0
    v_accvgpr_read_b32 v28, a129
    v_accvgpr_read_b32 v29, a133
    v_accvgpr_read_b32 v30, a137
    v_accvgpr_read_b32 v31, a141
    v_accvgpr_read_b32 v32, a145
    v_accvgpr_read_b32 v33, a149
    v_accvgpr_read_b32 v34, a153
    v_accvgpr_read_b32 v35, a157
    v_cvt_pk_bf16_f32 v36, v28, v29
    v_cvt_pk_bf16_f32 v37, v30, v31
    v_cvt_pk_bf16_f32 v38, v32, v33
    v_cvt_pk_bf16_f32 v39, v34, v35
    ds_write_b128 v8, v[36:39] offset:16
    v_accvgpr_read_b32 v40, a130
    v_accvgpr_read_b32 v41, a134
    v_accvgpr_read_b32 v42, a138
    v_accvgpr_read_b32 v43, a142
    v_accvgpr_read_b32 v44, a146
    v_accvgpr_read_b32 v45, a150
    v_accvgpr_read_b32 v46, a154
    v_accvgpr_read_b32 v47, a158
    v_cvt_pk_bf16_f32 v48, v40, v41
    v_cvt_pk_bf16_f32 v49, v42, v43
    v_cvt_pk_bf16_f32 v50, v44, v45
    v_cvt_pk_bf16_f32 v51, v46, v47
    ds_write_b128 v8, v[48:51] offset:32
    v_accvgpr_read_b32 v52, a131
    v_accvgpr_read_b32 v53, a135
    v_accvgpr_read_b32 v54, a139
    v_accvgpr_read_b32 v55, a143
    v_accvgpr_read_b32 v56, a147
    v_accvgpr_read_b32 v57, a151
    v_accvgpr_read_b32 v58, a155
    v_accvgpr_read_b32 v59, a159
    v_cvt_pk_bf16_f32 v60, v52, v53
    v_cvt_pk_bf16_f32 v61, v54, v55
    v_cvt_pk_bf16_f32 v62, v56, v57
    v_cvt_pk_bf16_f32 v63, v58, v59
    ds_write_b128 v8, v[60:63] offset:48
    v_accvgpr_read_b32 v64, a160
    v_accvgpr_read_b32 v65, a164
    v_accvgpr_read_b32 v66, a168
    v_accvgpr_read_b32 v67, a172
    v_accvgpr_read_b32 v68, a176
    v_accvgpr_read_b32 v69, a180
    v_accvgpr_read_b32 v70, a184
    v_accvgpr_read_b32 v71, a188
    v_cvt_pk_bf16_f32 v72, v64, v65
    v_cvt_pk_bf16_f32 v73, v66, v67
    v_cvt_pk_bf16_f32 v74, v68, v69
    v_cvt_pk_bf16_f32 v75, v70, v71
    ds_write_b128 v8, v[72:75] offset:4096
    v_accvgpr_read_b32 v76, a161
    v_accvgpr_read_b32 v77, a165
    v_accvgpr_read_b32 v78, a169
    v_accvgpr_read_b32 v79, a173
    v_accvgpr_read_b32 v80, a177
    v_accvgpr_read_b32 v81, a181
    v_accvgpr_read_b32 v82, a185
    v_accvgpr_read_b32 v83, a189
    v_cvt_pk_bf16_f32 v84, v76, v77
    v_cvt_pk_bf16_f32 v85, v78, v79
    v_cvt_pk_bf16_f32 v86, v80, v81
    v_cvt_pk_bf16_f32 v87, v82, v83
    ds_write_b128 v8, v[84:87] offset:4112
    v_accvgpr_read_b32 v88, a162
    v_accvgpr_read_b32 v89, a166
    v_accvgpr_read_b32 v90, a170
    v_accvgpr_read_b32 v91, a174
    v_accvgpr_read_b32 v92, a178
    v_accvgpr_read_b32 v93, a182
    v_accvgpr_read_b32 v94, a186
    v_accvgpr_read_b32 v95, a190
    v_cvt_pk_bf16_f32 v96, v88, v89
    v_cvt_pk_bf16_f32 v97, v90, v91
    v_cvt_pk_bf16_f32 v98, v92, v93
    v_cvt_pk_bf16_f32 v99, v94, v95
    ds_write_b128 v8, v[96:99] offset:4128
    v_accvgpr_read_b32 v100, a163
    v_accvgpr_read_b32 v101, a167
    v_accvgpr_read_b32 v102, a171
    v_accvgpr_read_b32 v103, a175
    v_accvgpr_read_b32 v104, a179
    v_accvgpr_read_b32 v105, a183
    v_accvgpr_read_b32 v106, a187
    v_accvgpr_read_b32 v107, a191
    v_cvt_pk_bf16_f32 v108, v100, v101
    v_cvt_pk_bf16_f32 v109, v102, v103
    v_cvt_pk_bf16_f32 v110, v104, v105
    v_cvt_pk_bf16_f32 v111, v106, v107
    ds_write_b128 v8, v[108:111] offset:4144
    s_waitcnt lgkmcnt(0)
    ds_read_b128 v[128:131], v9 offset:0
    ds_read_b128 v[132:135], v9 offset:1024
    ds_read_b128 v[136:139], v9 offset:2048
    ds_read_b128 v[140:143], v9 offset:3072
    ds_read_b128 v[144:147], v9 offset:4096
    ds_read_b128 v[148:151], v9 offset:5120
    ds_read_b128 v[152:155], v9 offset:6144
    ds_read_b128 v[156:159], v9 offset:7168
    s_mov_b32 s41, 0x80000
    s_add_u32 s41, s41, s40
    s_add_u32 s43, s41, 4096
    s_waitcnt lgkmcnt(7)
    buffer_store_dwordx4 v[128:131], v5, s[8:11], s41 offen offset:0 sc1
    s_waitcnt lgkmcnt(6)
    buffer_store_dwordx4 v[132:135], v5, s[8:11], s41 offen offset:1024 sc1
    s_waitcnt lgkmcnt(5)
    buffer_store_dwordx4 v[136:139], v5, s[8:11], s41 offen offset:2048 sc1
    s_waitcnt lgkmcnt(4)
    buffer_store_dwordx4 v[140:143], v5, s[8:11], s41 offen offset:3072 sc1
    s_waitcnt lgkmcnt(3)
    buffer_store_dwordx4 v[144:147], v5, s[8:11], s43 offen offset:0 sc1
    s_waitcnt lgkmcnt(2)
    buffer_store_dwordx4 v[148:151], v5, s[8:11], s43 offen offset:1024 sc1
    s_waitcnt lgkmcnt(1)
    buffer_store_dwordx4 v[152:155], v5, s[8:11], s43 offen offset:2048 sc1
    s_waitcnt lgkmcnt(0)
    buffer_store_dwordx4 v[156:159], v5, s[8:11], s43 offen offset:3072 sc1
    v_accvgpr_read_b32 v16, a192
    v_accvgpr_read_b32 v17, a196
    v_accvgpr_read_b32 v18, a200
    v_accvgpr_read_b32 v19, a204
    v_accvgpr_read_b32 v20, a208
    v_accvgpr_read_b32 v21, a212
    v_accvgpr_read_b32 v22, a216
    v_accvgpr_read_b32 v23, a220
    v_cvt_pk_bf16_f32 v24, v16, v17
    v_cvt_pk_bf16_f32 v25, v18, v19
    v_cvt_pk_bf16_f32 v26, v20, v21
    v_cvt_pk_bf16_f32 v27, v22, v23
    ds_write_b128 v8, v[24:27] offset:0
    v_accvgpr_read_b32 v28, a193
    v_accvgpr_read_b32 v29, a197
    v_accvgpr_read_b32 v30, a201
    v_accvgpr_read_b32 v31, a205
    v_accvgpr_read_b32 v32, a209
    v_accvgpr_read_b32 v33, a213
    v_accvgpr_read_b32 v34, a217
    v_accvgpr_read_b32 v35, a221
    v_cvt_pk_bf16_f32 v36, v28, v29
    v_cvt_pk_bf16_f32 v37, v30, v31
    v_cvt_pk_bf16_f32 v38, v32, v33
    v_cvt_pk_bf16_f32 v39, v34, v35
    ds_write_b128 v8, v[36:39] offset:16
    v_accvgpr_read_b32 v40, a194
    v_accvgpr_read_b32 v41, a198
    v_accvgpr_read_b32 v42, a202
    v_accvgpr_read_b32 v43, a206
    v_accvgpr_read_b32 v44, a210
    v_accvgpr_read_b32 v45, a214
    v_accvgpr_read_b32 v46, a218
    v_accvgpr_read_b32 v47, a222
    v_cvt_pk_bf16_f32 v48, v40, v41
    v_cvt_pk_bf16_f32 v49, v42, v43
    v_cvt_pk_bf16_f32 v50, v44, v45
    v_cvt_pk_bf16_f32 v51, v46, v47
    ds_write_b128 v8, v[48:51] offset:32
    v_accvgpr_read_b32 v52, a195
    v_accvgpr_read_b32 v53, a199
    v_accvgpr_read_b32 v54, a203
    v_accvgpr_read_b32 v55, a207
    v_accvgpr_read_b32 v56, a211
    v_accvgpr_read_b32 v57, a215
    v_accvgpr_read_b32 v58, a219
    v_accvgpr_read_b32 v59, a223
    v_cvt_pk_bf16_f32 v60, v52, v53
    v_cvt_pk_bf16_f32 v61, v54, v55
    v_cvt_pk_bf16_f32 v62, v56, v57
    v_cvt_pk_bf16_f32 v63, v58, v59
    ds_write_b128 v8, v[60:63] offset:48
    v_accvgpr_read_b32 v64, a224
    v_accvgpr_read_b32 v65, a228
    v_accvgpr_read_b32 v66, a232
    v_accvgpr_read_b32 v67, a236
    v_accvgpr_read_b32 v68, a240
    v_accvgpr_read_b32 v69, a244
    v_accvgpr_read_b32 v70, a248
    v_accvgpr_read_b32 v71, a252
    v_cvt_pk_bf16_f32 v72, v64, v65
    v_cvt_pk_bf16_f32 v73, v66, v67
    v_cvt_pk_bf16_f32 v74, v68, v69
    v_cvt_pk_bf16_f32 v75, v70, v71
    ds_write_b128 v8, v[72:75] offset:4096
    v_accvgpr_read_b32 v76, a225
    v_accvgpr_read_b32 v77, a229
    v_accvgpr_read_b32 v78, a233
    v_accvgpr_read_b32 v79, a237
    v_accvgpr_read_b32 v80, a241
    v_accvgpr_read_b32 v81, a245
    v_accvgpr_read_b32 v82, a249
    v_accvgpr_read_b32 v83, a253
    v_cvt_pk_bf16_f32 v84, v76, v77
    v_cvt_pk_bf16_f32 v85, v78, v79
    v_cvt_pk_bf16_f32 v86, v80, v81
    v_cvt_pk_bf16_f32 v87, v82, v83
    ds_write_b128 v8, v[84:87] offset:4112
    v_accvgpr_read_b32 v88, a226
    v_accvgpr_read_b32 v89, a230
    v_accvgpr_read_b32 v90, a234
    v_accvgpr_read_b32 v91, a238
    v_accvgpr_read_b32 v92, a242
    v_accvgpr_read_b32 v93, a246
    v_accvgpr_read_b32 v94, a250
    v_accvgpr_read_b32 v95, a254
    v_cvt_pk_bf16_f32 v96, v88, v89
    v_cvt_pk_bf16_f32 v97, v90, v91
    v_cvt_pk_bf16_f32 v98, v92, v93
    v_cvt_pk_bf16_f32 v99, v94, v95
    ds_write_b128 v8, v[96:99] offset:4128
    v_accvgpr_read_b32 v100, a227
    v_accvgpr_read_b32 v101, a231
    v_accvgpr_read_b32 v102, a235
    v_accvgpr_read_b32 v103, a239
    v_accvgpr_read_b32 v104, a243
    v_accvgpr_read_b32 v105, a247
    v_accvgpr_read_b32 v106, a251
    v_accvgpr_read_b32 v107, a255
    v_cvt_pk_bf16_f32 v108, v100, v101
    v_cvt_pk_bf16_f32 v109, v102, v103
    v_cvt_pk_bf16_f32 v110, v104, v105
    v_cvt_pk_bf16_f32 v111, v106, v107
    ds_write_b128 v8, v[108:111] offset:4144
    s_waitcnt lgkmcnt(0)
    ds_read_b128 v[160:163], v9 offset:0
    ds_read_b128 v[164:167], v9 offset:1024
    ds_read_b128 v[168:171], v9 offset:2048
    ds_read_b128 v[172:175], v9 offset:3072
    ds_read_b128 v[176:179], v9 offset:4096
    ds_read_b128 v[180:183], v9 offset:5120
    ds_read_b128 v[184:187], v9 offset:6144
    ds_read_b128 v[188:191], v9 offset:7168
    s_mov_b32 s41, 0xc0000
    s_add_u32 s41, s41, s40
    s_add_u32 s43, s41, 4096
    s_waitcnt lgkmcnt(7)
    buffer_store_dwordx4 v[160:163], v5, s[8:11], s41 offen offset:0 sc1
    s_waitcnt lgkmcnt(6)
    buffer_store_dwordx4 v[164:167], v5, s[8:11], s41 offen offset:1024 sc1
    s_waitcnt lgkmcnt(5)
    buffer_store_dwordx4 v[168:171], v5, s[8:11], s41 offen offset:2048 sc1
    s_waitcnt lgkmcnt(4)
    buffer_store_dwordx4 v[172:175], v5, s[8:11], s41 offen offset:3072 sc1
    s_waitcnt lgkmcnt(3)
    buffer_store_dwordx4 v[176:179], v5, s[8:11], s43 offen offset:0 sc1
    s_waitcnt lgkmcnt(2)
    buffer_store_dwordx4 v[180:183], v5, s[8:11], s43 offen offset:1024 sc1
    s_waitcnt lgkmcnt(1)
    buffer_store_dwordx4 v[184:187], v5, s[8:11], s43 offen offset:2048 sc1
    s_waitcnt lgkmcnt(0)
    buffer_store_dwordx4 v[188:191], v5, s[8:11], s43 offen offset:3072 sc1
    s_branch Le_57
Lv_56:
    s_add_u32 s40, s40, 0x4000000
    v_lshrrev_b32 v8, 2, v2
    v_lshlrev_b32 v8, 11, v8
    v_and_b32 v9, 3, v2
    v_lshl_add_u32 v8, v9, 6, v8
    v_lshl_add_u32 v8, v3, 8, v8
    s_lshl_b32 s43, s4, 13
    s_add_u32 s43, s43, 0x20000
    v_add_u32 v8, s43, v8
    v_add_u32 v9, s43, v5
    v_accvgpr_read_b32 v16, a0
    v_accvgpr_read_b32 v17, a1
    v_accvgpr_read_b32 v18, a2
    v_accvgpr_read_b32 v19, a3
    v_accvgpr_read_b32 v20, a32
    v_accvgpr_read_b32 v21, a33
    v_accvgpr_read_b32 v22, a34
    v_accvgpr_read_b32 v23, a35
    v_cvt_pk_bf16_f32 v24, v16, v17
    v_cvt_pk_bf16_f32 v25, v18, v19
    v_cvt_pk_bf16_f32 v26, v20, v21
    v_cvt_pk_bf16_f32 v27, v22, v23
    ds_write_b128 v8, v[24:27] offset:0
    v_accvgpr_read_b32 v28, a4
    v_accvgpr_read_b32 v29, a5
    v_accvgpr_read_b32 v30, a6
    v_accvgpr_read_b32 v31, a7
    v_accvgpr_read_b32 v32, a36
    v_accvgpr_read_b32 v33, a37
    v_accvgpr_read_b32 v34, a38
    v_accvgpr_read_b32 v35, a39
    v_cvt_pk_bf16_f32 v36, v28, v29
    v_cvt_pk_bf16_f32 v37, v30, v31
    v_cvt_pk_bf16_f32 v38, v32, v33
    v_cvt_pk_bf16_f32 v39, v34, v35
    ds_write_b128 v8, v[36:39] offset:1024
    v_accvgpr_read_b32 v40, a8
    v_accvgpr_read_b32 v41, a9
    v_accvgpr_read_b32 v42, a10
    v_accvgpr_read_b32 v43, a11
    v_accvgpr_read_b32 v44, a40
    v_accvgpr_read_b32 v45, a41
    v_accvgpr_read_b32 v46, a42
    v_accvgpr_read_b32 v47, a43
    v_cvt_pk_bf16_f32 v48, v40, v41
    v_cvt_pk_bf16_f32 v49, v42, v43
    v_cvt_pk_bf16_f32 v50, v44, v45
    v_cvt_pk_bf16_f32 v51, v46, v47
    ds_write_b128 v8, v[48:51] offset:16
    v_accvgpr_read_b32 v52, a12
    v_accvgpr_read_b32 v53, a13
    v_accvgpr_read_b32 v54, a14
    v_accvgpr_read_b32 v55, a15
    v_accvgpr_read_b32 v56, a44
    v_accvgpr_read_b32 v57, a45
    v_accvgpr_read_b32 v58, a46
    v_accvgpr_read_b32 v59, a47
    v_cvt_pk_bf16_f32 v60, v52, v53
    v_cvt_pk_bf16_f32 v61, v54, v55
    v_cvt_pk_bf16_f32 v62, v56, v57
    v_cvt_pk_bf16_f32 v63, v58, v59
    ds_write_b128 v8, v[60:63] offset:1040
    v_accvgpr_read_b32 v64, a16
    v_accvgpr_read_b32 v65, a17
    v_accvgpr_read_b32 v66, a18
    v_accvgpr_read_b32 v67, a19
    v_accvgpr_read_b32 v68, a48
    v_accvgpr_read_b32 v69, a49
    v_accvgpr_read_b32 v70, a50
    v_accvgpr_read_b32 v71, a51
    v_cvt_pk_bf16_f32 v72, v64, v65
    v_cvt_pk_bf16_f32 v73, v66, v67
    v_cvt_pk_bf16_f32 v74, v68, v69
    v_cvt_pk_bf16_f32 v75, v70, v71
    ds_write_b128 v8, v[72:75] offset:32
    v_accvgpr_read_b32 v76, a20
    v_accvgpr_read_b32 v77, a21
    v_accvgpr_read_b32 v78, a22
    v_accvgpr_read_b32 v79, a23
    v_accvgpr_read_b32 v80, a52
    v_accvgpr_read_b32 v81, a53
    v_accvgpr_read_b32 v82, a54
    v_accvgpr_read_b32 v83, a55
    v_cvt_pk_bf16_f32 v84, v76, v77
    v_cvt_pk_bf16_f32 v85, v78, v79
    v_cvt_pk_bf16_f32 v86, v80, v81
    v_cvt_pk_bf16_f32 v87, v82, v83
    ds_write_b128 v8, v[84:87] offset:1056
    v_accvgpr_read_b32 v88, a24
    v_accvgpr_read_b32 v89, a25
    v_accvgpr_read_b32 v90, a26
    v_accvgpr_read_b32 v91, a27
    v_accvgpr_read_b32 v92, a56
    v_accvgpr_read_b32 v93, a57
    v_accvgpr_read_b32 v94, a58
    v_accvgpr_read_b32 v95, a59
    v_cvt_pk_bf16_f32 v96, v88, v89
    v_cvt_pk_bf16_f32 v97, v90, v91
    v_cvt_pk_bf16_f32 v98, v92, v93
    v_cvt_pk_bf16_f32 v99, v94, v95
    ds_write_b128 v8, v[96:99] offset:48
    v_accvgpr_read_b32 v100, a28
    v_accvgpr_read_b32 v101, a29
    v_accvgpr_read_b32 v102, a30
    v_accvgpr_read_b32 v103, a31
    v_accvgpr_read_b32 v104, a60
    v_accvgpr_read_b32 v105, a61
    v_accvgpr_read_b32 v106, a62
    v_accvgpr_read_b32 v107, a63
    v_cvt_pk_bf16_f32 v108, v100, v101
    v_cvt_pk_bf16_f32 v109, v102, v103
    v_cvt_pk_bf16_f32 v110, v104, v105
    v_cvt_pk_bf16_f32 v111, v106, v107
    ds_write_b128 v8, v[108:111] offset:1072
    s_waitcnt lgkmcnt(0)
    ds_read_b128 v[128:131], v9 offset:0
    ds_read_b128 v[132:135], v9 offset:1024
    ds_read_b128 v[136:139], v9 offset:2048
    ds_read_b128 v[140:143], v9 offset:3072
    ds_read_b128 v[144:147], v9 offset:4096
    ds_read_b128 v[148:151], v9 offset:5120
    ds_read_b128 v[152:155], v9 offset:6144
    ds_read_b128 v[156:159], v9 offset:7168
    s_mov_b32 s41, 0
    s_add_u32 s41, s41, s40
    s_add_u32 s43, s41, 4096
    s_waitcnt lgkmcnt(7)
    buffer_store_dwordx4 v[128:131], v5, s[8:11], s41 offen offset:0 sc1
    s_waitcnt lgkmcnt(6)
    buffer_store_dwordx4 v[132:135], v5, s[8:11], s41 offen offset:1024 sc1
    s_waitcnt lgkmcnt(5)
    buffer_store_dwordx4 v[136:139], v5, s[8:11], s41 offen offset:2048 sc1
    s_waitcnt lgkmcnt(4)
    buffer_store_dwordx4 v[140:143], v5, s[8:11], s41 offen offset:3072 sc1
    s_waitcnt lgkmcnt(3)
    buffer_store_dwordx4 v[144:147], v5, s[8:11], s43 offen offset:0 sc1
    s_waitcnt lgkmcnt(2)
    buffer_store_dwordx4 v[148:151], v5, s[8:11], s43 offen offset:1024 sc1
    s_waitcnt lgkmcnt(1)
    buffer_store_dwordx4 v[152:155], v5, s[8:11], s43 offen offset:2048 sc1
    s_waitcnt lgkmcnt(0)
    buffer_store_dwordx4 v[156:159], v5, s[8:11], s43 offen offset:3072 sc1
    v_accvgpr_read_b32 v16, a64
    v_accvgpr_read_b32 v17, a65
    v_accvgpr_read_b32 v18, a66
    v_accvgpr_read_b32 v19, a67
    v_accvgpr_read_b32 v20, a96
    v_accvgpr_read_b32 v21, a97
    v_accvgpr_read_b32 v22, a98
    v_accvgpr_read_b32 v23, a99
    v_cvt_pk_bf16_f32 v24, v16, v17
    v_cvt_pk_bf16_f32 v25, v18, v19
    v_cvt_pk_bf16_f32 v26, v20, v21
    v_cvt_pk_bf16_f32 v27, v22, v23
    ds_write_b128 v8, v[24:27] offset:0
    v_accvgpr_read_b32 v28, a68
    v_accvgpr_read_b32 v29, a69
    v_accvgpr_read_b32 v30, a70
    v_accvgpr_read_b32 v31, a71
    v_accvgpr_read_b32 v32, a100
    v_accvgpr_read_b32 v33, a101
    v_accvgpr_read_b32 v34, a102
    v_accvgpr_read_b32 v35, a103
    v_cvt_pk_bf16_f32 v36, v28, v29
    v_cvt_pk_bf16_f32 v37, v30, v31
    v_cvt_pk_bf16_f32 v38, v32, v33
    v_cvt_pk_bf16_f32 v39, v34, v35
    ds_write_b128 v8, v[36:39] offset:1024
    v_accvgpr_read_b32 v40, a72
    v_accvgpr_read_b32 v41, a73
    v_accvgpr_read_b32 v42, a74
    v_accvgpr_read_b32 v43, a75
    v_accvgpr_read_b32 v44, a104
    v_accvgpr_read_b32 v45, a105
    v_accvgpr_read_b32 v46, a106
    v_accvgpr_read_b32 v47, a107
    v_cvt_pk_bf16_f32 v48, v40, v41
    v_cvt_pk_bf16_f32 v49, v42, v43
    v_cvt_pk_bf16_f32 v50, v44, v45
    v_cvt_pk_bf16_f32 v51, v46, v47
    ds_write_b128 v8, v[48:51] offset:16
    v_accvgpr_read_b32 v52, a76
    v_accvgpr_read_b32 v53, a77
    v_accvgpr_read_b32 v54, a78
    v_accvgpr_read_b32 v55, a79
    v_accvgpr_read_b32 v56, a108
    v_accvgpr_read_b32 v57, a109
    v_accvgpr_read_b32 v58, a110
    v_accvgpr_read_b32 v59, a111
    v_cvt_pk_bf16_f32 v60, v52, v53
    v_cvt_pk_bf16_f32 v61, v54, v55
    v_cvt_pk_bf16_f32 v62, v56, v57
    v_cvt_pk_bf16_f32 v63, v58, v59
    ds_write_b128 v8, v[60:63] offset:1040
    v_accvgpr_read_b32 v64, a80
    v_accvgpr_read_b32 v65, a81
    v_accvgpr_read_b32 v66, a82
    v_accvgpr_read_b32 v67, a83
    v_accvgpr_read_b32 v68, a112
    v_accvgpr_read_b32 v69, a113
    v_accvgpr_read_b32 v70, a114
    v_accvgpr_read_b32 v71, a115
    v_cvt_pk_bf16_f32 v72, v64, v65
    v_cvt_pk_bf16_f32 v73, v66, v67
    v_cvt_pk_bf16_f32 v74, v68, v69
    v_cvt_pk_bf16_f32 v75, v70, v71
    ds_write_b128 v8, v[72:75] offset:32
    v_accvgpr_read_b32 v76, a84
    v_accvgpr_read_b32 v77, a85
    v_accvgpr_read_b32 v78, a86
    v_accvgpr_read_b32 v79, a87
    v_accvgpr_read_b32 v80, a116
    v_accvgpr_read_b32 v81, a117
    v_accvgpr_read_b32 v82, a118
    v_accvgpr_read_b32 v83, a119
    v_cvt_pk_bf16_f32 v84, v76, v77
    v_cvt_pk_bf16_f32 v85, v78, v79
    v_cvt_pk_bf16_f32 v86, v80, v81
    v_cvt_pk_bf16_f32 v87, v82, v83
    ds_write_b128 v8, v[84:87] offset:1056
    v_accvgpr_read_b32 v88, a88
    v_accvgpr_read_b32 v89, a89
    v_accvgpr_read_b32 v90, a90
    v_accvgpr_read_b32 v91, a91
    v_accvgpr_read_b32 v92, a120
    v_accvgpr_read_b32 v93, a121
    v_accvgpr_read_b32 v94, a122
    v_accvgpr_read_b32 v95, a123
    v_cvt_pk_bf16_f32 v96, v88, v89
    v_cvt_pk_bf16_f32 v97, v90, v91
    v_cvt_pk_bf16_f32 v98, v92, v93
    v_cvt_pk_bf16_f32 v99, v94, v95
    ds_write_b128 v8, v[96:99] offset:48
    v_accvgpr_read_b32 v100, a92
    v_accvgpr_read_b32 v101, a93
    v_accvgpr_read_b32 v102, a94
    v_accvgpr_read_b32 v103, a95
    v_accvgpr_read_b32 v104, a124
    v_accvgpr_read_b32 v105, a125
    v_accvgpr_read_b32 v106, a126
    v_accvgpr_read_b32 v107, a127
    v_cvt_pk_bf16_f32 v108, v100, v101
    v_cvt_pk_bf16_f32 v109, v102, v103
    v_cvt_pk_bf16_f32 v110, v104, v105
    v_cvt_pk_bf16_f32 v111, v106, v107
    ds_write_b128 v8, v[108:111] offset:1072
    s_waitcnt lgkmcnt(0)
    ds_read_b128 v[160:163], v9 offset:0
    ds_read_b128 v[164:167], v9 offset:1024
    ds_read_b128 v[168:171], v9 offset:2048
    ds_read_b128 v[172:175], v9 offset:3072
    ds_read_b128 v[176:179], v9 offset:4096
    ds_read_b128 v[180:183], v9 offset:5120
    ds_read_b128 v[184:187], v9 offset:6144
    ds_read_b128 v[188:191], v9 offset:7168
    s_mov_b32 s41, 0x40000
    s_add_u32 s41, s41, s40
    s_add_u32 s43, s41, 4096
    s_waitcnt lgkmcnt(7)
    buffer_store_dwordx4 v[160:163], v5, s[8:11], s41 offen offset:0 sc1
    s_waitcnt lgkmcnt(6)
    buffer_store_dwordx4 v[164:167], v5, s[8:11], s41 offen offset:1024 sc1
    s_waitcnt lgkmcnt(5)
    buffer_store_dwordx4 v[168:171], v5, s[8:11], s41 offen offset:2048 sc1
    s_waitcnt lgkmcnt(4)
    buffer_store_dwordx4 v[172:175], v5, s[8:11], s41 offen offset:3072 sc1
    s_waitcnt lgkmcnt(3)
    buffer_store_dwordx4 v[176:179], v5, s[8:11], s43 offen offset:0 sc1
    s_waitcnt lgkmcnt(2)
    buffer_store_dwordx4 v[180:183], v5, s[8:11], s43 offen offset:1024 sc1
    s_waitcnt lgkmcnt(1)
    buffer_store_dwordx4 v[184:187], v5, s[8:11], s43 offen offset:2048 sc1
    s_waitcnt lgkmcnt(0)
    buffer_store_dwordx4 v[188:191], v5, s[8:11], s43 offen offset:3072 sc1
    v_accvgpr_read_b32 v16, a128
    v_accvgpr_read_b32 v17, a129
    v_accvgpr_read_b32 v18, a130
    v_accvgpr_read_b32 v19, a131
    v_accvgpr_read_b32 v20, a160
    v_accvgpr_read_b32 v21, a161
    v_accvgpr_read_b32 v22, a162
    v_accvgpr_read_b32 v23, a163
    v_cvt_pk_bf16_f32 v24, v16, v17
    v_cvt_pk_bf16_f32 v25, v18, v19
    v_cvt_pk_bf16_f32 v26, v20, v21
    v_cvt_pk_bf16_f32 v27, v22, v23
    ds_write_b128 v8, v[24:27] offset:0
    v_accvgpr_read_b32 v28, a132
    v_accvgpr_read_b32 v29, a133
    v_accvgpr_read_b32 v30, a134
    v_accvgpr_read_b32 v31, a135
    v_accvgpr_read_b32 v32, a164
    v_accvgpr_read_b32 v33, a165
    v_accvgpr_read_b32 v34, a166
    v_accvgpr_read_b32 v35, a167
    v_cvt_pk_bf16_f32 v36, v28, v29
    v_cvt_pk_bf16_f32 v37, v30, v31
    v_cvt_pk_bf16_f32 v38, v32, v33
    v_cvt_pk_bf16_f32 v39, v34, v35
    ds_write_b128 v8, v[36:39] offset:1024
    v_accvgpr_read_b32 v40, a136
    v_accvgpr_read_b32 v41, a137
    v_accvgpr_read_b32 v42, a138
    v_accvgpr_read_b32 v43, a139
    v_accvgpr_read_b32 v44, a168
    v_accvgpr_read_b32 v45, a169
    v_accvgpr_read_b32 v46, a170
    v_accvgpr_read_b32 v47, a171
    v_cvt_pk_bf16_f32 v48, v40, v41
    v_cvt_pk_bf16_f32 v49, v42, v43
    v_cvt_pk_bf16_f32 v50, v44, v45
    v_cvt_pk_bf16_f32 v51, v46, v47
    ds_write_b128 v8, v[48:51] offset:16
    v_accvgpr_read_b32 v52, a140
    v_accvgpr_read_b32 v53, a141
    v_accvgpr_read_b32 v54, a142
    v_accvgpr_read_b32 v55, a143
    v_accvgpr_read_b32 v56, a172
    v_accvgpr_read_b32 v57, a173
    v_accvgpr_read_b32 v58, a174
    v_accvgpr_read_b32 v59, a175
    v_cvt_pk_bf16_f32 v60, v52, v53
    v_cvt_pk_bf16_f32 v61, v54, v55
    v_cvt_pk_bf16_f32 v62, v56, v57
    v_cvt_pk_bf16_f32 v63, v58, v59
    ds_write_b128 v8, v[60:63] offset:1040
    v_accvgpr_read_b32 v64, a144
    v_accvgpr_read_b32 v65, a145
    v_accvgpr_read_b32 v66, a146
    v_accvgpr_read_b32 v67, a147
    v_accvgpr_read_b32 v68, a176
    v_accvgpr_read_b32 v69, a177
    v_accvgpr_read_b32 v70, a178
    v_accvgpr_read_b32 v71, a179
    v_cvt_pk_bf16_f32 v72, v64, v65
    v_cvt_pk_bf16_f32 v73, v66, v67
    v_cvt_pk_bf16_f32 v74, v68, v69
    v_cvt_pk_bf16_f32 v75, v70, v71
    ds_write_b128 v8, v[72:75] offset:32
    v_accvgpr_read_b32 v76, a148
    v_accvgpr_read_b32 v77, a149
    v_accvgpr_read_b32 v78, a150
    v_accvgpr_read_b32 v79, a151
    v_accvgpr_read_b32 v80, a180
    v_accvgpr_read_b32 v81, a181
    v_accvgpr_read_b32 v82, a182
    v_accvgpr_read_b32 v83, a183
    v_cvt_pk_bf16_f32 v84, v76, v77
    v_cvt_pk_bf16_f32 v85, v78, v79
    v_cvt_pk_bf16_f32 v86, v80, v81
    v_cvt_pk_bf16_f32 v87, v82, v83
    ds_write_b128 v8, v[84:87] offset:1056
    v_accvgpr_read_b32 v88, a152
    v_accvgpr_read_b32 v89, a153
    v_accvgpr_read_b32 v90, a154
    v_accvgpr_read_b32 v91, a155
    v_accvgpr_read_b32 v92, a184
    v_accvgpr_read_b32 v93, a185
    v_accvgpr_read_b32 v94, a186
    v_accvgpr_read_b32 v95, a187
    v_cvt_pk_bf16_f32 v96, v88, v89
    v_cvt_pk_bf16_f32 v97, v90, v91
    v_cvt_pk_bf16_f32 v98, v92, v93
    v_cvt_pk_bf16_f32 v99, v94, v95
    ds_write_b128 v8, v[96:99] offset:48
    v_accvgpr_read_b32 v100, a156
    v_accvgpr_read_b32 v101, a157
    v_accvgpr_read_b32 v102, a158
    v_accvgpr_read_b32 v103, a159
    v_accvgpr_read_b32 v104, a188
    v_accvgpr_read_b32 v105, a189
    v_accvgpr_read_b32 v106, a190
    v_accvgpr_read_b32 v107, a191
    v_cvt_pk_bf16_f32 v108, v100, v101
    v_cvt_pk_bf16_f32 v109, v102, v103
    v_cvt_pk_bf16_f32 v110, v104, v105
    v_cvt_pk_bf16_f32 v111, v106, v107
    ds_write_b128 v8, v[108:111] offset:1072
    s_waitcnt lgkmcnt(0)
    ds_read_b128 v[128:131], v9 offset:0
    ds_read_b128 v[132:135], v9 offset:1024
    ds_read_b128 v[136:139], v9 offset:2048
    ds_read_b128 v[140:143], v9 offset:3072
    ds_read_b128 v[144:147], v9 offset:4096
    ds_read_b128 v[148:151], v9 offset:5120
    ds_read_b128 v[152:155], v9 offset:6144
    ds_read_b128 v[156:159], v9 offset:7168
    s_mov_b32 s41, 0x80000
    s_add_u32 s41, s41, s40
    s_add_u32 s43, s41, 4096
    s_waitcnt lgkmcnt(7)
    buffer_store_dwordx4 v[128:131], v5, s[8:11], s41 offen offset:0 sc1
    s_waitcnt lgkmcnt(6)
    buffer_store_dwordx4 v[132:135], v5, s[8:11], s41 offen offset:1024 sc1
    s_waitcnt lgkmcnt(5)
    buffer_store_dwordx4 v[136:139], v5, s[8:11], s41 offen offset:2048 sc1
    s_waitcnt lgkmcnt(4)
    buffer_store_dwordx4 v[140:143], v5, s[8:11], s41 offen offset:3072 sc1
    s_waitcnt lgkmcnt(3)
    buffer_store_dwordx4 v[144:147], v5, s[8:11], s43 offen offset:0 sc1
    s_waitcnt lgkmcnt(2)
    buffer_store_dwordx4 v[148:151], v5, s[8:11], s43 offen offset:1024 sc1
    s_waitcnt lgkmcnt(1)
    buffer_store_dwordx4 v[152:155], v5, s[8:11], s43 offen offset:2048 sc1
    s_waitcnt lgkmcnt(0)
    buffer_store_dwordx4 v[156:159], v5, s[8:11], s43 offen offset:3072 sc1
    v_accvgpr_read_b32 v16, a192
    v_accvgpr_read_b32 v17, a193
    v_accvgpr_read_b32 v18, a194
    v_accvgpr_read_b32 v19, a195
    v_accvgpr_read_b32 v20, a224
    v_accvgpr_read_b32 v21, a225
    v_accvgpr_read_b32 v22, a226
    v_accvgpr_read_b32 v23, a227
    v_cvt_pk_bf16_f32 v24, v16, v17
    v_cvt_pk_bf16_f32 v25, v18, v19
    v_cvt_pk_bf16_f32 v26, v20, v21
    v_cvt_pk_bf16_f32 v27, v22, v23
    ds_write_b128 v8, v[24:27] offset:0
    v_accvgpr_read_b32 v28, a196
    v_accvgpr_read_b32 v29, a197
    v_accvgpr_read_b32 v30, a198
    v_accvgpr_read_b32 v31, a199
    v_accvgpr_read_b32 v32, a228
    v_accvgpr_read_b32 v33, a229
    v_accvgpr_read_b32 v34, a230
    v_accvgpr_read_b32 v35, a231
    v_cvt_pk_bf16_f32 v36, v28, v29
    v_cvt_pk_bf16_f32 v37, v30, v31
    v_cvt_pk_bf16_f32 v38, v32, v33
    v_cvt_pk_bf16_f32 v39, v34, v35
    ds_write_b128 v8, v[36:39] offset:1024
    v_accvgpr_read_b32 v40, a200
    v_accvgpr_read_b32 v41, a201
    v_accvgpr_read_b32 v42, a202
    v_accvgpr_read_b32 v43, a203
    v_accvgpr_read_b32 v44, a232
    v_accvgpr_read_b32 v45, a233
    v_accvgpr_read_b32 v46, a234
    v_accvgpr_read_b32 v47, a235
    v_cvt_pk_bf16_f32 v48, v40, v41
    v_cvt_pk_bf16_f32 v49, v42, v43
    v_cvt_pk_bf16_f32 v50, v44, v45
    v_cvt_pk_bf16_f32 v51, v46, v47
    ds_write_b128 v8, v[48:51] offset:16
    v_accvgpr_read_b32 v52, a204
    v_accvgpr_read_b32 v53, a205
    v_accvgpr_read_b32 v54, a206
    v_accvgpr_read_b32 v55, a207
    v_accvgpr_read_b32 v56, a236
    v_accvgpr_read_b32 v57, a237
    v_accvgpr_read_b32 v58, a238
    v_accvgpr_read_b32 v59, a239
    v_cvt_pk_bf16_f32 v60, v52, v53
    v_cvt_pk_bf16_f32 v61, v54, v55
    v_cvt_pk_bf16_f32 v62, v56, v57
    v_cvt_pk_bf16_f32 v63, v58, v59
    ds_write_b128 v8, v[60:63] offset:1040
    v_accvgpr_read_b32 v64, a208
    v_accvgpr_read_b32 v65, a209
    v_accvgpr_read_b32 v66, a210
    v_accvgpr_read_b32 v67, a211
    v_accvgpr_read_b32 v68, a240
    v_accvgpr_read_b32 v69, a241
    v_accvgpr_read_b32 v70, a242
    v_accvgpr_read_b32 v71, a243
    v_cvt_pk_bf16_f32 v72, v64, v65
    v_cvt_pk_bf16_f32 v73, v66, v67
    v_cvt_pk_bf16_f32 v74, v68, v69
    v_cvt_pk_bf16_f32 v75, v70, v71
    ds_write_b128 v8, v[72:75] offset:32
    v_accvgpr_read_b32 v76, a212
    v_accvgpr_read_b32 v77, a213
    v_accvgpr_read_b32 v78, a214
    v_accvgpr_read_b32 v79, a215
    v_accvgpr_read_b32 v80, a244
    v_accvgpr_read_b32 v81, a245
    v_accvgpr_read_b32 v82, a246
    v_accvgpr_read_b32 v83, a247
    v_cvt_pk_bf16_f32 v84, v76, v77
    v_cvt_pk_bf16_f32 v85, v78, v79
    v_cvt_pk_bf16_f32 v86, v80, v81
    v_cvt_pk_bf16_f32 v87, v82, v83
    ds_write_b128 v8, v[84:87] offset:1056
    v_accvgpr_read_b32 v88, a216
    v_accvgpr_read_b32 v89, a217
    v_accvgpr_read_b32 v90, a218
    v_accvgpr_read_b32 v91, a219
    v_accvgpr_read_b32 v92, a248
    v_accvgpr_read_b32 v93, a249
    v_accvgpr_read_b32 v94, a250
    v_accvgpr_read_b32 v95, a251
    v_cvt_pk_bf16_f32 v96, v88, v89
    v_cvt_pk_bf16_f32 v97, v90, v91
    v_cvt_pk_bf16_f32 v98, v92, v93
    v_cvt_pk_bf16_f32 v99, v94, v95
    ds_write_b128 v8, v[96:99] offset:48
    v_accvgpr_read_b32 v100, a220
    v_accvgpr_read_b32 v101, a221
    v_accvgpr_read_b32 v102, a222
    v_accvgpr_read_b32 v103, a223
    v_accvgpr_read_b32 v104, a252
    v_accvgpr_read_b32 v105, a253
    v_accvgpr_read_b32 v106, a254
    v_accvgpr_read_b32 v107, a255
    v_cvt_pk_bf16_f32 v108, v100, v101
    v_cvt_pk_bf16_f32 v109, v102, v103
    v_cvt_pk_bf16_f32 v110, v104, v105
    v_cvt_pk_bf16_f32 v111, v106, v107
    ds_write_b128 v8, v[108:111] offset:1072
    s_waitcnt lgkmcnt(0)
    ds_read_b128 v[160:163], v9 offset:0
    ds_read_b128 v[164:167], v9 offset:1024
    ds_read_b128 v[168:171], v9 offset:2048
    ds_read_b128 v[172:175], v9 offset:3072
    ds_read_b128 v[176:179], v9 offset:4096
    ds_read_b128 v[180:183], v9 offset:5120
    ds_read_b128 v[184:187], v9 offset:6144
    ds_read_b128 v[188:191], v9 offset:7168
    s_mov_b32 s41, 0xc0000
    s_add_u32 s41, s41, s40
    s_add_u32 s43, s41, 4096
    s_waitcnt lgkmcnt(7)
    buffer_store_dwordx4 v[160:163], v5, s[8:11], s41 offen offset:0 sc1
    s_waitcnt lgkmcnt(6)
    buffer_store_dwordx4 v[164:167], v5, s[8:11], s41 offen offset:1024 sc1
    s_waitcnt lgkmcnt(5)
    buffer_store_dwordx4 v[168:171], v5, s[8:11], s41 offen offset:2048 sc1
    s_waitcnt lgkmcnt(4)
    buffer_store_dwordx4 v[172:175], v5, s[8:11], s41 offen offset:3072 sc1
    s_waitcnt lgkmcnt(3)
    buffer_store_dwordx4 v[176:179], v5, s[8:11], s43 offen offset:0 sc1
    s_waitcnt lgkmcnt(2)
    buffer_store_dwordx4 v[180:183], v5, s[8:11], s43 offen offset:1024 sc1
    s_waitcnt lgkmcnt(1)
    buffer_store_dwordx4 v[184:187], v5, s[8:11], s43 offen offset:2048 sc1
    s_waitcnt lgkmcnt(0)
    buffer_store_dwordx4 v[188:191], v5, s[8:11], s43 offen offset:3072 sc1
Le_57:
    s_add_u32 s35, s33, 32
    s_cmp_lt_u32 s42, 8
    s_cselect_b32 s41, 16, 0
    s_add_u32 s35, s35, s41
    s_lshl_b32 s35, s35, 6
    s_waitcnt vmcnt(0) lgkmcnt(0)
    s_barrier
    s_cmp_lg_u32 s4, 0
    s_cbranch_scc1 Lsg_58
    v_mov_b32 v7, 1
    s_mov_b64 exec, 1
    buffer_atomic_add v7, off, s[8:11], s35 sc1
    s_mov_b64 exec, -1
Lsg_58:
    s_cmp_lg_u32 s63, 0
    s_cbranch_scc1 Lq2d_52
    s_mov_b32 s63, 1
    s_mul_hi_u32 s34, s5, 0x12492493
    s_mul_i32 s33, s34, 14
    s_sub_u32 s33, s5, s33
    s_mov_b32 s62, 0
    s_cmp_lt_u32 s34, 8
    s_cbranch_scc1 Lq2_51
    s_sub_u32 s35, s5, 112
    s_cmp_ge_u32 s35, 48
    s_cbranch_scc1 Lq2d_52
    s_mov_b32 s62, 1
    s_and_b32 s33, s35, 1
    s_add_u32 s33, s33, 14
    s_lshr_b32 s34, s35, 1
    s_branch Lq2_51
Lq2d_52:
    s_cmp_ge_u32 s5, 96
    s_cbranch_scc1 Lrole_60
    s_sub_u32 s62, s5, 0
    s_mul_hi_u32 s63, s62, 0x10000000
    s_mul_i32 s33, s63, 16
    s_sub_u32 s62, s62, s33
    s_mov_b32 s33, s62
    s_mov_b32 s12, s74
    s_and_b32 s13, s75, 0xffff
    s_mov_b32 s14, 0x400000
    s_mov_b32 s15, 0x20000
    v_lshlrev_b32 v10, 13, v3
    v_lshl_add_u32 v10, v2, 4, v10
    s_lshl_b32 s49, s33, 18
    s_lshl_b32 s50, s4, 8
    s_add_u32 s49, s49, s50
    v_add_u32 v10, s49, v10
    s_mov_b32 s21, 0x5040100
    s_mov_b32 s22, 0x7060302
    s_mov_b32 s23, 0x8000
    s_mov_b32 s24, 0
    s_mov_b32 s25, 0x400
    s_mov_b32 s26, 0x800
    s_mov_b32 s27, 0xc00
    s_mov_b32 s28, 0x1000
    s_mov_b32 s29, 0x1400
    s_mov_b32 s30, 0x1800
    s_mov_b32 s31, 0x1c00
    buffer_load_dwordx4 v[16:19], v10, s[12:15], s24 offen
    buffer_load_dwordx4 v[20:23], v10, s[12:15], s25 offen
    buffer_load_dwordx4 v[24:27], v10, s[12:15], s26 offen
    buffer_load_dwordx4 v[28:31], v10, s[12:15], s27 offen
    buffer_load_dwordx4 v[32:35], v10, s[12:15], s28 offen
    buffer_load_dwordx4 v[36:39], v10, s[12:15], s29 offen
    buffer_load_dwordx4 v[40:43], v10, s[12:15], s30 offen
    buffer_load_dwordx4 v[44:47], v10, s[12:15], s31 offen
    v_add_u32 v10, s23, v10
    buffer_load_dwordx4 v[48:51], v10, s[12:15], s24 offen
    buffer_load_dwordx4 v[52:55], v10, s[12:15], s25 offen
    buffer_load_dwordx4 v[56:59], v10, s[12:15], s26 offen
    buffer_load_dwordx4 v[60:63], v10, s[12:15], s27 offen
    buffer_load_dwordx4 v[64:67], v10, s[12:15], s28 offen
    buffer_load_dwordx4 v[68:71], v10, s[12:15], s29 offen
    buffer_load_dwordx4 v[72:75], v10, s[12:15], s30 offen
    buffer_load_dwordx4 v[76:79], v10, s[12:15], s31 offen
    v_add_u32 v10, s23, v10
    buffer_load_dwordx4 v[80:83], v10, s[12:15], s24 offen
    buffer_load_dwordx4 v[84:87], v10, s[12:15], s25 offen
    buffer_load_dwordx4 v[88:91], v10, s[12:15], s26 offen
    buffer_load_dwordx4 v[92:95], v10, s[12:15], s27 offen
    buffer_load_dwordx4 v[96:99], v10, s[12:15], s28 offen
    buffer_load_dwordx4 v[100:103], v10, s[12:15], s29 offen
    buffer_load_dwordx4 v[104:107], v10, s[12:15], s30 offen
    buffer_load_dwordx4 v[108:111], v10, s[12:15], s31 offen
    v_add_u32 v10, s23, v10
    buffer_load_dwordx4 v[112:115], v10, s[12:15], s24 offen
    buffer_load_dwordx4 v[116:119], v10, s[12:15], s25 offen
    buffer_load_dwordx4 v[120:123], v10, s[12:15], s26 offen
    buffer_load_dwordx4 v[124:127], v10, s[12:15], s27 offen
    buffer_load_dwordx4 v[128:131], v10, s[12:15], s28 offen
    buffer_load_dwordx4 v[132:135], v10, s[12:15], s29 offen
    buffer_load_dwordx4 v[136:139], v10, s[12:15], s30 offen
    buffer_load_dwordx4 v[140:143], v10, s[12:15], s31 offen
    v_add_u32 v10, s23, v10
    s_waitcnt vmcnt(24)
    v_perm_b32 v176, v20, v16, s21
    v_perm_b32 v177, v28, v24, s21
    v_perm_b32 v178, v36, v32, s21
    v_perm_b32 v179, v44, v40, s21
    v_perm_b32 v180, v20, v16, s22
    v_perm_b32 v181, v28, v24, s22
    v_perm_b32 v182, v36, v32, s22
    v_perm_b32 v183, v44, v40, s22
    v_perm_b32 v184, v21, v17, s21
    v_perm_b32 v185, v29, v25, s21
    v_perm_b32 v186, v37, v33, s21
    v_perm_b32 v187, v45, v41, s21
    v_perm_b32 v188, v21, v17, s22
    v_perm_b32 v189, v29, v25, s22
    v_perm_b32 v190, v37, v33, s22
    v_perm_b32 v191, v45, v41, s22
    v_perm_b32 v192, v22, v18, s21
    v_perm_b32 v193, v30, v26, s21
    v_perm_b32 v194, v38, v34, s21
    v_perm_b32 v195, v46, v42, s21
    v_perm_b32 v196, v22, v18, s22
    v_perm_b32 v197, v30, v26, s22
    v_perm_b32 v198, v38, v34, s22
    v_perm_b32 v199, v46, v42, s22
    v_perm_b32 v200, v23, v19, s21
    v_perm_b32 v201, v31, v27, s21
    v_perm_b32 v202, v39, v35, s21
    v_perm_b32 v203, v47, v43, s21
    v_perm_b32 v204, v23, v19, s22
    v_perm_b32 v205, v31, v27, s22
    v_perm_b32 v206, v39, v35, s22
    v_perm_b32 v207, v47, v43, s22
    buffer_load_dwordx4 v[16:19], v10, s[12:15], s24 offen
    buffer_load_dwordx4 v[20:23], v10, s[12:15], s25 offen
    buffer_load_dwordx4 v[24:27], v10, s[12:15], s26 offen
    buffer_load_dwordx4 v[28:31], v10, s[12:15], s27 offen
    buffer_load_dwordx4 v[32:35], v10, s[12:15], s28 offen
    buffer_load_dwordx4 v[36:39], v10, s[12:15], s29 offen
    buffer_load_dwordx4 v[40:43], v10, s[12:15], s30 offen
    buffer_load_dwordx4 v[44:47], v10, s[12:15], s31 offen
    v_add_u32 v10, s23, v10
    v_accvgpr_write_b32 a0, v176
    v_accvgpr_write_b32 a1, v177
    v_accvgpr_write_b32 a2, v178
    v_accvgpr_write_b32 a3, v179
    v_accvgpr_write_b32 a4, v180
    v_accvgpr_write_b32 a5, v181
    v_accvgpr_write_b32 a6, v182
    v_accvgpr_write_b32 a7, v183
    v_accvgpr_write_b32 a8, v184
    v_accvgpr_write_b32 a9, v185
    v_accvgpr_write_b32 a10, v186
    v_accvgpr_write_b32 a11, v187
    v_accvgpr_write_b32 a12, v188
    v_accvgpr_write_b32 a13, v189
    v_accvgpr_write_b32 a14, v190
    v_accvgpr_write_b32 a15, v191
    v_accvgpr_write_b32 a16, v192
    v_accvgpr_write_b32 a17, v193
    v_accvgpr_write_b32 a18, v194
    v_accvgpr_write_b32 a19, v195
    v_accvgpr_write_b32 a20, v196
    v_accvgpr_write_b32 a21, v197
    v_accvgpr_write_b32 a22, v198
    v_accvgpr_write_b32 a23, v199
    v_accvgpr_write_b32 a24, v200
    v_accvgpr_write_b32 a25, v201
    v_accvgpr_write_b32 a26, v202
    v_accvgpr_write_b32 a27, v203
    v_accvgpr_write_b32 a28, v204
    v_accvgpr_write_b32 a29, v205
    v_accvgpr_write_b32 a30, v206
    v_accvgpr_write_b32 a31, v207
    s_waitcnt vmcnt(24)
    v_perm_b32 v176, v52, v48, s21
    v_perm_b32 v177, v60, v56, s21
    v_perm_b32 v178, v68, v64, s21
    v_perm_b32 v179, v76, v72, s21
    v_perm_b32 v180, v52, v48, s22
    v_perm_b32 v181, v60, v56, s22
    v_perm_b32 v182, v68, v64, s22
    v_perm_b32 v183, v76, v72, s22
    v_perm_b32 v184, v53, v49, s21
    v_perm_b32 v185, v61, v57, s21
    v_perm_b32 v186, v69, v65, s21
    v_perm_b32 v187, v77, v73, s21
    v_perm_b32 v188, v53, v49, s22
    v_perm_b32 v189, v61, v57, s22
    v_perm_b32 v190, v69, v65, s22
    v_perm_b32 v191, v77, v73, s22
    v_perm_b32 v192, v54, v50, s21
    v_perm_b32 v193, v62, v58, s21
    v_perm_b32 v194, v70, v66, s21
    v_perm_b32 v195, v78, v74, s21
    v_perm_b32 v196, v54, v50, s22
    v_perm_b32 v197, v62, v58, s22
    v_perm_b32 v198, v70, v66, s22
    v_perm_b32 v199, v78, v74, s22
    v_perm_b32 v200, v55, v51, s21
    v_perm_b32 v201, v63, v59, s21
    v_perm_b32 v202, v71, v67, s21
    v_perm_b32 v203, v79, v75, s21
    v_perm_b32 v204, v55, v51, s22
    v_perm_b32 v205, v63, v59, s22
    v_perm_b32 v206, v71, v67, s22
    v_perm_b32 v207, v79, v75, s22
    buffer_load_dwordx4 v[48:51], v10, s[12:15], s24 offen
    buffer_load_dwordx4 v[52:55], v10, s[12:15], s25 offen
    buffer_load_dwordx4 v[56:59], v10, s[12:15], s26 offen
    buffer_load_dwordx4 v[60:63], v10, s[12:15], s27 offen
    buffer_load_dwordx4 v[64:67], v10, s[12:15], s28 offen
    buffer_load_dwordx4 v[68:71], v10, s[12:15], s29 offen
    buffer_load_dwordx4 v[72:75], v10, s[12:15], s30 offen
    buffer_load_dwordx4 v[76:79], v10, s[12:15], s31 offen
    v_add_u32 v10, s23, v10
    v_accvgpr_write_b32 a32, v176
    v_accvgpr_write_b32 a33, v177
    v_accvgpr_write_b32 a34, v178
    v_accvgpr_write_b32 a35, v179
    v_accvgpr_write_b32 a36, v180
    v_accvgpr_write_b32 a37, v181
    v_accvgpr_write_b32 a38, v182
    v_accvgpr_write_b32 a39, v183
    v_accvgpr_write_b32 a40, v184
    v_accvgpr_write_b32 a41, v185
    v_accvgpr_write_b32 a42, v186
    v_accvgpr_write_b32 a43, v187
    v_accvgpr_write_b32 a44, v188
    v_accvgpr_write_b32 a45, v189
    v_accvgpr_write_b32 a46, v190
    v_accvgpr_write_b32 a47, v191
    v_accvgpr_write_b32 a48, v192
    v_accvgpr_write_b32 a49, v193
    v_accvgpr_write_b32 a50, v194
    v_accvgpr_write_b32 a51, v195
    v_accvgpr_write_b32 a52, v196
    v_accvgpr_write_b32 a53, v197
    v_accvgpr_write_b32 a54, v198
    v_accvgpr_write_b32 a55, v199
    v_accvgpr_write_b32 a56, v200
    v_accvgpr_write_b32 a57, v201
    v_accvgpr_write_b32 a58, v202
    v_accvgpr_write_b32 a59, v203
    v_accvgpr_write_b32 a60, v204
    v_accvgpr_write_b32 a61, v205
    v_accvgpr_write_b32 a62, v206
    v_accvgpr_write_b32 a63, v207
    s_waitcnt vmcnt(24)
    v_perm_b32 v176, v84, v80, s21
    v_perm_b32 v177, v92, v88, s21
    v_perm_b32 v178, v100, v96, s21
    v_perm_b32 v179, v108, v104, s21
    v_perm_b32 v180, v84, v80, s22
    v_perm_b32 v181, v92, v88, s22
    v_perm_b32 v182, v100, v96, s22
    v_perm_b32 v183, v108, v104, s22
    v_perm_b32 v184, v85, v81, s21
    v_perm_b32 v185, v93, v89, s21
    v_perm_b32 v186, v101, v97, s21
    v_perm_b32 v187, v109, v105, s21
    v_perm_b32 v188, v85, v81, s22
    v_perm_b32 v189, v93, v89, s22
    v_perm_b32 v190, v101, v97, s22
    v_perm_b32 v191, v109, v105, s22
    v_perm_b32 v192, v86, v82, s21
    v_perm_b32 v193, v94, v90, s21
    v_perm_b32 v194, v102, v98, s21
    v_perm_b32 v195, v110, v106, s21
    v_perm_b32 v196, v86, v82, s22
    v_perm_b32 v197, v94, v90, s22
    v_perm_b32 v198, v102, v98, s22
    v_perm_b32 v199, v110, v106, s22
    v_perm_b32 v200, v87, v83, s21
    v_perm_b32 v201, v95, v91, s21
    v_perm_b32 v202, v103, v99, s21
    v_perm_b32 v203, v111, v107, s21
    v_perm_b32 v204, v87, v83, s22
    v_perm_b32 v205, v95, v91, s22
    v_perm_b32 v206, v103, v99, s22
    v_perm_b32 v207, v111, v107, s22
    buffer_load_dwordx4 v[80:83], v10, s[12:15], s24 offen
    buffer_load_dwordx4 v[84:87], v10, s[12:15], s25 offen
    buffer_load_dwordx4 v[88:91], v10, s[12:15], s26 offen
    buffer_load_dwordx4 v[92:95], v10, s[12:15], s27 offen
    buffer_load_dwordx4 v[96:99], v10, s[12:15], s28 offen
    buffer_load_dwordx4 v[100:103], v10, s[12:15], s29 offen
    buffer_load_dwordx4 v[104:107], v10, s[12:15], s30 offen
    buffer_load_dwordx4 v[108:111], v10, s[12:15], s31 offen
    v_add_u32 v10, s23, v10
    v_accvgpr_write_b32 a64, v176
    v_accvgpr_write_b32 a65, v177
    v_accvgpr_write_b32 a66, v178
    v_accvgpr_write_b32 a67, v179
    v_accvgpr_write_b32 a68, v180
    v_accvgpr_write_b32 a69, v181
    v_accvgpr_write_b32 a70, v182
    v_accvgpr_write_b32 a71, v183
    v_accvgpr_write_b32 a72, v184
    v_accvgpr_write_b32 a73, v185
    v_accvgpr_write_b32 a74, v186
    v_accvgpr_write_b32 a75, v187
    v_accvgpr_write_b32 a76, v188
    v_accvgpr_write_b32 a77, v189
    v_accvgpr_write_b32 a78, v190
    v_accvgpr_write_b32 a79, v191
    v_accvgpr_write_b32 a80, v192
    v_accvgpr_write_b32 a81, v193
    v_accvgpr_write_b32 a82, v194
    v_accvgpr_write_b32 a83, v195
    v_accvgpr_write_b32 a84, v196
    v_accvgpr_write_b32 a85, v197
    v_accvgpr_write_b32 a86, v198
    v_accvgpr_write_b32 a87, v199
    v_accvgpr_write_b32 a88, v200
    v_accvgpr_write_b32 a89, v201
    v_accvgpr_write_b32 a90, v202
    v_accvgpr_write_b32 a91, v203
    v_accvgpr_write_b32 a92, v204
    v_accvgpr_write_b32 a93, v205
    v_accvgpr_write_b32 a94, v206
    v_accvgpr_write_b32 a95, v207
    s_waitcnt vmcnt(24)
    v_perm_b32 v176, v116, v112, s21
    v_perm_b32 v177, v124, v120, s21
    v_perm_b32 v178, v132, v128, s21
    v_perm_b32 v179, v140, v136, s21
    v_perm_b32 v180, v116, v112, s22
    v_perm_b32 v181, v124, v120, s22
    v_perm_b32 v182, v132, v128, s22
    v_perm_b32 v183, v140, v136, s22
    v_perm_b32 v184, v117, v113, s21
    v_perm_b32 v185, v125, v121, s21
    v_perm_b32 v186, v133, v129, s21
    v_perm_b32 v187, v141, v137, s21
    v_perm_b32 v188, v117, v113, s22
    v_perm_b32 v189, v125, v121, s22
    v_perm_b32 v190, v133, v129, s22
    v_perm_b32 v191, v141, v137, s22
    v_perm_b32 v192, v118, v114, s21
    v_perm_b32 v193, v126, v122, s21
    v_perm_b32 v194, v134, v130, s21
    v_perm_b32 v195, v142, v138, s21
    v_perm_b32 v196, v118, v114, s22
    v_perm_b32 v197, v126, v122, s22
    v_perm_b32 v198, v134, v130, s22
    v_perm_b32 v199, v142, v138, s22
    v_perm_b32 v200, v119, v115, s21
    v_perm_b32 v201, v127, v123, s21
    v_perm_b32 v202, v135, v131, s21
    v_perm_b32 v203, v143, v139, s21
    v_perm_b32 v204, v119, v115, s22
    v_perm_b32 v205, v127, v123, s22
    v_perm_b32 v206, v135, v131, s22
    v_perm_b32 v207, v143, v139, s22
    buffer_load_dwordx4 v[112:115], v10, s[12:15], s24 offen
    buffer_load_dwordx4 v[116:119], v10, s[12:15], s25 offen
    buffer_load_dwordx4 v[120:123], v10, s[12:15], s26 offen
    buffer_load_dwordx4 v[124:127], v10, s[12:15], s27 offen
    buffer_load_dwordx4 v[128:131], v10, s[12:15], s28 offen
    buffer_load_dwordx4 v[132:135], v10, s[12:15], s29 offen
    buffer_load_dwordx4 v[136:139], v10, s[12:15], s30 offen
    buffer_load_dwordx4 v[140:143], v10, s[12:15], s31 offen
    v_add_u32 v10, s23, v10
    v_accvgpr_write_b32 a96, v176
    v_accvgpr_write_b32 a97, v177
    v_accvgpr_write_b32 a98, v178
    v_accvgpr_write_b32 a99, v179
    v_accvgpr_write_b32 a100, v180
    v_accvgpr_write_b32 a101, v181
    v_accvgpr_write_b32 a102, v182
    v_accvgpr_write_b32 a103, v183
    v_accvgpr_write_b32 a104, v184
    v_accvgpr_write_b32 a105, v185
    v_accvgpr_write_b32 a106, v186
    v_accvgpr_write_b32 a107, v187
    v_accvgpr_write_b32 a108, v188
    v_accvgpr_write_b32 a109, v189
    v_accvgpr_write_b32 a110, v190
    v_accvgpr_write_b32 a111, v191
    v_accvgpr_write_b32 a112, v192
    v_accvgpr_write_b32 a113, v193
    v_accvgpr_write_b32 a114, v194
    v_accvgpr_write_b32 a115, v195
    v_accvgpr_write_b32 a116, v196
    v_accvgpr_write_b32 a117, v197
    v_accvgpr_write_b32 a118, v198
    v_accvgpr_write_b32 a119, v199
    v_accvgpr_write_b32 a120, v200
    v_accvgpr_write_b32 a121, v201
    v_accvgpr_write_b32 a122, v202
    v_accvgpr_write_b32 a123, v203
    v_accvgpr_write_b32 a124, v204
    v_accvgpr_write_b32 a125, v205
    v_accvgpr_write_b32 a126, v206
    v_accvgpr_write_b32 a127, v207
    s_waitcnt vmcnt(24)
    v_perm_b32 v176, v20, v16, s21
    v_perm_b32 v177, v28, v24, s21
    v_perm_b32 v178, v36, v32, s21
    v_perm_b32 v179, v44, v40, s21
    v_perm_b32 v180, v20, v16, s22
    v_perm_b32 v181, v28, v24, s22
    v_perm_b32 v182, v36, v32, s22
    v_perm_b32 v183, v44, v40, s22
    v_perm_b32 v184, v21, v17, s21
    v_perm_b32 v185, v29, v25, s21
    v_perm_b32 v186, v37, v33, s21
    v_perm_b32 v187, v45, v41, s21
    v_perm_b32 v188, v21, v17, s22
    v_perm_b32 v189, v29, v25, s22
    v_perm_b32 v190, v37, v33, s22
    v_perm_b32 v191, v45, v41, s22
    v_perm_b32 v192, v22, v18, s21
    v_perm_b32 v193, v30, v26, s21
    v_perm_b32 v194, v38, v34, s21
    v_perm_b32 v195, v46, v42, s21
    v_perm_b32 v196, v22, v18, s22
    v_perm_b32 v197, v30, v26, s22
    v_perm_b32 v198, v38, v34, s22
    v_perm_b32 v199, v46, v42, s22
    v_perm_b32 v200, v23, v19, s21
    v_perm_b32 v201, v31, v27, s21
    v_perm_b32 v202, v39, v35, s21
    v_perm_b32 v203, v47, v43, s21
    v_perm_b32 v204, v23, v19, s22
    v_perm_b32 v205, v31, v27, s22
    v_perm_b32 v206, v39, v35, s22
    v_perm_b32 v207, v47, v43, s22
    v_accvgpr_write_b32 a128, v176
    v_accvgpr_write_b32 a129, v177
    v_accvgpr_write_b32 a130, v178
    v_accvgpr_write_b32 a131, v179
    v_accvgpr_write_b32 a132, v180
    v_accvgpr_write_b32 a133, v181
    v_accvgpr_write_b32 a134, v182
    v_accvgpr_write_b32 a135, v183
    v_accvgpr_write_b32 a136, v184
    v_accvgpr_write_b32 a137, v185
    v_accvgpr_write_b32 a138, v186
    v_accvgpr_write_b32 a139, v187
    v_accvgpr_write_b32 a140, v188
    v_accvgpr_write_b32 a141, v189
    v_accvgpr_write_b32 a142, v190
    v_accvgpr_write_b32 a143, v191
    v_accvgpr_write_b32 a144, v192
    v_accvgpr_write_b32 a145, v193
    v_accvgpr_write_b32 a146, v194
    v_accvgpr_write_b32 a147, v195
    v_accvgpr_write_b32 a148, v196
    v_accvgpr_write_b32 a149, v197
    v_accvgpr_write_b32 a150, v198
    v_accvgpr_write_b32 a151, v199
    v_accvgpr_write_b32 a152, v200
    v_accvgpr_write_b32 a153, v201
    v_accvgpr_write_b32 a154, v202
    v_accvgpr_write_b32 a155, v203
    v_accvgpr_write_b32 a156, v204
    v_accvgpr_write_b32 a157, v205
    v_accvgpr_write_b32 a158, v206
    v_accvgpr_write_b32 a159, v207
    s_waitcnt vmcnt(16)
    v_perm_b32 v176, v52, v48, s21
    v_perm_b32 v177, v60, v56, s21
    v_perm_b32 v178, v68, v64, s21
    v_perm_b32 v179, v76, v72, s21
    v_perm_b32 v180, v52, v48, s22
    v_perm_b32 v181, v60, v56, s22
    v_perm_b32 v182, v68, v64, s22
    v_perm_b32 v183, v76, v72, s22
    v_perm_b32 v184, v53, v49, s21
    v_perm_b32 v185, v61, v57, s21
    v_perm_b32 v186, v69, v65, s21
    v_perm_b32 v187, v77, v73, s21
    v_perm_b32 v188, v53, v49, s22
    v_perm_b32 v189, v61, v57, s22
    v_perm_b32 v190, v69, v65, s22
    v_perm_b32 v191, v77, v73, s22
    v_perm_b32 v192, v54, v50, s21
    v_perm_b32 v193, v62, v58, s21
    v_perm_b32 v194, v70, v66, s21
    v_perm_b32 v195, v78, v74, s21
    v_perm_b32 v196, v54, v50, s22
    v_perm_b32 v197, v62, v58, s22
    v_perm_b32 v198, v70, v66, s22
    v_perm_b32 v199, v78, v74, s22
    v_perm_b32 v200, v55, v51, s21
    v_perm_b32 v201, v63, v59, s21
    v_perm_b32 v202, v71, v67, s21
    v_perm_b32 v203, v79, v75, s21
    v_perm_b32 v204, v55, v51, s22
    v_perm_b32 v205, v63, v59, s22
    v_perm_b32 v206, v71, v67, s22
    v_perm_b32 v207, v79, v75, s22
    v_accvgpr_write_b32 a160, v176
    v_accvgpr_write_b32 a161, v177
    v_accvgpr_write_b32 a162, v178
    v_accvgpr_write_b32 a163, v179
    v_accvgpr_write_b32 a164, v180
    v_accvgpr_write_b32 a165, v181
    v_accvgpr_write_b32 a166, v182
    v_accvgpr_write_b32 a167, v183
    v_accvgpr_write_b32 a168, v184
    v_accvgpr_write_b32 a169, v185
    v_accvgpr_write_b32 a170, v186
    v_accvgpr_write_b32 a171, v187
    v_accvgpr_write_b32 a172, v188
    v_accvgpr_write_b32 a173, v189
    v_accvgpr_write_b32 a174, v190
    v_accvgpr_write_b32 a175, v191
    v_accvgpr_write_b32 a176, v192
    v_accvgpr_write_b32 a177, v193
    v_accvgpr_write_b32 a178, v194
    v_accvgpr_write_b32 a179, v195
    v_accvgpr_write_b32 a180, v196
    v_accvgpr_write_b32 a181, v197
    v_accvgpr_write_b32 a182, v198
    v_accvgpr_write_b32 a183, v199
    v_accvgpr_write_b32 a184, v200
    v_accvgpr_write_b32 a185, v201
    v_accvgpr_write_b32 a186, v202
    v_accvgpr_write_b32 a187, v203
    v_accvgpr_write_b32 a188, v204
    v_accvgpr_write_b32 a189, v205
    v_accvgpr_write_b32 a190, v206
    v_accvgpr_write_b32 a191, v207
    s_waitcnt vmcnt(8)
    v_perm_b32 v176, v84, v80, s21
    v_perm_b32 v177, v92, v88, s21
    v_perm_b32 v178, v100, v96, s21
    v_perm_b32 v179, v108, v104, s21
    v_perm_b32 v180, v84, v80, s22
    v_perm_b32 v181, v92, v88, s22
    v_perm_b32 v182, v100, v96, s22
    v_perm_b32 v183, v108, v104, s22
    v_perm_b32 v184, v85, v81, s21
    v_perm_b32 v185, v93, v89, s21
    v_perm_b32 v186, v101, v97, s21
    v_perm_b32 v187, v109, v105, s21
    v_perm_b32 v188, v85, v81, s22
    v_perm_b32 v189, v93, v89, s22
    v_perm_b32 v190, v101, v97, s22
    v_perm_b32 v191, v109, v105, s22
    v_perm_b32 v192, v86, v82, s21
    v_perm_b32 v193, v94, v90, s21
    v_perm_b32 v194, v102, v98, s21
    v_perm_b32 v195, v110, v106, s21
    v_perm_b32 v196, v86, v82, s22
    v_perm_b32 v197, v94, v90, s22
    v_perm_b32 v198, v102, v98, s22
    v_perm_b32 v199, v110, v106, s22
    v_perm_b32 v200, v87, v83, s21
    v_perm_b32 v201, v95, v91, s21
    v_perm_b32 v202, v103, v99, s21
    v_perm_b32 v203, v111, v107, s21
    v_perm_b32 v204, v87, v83, s22
    v_perm_b32 v205, v95, v91, s22
    v_perm_b32 v206, v103, v99, s22
    v_perm_b32 v207, v111, v107, s22
    v_accvgpr_write_b32 a192, v176
    v_accvgpr_write_b32 a193, v177
    v_accvgpr_write_b32 a194, v178
    v_accvgpr_write_b32 a195, v179
    v_accvgpr_write_b32 a196, v180
    v_accvgpr_write_b32 a197, v181
    v_accvgpr_write_b32 a198, v182
    v_accvgpr_write_b32 a199, v183
    v_accvgpr_write_b32 a200, v184
    v_accvgpr_write_b32 a201, v185
    v_accvgpr_write_b32 a202, v186
    v_accvgpr_write_b32 a203, v187
    v_accvgpr_write_b32 a204, v188
    v_accvgpr_write_b32 a205, v189
    v_accvgpr_write_b32 a206, v190
    v_accvgpr_write_b32 a207, v191
    v_accvgpr_write_b32 a208, v192
    v_accvgpr_write_b32 a209, v193
    v_accvgpr_write_b32 a210, v194
    v_accvgpr_write_b32 a211, v195
    v_accvgpr_write_b32 a212, v196
    v_accvgpr_write_b32 a213, v197
    v_accvgpr_write_b32 a214, v198
    v_accvgpr_write_b32 a215, v199
    v_accvgpr_write_b32 a216, v200
    v_accvgpr_write_b32 a217, v201
    v_accvgpr_write_b32 a218, v202
    v_accvgpr_write_b32 a219, v203
    v_accvgpr_write_b32 a220, v204
    v_accvgpr_write_b32 a221, v205
    v_accvgpr_write_b32 a222, v206
    v_accvgpr_write_b32 a223, v207
    s_waitcnt vmcnt(0)
    v_perm_b32 v176, v116, v112, s21
    v_perm_b32 v177, v124, v120, s21
    v_perm_b32 v178, v132, v128, s21
    v_perm_b32 v179, v140, v136, s21
    v_perm_b32 v180, v116, v112, s22
    v_perm_b32 v181, v124, v120, s22
    v_perm_b32 v182, v132, v128, s22
    v_perm_b32 v183, v140, v136, s22
    v_perm_b32 v184, v117, v113, s21
    v_perm_b32 v185, v125, v121, s21
    v_perm_b32 v186, v133, v129, s21
    v_perm_b32 v187, v141, v137, s21
    v_perm_b32 v188, v117, v113, s22
    v_perm_b32 v189, v125, v121, s22
    v_perm_b32 v190, v133, v129, s22
    v_perm_b32 v191, v141, v137, s22
    v_perm_b32 v192, v118, v114, s21
    v_perm_b32 v193, v126, v122, s21
    v_perm_b32 v194, v134, v130, s21
    v_perm_b32 v195, v142, v138, s21
    v_perm_b32 v196, v118, v114, s22
    v_perm_b32 v197, v126, v122, s22
    v_perm_b32 v198, v134, v130, s22
    v_perm_b32 v199, v142, v138, s22
    v_perm_b32 v200, v119, v115, s21
    v_perm_b32 v201, v127, v123, s21
    v_perm_b32 v202, v135, v131, s21
    v_perm_b32 v203, v143, v139, s21
    v_perm_b32 v204, v119, v115, s22
    v_perm_b32 v205, v127, v123, s22
    v_perm_b32 v206, v135, v131, s22
    v_perm_b32 v207, v143, v139, s22
    v_accvgpr_write_b32 a224, v176
    v_accvgpr_write_b32 a225, v177
    v_accvgpr_write_b32 a226, v178
    v_accvgpr_write_b32 a227, v179
    v_accvgpr_write_b32 a228, v180
    v_accvgpr_write_b32 a229, v181
    v_accvgpr_write_b32 a230, v182
    v_accvgpr_write_b32 a231, v183
    v_accvgpr_write_b32 a232, v184
    v_accvgpr_write_b32 a233, v185
    v_accvgpr_write_b32 a234, v186
    v_accvgpr_write_b32 a235, v187
    v_accvgpr_write_b32 a236, v188
    v_accvgpr_write_b32 a237, v189
    v_accvgpr_write_b32 a238, v190
    v_accvgpr_write_b32 a239, v191
    v_accvgpr_write_b32 a240, v192
    v_accvgpr_write_b32 a241, v193
    v_accvgpr_write_b32 a242, v194
    v_accvgpr_write_b32 a243, v195
    v_accvgpr_write_b32 a244, v196
    v_accvgpr_write_b32 a245, v197
    v_accvgpr_write_b32 a246, v198
    v_accvgpr_write_b32 a247, v199
    v_accvgpr_write_b32 a248, v200
    v_accvgpr_write_b32 a249, v201
    v_accvgpr_write_b32 a250, v202
    v_accvgpr_write_b32 a251, v203
    v_accvgpr_write_b32 a252, v204
    v_accvgpr_write_b32 a253, v205
    v_accvgpr_write_b32 a254, v206
    v_accvgpr_write_b32 a255, v207
    s_nop 3
Ltl_61:
    s_mov_b32 s32, s63
    s_mov_b32 s33, s62
    s_lshr_b32 s35, s32, 2
    s_add_u32 s35, s35, 32
    s_lshl_b32 s35, s35, 6
Lw_62:
    buffer_load_dword v7, off, s[8:11], s35 sc1
    s_add_u32 s61, s61, 1
    s_cmp_gt_u32 s61, 0x40000
    s_cbranch_scc1 Lwd_63
    s_waitcnt vmcnt(0)
    v_readfirstlane_b32 s60, v7
    s_nop 3
    s_cmp_ge_u32 s60, 16
    s_cbranch_scc1 Lwd_63
    s_sleep 2
    s_branch Lw_62
Lwd_63:
    s_lshr_b32 s35, s32, 2
    s_add_u32 s35, s35, 48
    s_lshl_b32 s35, s35, 6
Lw_64:
    buffer_load_dword v7, off, s[8:11], s35 sc1
    s_add_u32 s61, s61, 1
    s_cmp_gt_u32 s61, 0x40000
    s_cbranch_scc1 Lwd_65
    s_waitcnt vmcnt(0)
    v_readfirstlane_b32 s60, v7
    s_nop 3
    s_cmp_ge_u32 s60, 8
    s_cbranch_scc1 Lwd_65
    s_sleep 2
    s_branch Lw_64
Lwd_65:
    s_lshr_b32 s36, s4, 1
    s_and_b32 s37, s4, 1
    s_lshl_b32 s38, s33, 1
    s_add_u32 s38, s38, s36
    s_lshl_b32 s39, s32, 5
    s_add_u32 s39, s39, s38
    s_lshl_b32 s40, s39, 13
    s_lshl_b32 s41, s39, 11
    v_lshlrev_b32 v4, 4, v1
    s_lshl_b32 s42, s37, 12
    s_add_u32 s42, s42, s40
    s_add_u32 s42, s42, 0x2000000
    buffer_load_dwordx4 v[16:19], v4, s[8:11], s42 offen offset:0 sc1
    buffer_load_dwordx4 v[20:23], v4, s[8:11], s42 offen offset:1024 sc1
    buffer_load_dwordx4 v[24:27], v4, s[8:11], s42 offen offset:2048 sc1
    buffer_load_dwordx4 v[28:31], v4, s[8:11], s42 offen offset:3072 sc1
    s_add_u32 s42, s40, 0x3000000
    s_add_u32 s43, s42, 4096
    buffer_load_dwordx4 v[32:35], v4, s[8:11], s42 offen offset:0 sc1
    buffer_load_dwordx4 v[36:39], v4, s[8:11], s42 offen offset:1024 sc1
    buffer_load_dwordx4 v[40:43], v4, s[8:11], s42 offen offset:2048 sc1
    buffer_load_dwordx4 v[44:47], v4, s[8:11], s42 offen offset:3072 sc1
    buffer_load_dwordx4 v[48:51], v4, s[8:11], s43 offen offset:0 sc1
    buffer_load_dwordx4 v[52:55], v4, s[8:11], s43 offen offset:1024 sc1
    buffer_load_dwordx4 v[56:59], v4, s[8:11], s43 offen offset:2048 sc1
    buffer_load_dwordx4 v[60:63], v4, s[8:11], s43 offen offset:3072 sc1
    s_add_u32 s42, s40, 0x4000000
    s_add_u32 s43, s42, 4096
    buffer_load_dwordx4 v[80:83], v4, s[8:11], s42 offen offset:0 sc1
    buffer_load_dwordx4 v[84:87], v4, s[8:11], s42 offen offset:1024 sc1
    buffer_load_dwordx4 v[88:91], v4, s[8:11], s42 offen offset:2048 sc1
    buffer_load_dwordx4 v[92:95], v4, s[8:11], s42 offen offset:3072 sc1
    buffer_load_dwordx4 v[96:99], v4, s[8:11], s43 offen offset:0 sc1
    buffer_load_dwordx4 v[100:103], v4, s[8:11], s43 offen offset:1024 sc1
    buffer_load_dwordx4 v[104:107], v4, s[8:11], s43 offen offset:2048 sc1
    buffer_load_dwordx4 v[108:111], v4, s[8:11], s43 offen offset:3072 sc1
    s_add_u32 s35, s32, 64
    s_lshl_b32 s35, s35, 6
Lw_66:
    buffer_load_dword v7, off, s[8:11], s35 sc1
    s_add_u32 s61, s61, 1
    s_cmp_gt_u32 s61, 0x40000
    s_cbranch_scc1 Lwd_67
    s_waitcnt vmcnt(0)
    v_readfirstlane_b32 s60, v7
    s_nop 3
    s_cmp_ge_u32 s60, 32
    s_cbranch_scc1 Lwd_67
    s_sleep 2
    s_branch Lw_66
Lwd_67:
    v_and_b32 v5, 7, v2
    v_lshlrev_b32 v5, 8, v5
    v_lshl_add_u32 v5, v3, 4, v5
    s_add_u32 s43, s41, 0x1000000
    buffer_load_dwordx4 v[64:67], v5, s[8:11], s43 offen offset:0 sc1
    buffer_load_dwordx4 v[68:71], v5, s[8:11], s43 offen offset:64 sc1
    buffer_load_dwordx4 v[72:75], v5, s[8:11], s43 offen offset:128 sc1
    buffer_load_dwordx4 v[76:79], v5, s[8:11], s43 offen offset:192 sc1
    v_lshlrev_b32 v6, 3, v1
    s_add_u32 s43, s41, 0x1400000
    buffer_load_dwordx2 v[112:113], v6, s[8:11], s43 offen offset:0 sc1
    buffer_load_dwordx2 v[114:115], v6, s[8:11], s43 offen offset:512 sc1
    buffer_load_dwordx2 v[116:117], v6, s[8:11], s43 offen offset:1024 sc1
    buffer_load_dwordx2 v[118:119], v6, s[8:11], s43 offen offset:1536 sc1
    s_mov_b32 s44, -1
    s_mov_b32 s45, 0
    s_mov_b32 s46, 0
    s_mov_b32 s47, -1
    s_mov_b32 s48, 0x3e0293ee
    s_lshl_b32 s49, s37, 4
    v_lshlrev_b32 v7, 2, v3
    v_sub_u32 v7, v2, v7
    v_add_u32 v7, s49, v7
    v_subrev_u32 v8, 16, v7
    v_mov_b32 v9, 0xf149f2ca
    v_mfma_f32_16x16x32_bf16 v[124:127], v[32:35], v[16:19], 0
    v_mfma_f32_16x16x32_bf16 v[128:131], v[48:51], v[16:19], 0
    v_mfma_f32_16x16x32_bf16 v[124:127], v[36:39], v[20:23], v[124:127]
    v_mfma_f32_16x16x32_bf16 v[128:131], v[52:55], v[20:23], v[128:131]
    v_mfma_f32_16x16x32_bf16 v[124:127], v[40:43], v[24:27], v[124:127]
    v_mfma_f32_16x16x32_bf16 v[128:131], v[56:59], v[24:27], v[128:131]
    v_mfma_f32_16x16x32_bf16 v[124:127], v[44:47], v[28:31], v[124:127]
    v_mfma_f32_16x16x32_bf16 v[128:131], v[60:63], v[28:31], v[128:131]
    s_waitcnt vmcnt(4)
    v_mfma_f32_16x16x32_bf16 v[120:123], v[64:67], v[16:19], 0
    v_mfma_f32_16x16x32_bf16 v[120:123], v[68:71], v[20:23], v[120:123]
    v_mfma_f32_16x16x32_bf16 v[120:123], v[72:75], v[24:27], v[120:123]
    v_mfma_f32_16x16x32_bf16 v[120:123], v[76:79], v[28:31], v[120:123]
    s_nop 7
    v_cmp_le_i32 vcc, 0, v7
    v_cndmask_b32 v124, v9, v124, vcc
    v_cmp_le_i32 vcc, 1, v7
    v_cndmask_b32 v125, v9, v125, vcc
    v_cmp_le_i32 vcc, 2, v7
    v_cndmask_b32 v126, v9, v126, vcc
    v_cmp_le_i32 vcc, 3, v7
    v_cndmask_b32 v127, v9, v127, vcc
    v_cmp_le_i32 vcc, 0, v8
    v_cndmask_b32 v128, v9, v128, vcc
    v_cmp_le_i32 vcc, 1, v8
    v_cndmask_b32 v129, v9, v129, vcc
    v_cmp_le_i32 vcc, 2, v8
    v_cndmask_b32 v130, v9, v130, vcc
    v_cmp_le_i32 vcc, 3, v8
    v_cndmask_b32 v131, v9, v131, vcc
    v_max3_f32 v144, v124, v125, v126
    v_max3_f32 v145, v127, v128, v129
    v_max3_f32 v144, v130, v131, v144
    v_max3_f32 v145, v120, v121, v145
    v_max3_f32 v144, v122, v123, v144
    v_max_f32 v144, v144, v145
    v_mov_b32 v145, v144
    s_nop 1
    v_permlane16_swap_b32 v144, v145
    s_nop 1
    v_max_f32 v144, v144, v145
    v_mov_b32 v145, v144
    s_nop 1
    v_permlane32_swap_b32 v144, v145
    s_nop 1
    v_max_f32 v144, v144, v145
    v_mul_f32 v144, s48, v144
    v_fma_f32 v120, v120, s48, -v144
    v_fma_f32 v121, v121, s48, -v144
    v_fma_f32 v122, v122, s48, -v144
    v_fma_f32 v123, v123, s48, -v144
    v_fma_f32 v124, v124, s48, -v144
    v_fma_f32 v125, v125, s48, -v144
    v_fma_f32 v126, v126, s48, -v144
    v_fma_f32 v127, v127, s48, -v144
    v_fma_f32 v128, v128, s48, -v144
    v_fma_f32 v129, v129, s48, -v144
    v_fma_f32 v130, v130, s48, -v144
    v_fma_f32 v131, v131, s48, -v144
    v_exp_f32 v120, v120
    v_exp_f32 v121, v121
    v_exp_f32 v122, v122
    v_exp_f32 v123, v123
    v_exp_f32 v124, v124
    v_exp_f32 v125, v125
    v_exp_f32 v126, v126
    v_exp_f32 v127, v127
    v_exp_f32 v128, v128
    v_exp_f32 v129, v129
    v_exp_f32 v130, v130
    v_exp_f32 v131, v131
    s_nop 0
    v_cvt_pk_bf16_f32 v132, v124, v125
    v_cvt_pk_bf16_f32 v133, v126, v127
    v_cvt_pk_bf16_f32 v134, v128, v129
    v_cvt_pk_bf16_f32 v135, v130, v131
    v_cvt_pk_bf16_f32 v136, v120, v121
    v_cvt_pk_bf16_f32 v137, v122, v123
    v_cndmask_b32 v138, 0, v136, s[44:45]
    v_cndmask_b32 v140, 0, v136, s[46:47]
    v_cndmask_b32 v139, 0, v137, s[44:45]
    v_cndmask_b32 v141, 0, v137, s[46:47]
    v_add_f32 v144, v120, v121
    v_add_f32 v145, v122, v123
    v_add_f32 v144, v144, v145
    v_cndmask_b32 v144, 0, v144, s[44:45]
    v_add_f32 v145, v124, v125
    v_add_f32 v146, v126, v127
    v_add_f32 v147, v128, v129
    v_add_f32 v144, v144, v130
    v_add_f32 v145, v145, v131
    v_add_f32 v146, v146, v147
    v_add_f32 v144, v144, v145
    v_add_f32 v144, v144, v146
    v_mov_b32 v145, v144
    s_nop 1
    v_permlane16_swap_b32 v144, v145
    s_nop 1
    v_add_f32 v144, v144, v145
    v_mov_b32 v145, v144
    s_nop 1
    v_permlane32_swap_b32 v144, v145
    s_nop 1
    v_add_f32 v144, v144, v145
    v_rcp_f32 v144, v144
    s_waitcnt vmcnt(0)
    v_mfma_f32_16x16x32_bf16 v[176:179], v[80:83], v[132:135], 0
    v_mfma_f32_16x16x32_bf16 v[180:183], v[84:87], v[132:135], 0
    v_mfma_f32_16x16x32_bf16 v[184:187], v[88:91], v[132:135], 0
    v_mfma_f32_16x16x32_bf16 v[188:191], v[92:95], v[132:135], 0
    v_mfma_f32_16x16x32_bf16 v[192:195], v[96:99], v[132:135], 0
    v_mfma_f32_16x16x32_bf16 v[196:199], v[100:103], v[132:135], 0
    v_mfma_f32_16x16x32_bf16 v[200:203], v[104:107], v[132:135], 0
    v_mfma_f32_16x16x32_bf16 v[204:207], v[108:111], v[132:135], 0
    v_mfma_f32_16x16x16_bf16 v[176:179], v[112:113], v[138:139], v[176:179]
    v_mfma_f32_16x16x16_bf16 v[180:183], v[112:113], v[140:141], v[180:183]
    v_mfma_f32_16x16x16_bf16 v[184:187], v[114:115], v[138:139], v[184:187]
    v_mfma_f32_16x16x16_bf16 v[188:191], v[114:115], v[140:141], v[188:191]
    v_mfma_f32_16x16x16_bf16 v[192:195], v[116:117], v[138:139], v[192:195]
    v_mfma_f32_16x16x16_bf16 v[196:199], v[116:117], v[140:141], v[196:199]
    v_mfma_f32_16x16x16_bf16 v[200:203], v[118:119], v[138:139], v[200:203]
    v_mfma_f32_16x16x16_bf16 v[204:207], v[118:119], v[140:141], v[204:207]
    s_lshl_b32 s49, s36, 13
    s_lshl_b32 s50, s37, 10
    s_add_u32 s49, s49, s50
    v_add_u32 v5, s49, v4
    s_nop 7
    v_mul_f32 v176, v176, v144
    v_mul_f32 v180, v180, v144
    v_mul_f32 v177, v177, v144
    v_mul_f32 v181, v181, v144
    v_mul_f32 v178, v178, v144
    v_mul_f32 v182, v182, v144
    v_mul_f32 v179, v179, v144
    v_mul_f32 v183, v183, v144
    v_cvt_pk_bf16_f32 v156, v176, v180
    v_cvt_pk_bf16_f32 v157, v177, v181
    v_cvt_pk_bf16_f32 v158, v178, v182
    v_cvt_pk_bf16_f32 v159, v179, v183
    ds_write_b128 v5, v[156:159] offset:0
    v_mul_f32 v184, v184, v144
    v_mul_f32 v188, v188, v144
    v_mul_f32 v185, v185, v144
    v_mul_f32 v189, v189, v144
    v_mul_f32 v186, v186, v144
    v_mul_f32 v190, v190, v144
    v_mul_f32 v187, v187, v144
    v_mul_f32 v191, v191, v144
    v_cvt_pk_bf16_f32 v160, v184, v188
    v_cvt_pk_bf16_f32 v161, v185, v189
    v_cvt_pk_bf16_f32 v162, v186, v190
    v_cvt_pk_bf16_f32 v163, v187, v191
    ds_write_b128 v5, v[160:163] offset:2048
    v_mul_f32 v192, v192, v144
    v_mul_f32 v196, v196, v144
    v_mul_f32 v193, v193, v144
    v_mul_f32 v197, v197, v144
    v_mul_f32 v194, v194, v144
    v_mul_f32 v198, v198, v144
    v_mul_f32 v195, v195, v144
    v_mul_f32 v199, v199, v144
    v_cvt_pk_bf16_f32 v164, v192, v196
    v_cvt_pk_bf16_f32 v165, v193, v197
    v_cvt_pk_bf16_f32 v166, v194, v198
    v_cvt_pk_bf16_f32 v167, v195, v199
    ds_write_b128 v5, v[164:167] offset:4096
    v_mul_f32 v200, v200, v144
    v_mul_f32 v204, v204, v144
    v_mul_f32 v201, v201, v144
    v_mul_f32 v205, v205, v144
    v_mul_f32 v202, v202, v144
    v_mul_f32 v206, v206, v144
    v_mul_f32 v203, v203, v144
    v_mul_f32 v207, v207, v144
    v_cvt_pk_bf16_f32 v168, v200, v204
    v_cvt_pk_bf16_f32 v169, v201, v205
    v_cvt_pk_bf16_f32 v170, v202, v206
    v_cvt_pk_bf16_f32 v171, v203, v207
    ds_write_b128 v5, v[168:171] offset:6144
    s_waitcnt lgkmcnt(0)
    s_barrier
    ds_read_b128 v[16:19], v4 offset:0
    ds_read_b128 v[20:23], v4 offset:1024
    ds_read_b128 v[24:27], v4 offset:2048
    ds_read_b128 v[28:31], v4 offset:3072
    ds_read_b128 v[32:35], v4 offset:4096
    ds_read_b128 v[36:39], v4 offset:5120
    ds_read_b128 v[40:43], v4 offset:6144
    ds_read_b128 v[44:47], v4 offset:7168
    ds_read_b128 v[48:51], v4 offset:8192
    ds_read_b128 v[52:55], v4 offset:9216
    ds_read_b128 v[56:59], v4 offset:10240
    ds_read_b128 v[60:63], v4 offset:11264
    ds_read_b128 v[64:67], v4 offset:12288
    ds_read_b128 v[68:71], v4 offset:13312
    ds_read_b128 v[72:75], v4 offset:14336
    ds_read_b128 v[76:79], v4 offset:15360
    s_waitcnt lgkmcnt(14)
    v_mfma_f32_16x16x32_bf16 v[96:99], v[16:19], a[0:3], 0
    v_mfma_f32_16x16x32_bf16 v[128:131], v[20:23], a[0:3], 0
    v_mfma_f32_16x16x32_bf16 v[100:103], v[16:19], a[4:7], 0
    v_mfma_f32_16x16x32_bf16 v[132:135], v[20:23], a[4:7], 0
    v_mfma_f32_16x16x32_bf16 v[104:107], v[16:19], a[8:11], 0
    v_mfma_f32_16x16x32_bf16 v[136:139], v[20:23], a[8:11], 0
    v_mfma_f32_16x16x32_bf16 v[108:111], v[16:19], a[12:15], 0
    v_mfma_f32_16x16x32_bf16 v[140:143], v[20:23], a[12:15], 0
    v_mfma_f32_16x16x32_bf16 v[112:115], v[16:19], a[16:19], 0
    v_mfma_f32_16x16x32_bf16 v[144:147], v[20:23], a[16:19], 0
    v_mfma_f32_16x16x32_bf16 v[116:119], v[16:19], a[20:23], 0
    v_mfma_f32_16x16x32_bf16 v[148:151], v[20:23], a[20:23], 0
    v_mfma_f32_16x16x32_bf16 v[120:123], v[16:19], a[24:27], 0
    v_mfma_f32_16x16x32_bf16 v[152:155], v[20:23], a[24:27], 0
    v_mfma_f32_16x16x32_bf16 v[124:127], v[16:19], a[28:31], 0
    v_mfma_f32_16x16x32_bf16 v[156:159], v[20:23], a[28:31], 0
    s_waitcnt lgkmcnt(12)
    v_mfma_f32_16x16x32_bf16 v[96:99], v[24:27], a[32:35], v[96:99]
    v_mfma_f32_16x16x32_bf16 v[128:131], v[28:31], a[32:35], v[128:131]
    v_mfma_f32_16x16x32_bf16 v[100:103], v[24:27], a[36:39], v[100:103]
    v_mfma_f32_16x16x32_bf16 v[132:135], v[28:31], a[36:39], v[132:135]
    v_mfma_f32_16x16x32_bf16 v[104:107], v[24:27], a[40:43], v[104:107]
    v_mfma_f32_16x16x32_bf16 v[136:139], v[28:31], a[40:43], v[136:139]
    v_mfma_f32_16x16x32_bf16 v[108:111], v[24:27], a[44:47], v[108:111]
    v_mfma_f32_16x16x32_bf16 v[140:143], v[28:31], a[44:47], v[140:143]
    v_mfma_f32_16x16x32_bf16 v[112:115], v[24:27], a[48:51], v[112:115]
    v_mfma_f32_16x16x32_bf16 v[144:147], v[28:31], a[48:51], v[144:147]
    v_mfma_f32_16x16x32_bf16 v[116:119], v[24:27], a[52:55], v[116:119]
    v_mfma_f32_16x16x32_bf16 v[148:151], v[28:31], a[52:55], v[148:151]
    v_mfma_f32_16x16x32_bf16 v[120:123], v[24:27], a[56:59], v[120:123]
    v_mfma_f32_16x16x32_bf16 v[152:155], v[28:31], a[56:59], v[152:155]
    v_mfma_f32_16x16x32_bf16 v[124:127], v[24:27], a[60:63], v[124:127]
    v_mfma_f32_16x16x32_bf16 v[156:159], v[28:31], a[60:63], v[156:159]
    s_waitcnt lgkmcnt(10)
    v_mfma_f32_16x16x32_bf16 v[96:99], v[32:35], a[64:67], v[96:99]
    v_mfma_f32_16x16x32_bf16 v[128:131], v[36:39], a[64:67], v[128:131]
    v_mfma_f32_16x16x32_bf16 v[100:103], v[32:35], a[68:71], v[100:103]
    v_mfma_f32_16x16x32_bf16 v[132:135], v[36:39], a[68:71], v[132:135]
    v_mfma_f32_16x16x32_bf16 v[104:107], v[32:35], a[72:75], v[104:107]
    v_mfma_f32_16x16x32_bf16 v[136:139], v[36:39], a[72:75], v[136:139]
    v_mfma_f32_16x16x32_bf16 v[108:111], v[32:35], a[76:79], v[108:111]
    v_mfma_f32_16x16x32_bf16 v[140:143], v[36:39], a[76:79], v[140:143]
    v_mfma_f32_16x16x32_bf16 v[112:115], v[32:35], a[80:83], v[112:115]
    v_mfma_f32_16x16x32_bf16 v[144:147], v[36:39], a[80:83], v[144:147]
    v_mfma_f32_16x16x32_bf16 v[116:119], v[32:35], a[84:87], v[116:119]
    v_mfma_f32_16x16x32_bf16 v[148:151], v[36:39], a[84:87], v[148:151]
    v_mfma_f32_16x16x32_bf16 v[120:123], v[32:35], a[88:91], v[120:123]
    v_mfma_f32_16x16x32_bf16 v[152:155], v[36:39], a[88:91], v[152:155]
    v_mfma_f32_16x16x32_bf16 v[124:127], v[32:35], a[92:95], v[124:127]
    v_mfma_f32_16x16x32_bf16 v[156:159], v[36:39], a[92:95], v[156:159]
    s_waitcnt lgkmcnt(8)
    v_mfma_f32_16x16x32_bf16 v[96:99], v[40:43], a[96:99], v[96:99]
    v_mfma_f32_16x16x32_bf16 v[128:131], v[44:47], a[96:99], v[128:131]
    v_mfma_f32_16x16x32_bf16 v[100:103], v[40:43], a[100:103], v[100:103]
    v_mfma_f32_16x16x32_bf16 v[132:135], v[44:47], a[100:103], v[132:135]
    v_mfma_f32_16x16x32_bf16 v[104:107], v[40:43], a[104:107], v[104:107]
    v_mfma_f32_16x16x32_bf16 v[136:139], v[44:47], a[104:107], v[136:139]
    v_mfma_f32_16x16x32_bf16 v[108:111], v[40:43], a[108:111], v[108:111]
    v_mfma_f32_16x16x32_bf16 v[140:143], v[44:47], a[108:111], v[140:143]
    v_mfma_f32_16x16x32_bf16 v[112:115], v[40:43], a[112:115], v[112:115]
    v_mfma_f32_16x16x32_bf16 v[144:147], v[44:47], a[112:115], v[144:147]
    v_mfma_f32_16x16x32_bf16 v[116:119], v[40:43], a[116:119], v[116:119]
    v_mfma_f32_16x16x32_bf16 v[148:151], v[44:47], a[116:119], v[148:151]
    v_mfma_f32_16x16x32_bf16 v[120:123], v[40:43], a[120:123], v[120:123]
    v_mfma_f32_16x16x32_bf16 v[152:155], v[44:47], a[120:123], v[152:155]
    v_mfma_f32_16x16x32_bf16 v[124:127], v[40:43], a[124:127], v[124:127]
    v_mfma_f32_16x16x32_bf16 v[156:159], v[44:47], a[124:127], v[156:159]
    s_waitcnt lgkmcnt(6)
    v_mfma_f32_16x16x32_bf16 v[96:99], v[48:51], a[128:131], v[96:99]
    v_mfma_f32_16x16x32_bf16 v[128:131], v[52:55], a[128:131], v[128:131]
    v_mfma_f32_16x16x32_bf16 v[100:103], v[48:51], a[132:135], v[100:103]
    v_mfma_f32_16x16x32_bf16 v[132:135], v[52:55], a[132:135], v[132:135]
    v_mfma_f32_16x16x32_bf16 v[104:107], v[48:51], a[136:139], v[104:107]
    v_mfma_f32_16x16x32_bf16 v[136:139], v[52:55], a[136:139], v[136:139]
    v_mfma_f32_16x16x32_bf16 v[108:111], v[48:51], a[140:143], v[108:111]
    v_mfma_f32_16x16x32_bf16 v[140:143], v[52:55], a[140:143], v[140:143]
    v_mfma_f32_16x16x32_bf16 v[112:115], v[48:51], a[144:147], v[112:115]
    v_mfma_f32_16x16x32_bf16 v[144:147], v[52:55], a[144:147], v[144:147]
    v_mfma_f32_16x16x32_bf16 v[116:119], v[48:51], a[148:151], v[116:119]
    v_mfma_f32_16x16x32_bf16 v[148:151], v[52:55], a[148:151], v[148:151]
    v_mfma_f32_16x16x32_bf16 v[120:123], v[48:51], a[152:155], v[120:123]
    v_mfma_f32_16x16x32_bf16 v[152:155], v[52:55], a[152:155], v[152:155]
    v_mfma_f32_16x16x32_bf16 v[124:127], v[48:51], a[156:159], v[124:127]
    v_mfma_f32_16x16x32_bf16 v[156:159], v[52:55], a[156:159], v[156:159]
    s_waitcnt lgkmcnt(4)
    v_mfma_f32_16x16x32_bf16 v[96:99], v[56:59], a[160:163], v[96:99]
    v_mfma_f32_16x16x32_bf16 v[128:131], v[60:63], a[160:163], v[128:131]
    v_mfma_f32_16x16x32_bf16 v[100:103], v[56:59], a[164:167], v[100:103]
    v_mfma_f32_16x16x32_bf16 v[132:135], v[60:63], a[164:167], v[132:135]
    v_mfma_f32_16x16x32_bf16 v[104:107], v[56:59], a[168:171], v[104:107]
    v_mfma_f32_16x16x32_bf16 v[136:139], v[60:63], a[168:171], v[136:139]
    v_mfma_f32_16x16x32_bf16 v[108:111], v[56:59], a[172:175], v[108:111]
    v_mfma_f32_16x16x32_bf16 v[140:143], v[60:63], a[172:175], v[140:143]
    v_mfma_f32_16x16x32_bf16 v[112:115], v[56:59], a[176:179], v[112:115]
    v_mfma_f32_16x16x32_bf16 v[144:147], v[60:63], a[176:179], v[144:147]
    v_mfma_f32_16x16x32_bf16 v[116:119], v[56:59], a[180:183], v[116:119]
    v_mfma_f32_16x16x32_bf16 v[148:151], v[60:63], a[180:183], v[148:151]
    v_mfma_f32_16x16x32_bf16 v[120:123], v[56:59], a[184:187], v[120:123]
    v_mfma_f32_16x16x32_bf16 v[152:155], v[60:63], a[184:187], v[152:155]
    v_mfma_f32_16x16x32_bf16 v[124:127], v[56:59], a[188:191], v[124:127]
    v_mfma_f32_16x16x32_bf16 v[156:159], v[60:63], a[188:191], v[156:159]
    s_waitcnt lgkmcnt(2)
    v_mfma_f32_16x16x32_bf16 v[96:99], v[64:67], a[192:195], v[96:99]
    v_mfma_f32_16x16x32_bf16 v[128:131], v[68:71], a[192:195], v[128:131]
    v_mfma_f32_16x16x32_bf16 v[100:103], v[64:67], a[196:199], v[100:103]
    v_mfma_f32_16x16x32_bf16 v[132:135], v[68:71], a[196:199], v[132:135]
    v_mfma_f32_16x16x32_bf16 v[104:107], v[64:67], a[200:203], v[104:107]
    v_mfma_f32_16x16x32_bf16 v[136:139], v[68:71], a[200:203], v[136:139]
    v_mfma_f32_16x16x32_bf16 v[108:111], v[64:67], a[204:207], v[108:111]
    v_mfma_f32_16x16x32_bf16 v[140:143], v[68:71], a[204:207], v[140:143]
    v_mfma_f32_16x16x32_bf16 v[112:115], v[64:67], a[208:211], v[112:115]
    v_mfma_f32_16x16x32_bf16 v[144:147], v[68:71], a[208:211], v[144:147]
    v_mfma_f32_16x16x32_bf16 v[116:119], v[64:67], a[212:215], v[116:119]
    v_mfma_f32_16x16x32_bf16 v[148:151], v[68:71], a[212:215], v[148:151]
    v_mfma_f32_16x16x32_bf16 v[120:123], v[64:67], a[216:219], v[120:123]
    v_mfma_f32_16x16x32_bf16 v[152:155], v[68:71], a[216:219], v[152:155]
    v_mfma_f32_16x16x32_bf16 v[124:127], v[64:67], a[220:223], v[124:127]
    v_mfma_f32_16x16x32_bf16 v[156:159], v[68:71], a[220:223], v[156:159]
    s_waitcnt lgkmcnt(0)
    v_mfma_f32_16x16x32_bf16 v[96:99], v[72:75], a[224:227], v[96:99]
    v_mfma_f32_16x16x32_bf16 v[128:131], v[76:79], a[224:227], v[128:131]
    v_mfma_f32_16x16x32_bf16 v[100:103], v[72:75], a[228:231], v[100:103]
    v_mfma_f32_16x16x32_bf16 v[132:135], v[76:79], a[228:231], v[132:135]
    v_mfma_f32_16x16x32_bf16 v[104:107], v[72:75], a[232:235], v[104:107]
    v_mfma_f32_16x16x32_bf16 v[136:139], v[76:79], a[232:235], v[136:139]
    v_mfma_f32_16x16x32_bf16 v[108:111], v[72:75], a[236:239], v[108:111]
    v_mfma_f32_16x16x32_bf16 v[140:143], v[76:79], a[236:239], v[140:143]
    v_mfma_f32_16x16x32_bf16 v[112:115], v[72:75], a[240:243], v[112:115]
    v_mfma_f32_16x16x32_bf16 v[144:147], v[76:79], a[240:243], v[144:147]
    v_mfma_f32_16x16x32_bf16 v[116:119], v[72:75], a[244:247], v[116:119]
    v_mfma_f32_16x16x32_bf16 v[148:151], v[76:79], a[244:247], v[148:151]
    v_mfma_f32_16x16x32_bf16 v[120:123], v[72:75], a[248:251], v[120:123]
    v_mfma_f32_16x16x32_bf16 v[152:155], v[76:79], a[248:251], v[152:155]
    v_mfma_f32_16x16x32_bf16 v[124:127], v[72:75], a[252:255], v[124:127]
    v_mfma_f32_16x16x32_bf16 v[156:159], v[76:79], a[252:255], v[156:159]
    s_nop 7
    s_nop 7
    v_lshlrev_b32 v8, 13, v3
    v_lshl_add_u32 v8, v2, 4, v8
    s_lshl_b32 s50, s4, 9
    v_add_u32 v8, s50, v8
    s_lshl_b32 s49, s32, 4
    s_add_u32 s49, s49, s33
    s_lshl_b32 s49, s49, 16
    s_add_u32 s49, s49, 0x5000000
    v_mov_b32 v16, v96
    v_mov_b32 v17, v100
    v_mov_b32 v18, v104
    v_mov_b32 v19, v108
    v_mov_b32 v20, v112
    v_mov_b32 v21, v116
    v_mov_b32 v22, v120
    v_mov_b32 v23, v124
    buffer_store_dwordx4 v[16:19], v8, s[8:11], s49 offen offset:0 sc1
    buffer_store_dwordx4 v[20:23], v8, s[8:11], s49 offen offset:256 sc1
    v_mov_b32 v24, v97
    v_mov_b32 v25, v101
    v_mov_b32 v26, v105
    v_mov_b32 v27, v109
    v_mov_b32 v28, v113
    v_mov_b32 v29, v117
    v_mov_b32 v30, v121
    v_mov_b32 v31, v125
    buffer_store_dwordx4 v[24:27], v8, s[8:11], s49 offen offset:2048 sc1
    buffer_store_dwordx4 v[28:31], v8, s[8:11], s49 offen offset:2304 sc1
    v_mov_b32 v32, v98
    v_mov_b32 v33, v102
    v_mov_b32 v34, v106
    v_mov_b32 v35, v110
    v_mov_b32 v36, v114
    v_mov_b32 v37, v118
    v_mov_b32 v38, v122
    v_mov_b32 v39, v126
    s_add_u32 s49, s49, 0x1000
    buffer_store_dwordx4 v[32:35], v8, s[8:11], s49 offen offset:0 sc1
    buffer_store_dwordx4 v[36:39], v8, s[8:11], s49 offen offset:256 sc1
    v_mov_b32 v40, v99
    v_mov_b32 v41, v103
    v_mov_b32 v42, v107
    v_mov_b32 v43, v111
    v_mov_b32 v44, v115
    v_mov_b32 v45, v119
    v_mov_b32 v46, v123
    v_mov_b32 v47, v127
    buffer_store_dwordx4 v[40:43], v8, s[8:11], s49 offen offset:2048 sc1
    buffer_store_dwordx4 v[44:47], v8, s[8:11], s49 offen offset:2304 sc1
    v_mov_b32 v16, v128
    v_mov_b32 v17, v132
    v_mov_b32 v18, v136
    v_mov_b32 v19, v140
    v_mov_b32 v20, v144
    v_mov_b32 v21, v148
    v_mov_b32 v22, v152
    v_mov_b32 v23, v156
    s_add_u32 s49, s49, 0x7000
    buffer_store_dwordx4 v[16:19], v8, s[8:11], s49 offen offset:0 sc1
    buffer_store_dwordx4 v[20:23], v8, s[8:11], s49 offen offset:256 sc1
    v_mov_b32 v24, v129
    v_mov_b32 v25, v133
    v_mov_b32 v26, v137
    v_mov_b32 v27, v141
    v_mov_b32 v28, v145
    v_mov_b32 v29, v149
    v_mov_b32 v30, v153
    v_mov_b32 v31, v157
    buffer_store_dwordx4 v[24:27], v8, s[8:11], s49 offen offset:2048 sc1
    buffer_store_dwordx4 v[28:31], v8, s[8:11], s49 offen offset:2304 sc1
    v_mov_b32 v32, v130
    v_mov_b32 v33, v134
    v_mov_b32 v34, v138
    v_mov_b32 v35, v142
    v_mov_b32 v36, v146
    v_mov_b32 v37, v150
    v_mov_b32 v38, v154
    v_mov_b32 v39, v158
    s_add_u32 s49, s49, 0x1000
    buffer_store_dwordx4 v[32:35], v8, s[8:11], s49 offen offset:0 sc1
    buffer_store_dwordx4 v[36:39], v8, s[8:11], s49 offen offset:256 sc1
    v_mov_b32 v40, v131
    v_mov_b32 v41, v135
    v_mov_b32 v42, v139
    v_mov_b32 v43, v143
    v_mov_b32 v44, v147
    v_mov_b32 v45, v151
    v_mov_b32 v46, v155
    v_mov_b32 v47, v159
    buffer_store_dwordx4 v[40:43], v8, s[8:11], s49 offen offset:2048 sc1
    buffer_store_dwordx4 v[44:47], v8, s[8:11], s49 offen offset:2304 sc1
    s_add_u32 s35, s32, 128
    s_lshl_b32 s35, s35, 6
    s_waitcnt vmcnt(0) lgkmcnt(0)
    s_barrier
    s_cmp_lg_u32 s4, 0
    s_cbranch_scc1 Lsg_68
    v_mov_b32 v7, 1
    s_mov_b64 exec, 1
    buffer_atomic_add v7, off, s[8:11], s35 sc1
    s_mov_b64 exec, -1
Lsg_68:
    s_add_u32 s63, s63, 6
    s_cmp_lt_u32 s63, 64
    s_cbranch_scc1 Ltl_61
    s_branch Lwend_59
Lrole_60:
    s_cmp_ge_u32 s5, 151
    s_cbranch_scc1 Lrole_69
    s_sub_u32 s62, s5, 96
    s_mul_hi_u32 s63, s62, 0x1745d175
    s_mul_i32 s33, s63, 11
    s_sub_u32 s62, s62, s33
    s_mov_b32 s33, s62
    s_mov_b32 s12, s80
    s_and_b32 s13, s81, 0xffff
    s_mov_b32 s14, 0x158000
    s_mov_b32 s15, 0x20000
    s_cmp_lt_u32 s4, 2
    s_cbranch_scc1 Lcg_70
    s_mov_b32 s12, s82
    s_and_b32 s13, s83, 0xffff
    s_mov_b32 s14, 0x158000
    s_mov_b32 s15, 0x20000
Lcg_70:
    s_and_b32 s36, s4, 1
    v_mul_u32_u24 v10, 22016, v3
    v_lshl_add_u32 v10, v2, 4, v10
    s_mul_i32 s37, s36, 704512
    s_lshl_b32 s38, s33, 8
    s_add_u32 s37, s37, s38
    v_add_u32 v10, s37, v10
    s_mov_b32 s21, 0x5040100
    s_mov_b32 s22, 0x7060302
    s_mov_b32 s23, 0x15800
    s_mov_b32 s24, 0
    s_mov_b32 s25, 0xac0
    s_mov_b32 s26, 0x1580
    s_mov_b32 s27, 0x2040
    s_mov_b32 s28, 0x2b00
    s_mov_b32 s29, 0x35c0
    s_mov_b32 s30, 0x4080
    s_mov_b32 s31, 0x4b40
    buffer_load_dwordx4 v[16:19], v10, s[12:15], s24 offen
    buffer_load_dwordx4 v[20:23], v10, s[12:15], s25 offen
    buffer_load_dwordx4 v[24:27], v10, s[12:15], s26 offen
    buffer_load_dwordx4 v[28:31], v10, s[12:15], s27 offen
    buffer_load_dwordx4 v[32:35], v10, s[12:15], s28 offen
    buffer_load_dwordx4 v[36:39], v10, s[12:15], s29 offen
    buffer_load_dwordx4 v[40:43], v10, s[12:15], s30 offen
    buffer_load_dwordx4 v[44:47], v10, s[12:15], s31 offen
    v_add_u32 v10, s23, v10
    buffer_load_dwordx4 v[48:51], v10, s[12:15], s24 offen
    buffer_load_dwordx4 v[52:55], v10, s[12:15], s25 offen
    buffer_load_dwordx4 v[56:59], v10, s[12:15], s26 offen
    buffer_load_dwordx4 v[60:63], v10, s[12:15], s27 offen
    buffer_load_dwordx4 v[64:67], v10, s[12:15], s28 offen
    buffer_load_dwordx4 v[68:71], v10, s[12:15], s29 offen
    buffer_load_dwordx4 v[72:75], v10, s[12:15], s30 offen
    buffer_load_dwordx4 v[76:79], v10, s[12:15], s31 offen
    v_add_u32 v10, s23, v10
    buffer_load_dwordx4 v[80:83], v10, s[12:15], s24 offen
    buffer_load_dwordx4 v[84:87], v10, s[12:15], s25 offen
    buffer_load_dwordx4 v[88:91], v10, s[12:15], s26 offen
    buffer_load_dwordx4 v[92:95], v10, s[12:15], s27 offen
    buffer_load_dwordx4 v[96:99], v10, s[12:15], s28 offen
    buffer_load_dwordx4 v[100:103], v10, s[12:15], s29 offen
    buffer_load_dwordx4 v[104:107], v10, s[12:15], s30 offen
    buffer_load_dwordx4 v[108:111], v10, s[12:15], s31 offen
    v_add_u32 v10, s23, v10
    buffer_load_dwordx4 v[112:115], v10, s[12:15], s24 offen
    buffer_load_dwordx4 v[116:119], v10, s[12:15], s25 offen
    buffer_load_dwordx4 v[120:123], v10, s[12:15], s26 offen
    buffer_load_dwordx4 v[124:127], v10, s[12:15], s27 offen
    buffer_load_dwordx4 v[128:131], v10, s[12:15], s28 offen
    buffer_load_dwordx4 v[132:135], v10, s[12:15], s29 offen
    buffer_load_dwordx4 v[136:139], v10, s[12:15], s30 offen
    buffer_load_dwordx4 v[140:143], v10, s[12:15], s31 offen
    v_add_u32 v10, s23, v10
    s_waitcnt vmcnt(24)
    v_perm_b32 v176, v20, v16, s21
    v_perm_b32 v177, v28, v24, s21
    v_perm_b32 v178, v36, v32, s21
    v_perm_b32 v179, v44, v40, s21
    v_perm_b32 v180, v20, v16, s22
    v_perm_b32 v181, v28, v24, s22
    v_perm_b32 v182, v36, v32, s22
    v_perm_b32 v183, v44, v40, s22
    v_perm_b32 v184, v21, v17, s21
    v_perm_b32 v185, v29, v25, s21
    v_perm_b32 v186, v37, v33, s21
    v_perm_b32 v187, v45, v41, s21
    v_perm_b32 v188, v21, v17, s22
    v_perm_b32 v189, v29, v25, s22
    v_perm_b32 v190, v37, v33, s22
    v_perm_b32 v191, v45, v41, s22
    v_perm_b32 v192, v22, v18, s21
    v_perm_b32 v193, v30, v26, s21
    v_perm_b32 v194, v38, v34, s21
    v_perm_b32 v195, v46, v42, s21
    v_perm_b32 v196, v22, v18, s22
    v_perm_b32 v197, v30, v26, s22
    v_perm_b32 v198, v38, v34, s22
    v_perm_b32 v199, v46, v42, s22
    v_perm_b32 v200, v23, v19, s21
    v_perm_b32 v201, v31, v27, s21
    v_perm_b32 v202, v39, v35, s21
    v_perm_b32 v203, v47, v43, s21
    v_perm_b32 v204, v23, v19, s22
    v_perm_b32 v205, v31, v27, s22
    v_perm_b32 v206, v39, v35, s22
    v_perm_b32 v207, v47, v43, s22
    buffer_load_dwordx4 v[16:19], v10, s[12:15], s24 offen
    buffer_load_dwordx4 v[20:23], v10, s[12:15], s25 offen
    buffer_load_dwordx4 v[24:27], v10, s[12:15], s26 offen
    buffer_load_dwordx4 v[28:31], v10, s[12:15], s27 offen
    buffer_load_dwordx4 v[32:35], v10, s[12:15], s28 offen
    buffer_load_dwordx4 v[36:39], v10, s[12:15], s29 offen
    buffer_load_dwordx4 v[40:43], v10, s[12:15], s30 offen
    buffer_load_dwordx4 v[44:47], v10, s[12:15], s31 offen
    v_add_u32 v10, s23, v10
    v_accvgpr_write_b32 a0, v176
    v_accvgpr_write_b32 a1, v177
    v_accvgpr_write_b32 a2, v178
    v_accvgpr_write_b32 a3, v179
    v_accvgpr_write_b32 a4, v180
    v_accvgpr_write_b32 a5, v181
    v_accvgpr_write_b32 a6, v182
    v_accvgpr_write_b32 a7, v183
    v_accvgpr_write_b32 a8, v184
    v_accvgpr_write_b32 a9, v185
    v_accvgpr_write_b32 a10, v186
    v_accvgpr_write_b32 a11, v187
    v_accvgpr_write_b32 a12, v188
    v_accvgpr_write_b32 a13, v189
    v_accvgpr_write_b32 a14, v190
    v_accvgpr_write_b32 a15, v191
    v_accvgpr_write_b32 a16, v192
    v_accvgpr_write_b32 a17, v193
    v_accvgpr_write_b32 a18, v194
    v_accvgpr_write_b32 a19, v195
    v_accvgpr_write_b32 a20, v196
    v_accvgpr_write_b32 a21, v197
    v_accvgpr_write_b32 a22, v198
    v_accvgpr_write_b32 a23, v199
    v_accvgpr_write_b32 a24, v200
    v_accvgpr_write_b32 a25, v201
    v_accvgpr_write_b32 a26, v202
    v_accvgpr_write_b32 a27, v203
    v_accvgpr_write_b32 a28, v204
    v_accvgpr_write_b32 a29, v205
    v_accvgpr_write_b32 a30, v206
    v_accvgpr_write_b32 a31, v207
    s_waitcnt vmcnt(24)
    v_perm_b32 v176, v52, v48, s21
    v_perm_b32 v177, v60, v56, s21
    v_perm_b32 v178, v68, v64, s21
    v_perm_b32 v179, v76, v72, s21
    v_perm_b32 v180, v52, v48, s22
    v_perm_b32 v181, v60, v56, s22
    v_perm_b32 v182, v68, v64, s22
    v_perm_b32 v183, v76, v72, s22
    v_perm_b32 v184, v53, v49, s21
    v_perm_b32 v185, v61, v57, s21
    v_perm_b32 v186, v69, v65, s21
    v_perm_b32 v187, v77, v73, s21
    v_perm_b32 v188, v53, v49, s22
    v_perm_b32 v189, v61, v57, s22
    v_perm_b32 v190, v69, v65, s22
    v_perm_b32 v191, v77, v73, s22
    v_perm_b32 v192, v54, v50, s21
    v_perm_b32 v193, v62, v58, s21
    v_perm_b32 v194, v70, v66, s21
    v_perm_b32 v195, v78, v74, s21
    v_perm_b32 v196, v54, v50, s22
    v_perm_b32 v197, v62, v58, s22
    v_perm_b32 v198, v70, v66, s22
    v_perm_b32 v199, v78, v74, s22
    v_perm_b32 v200, v55, v51, s21
    v_perm_b32 v201, v63, v59, s21
    v_perm_b32 v202, v71, v67, s21
    v_perm_b32 v203, v79, v75, s21
    v_perm_b32 v204, v55, v51, s22
    v_perm_b32 v205, v63, v59, s22
    v_perm_b32 v206, v71, v67, s22
    v_perm_b32 v207, v79, v75, s22
    buffer_load_dwordx4 v[48:51], v10, s[12:15], s24 offen
    buffer_load_dwordx4 v[52:55], v10, s[12:15], s25 offen
    buffer_load_dwordx4 v[56:59], v10, s[12:15], s26 offen
    buffer_load_dwordx4 v[60:63], v10, s[12:15], s27 offen
    buffer_load_dwordx4 v[64:67], v10, s[12:15], s28 offen
    buffer_load_dwordx4 v[68:71], v10, s[12:15], s29 offen
    buffer_load_dwordx4 v[72:75], v10, s[12:15], s30 offen
    buffer_load_dwordx4 v[76:79], v10, s[12:15], s31 offen
    v_add_u32 v10, s23, v10
    v_accvgpr_write_b32 a32, v176
    v_accvgpr_write_b32 a33, v177
    v_accvgpr_write_b32 a34, v178
    v_accvgpr_write_b32 a35, v179
    v_accvgpr_write_b32 a36, v180
    v_accvgpr_write_b32 a37, v181
    v_accvgpr_write_b32 a38, v182
    v_accvgpr_write_b32 a39, v183
    v_accvgpr_write_b32 a40, v184
    v_accvgpr_write_b32 a41, v185
    v_accvgpr_write_b32 a42, v186
    v_accvgpr_write_b32 a43, v187
    v_accvgpr_write_b32 a44, v188
    v_accvgpr_write_b32 a45, v189
    v_accvgpr_write_b32 a46, v190
    v_accvgpr_write_b32 a47, v191
    v_accvgpr_write_b32 a48, v192
    v_accvgpr_write_b32 a49, v193
    v_accvgpr_write_b32 a50, v194
    v_accvgpr_write_b32 a51, v195
    v_accvgpr_write_b32 a52, v196
    v_accvgpr_write_b32 a53, v197
    v_accvgpr_write_b32 a54, v198
    v_accvgpr_write_b32 a55, v199
    v_accvgpr_write_b32 a56, v200
    v_accvgpr_write_b32 a57, v201
    v_accvgpr_write_b32 a58, v202
    v_accvgpr_write_b32 a59, v203
    v_accvgpr_write_b32 a60, v204
    v_accvgpr_write_b32 a61, v205
    v_accvgpr_write_b32 a62, v206
    v_accvgpr_write_b32 a63, v207
    s_waitcnt vmcnt(24)
    v_perm_b32 v176, v84, v80, s21
    v_perm_b32 v177, v92, v88, s21
    v_perm_b32 v178, v100, v96, s21
    v_perm_b32 v179, v108, v104, s21
    v_perm_b32 v180, v84, v80, s22
    v_perm_b32 v181, v92, v88, s22
    v_perm_b32 v182, v100, v96, s22
    v_perm_b32 v183, v108, v104, s22
    v_perm_b32 v184, v85, v81, s21
    v_perm_b32 v185, v93, v89, s21
    v_perm_b32 v186, v101, v97, s21
    v_perm_b32 v187, v109, v105, s21
    v_perm_b32 v188, v85, v81, s22
    v_perm_b32 v189, v93, v89, s22
    v_perm_b32 v190, v101, v97, s22
    v_perm_b32 v191, v109, v105, s22
    v_perm_b32 v192, v86, v82, s21
    v_perm_b32 v193, v94, v90, s21
    v_perm_b32 v194, v102, v98, s21
    v_perm_b32 v195, v110, v106, s21
    v_perm_b32 v196, v86, v82, s22
    v_perm_b32 v197, v94, v90, s22
    v_perm_b32 v198, v102, v98, s22
    v_perm_b32 v199, v110, v106, s22
    v_perm_b32 v200, v87, v83, s21
    v_perm_b32 v201, v95, v91, s21
    v_perm_b32 v202, v103, v99, s21
    v_perm_b32 v203, v111, v107, s21
    v_perm_b32 v204, v87, v83, s22
    v_perm_b32 v205, v95, v91, s22
    v_perm_b32 v206, v103, v99, s22
    v_perm_b32 v207, v111, v107, s22
    buffer_load_dwordx4 v[80:83], v10, s[12:15], s24 offen
    buffer_load_dwordx4 v[84:87], v10, s[12:15], s25 offen
    buffer_load_dwordx4 v[88:91], v10, s[12:15], s26 offen
    buffer_load_dwordx4 v[92:95], v10, s[12:15], s27 offen
    buffer_load_dwordx4 v[96:99], v10, s[12:15], s28 offen
    buffer_load_dwordx4 v[100:103], v10, s[12:15], s29 offen
    buffer_load_dwordx4 v[104:107], v10, s[12:15], s30 offen
    buffer_load_dwordx4 v[108:111], v10, s[12:15], s31 offen
    v_add_u32 v10, s23, v10
    v_accvgpr_write_b32 a64, v176
    v_accvgpr_write_b32 a65, v177
    v_accvgpr_write_b32 a66, v178
    v_accvgpr_write_b32 a67, v179
    v_accvgpr_write_b32 a68, v180
    v_accvgpr_write_b32 a69, v181
    v_accvgpr_write_b32 a70, v182
    v_accvgpr_write_b32 a71, v183
    v_accvgpr_write_b32 a72, v184
    v_accvgpr_write_b32 a73, v185
    v_accvgpr_write_b32 a74, v186
    v_accvgpr_write_b32 a75, v187
    v_accvgpr_write_b32 a76, v188
    v_accvgpr_write_b32 a77, v189
    v_accvgpr_write_b32 a78, v190
    v_accvgpr_write_b32 a79, v191
    v_accvgpr_write_b32 a80, v192
    v_accvgpr_write_b32 a81, v193
    v_accvgpr_write_b32 a82, v194
    v_accvgpr_write_b32 a83, v195
    v_accvgpr_write_b32 a84, v196
    v_accvgpr_write_b32 a85, v197
    v_accvgpr_write_b32 a86, v198
    v_accvgpr_write_b32 a87, v199
    v_accvgpr_write_b32 a88, v200
    v_accvgpr_write_b32 a89, v201
    v_accvgpr_write_b32 a90, v202
    v_accvgpr_write_b32 a91, v203
    v_accvgpr_write_b32 a92, v204
    v_accvgpr_write_b32 a93, v205
    v_accvgpr_write_b32 a94, v206
    v_accvgpr_write_b32 a95, v207
    s_waitcnt vmcnt(24)
    v_perm_b32 v176, v116, v112, s21
    v_perm_b32 v177, v124, v120, s21
    v_perm_b32 v178, v132, v128, s21
    v_perm_b32 v179, v140, v136, s21
    v_perm_b32 v180, v116, v112, s22
    v_perm_b32 v181, v124, v120, s22
    v_perm_b32 v182, v132, v128, s22
    v_perm_b32 v183, v140, v136, s22
    v_perm_b32 v184, v117, v113, s21
    v_perm_b32 v185, v125, v121, s21
    v_perm_b32 v186, v133, v129, s21
    v_perm_b32 v187, v141, v137, s21
    v_perm_b32 v188, v117, v113, s22
    v_perm_b32 v189, v125, v121, s22
    v_perm_b32 v190, v133, v129, s22
    v_perm_b32 v191, v141, v137, s22
    v_perm_b32 v192, v118, v114, s21
    v_perm_b32 v193, v126, v122, s21
    v_perm_b32 v194, v134, v130, s21
    v_perm_b32 v195, v142, v138, s21
    v_perm_b32 v196, v118, v114, s22
    v_perm_b32 v197, v126, v122, s22
    v_perm_b32 v198, v134, v130, s22
    v_perm_b32 v199, v142, v138, s22
    v_perm_b32 v200, v119, v115, s21
    v_perm_b32 v201, v127, v123, s21
    v_perm_b32 v202, v135, v131, s21
    v_perm_b32 v203, v143, v139, s21
    v_perm_b32 v204, v119, v115, s22
    v_perm_b32 v205, v127, v123, s22
    v_perm_b32 v206, v135, v131, s22
    v_perm_b32 v207, v143, v139, s22
    buffer_load_dwordx4 v[112:115], v10, s[12:15], s24 offen
    buffer_load_dwordx4 v[116:119], v10, s[12:15], s25 offen
    buffer_load_dwordx4 v[120:123], v10, s[12:15], s26 offen
    buffer_load_dwordx4 v[124:127], v10, s[12:15], s27 offen
    buffer_load_dwordx4 v[128:131], v10, s[12:15], s28 offen
    buffer_load_dwordx4 v[132:135], v10, s[12:15], s29 offen
    buffer_load_dwordx4 v[136:139], v10, s[12:15], s30 offen
    buffer_load_dwordx4 v[140:143], v10, s[12:15], s31 offen
    v_add_u32 v10, s23, v10
    v_accvgpr_write_b32 a96, v176
    v_accvgpr_write_b32 a97, v177
    v_accvgpr_write_b32 a98, v178
    v_accvgpr_write_b32 a99, v179
    v_accvgpr_write_b32 a100, v180
    v_accvgpr_write_b32 a101, v181
    v_accvgpr_write_b32 a102, v182
    v_accvgpr_write_b32 a103, v183
    v_accvgpr_write_b32 a104, v184
    v_accvgpr_write_b32 a105, v185
    v_accvgpr_write_b32 a106, v186
    v_accvgpr_write_b32 a107, v187
    v_accvgpr_write_b32 a108, v188
    v_accvgpr_write_b32 a109, v189
    v_accvgpr_write_b32 a110, v190
    v_accvgpr_write_b32 a111, v191
    v_accvgpr_write_b32 a112, v192
    v_accvgpr_write_b32 a113, v193
    v_accvgpr_write_b32 a114, v194
    v_accvgpr_write_b32 a115, v195
    v_accvgpr_write_b32 a116, v196
    v_accvgpr_write_b32 a117, v197
    v_accvgpr_write_b32 a118, v198
    v_accvgpr_write_b32 a119, v199
    v_accvgpr_write_b32 a120, v200
    v_accvgpr_write_b32 a121, v201
    v_accvgpr_write_b32 a122, v202
    v_accvgpr_write_b32 a123, v203
    v_accvgpr_write_b32 a124, v204
    v_accvgpr_write_b32 a125, v205
    v_accvgpr_write_b32 a126, v206
    v_accvgpr_write_b32 a127, v207
    s_waitcnt vmcnt(24)
    v_perm_b32 v176, v20, v16, s21
    v_perm_b32 v177, v28, v24, s21
    v_perm_b32 v178, v36, v32, s21
    v_perm_b32 v179, v44, v40, s21
    v_perm_b32 v180, v20, v16, s22
    v_perm_b32 v181, v28, v24, s22
    v_perm_b32 v182, v36, v32, s22
    v_perm_b32 v183, v44, v40, s22
    v_perm_b32 v184, v21, v17, s21
    v_perm_b32 v185, v29, v25, s21
    v_perm_b32 v186, v37, v33, s21
    v_perm_b32 v187, v45, v41, s21
    v_perm_b32 v188, v21, v17, s22
    v_perm_b32 v189, v29, v25, s22
    v_perm_b32 v190, v37, v33, s22
    v_perm_b32 v191, v45, v41, s22
    v_perm_b32 v192, v22, v18, s21
    v_perm_b32 v193, v30, v26, s21
    v_perm_b32 v194, v38, v34, s21
    v_perm_b32 v195, v46, v42, s21
    v_perm_b32 v196, v22, v18, s22
    v_perm_b32 v197, v30, v26, s22
    v_perm_b32 v198, v38, v34, s22
    v_perm_b32 v199, v46, v42, s22
    v_perm_b32 v200, v23, v19, s21
    v_perm_b32 v201, v31, v27, s21
    v_perm_b32 v202, v39, v35, s21
    v_perm_b32 v203, v47, v43, s21
    v_perm_b32 v204, v23, v19, s22
    v_perm_b32 v205, v31, v27, s22
    v_perm_b32 v206, v39, v35, s22
    v_perm_b32 v207, v47, v43, s22
    v_accvgpr_write_b32 a128, v176
    v_accvgpr_write_b32 a129, v177
    v_accvgpr_write_b32 a130, v178
    v_accvgpr_write_b32 a131, v179
    v_accvgpr_write_b32 a132, v180
    v_accvgpr_write_b32 a133, v181
    v_accvgpr_write_b32 a134, v182
    v_accvgpr_write_b32 a135, v183
    v_accvgpr_write_b32 a136, v184
    v_accvgpr_write_b32 a137, v185
    v_accvgpr_write_b32 a138, v186
    v_accvgpr_write_b32 a139, v187
    v_accvgpr_write_b32 a140, v188
    v_accvgpr_write_b32 a141, v189
    v_accvgpr_write_b32 a142, v190
    v_accvgpr_write_b32 a143, v191
    v_accvgpr_write_b32 a144, v192
    v_accvgpr_write_b32 a145, v193
    v_accvgpr_write_b32 a146, v194
    v_accvgpr_write_b32 a147, v195
    v_accvgpr_write_b32 a148, v196
    v_accvgpr_write_b32 a149, v197
    v_accvgpr_write_b32 a150, v198
    v_accvgpr_write_b32 a151, v199
    v_accvgpr_write_b32 a152, v200
    v_accvgpr_write_b32 a153, v201
    v_accvgpr_write_b32 a154, v202
    v_accvgpr_write_b32 a155, v203
    v_accvgpr_write_b32 a156, v204
    v_accvgpr_write_b32 a157, v205
    v_accvgpr_write_b32 a158, v206
    v_accvgpr_write_b32 a159, v207
    s_waitcnt vmcnt(16)
    v_perm_b32 v176, v52, v48, s21
    v_perm_b32 v177, v60, v56, s21
    v_perm_b32 v178, v68, v64, s21
    v_perm_b32 v179, v76, v72, s21
    v_perm_b32 v180, v52, v48, s22
    v_perm_b32 v181, v60, v56, s22
    v_perm_b32 v182, v68, v64, s22
    v_perm_b32 v183, v76, v72, s22
    v_perm_b32 v184, v53, v49, s21
    v_perm_b32 v185, v61, v57, s21
    v_perm_b32 v186, v69, v65, s21
    v_perm_b32 v187, v77, v73, s21
    v_perm_b32 v188, v53, v49, s22
    v_perm_b32 v189, v61, v57, s22
    v_perm_b32 v190, v69, v65, s22
    v_perm_b32 v191, v77, v73, s22
    v_perm_b32 v192, v54, v50, s21
    v_perm_b32 v193, v62, v58, s21
    v_perm_b32 v194, v70, v66, s21
    v_perm_b32 v195, v78, v74, s21
    v_perm_b32 v196, v54, v50, s22
    v_perm_b32 v197, v62, v58, s22
    v_perm_b32 v198, v70, v66, s22
    v_perm_b32 v199, v78, v74, s22
    v_perm_b32 v200, v55, v51, s21
    v_perm_b32 v201, v63, v59, s21
    v_perm_b32 v202, v71, v67, s21
    v_perm_b32 v203, v79, v75, s21
    v_perm_b32 v204, v55, v51, s22
    v_perm_b32 v205, v63, v59, s22
    v_perm_b32 v206, v71, v67, s22
    v_perm_b32 v207, v79, v75, s22
    v_accvgpr_write_b32 a160, v176
    v_accvgpr_write_b32 a161, v177
    v_accvgpr_write_b32 a162, v178
    v_accvgpr_write_b32 a163, v179
    v_accvgpr_write_b32 a164, v180
    v_accvgpr_write_b32 a165, v181
    v_accvgpr_write_b32 a166, v182
    v_accvgpr_write_b32 a167, v183
    v_accvgpr_write_b32 a168, v184
    v_accvgpr_write_b32 a169, v185
    v_accvgpr_write_b32 a170, v186
    v_accvgpr_write_b32 a171, v187
    v_accvgpr_write_b32 a172, v188
    v_accvgpr_write_b32 a173, v189
    v_accvgpr_write_b32 a174, v190
    v_accvgpr_write_b32 a175, v191
    v_accvgpr_write_b32 a176, v192
    v_accvgpr_write_b32 a177, v193
    v_accvgpr_write_b32 a178, v194
    v_accvgpr_write_b32 a179, v195
    v_accvgpr_write_b32 a180, v196
    v_accvgpr_write_b32 a181, v197
    v_accvgpr_write_b32 a182, v198
    v_accvgpr_write_b32 a183, v199
    v_accvgpr_write_b32 a184, v200
    v_accvgpr_write_b32 a185, v201
    v_accvgpr_write_b32 a186, v202
    v_accvgpr_write_b32 a187, v203
    v_accvgpr_write_b32 a188, v204
    v_accvgpr_write_b32 a189, v205
    v_accvgpr_write_b32 a190, v206
    v_accvgpr_write_b32 a191, v207
    s_waitcnt vmcnt(8)
    v_perm_b32 v176, v84, v80, s21
    v_perm_b32 v177, v92, v88, s21
    v_perm_b32 v178, v100, v96, s21
    v_perm_b32 v179, v108, v104, s21
    v_perm_b32 v180, v84, v80, s22
    v_perm_b32 v181, v92, v88, s22
    v_perm_b32 v182, v100, v96, s22
    v_perm_b32 v183, v108, v104, s22
    v_perm_b32 v184, v85, v81, s21
    v_perm_b32 v185, v93, v89, s21
    v_perm_b32 v186, v101, v97, s21
    v_perm_b32 v187, v109, v105, s21
    v_perm_b32 v188, v85, v81, s22
    v_perm_b32 v189, v93, v89, s22
    v_perm_b32 v190, v101, v97, s22
    v_perm_b32 v191, v109, v105, s22
    v_perm_b32 v192, v86, v82, s21
    v_perm_b32 v193, v94, v90, s21
    v_perm_b32 v194, v102, v98, s21
    v_perm_b32 v195, v110, v106, s21
    v_perm_b32 v196, v86, v82, s22
    v_perm_b32 v197, v94, v90, s22
    v_perm_b32 v198, v102, v98, s22
    v_perm_b32 v199, v110, v106, s22
    v_perm_b32 v200, v87, v83, s21
    v_perm_b32 v201, v95, v91, s21
    v_perm_b32 v202, v103, v99, s21
    v_perm_b32 v203, v111, v107, s21
    v_perm_b32 v204, v87, v83, s22
    v_perm_b32 v205, v95, v91, s22
    v_perm_b32 v206, v103, v99, s22
    v_perm_b32 v207, v111, v107, s22
    v_accvgpr_write_b32 a192, v176
    v_accvgpr_write_b32 a193, v177
    v_accvgpr_write_b32 a194, v178
    v_accvgpr_write_b32 a195, v179
    v_accvgpr_write_b32 a196, v180
    v_accvgpr_write_b32 a197, v181
    v_accvgpr_write_b32 a198, v182
    v_accvgpr_write_b32 a199, v183
    v_accvgpr_write_b32 a200, v184
    v_accvgpr_write_b32 a201, v185
    v_accvgpr_write_b32 a202, v186
    v_accvgpr_write_b32 a203, v187
    v_accvgpr_write_b32 a204, v188
    v_accvgpr_write_b32 a205, v189
    v_accvgpr_write_b32 a206, v190
    v_accvgpr_write_b32 a207, v191
    v_accvgpr_write_b32 a208, v192
    v_accvgpr_write_b32 a209, v193
    v_accvgpr_write_b32 a210, v194
    v_accvgpr_write_b32 a211, v195
    v_accvgpr_write_b32 a212, v196
    v_accvgpr_write_b32 a213, v197
    v_accvgpr_write_b32 a214, v198
    v_accvgpr_write_b32 a215, v199
    v_accvgpr_write_b32 a216, v200
    v_accvgpr_write_b32 a217, v201
    v_accvgpr_write_b32 a218, v202
    v_accvgpr_write_b32 a219, v203
    v_accvgpr_write_b32 a220, v204
    v_accvgpr_write_b32 a221, v205
    v_accvgpr_write_b32 a222, v206
    v_accvgpr_write_b32 a223, v207
    s_waitcnt vmcnt(0)
    v_perm_b32 v176, v116, v112, s21
    v_perm_b32 v177, v124, v120, s21
    v_perm_b32 v178, v132, v128, s21
    v_perm_b32 v179, v140, v136, s21
    v_perm_b32 v180, v116, v112, s22
    v_perm_b32 v181, v124, v120, s22
    v_perm_b32 v182, v132, v128, s22
    v_perm_b32 v183, v140, v136, s22
    v_perm_b32 v184, v117, v113, s21
    v_perm_b32 v185, v125, v121, s21
    v_perm_b32 v186, v133, v129, s21
    v_perm_b32 v187, v141, v137, s21
    v_perm_b32 v188, v117, v113, s22
    v_perm_b32 v189, v125, v121, s22
    v_perm_b32 v190, v133, v129, s22
    v_perm_b32 v191, v141, v137, s22
    v_perm_b32 v192, v118, v114, s21
    v_perm_b32 v193, v126, v122, s21
    v_perm_b32 v194, v134, v130, s21
    v_perm_b32 v195, v142, v138, s21
    v_perm_b32 v196, v118, v114, s22
    v_perm_b32 v197, v126, v122, s22
    v_perm_b32 v198, v134, v130, s22
    v_perm_b32 v199, v142, v138, s22
    v_perm_b32 v200, v119, v115, s21
    v_perm_b32 v201, v127, v123, s21
    v_perm_b32 v202, v135, v131, s21
    v_perm_b32 v203, v143, v139, s21
    v_perm_b32 v204, v119, v115, s22
    v_perm_b32 v205, v127, v123, s22
    v_perm_b32 v206, v135, v131, s22
    v_perm_b32 v207, v143, v139, s22
    v_accvgpr_write_b32 a224, v176
    v_accvgpr_write_b32 a225, v177
    v_accvgpr_write_b32 a226, v178
    v_accvgpr_write_b32 a227, v179
    v_accvgpr_write_b32 a228, v180
    v_accvgpr_write_b32 a229, v181
    v_accvgpr_write_b32 a230, v182
    v_accvgpr_write_b32 a231, v183
    v_accvgpr_write_b32 a232, v184
    v_accvgpr_write_b32 a233, v185
    v_accvgpr_write_b32 a234, v186
    v_accvgpr_write_b32 a235, v187
    v_accvgpr_write_b32 a236, v188
    v_accvgpr_write_b32 a237, v189
    v_accvgpr_write_b32 a238, v190
    v_accvgpr_write_b32 a239, v191
    v_accvgpr_write_b32 a240, v192
    v_accvgpr_write_b32 a241, v193
    v_accvgpr_write_b32 a242, v194
    v_accvgpr_write_b32 a243, v195
    v_accvgpr_write_b32 a244, v196
    v_accvgpr_write_b32 a245, v197
    v_accvgpr_write_b32 a246, v198
    v_accvgpr_write_b32 a247, v199
    v_accvgpr_write_b32 a248, v200
    v_accvgpr_write_b32 a249, v201
    v_accvgpr_write_b32 a250, v202
    v_accvgpr_write_b32 a251, v203
    v_accvgpr_write_b32 a252, v204
    v_accvgpr_write_b32 a253, v205
    v_accvgpr_write_b32 a254, v206
    v_accvgpr_write_b32 a255, v207
    s_nop 3
Ltl_71:
    s_mov_b32 s32, s63
    s_mov_b32 s33, s62
    s_and_b32 s36, s4, 1
    v_lshlrev_b32 v5, 10, v2
    v_lshl_add_u32 v5, v3, 4, v5
    v_add_u32 v6, 16384, v5
    s_lshl_b32 s39, s32, 15
    s_lshl_b32 s38, s36, 9
    s_add_u32 s39, s39, s38
    s_add_u32 s39, s39, 0x600000
    s_add_u32 s35, s32, 192
    s_lshl_b32 s35, s35, 6
Lw_72:
    buffer_load_dword v7, off, s[8:11], s35 sc1
    s_add_u32 s61, s61, 1
    s_cmp_gt_u32 s61, 0x40000
    s_cbranch_scc1 Lwd_73
    s_waitcnt vmcnt(0)
    v_readfirstlane_b32 s60, v7
    s_nop 3
    s_cmp_ge_u32 s60, 8
    s_cbranch_scc1 Lwd_73
    s_sleep 2
    s_branch Lw_72
Lwd_73:
    buffer_load_dwordx4 v[16:19], v5, s[8:11], s39 offen offset:0 sc1
    buffer_load_dwordx4 v[20:23], v6, s[8:11], s39 offen offset:0 sc1
    buffer_load_dwordx4 v[24:27], v5, s[8:11], s39 offen offset:64 sc1
    buffer_load_dwordx4 v[28:31], v6, s[8:11], s39 offen offset:64 sc1
    buffer_load_dwordx4 v[32:35], v5, s[8:11], s39 offen offset:128 sc1
    buffer_load_dwordx4 v[36:39], v6, s[8:11], s39 offen offset:128 sc1
    buffer_load_dwordx4 v[40:43], v5, s[8:11], s39 offen offset:192 sc1
    buffer_load_dwordx4 v[44:47], v6, s[8:11], s39 offen offset:192 sc1
    buffer_load_dwordx4 v[48:51], v5, s[8:11], s39 offen offset:256 sc1
    buffer_load_dwordx4 v[52:55], v6, s[8:11], s39 offen offset:256 sc1
    buffer_load_dwordx4 v[56:59], v5, s[8:11], s39 offen offset:320 sc1
    buffer_load_dwordx4 v[60:63], v6, s[8:11], s39 offen offset:320 sc1
    buffer_load_dwordx4 v[64:67], v5, s[8:11], s39 offen offset:384 sc1
    buffer_load_dwordx4 v[68:71], v6, s[8:11], s39 offen offset:384 sc1
    buffer_load_dwordx4 v[72:75], v5, s[8:11], s39 offen offset:448 sc1
    buffer_load_dwordx4 v[76:79], v6, s[8:11], s39 offen offset:448 sc1
    s_waitcnt vmcnt(14)
    v_mfma_f32_16x16x32_bf16 v[96:99], v[16:19], a[0:3], 0
    v_mfma_f32_16x16x32_bf16 v[128:131], v[20:23], a[0:3], 0
    v_mfma_f32_16x16x32_bf16 v[100:103], v[16:19], a[4:7], 0
    v_mfma_f32_16x16x32_bf16 v[132:135], v[20:23], a[4:7], 0
    v_mfma_f32_16x16x32_bf16 v[104:107], v[16:19], a[8:11], 0
    v_mfma_f32_16x16x32_bf16 v[136:139], v[20:23], a[8:11], 0
    v_mfma_f32_16x16x32_bf16 v[108:111], v[16:19], a[12:15], 0
    v_mfma_f32_16x16x32_bf16 v[140:143], v[20:23], a[12:15], 0
    v_mfma_f32_16x16x32_bf16 v[112:115], v[16:19], a[16:19], 0
    v_mfma_f32_16x16x32_bf16 v[144:147], v[20:23], a[16:19], 0
    v_mfma_f32_16x16x32_bf16 v[116:119], v[16:19], a[20:23], 0
    v_mfma_f32_16x16x32_bf16 v[148:151], v[20:23], a[20:23], 0
    v_mfma_f32_16x16x32_bf16 v[120:123], v[16:19], a[24:27], 0
    v_mfma_f32_16x16x32_bf16 v[152:155], v[20:23], a[24:27], 0
    v_mfma_f32_16x16x32_bf16 v[124:127], v[16:19], a[28:31], 0
    v_mfma_f32_16x16x32_bf16 v[156:159], v[20:23], a[28:31], 0
    s_waitcnt vmcnt(12)
    v_mfma_f32_16x16x32_bf16 v[96:99], v[24:27], a[32:35], v[96:99]
    v_mfma_f32_16x16x32_bf16 v[128:131], v[28:31], a[32:35], v[128:131]
    v_mfma_f32_16x16x32_bf16 v[100:103], v[24:27], a[36:39], v[100:103]
    v_mfma_f32_16x16x32_bf16 v[132:135], v[28:31], a[36:39], v[132:135]
    v_mfma_f32_16x16x32_bf16 v[104:107], v[24:27], a[40:43], v[104:107]
    v_mfma_f32_16x16x32_bf16 v[136:139], v[28:31], a[40:43], v[136:139]
    v_mfma_f32_16x16x32_bf16 v[108:111], v[24:27], a[44:47], v[108:111]
    v_mfma_f32_16x16x32_bf16 v[140:143], v[28:31], a[44:47], v[140:143]
    v_mfma_f32_16x16x32_bf16 v[112:115], v[24:27], a[48:51], v[112:115]
    v_mfma_f32_16x16x32_bf16 v[144:147], v[28:31], a[48:51], v[144:147]
    v_mfma_f32_16x16x32_bf16 v[116:119], v[24:27], a[52:55], v[116:119]
    v_mfma_f32_16x16x32_bf16 v[148:151], v[28:31], a[52:55], v[148:151]
    v_mfma_f32_16x16x32_bf16 v[120:123], v[24:27], a[56:59], v[120:123]
    v_mfma_f32_16x16x32_bf16 v[152:155], v[28:31], a[56:59], v[152:155]
    v_mfma_f32_16x16x32_bf16 v[124:127], v[24:27], a[60:63], v[124:127]
    v_mfma_f32_16x16x32_bf16 v[156:159], v[28:31], a[60:63], v[156:159]
    s_waitcnt vmcnt(10)
    v_mfma_f32_16x16x32_bf16 v[96:99], v[32:35], a[64:67], v[96:99]
    v_mfma_f32_16x16x32_bf16 v[128:131], v[36:39], a[64:67], v[128:131]
    v_mfma_f32_16x16x32_bf16 v[100:103], v[32:35], a[68:71], v[100:103]
    v_mfma_f32_16x16x32_bf16 v[132:135], v[36:39], a[68:71], v[132:135]
    v_mfma_f32_16x16x32_bf16 v[104:107], v[32:35], a[72:75], v[104:107]
    v_mfma_f32_16x16x32_bf16 v[136:139], v[36:39], a[72:75], v[136:139]
    v_mfma_f32_16x16x32_bf16 v[108:111], v[32:35], a[76:79], v[108:111]
    v_mfma_f32_16x16x32_bf16 v[140:143], v[36:39], a[76:79], v[140:143]
    v_mfma_f32_16x16x32_bf16 v[112:115], v[32:35], a[80:83], v[112:115]
    v_mfma_f32_16x16x32_bf16 v[144:147], v[36:39], a[80:83], v[144:147]
    v_mfma_f32_16x16x32_bf16 v[116:119], v[32:35], a[84:87], v[116:119]
    v_mfma_f32_16x16x32_bf16 v[148:151], v[36:39], a[84:87], v[148:151]
    v_mfma_f32_16x16x32_bf16 v[120:123], v[32:35], a[88:91], v[120:123]
    v_mfma_f32_16x16x32_bf16 v[152:155], v[36:39], a[88:91], v[152:155]
    v_mfma_f32_16x16x32_bf16 v[124:127], v[32:35], a[92:95], v[124:127]
    v_mfma_f32_16x16x32_bf16 v[156:159], v[36:39], a[92:95], v[156:159]
    s_waitcnt vmcnt(8)
    v_mfma_f32_16x16x32_bf16 v[96:99], v[40:43], a[96:99], v[96:99]
    v_mfma_f32_16x16x32_bf16 v[128:131], v[44:47], a[96:99], v[128:131]
    v_mfma_f32_16x16x32_bf16 v[100:103], v[40:43], a[100:103], v[100:103]
    v_mfma_f32_16x16x32_bf16 v[132:135], v[44:47], a[100:103], v[132:135]
    v_mfma_f32_16x16x32_bf16 v[104:107], v[40:43], a[104:107], v[104:107]
    v_mfma_f32_16x16x32_bf16 v[136:139], v[44:47], a[104:107], v[136:139]
    v_mfma_f32_16x16x32_bf16 v[108:111], v[40:43], a[108:111], v[108:111]
    v_mfma_f32_16x16x32_bf16 v[140:143], v[44:47], a[108:111], v[140:143]
    v_mfma_f32_16x16x32_bf16 v[112:115], v[40:43], a[112:115], v[112:115]
    v_mfma_f32_16x16x32_bf16 v[144:147], v[44:47], a[112:115], v[144:147]
    v_mfma_f32_16x16x32_bf16 v[116:119], v[40:43], a[116:119], v[116:119]
    v_mfma_f32_16x16x32_bf16 v[148:151], v[44:47], a[116:119], v[148:151]
    v_mfma_f32_16x16x32_bf16 v[120:123], v[40:43], a[120:123], v[120:123]
    v_mfma_f32_16x16x32_bf16 v[152:155], v[44:47], a[120:123], v[152:155]
    v_mfma_f32_16x16x32_bf16 v[124:127], v[40:43], a[124:127], v[124:127]
    v_mfma_f32_16x16x32_bf16 v[156:159], v[44:47], a[124:127], v[156:159]
    s_waitcnt vmcnt(6)
    v_mfma_f32_16x16x32_bf16 v[96:99], v[48:51], a[128:131], v[96:99]
    v_mfma_f32_16x16x32_bf16 v[128:131], v[52:55], a[128:131], v[128:131]
    v_mfma_f32_16x16x32_bf16 v[100:103], v[48:51], a[132:135], v[100:103]
    v_mfma_f32_16x16x32_bf16 v[132:135], v[52:55], a[132:135], v[132:135]
    v_mfma_f32_16x16x32_bf16 v[104:107], v[48:51], a[136:139], v[104:107]
    v_mfma_f32_16x16x32_bf16 v[136:139], v[52:55], a[136:139], v[136:139]
    v_mfma_f32_16x16x32_bf16 v[108:111], v[48:51], a[140:143], v[108:111]
    v_mfma_f32_16x16x32_bf16 v[140:143], v[52:55], a[140:143], v[140:143]
    v_mfma_f32_16x16x32_bf16 v[112:115], v[48:51], a[144:147], v[112:115]
    v_mfma_f32_16x16x32_bf16 v[144:147], v[52:55], a[144:147], v[144:147]
    v_mfma_f32_16x16x32_bf16 v[116:119], v[48:51], a[148:151], v[116:119]
    v_mfma_f32_16x16x32_bf16 v[148:151], v[52:55], a[148:151], v[148:151]
    v_mfma_f32_16x16x32_bf16 v[120:123], v[48:51], a[152:155], v[120:123]
    v_mfma_f32_16x16x32_bf16 v[152:155], v[52:55], a[152:155], v[152:155]
    v_mfma_f32_16x16x32_bf16 v[124:127], v[48:51], a[156:159], v[124:127]
    v_mfma_f32_16x16x32_bf16 v[156:159], v[52:55], a[156:159], v[156:159]
    s_waitcnt vmcnt(4)
    v_mfma_f32_16x16x32_bf16 v[96:99], v[56:59], a[160:163], v[96:99]
    v_mfma_f32_16x16x32_bf16 v[128:131], v[60:63], a[160:163], v[128:131]
    v_mfma_f32_16x16x32_bf16 v[100:103], v[56:59], a[164:167], v[100:103]
    v_mfma_f32_16x16x32_bf16 v[132:135], v[60:63], a[164:167], v[132:135]
    v_mfma_f32_16x16x32_bf16 v[104:107], v[56:59], a[168:171], v[104:107]
    v_mfma_f32_16x16x32_bf16 v[136:139], v[60:63], a[168:171], v[136:139]
    v_mfma_f32_16x16x32_bf16 v[108:111], v[56:59], a[172:175], v[108:111]
    v_mfma_f32_16x16x32_bf16 v[140:143], v[60:63], a[172:175], v[140:143]
    v_mfma_f32_16x16x32_bf16 v[112:115], v[56:59], a[176:179], v[112:115]
    v_mfma_f32_16x16x32_bf16 v[144:147], v[60:63], a[176:179], v[144:147]
    v_mfma_f32_16x16x32_bf16 v[116:119], v[56:59], a[180:183], v[116:119]
    v_mfma_f32_16x16x32_bf16 v[148:151], v[60:63], a[180:183], v[148:151]
    v_mfma_f32_16x16x32_bf16 v[120:123], v[56:59], a[184:187], v[120:123]
    v_mfma_f32_16x16x32_bf16 v[152:155], v[60:63], a[184:187], v[152:155]
    v_mfma_f32_16x16x32_bf16 v[124:127], v[56:59], a[188:191], v[124:127]
    v_mfma_f32_16x16x32_bf16 v[156:159], v[60:63], a[188:191], v[156:159]
    s_waitcnt vmcnt(2)
    v_mfma_f32_16x16x32_bf16 v[96:99], v[64:67], a[192:195], v[96:99]
    v_mfma_f32_16x16x32_bf16 v[128:131], v[68:71], a[192:195], v[128:131]
    v_mfma_f32_16x16x32_bf16 v[100:103], v[64:67], a[196:199], v[100:103]
    v_mfma_f32_16x16x32_bf16 v[132:135], v[68:71], a[196:199], v[132:135]
    v_mfma_f32_16x16x32_bf16 v[104:107], v[64:67], a[200:203], v[104:107]
    v_mfma_f32_16x16x32_bf16 v[136:139], v[68:71], a[200:203], v[136:139]
    v_mfma_f32_16x16x32_bf16 v[108:111], v[64:67], a[204:207], v[108:111]
    v_mfma_f32_16x16x32_bf16 v[140:143], v[68:71], a[204:207], v[140:143]
    v_mfma_f32_16x16x32_bf16 v[112:115], v[64:67], a[208:211], v[112:115]
    v_mfma_f32_16x16x32_bf16 v[144:147], v[68:71], a[208:211], v[144:147]
    v_mfma_f32_16x16x32_bf16 v[116:119], v[64:67], a[212:215], v[116:119]
    v_mfma_f32_16x16x32_bf16 v[148:151], v[68:71], a[212:215], v[148:151]
    v_mfma_f32_16x16x32_bf16 v[120:123], v[64:67], a[216:219], v[120:123]
    v_mfma_f32_16x16x32_bf16 v[152:155], v[68:71], a[216:219], v[152:155]
    v_mfma_f32_16x16x32_bf16 v[124:127], v[64:67], a[220:223], v[124:127]
    v_mfma_f32_16x16x32_bf16 v[156:159], v[68:71], a[220:223], v[156:159]
    s_waitcnt vmcnt(0)
    v_mfma_f32_16x16x32_bf16 v[96:99], v[72:75], a[224:227], v[96:99]
    v_mfma_f32_16x16x32_bf16 v[128:131], v[76:79], a[224:227], v[128:131]
    v_mfma_f32_16x16x32_bf16 v[100:103], v[72:75], a[228:231], v[100:103]
    v_mfma_f32_16x16x32_bf16 v[132:135], v[76:79], a[228:231], v[132:135]
    v_mfma_f32_16x16x32_bf16 v[104:107], v[72:75], a[232:235], v[104:107]
    v_mfma_f32_16x16x32_bf16 v[136:139], v[76:79], a[232:235], v[136:139]
    v_mfma_f32_16x16x32_bf16 v[108:111], v[72:75], a[236:239], v[108:111]
    v_mfma_f32_16x16x32_bf16 v[140:143], v[76:79], a[236:239], v[140:143]
    v_mfma_f32_16x16x32_bf16 v[112:115], v[72:75], a[240:243], v[112:115]
    v_mfma_f32_16x16x32_bf16 v[144:147], v[76:79], a[240:243], v[144:147]
    v_mfma_f32_16x16x32_bf16 v[116:119], v[72:75], a[244:247], v[116:119]
    v_mfma_f32_16x16x32_bf16 v[148:151], v[76:79], a[244:247], v[148:151]
    v_mfma_f32_16x16x32_bf16 v[120:123], v[72:75], a[248:251], v[120:123]
    v_mfma_f32_16x16x32_bf16 v[152:155], v[76:79], a[248:251], v[152:155]
    v_mfma_f32_16x16x32_bf16 v[124:127], v[72:75], a[252:255], v[124:127]
    v_mfma_f32_16x16x32_bf16 v[156:159], v[76:79], a[252:255], v[156:159]
    s_nop 7
    s_nop 7
    s_lshl_b32 s49, s4, 14
    v_lshlrev_b32 v8, 4, v1
    v_add_u32 v9, s49, v8
    v_mov_b32 v16, v96
    v_mov_b32 v17, v100
    v_mov_b32 v18, v104
    v_mov_b32 v19, v108
    v_mov_b32 v20, v112
    v_mov_b32 v21, v116
    v_mov_b32 v22, v120
    v_mov_b32 v23, v124
    ds_write_b128 v9, v[16:19] offset:0
    ds_write_b128 v9, v[20:23] offset:1024
    v_mov_b32 v24, v97
    v_mov_b32 v25, v101
    v_mov_b32 v26, v105
    v_mov_b32 v27, v109
    v_mov_b32 v28, v113
    v_mov_b32 v29, v117
    v_mov_b32 v30, v121
    v_mov_b32 v31, v125
    ds_write_b128 v9, v[24:27] offset:2048
    ds_write_b128 v9, v[28:31] offset:3072
    v_mov_b32 v32, v98
    v_mov_b32 v33, v102
    v_mov_b32 v34, v106
    v_mov_b32 v35, v110
    v_mov_b32 v36, v114
    v_mov_b32 v37, v118
    v_mov_b32 v38, v122
    v_mov_b32 v39, v126
    ds_write_b128 v9, v[32:35] offset:4096
    ds_write_b128 v9, v[36:39] offset:5120
    v_mov_b32 v40, v99
    v_mov_b32 v41, v103
    v_mov_b32 v42, v107
    v_mov_b32 v43, v111
    v_mov_b32 v44, v115
    v_mov_b32 v45, v119
    v_mov_b32 v46, v123
    v_mov_b32 v47, v127
    ds_write_b128 v9, v[40:43] offset:6144
    ds_write_b128 v9, v[44:47] offset:7168
    v_mov_b32 v16, v128
    v_mov_b32 v17, v132
    v_mov_b32 v18, v136
    v_mov_b32 v19, v140
    v_mov_b32 v20, v144
    v_mov_b32 v21, v148
    v_mov_b32 v22, v152
    v_mov_b32 v23, v156
    ds_write_b128 v9, v[16:19] offset:8192
    ds_write_b128 v9, v[20:23] offset:9216
    v_mov_b32 v24, v129
    v_mov_b32 v25, v133
    v_mov_b32 v26, v137
    v_mov_b32 v27, v141
    v_mov_b32 v28, v145
    v_mov_b32 v29, v149
    v_mov_b32 v30, v153
    v_mov_b32 v31, v157
    ds_write_b128 v9, v[24:27] offset:10240
    ds_write_b128 v9, v[28:31] offset:11264
    v_mov_b32 v32, v130
    v_mov_b32 v33, v134
    v_mov_b32 v34, v138
    v_mov_b32 v35, v142
    v_mov_b32 v36, v146
    v_mov_b32 v37, v150
    v_mov_b32 v38, v154
    v_mov_b32 v39, v158
    ds_write_b128 v9, v[32:35] offset:12288
    ds_write_b128 v9, v[36:39] offset:13312
    v_mov_b32 v40, v131
    v_mov_b32 v41, v135
    v_mov_b32 v42, v139
    v_mov_b32 v43, v143
    v_mov_b32 v44, v147
    v_mov_b32 v45, v151
    v_mov_b32 v46, v155
    v_mov_b32 v47, v159
    ds_write_b128 v9, v[40:43] offset:14336
    ds_write_b128 v9, v[44:47] offset:15360
    s_waitcnt lgkmcnt(0)
    s_barrier
    s_lshl_b32 s49, s4, 12
    v_add_u32 v9, s49, v8
    v_add_u32 v11, 0x8000, v9
    ds_read_b128 v[64:67], v9 offset:0
    ds_read_b128 v[68:71], v9 offset:1024
    ds_read_b128 v[72:75], v9 offset:16384
    ds_read_b128 v[76:79], v9 offset:17408
    ds_read_b128 v[80:83], v11 offset:0
    ds_read_b128 v[84:87], v11 offset:1024
    ds_read_b128 v[88:91], v11 offset:16384
    ds_read_b128 v[92:95], v11 offset:17408
    ds_read_b128 v[96:99], v9 offset:2048
    ds_read_b128 v[100:103], v9 offset:3072
    ds_read_b128 v[104:107], v9 offset:18432
    ds_read_b128 v[108:111], v9 offset:19456
    ds_read_b128 v[112:115], v11 offset:2048
    ds_read_b128 v[116:119], v11 offset:3072
    ds_read_b128 v[120:123], v11 offset:18432
    ds_read_b128 v[124:127], v11 offset:19456
    s_lshr_b32 s40, s4, 1
    s_lshl_b32 s40, s40, 4
    s_and_b32 s41, s4, 1
    s_lshl_b32 s41, s41, 1
    s_add_u32 s40, s40, s41
    s_lshl_b32 s41, s32, 5
    s_add_u32 s40, s40, s41
    v_mul_u32_u24 v12, 11264, v3
    v_lshl_add_u32 v12, v2, 4, v12
    s_mul_i32 s41, s40, 2816
    s_lshl_b32 s42, s33, 8
    s_add_u32 s41, s41, s42
    s_add_u32 s41, s41, 0x800000
    s_lshl_b32 s42, s33, 7
    v_lshl_add_u32 v13, v2, 3, s42
    v_cmp_gt_u32 vcc, 0x560, v13
    s_mov_b64 s[44:45], vcc
    s_mov_b32 s46, 0x3d372713
    s_mov_b32 s47, 0xc0135761
    s_waitcnt lgkmcnt(0)
    v_add_f32 v64, v64, v72
    v_add_f32 v80, v80, v88
    v_cvt_pk_bf16_f32 v64, v64, v64
    v_lshlrev_b32 v64, 16, v64
    v_cvt_pk_bf16_f32 v80, v80, v80
    v_lshlrev_b32 v80, 16, v80
    v_mul_f32 v16, v64, v64
    v_fma_f32 v16, v16, s46, 1.0
    v_mul_f32 v16, v16, v64
    v_mul_f32 v16, s47, v16
    v_add_f32 v65, v65, v73
    v_add_f32 v81, v81, v89
    v_cvt_pk_bf16_f32 v65, v65, v65
    v_lshlrev_b32 v65, 16, v65
    v_cvt_pk_bf16_f32 v81, v81, v81
    v_lshlrev_b32 v81, 16, v81
    v_mul_f32 v18, v65, v65
    v_fma_f32 v18, v18, s46, 1.0
    v_mul_f32 v18, v18, v65
    v_mul_f32 v18, s47, v18
    v_add_f32 v66, v66, v74
    v_add_f32 v82, v82, v90
    v_cvt_pk_bf16_f32 v66, v66, v66
    v_lshlrev_b32 v66, 16, v66
    v_cvt_pk_bf16_f32 v82, v82, v82
    v_lshlrev_b32 v82, 16, v82
    v_mul_f32 v20, v66, v66
    v_fma_f32 v20, v20, s46, 1.0
    v_mul_f32 v20, v20, v66
    v_mul_f32 v20, s47, v20
    v_add_f32 v67, v67, v75
    v_add_f32 v83, v83, v91
    v_cvt_pk_bf16_f32 v67, v67, v67
    v_lshlrev_b32 v67, 16, v67
    v_cvt_pk_bf16_f32 v83, v83, v83
    v_lshlrev_b32 v83, 16, v83
    v_mul_f32 v22, v67, v67
    v_fma_f32 v22, v22, s46, 1.0
    v_mul_f32 v22, v22, v67
    v_mul_f32 v22, s47, v22
    v_add_f32 v68, v68, v76
    v_add_f32 v84, v84, v92
    v_cvt_pk_bf16_f32 v68, v68, v68
    v_lshlrev_b32 v68, 16, v68
    v_cvt_pk_bf16_f32 v84, v84, v84
    v_lshlrev_b32 v84, 16, v84
    v_mul_f32 v24, v68, v68
    v_fma_f32 v24, v24, s46, 1.0
    v_mul_f32 v24, v24, v68
    v_mul_f32 v24, s47, v24
    v_add_f32 v69, v69, v77
    v_add_f32 v85, v85, v93
    v_cvt_pk_bf16_f32 v69, v69, v69
    v_lshlrev_b32 v69, 16, v69
    v_cvt_pk_bf16_f32 v85, v85, v85
    v_lshlrev_b32 v85, 16, v85
    v_mul_f32 v26, v69, v69
    v_fma_f32 v26, v26, s46, 1.0
    v_mul_f32 v26, v26, v69
    v_mul_f32 v26, s47, v26
    v_add_f32 v70, v70, v78
    v_add_f32 v86, v86, v94
    v_cvt_pk_bf16_f32 v70, v70, v70
    v_lshlrev_b32 v70, 16, v70
    v_cvt_pk_bf16_f32 v86, v86, v86
    v_lshlrev_b32 v86, 16, v86
    v_mul_f32 v28, v70, v70
    v_fma_f32 v28, v28, s46, 1.0
    v_mul_f32 v28, v28, v70
    v_mul_f32 v28, s47, v28
    v_add_f32 v71, v71, v79
    v_add_f32 v87, v87, v95
    v_cvt_pk_bf16_f32 v71, v71, v71
    v_lshlrev_b32 v71, 16, v71
    v_cvt_pk_bf16_f32 v87, v87, v87
    v_lshlrev_b32 v87, 16, v87
    v_mul_f32 v30, v71, v71
    v_fma_f32 v30, v30, s46, 1.0
    v_mul_f32 v30, v30, v71
    v_mul_f32 v30, s47, v30
    v_exp_f32 v16, v16
    v_exp_f32 v18, v18
    v_exp_f32 v20, v20
    v_exp_f32 v22, v22
    v_exp_f32 v24, v24
    v_exp_f32 v26, v26
    v_exp_f32 v28, v28
    v_exp_f32 v30, v30
    v_add_f32 v16, 1.0, v16
    v_add_f32 v18, 1.0, v18
    v_add_f32 v20, 1.0, v20
    v_add_f32 v22, 1.0, v22
    v_add_f32 v24, 1.0, v24
    v_add_f32 v26, 1.0, v26
    v_add_f32 v28, 1.0, v28
    v_add_f32 v30, 1.0, v30
    v_rcp_f32 v16, v16
    v_rcp_f32 v18, v18
    v_rcp_f32 v20, v20
    v_rcp_f32 v22, v22
    v_rcp_f32 v24, v24
    v_rcp_f32 v26, v26
    v_rcp_f32 v28, v28
    v_rcp_f32 v30, v30
    s_nop 0
    v_mul_f32 v64, v64, v16
    v_cvt_pk_bf16_f32 v64, v64, v64
    v_lshlrev_b32 v64, 16, v64
    v_mul_f32 v64, v64, v80
    v_cndmask_b32 v64, 0, v64, s[44:45]
    v_mul_f32 v65, v65, v18
    v_cvt_pk_bf16_f32 v65, v65, v65
    v_lshlrev_b32 v65, 16, v65
    v_mul_f32 v65, v65, v81
    v_cndmask_b32 v65, 0, v65, s[44:45]
    v_mul_f32 v66, v66, v20
    v_cvt_pk_bf16_f32 v66, v66, v66
    v_lshlrev_b32 v66, 16, v66
    v_mul_f32 v66, v66, v82
    v_cndmask_b32 v66, 0, v66, s[44:45]
    v_mul_f32 v67, v67, v22
    v_cvt_pk_bf16_f32 v67, v67, v67
    v_lshlrev_b32 v67, 16, v67
    v_mul_f32 v67, v67, v83
    v_cndmask_b32 v67, 0, v67, s[44:45]
    v_mul_f32 v68, v68, v24
    v_cvt_pk_bf16_f32 v68, v68, v68
    v_lshlrev_b32 v68, 16, v68
    v_mul_f32 v68, v68, v84
    v_cndmask_b32 v68, 0, v68, s[44:45]
    v_mul_f32 v69, v69, v26
    v_cvt_pk_bf16_f32 v69, v69, v69
    v_lshlrev_b32 v69, 16, v69
    v_mul_f32 v69, v69, v85
    v_cndmask_b32 v69, 0, v69, s[44:45]
    v_mul_f32 v70, v70, v28
    v_cvt_pk_bf16_f32 v70, v70, v70
    v_lshlrev_b32 v70, 16, v70
    v_mul_f32 v70, v70, v86
    v_cndmask_b32 v70, 0, v70, s[44:45]
    v_mul_f32 v71, v71, v30
    v_cvt_pk_bf16_f32 v71, v71, v71
    v_lshlrev_b32 v71, 16, v71
    v_mul_f32 v71, v71, v87
    v_cndmask_b32 v71, 0, v71, s[44:45]
    v_cvt_pk_bf16_f32 v32, v64, v65
    v_cvt_pk_bf16_f32 v33, v66, v67
    v_cvt_pk_bf16_f32 v34, v68, v69
    v_cvt_pk_bf16_f32 v35, v70, v71
    buffer_store_dwordx4 v[32:35], v12, s[8:11], s41 offen offset:0 sc1
    v_add_f32 v96, v96, v104
    v_add_f32 v112, v112, v120
    v_cvt_pk_bf16_f32 v96, v96, v96
    v_lshlrev_b32 v96, 16, v96
    v_cvt_pk_bf16_f32 v112, v112, v112
    v_lshlrev_b32 v112, 16, v112
    v_mul_f32 v16, v96, v96
    v_fma_f32 v16, v16, s46, 1.0
    v_mul_f32 v16, v16, v96
    v_mul_f32 v16, s47, v16
    v_add_f32 v97, v97, v105
    v_add_f32 v113, v113, v121
    v_cvt_pk_bf16_f32 v97, v97, v97
    v_lshlrev_b32 v97, 16, v97
    v_cvt_pk_bf16_f32 v113, v113, v113
    v_lshlrev_b32 v113, 16, v113
    v_mul_f32 v18, v97, v97
    v_fma_f32 v18, v18, s46, 1.0
    v_mul_f32 v18, v18, v97
    v_mul_f32 v18, s47, v18
    v_add_f32 v98, v98, v106
    v_add_f32 v114, v114, v122
    v_cvt_pk_bf16_f32 v98, v98, v98
    v_lshlrev_b32 v98, 16, v98
    v_cvt_pk_bf16_f32 v114, v114, v114
    v_lshlrev_b32 v114, 16, v114
    v_mul_f32 v20, v98, v98
    v_fma_f32 v20, v20, s46, 1.0
    v_mul_f32 v20, v20, v98
    v_mul_f32 v20, s47, v20
    v_add_f32 v99, v99, v107
    v_add_f32 v115, v115, v123
    v_cvt_pk_bf16_f32 v99, v99, v99
    v_lshlrev_b32 v99, 16, v99
    v_cvt_pk_bf16_f32 v115, v115, v115
    v_lshlrev_b32 v115, 16, v115
    v_mul_f32 v22, v99, v99
    v_fma_f32 v22, v22, s46, 1.0
    v_mul_f32 v22, v22, v99
    v_mul_f32 v22, s47, v22
    v_add_f32 v100, v100, v108
    v_add_f32 v116, v116, v124
    v_cvt_pk_bf16_f32 v100, v100, v100
    v_lshlrev_b32 v100, 16, v100
    v_cvt_pk_bf16_f32 v116, v116, v116
    v_lshlrev_b32 v116, 16, v116
    v_mul_f32 v24, v100, v100
    v_fma_f32 v24, v24, s46, 1.0
    v_mul_f32 v24, v24, v100
    v_mul_f32 v24, s47, v24
    v_add_f32 v101, v101, v109
    v_add_f32 v117, v117, v125
    v_cvt_pk_bf16_f32 v101, v101, v101
    v_lshlrev_b32 v101, 16, v101
    v_cvt_pk_bf16_f32 v117, v117, v117
    v_lshlrev_b32 v117, 16, v117
    v_mul_f32 v26, v101, v101
    v_fma_f32 v26, v26, s46, 1.0
    v_mul_f32 v26, v26, v101
    v_mul_f32 v26, s47, v26
    v_add_f32 v102, v102, v110
    v_add_f32 v118, v118, v126
    v_cvt_pk_bf16_f32 v102, v102, v102
    v_lshlrev_b32 v102, 16, v102
    v_cvt_pk_bf16_f32 v118, v118, v118
    v_lshlrev_b32 v118, 16, v118
    v_mul_f32 v28, v102, v102
    v_fma_f32 v28, v28, s46, 1.0
    v_mul_f32 v28, v28, v102
    v_mul_f32 v28, s47, v28
    v_add_f32 v103, v103, v111
    v_add_f32 v119, v119, v127
    v_cvt_pk_bf16_f32 v103, v103, v103
    v_lshlrev_b32 v103, 16, v103
    v_cvt_pk_bf16_f32 v119, v119, v119
    v_lshlrev_b32 v119, 16, v119
    v_mul_f32 v30, v103, v103
    v_fma_f32 v30, v30, s46, 1.0
    v_mul_f32 v30, v30, v103
    v_mul_f32 v30, s47, v30
    v_exp_f32 v16, v16
    v_exp_f32 v18, v18
    v_exp_f32 v20, v20
    v_exp_f32 v22, v22
    v_exp_f32 v24, v24
    v_exp_f32 v26, v26
    v_exp_f32 v28, v28
    v_exp_f32 v30, v30
    v_add_f32 v16, 1.0, v16
    v_add_f32 v18, 1.0, v18
    v_add_f32 v20, 1.0, v20
    v_add_f32 v22, 1.0, v22
    v_add_f32 v24, 1.0, v24
    v_add_f32 v26, 1.0, v26
    v_add_f32 v28, 1.0, v28
    v_add_f32 v30, 1.0, v30
    v_rcp_f32 v16, v16
    v_rcp_f32 v18, v18
    v_rcp_f32 v20, v20
    v_rcp_f32 v22, v22
    v_rcp_f32 v24, v24
    v_rcp_f32 v26, v26
    v_rcp_f32 v28, v28
    v_rcp_f32 v30, v30
    s_nop 0
    v_mul_f32 v96, v96, v16
    v_cvt_pk_bf16_f32 v96, v96, v96
    v_lshlrev_b32 v96, 16, v96
    v_mul_f32 v96, v96, v112
    v_cndmask_b32 v96, 0, v96, s[44:45]
    v_mul_f32 v97, v97, v18
    v_cvt_pk_bf16_f32 v97, v97, v97
    v_lshlrev_b32 v97, 16, v97
    v_mul_f32 v97, v97, v113
    v_cndmask_b32 v97, 0, v97, s[44:45]
    v_mul_f32 v98, v98, v20
    v_cvt_pk_bf16_f32 v98, v98, v98
    v_lshlrev_b32 v98, 16, v98
    v_mul_f32 v98, v98, v114
    v_cndmask_b32 v98, 0, v98, s[44:45]
    v_mul_f32 v99, v99, v22
    v_cvt_pk_bf16_f32 v99, v99, v99
    v_lshlrev_b32 v99, 16, v99
    v_mul_f32 v99, v99, v115
    v_cndmask_b32 v99, 0, v99, s[44:45]
    v_mul_f32 v100, v100, v24
    v_cvt_pk_bf16_f32 v100, v100, v100
    v_lshlrev_b32 v100, 16, v100
    v_mul_f32 v100, v100, v116
    v_cndmask_b32 v100, 0, v100, s[44:45]
    v_mul_f32 v101, v101, v26
    v_cvt_pk_bf16_f32 v101, v101, v101
    v_lshlrev_b32 v101, 16, v101
    v_mul_f32 v101, v101, v117
    v_cndmask_b32 v101, 0, v101, s[44:45]
    v_mul_f32 v102, v102, v28
    v_cvt_pk_bf16_f32 v102, v102, v102
    v_lshlrev_b32 v102, 16, v102
    v_mul_f32 v102, v102, v118
    v_cndmask_b32 v102, 0, v102, s[44:45]
    v_mul_f32 v103, v103, v30
    v_cvt_pk_bf16_f32 v103, v103, v103
    v_lshlrev_b32 v103, 16, v103
    v_mul_f32 v103, v103, v119
    v_cndmask_b32 v103, 0, v103, s[44:45]
    v_cvt_pk_bf16_f32 v36, v96, v97
    v_cvt_pk_bf16_f32 v37, v98, v99
    v_cvt_pk_bf16_f32 v38, v100, v101
    v_cvt_pk_bf16_f32 v39, v102, v103
    buffer_store_dwordx4 v[36:39], v12, s[8:11], s41 offen offset:2816 sc1
    s_add_u32 s35, s32, 256
    s_lshl_b32 s35, s35, 6
    s_waitcnt vmcnt(0) lgkmcnt(0)
    s_barrier
    s_cmp_lg_u32 s4, 0
    s_cbranch_scc1 Lsg_74
    v_mov_b32 v7, 1
    s_mov_b64 exec, 1
    buffer_atomic_add v7, off, s[8:11], s35 sc1
    s_mov_b64 exec, -1
Lsg_74:
    s_add_u32 s63, s63, 5
    s_cmp_lt_u32 s63, 64
    s_cbranch_scc1 Ltl_71
    s_branch Lwend_59
Lrole_69:
    s_cmp_ge_u32 s5, 171
    s_cbranch_scc1 Lrole_75
    s_sub_u32 s62, s5, 151
    s_mul_hi_u32 s63, s62, 0x40000000
    s_mul_i32 s33, s63, 4
    s_sub_u32 s62, s62, s33
    s_mov_b32 s33, s62
    s_mov_b32 s12, s84
    s_and_b32 s13, s85, 0xffff
    s_mov_b32 s14, 0x158000
    s_mov_b32 s15, 0x20000
    v_lshlrev_b32 v10, 13, v3
    v_lshl_add_u32 v10, v2, 4, v10
    s_mul_i32 s37, s4, 360448
    s_lshl_b32 s38, s33, 8
    s_add_u32 s37, s37, s38
    v_add_u32 v10, s37, v10
    s_mov_b32 s21, 0x5040100
    s_mov_b32 s22, 0x7060302
    s_mov_b32 s23, 0x8000
    s_mov_b32 s24, 0
    s_mov_b32 s25, 0x400
    s_mov_b32 s26, 0x800
    s_mov_b32 s27, 0xc00
    s_mov_b32 s28, 0x1000
    s_mov_b32 s29, 0x1400
    s_mov_b32 s30, 0x1800
    s_mov_b32 s31, 0x1c00
    buffer_load_dwordx4 v[16:19], v10, s[12:15], s24 offen
    buffer_load_dwordx4 v[20:23], v10, s[12:15], s25 offen
    buffer_load_dwordx4 v[24:27], v10, s[12:15], s26 offen
    buffer_load_dwordx4 v[28:31], v10, s[12:15], s27 offen
    buffer_load_dwordx4 v[32:35], v10, s[12:15], s28 offen
    buffer_load_dwordx4 v[36:39], v10, s[12:15], s29 offen
    buffer_load_dwordx4 v[40:43], v10, s[12:15], s30 offen
    buffer_load_dwordx4 v[44:47], v10, s[12:15], s31 offen
    v_add_u32 v10, s23, v10
    buffer_load_dwordx4 v[48:51], v10, s[12:15], s24 offen
    buffer_load_dwordx4 v[52:55], v10, s[12:15], s25 offen
    buffer_load_dwordx4 v[56:59], v10, s[12:15], s26 offen
    buffer_load_dwordx4 v[60:63], v10, s[12:15], s27 offen
    buffer_load_dwordx4 v[64:67], v10, s[12:15], s28 offen
    buffer_load_dwordx4 v[68:71], v10, s[12:15], s29 offen
    buffer_load_dwordx4 v[72:75], v10, s[12:15], s30 offen
    buffer_load_dwordx4 v[76:79], v10, s[12:15], s31 offen
    v_add_u32 v10, s23, v10
    buffer_load_dwordx4 v[80:83], v10, s[12:15], s24 offen
    buffer_load_dwordx4 v[84:87], v10, s[12:15], s25 offen
    buffer_load_dwordx4 v[88:91], v10, s[12:15], s26 offen
    buffer_load_dwordx4 v[92:95], v10, s[12:15], s27 offen
    buffer_load_dwordx4 v[96:99], v10, s[12:15], s28 offen
    buffer_load_dwordx4 v[100:103], v10, s[12:15], s29 offen
    buffer_load_dwordx4 v[104:107], v10, s[12:15], s30 offen
    buffer_load_dwordx4 v[108:111], v10, s[12:15], s31 offen
    v_add_u32 v10, s23, v10
    buffer_load_dwordx4 v[112:115], v10, s[12:15], s24 offen
    buffer_load_dwordx4 v[116:119], v10, s[12:15], s25 offen
    buffer_load_dwordx4 v[120:123], v10, s[12:15], s26 offen
    buffer_load_dwordx4 v[124:127], v10, s[12:15], s27 offen
    buffer_load_dwordx4 v[128:131], v10, s[12:15], s28 offen
    buffer_load_dwordx4 v[132:135], v10, s[12:15], s29 offen
    buffer_load_dwordx4 v[136:139], v10, s[12:15], s30 offen
    buffer_load_dwordx4 v[140:143], v10, s[12:15], s31 offen
    v_add_u32 v10, s23, v10
    s_waitcnt vmcnt(24)
    v_perm_b32 v176, v20, v16, s21
    v_perm_b32 v177, v28, v24, s21
    v_perm_b32 v178, v36, v32, s21
    v_perm_b32 v179, v44, v40, s21
    v_perm_b32 v180, v20, v16, s22
    v_perm_b32 v181, v28, v24, s22
    v_perm_b32 v182, v36, v32, s22
    v_perm_b32 v183, v44, v40, s22
    v_perm_b32 v184, v21, v17, s21
    v_perm_b32 v185, v29, v25, s21
    v_perm_b32 v186, v37, v33, s21
    v_perm_b32 v187, v45, v41, s21
    v_perm_b32 v188, v21, v17, s22
    v_perm_b32 v189, v29, v25, s22
    v_perm_b32 v190, v37, v33, s22
    v_perm_b32 v191, v45, v41, s22
    v_perm_b32 v192, v22, v18, s21
    v_perm_b32 v193, v30, v26, s21
    v_perm_b32 v194, v38, v34, s21
    v_perm_b32 v195, v46, v42, s21
    v_perm_b32 v196, v22, v18, s22
    v_perm_b32 v197, v30, v26, s22
    v_perm_b32 v198, v38, v34, s22
    v_perm_b32 v199, v46, v42, s22
    v_perm_b32 v200, v23, v19, s21
    v_perm_b32 v201, v31, v27, s21
    v_perm_b32 v202, v39, v35, s21
    v_perm_b32 v203, v47, v43, s21
    v_perm_b32 v204, v23, v19, s22
    v_perm_b32 v205, v31, v27, s22
    v_perm_b32 v206, v39, v35, s22
    v_perm_b32 v207, v47, v43, s22
    buffer_load_dwordx4 v[16:19], v10, s[12:15], s24 offen
    buffer_load_dwordx4 v[20:23], v10, s[12:15], s25 offen
    buffer_load_dwordx4 v[24:27], v10, s[12:15], s26 offen
    buffer_load_dwordx4 v[28:31], v10, s[12:15], s27 offen
    buffer_load_dwordx4 v[32:35], v10, s[12:15], s28 offen
    buffer_load_dwordx4 v[36:39], v10, s[12:15], s29 offen
    buffer_load_dwordx4 v[40:43], v10, s[12:15], s30 offen
    buffer_load_dwordx4 v[44:47], v10, s[12:15], s31 offen
    v_add_u32 v10, s23, v10
    v_accvgpr_write_b32 a0, v176
    v_accvgpr_write_b32 a1, v177
    v_accvgpr_write_b32 a2, v178
    v_accvgpr_write_b32 a3, v179
    v_accvgpr_write_b32 a4, v180
    v_accvgpr_write_b32 a5, v181
    v_accvgpr_write_b32 a6, v182
    v_accvgpr_write_b32 a7, v183
    v_accvgpr_write_b32 a8, v184
    v_accvgpr_write_b32 a9, v185
    v_accvgpr_write_b32 a10, v186
    v_accvgpr_write_b32 a11, v187
    v_accvgpr_write_b32 a12, v188
    v_accvgpr_write_b32 a13, v189
    v_accvgpr_write_b32 a14, v190
    v_accvgpr_write_b32 a15, v191
    v_accvgpr_write_b32 a16, v192
    v_accvgpr_write_b32 a17, v193
    v_accvgpr_write_b32 a18, v194
    v_accvgpr_write_b32 a19, v195
    v_accvgpr_write_b32 a20, v196
    v_accvgpr_write_b32 a21, v197
    v_accvgpr_write_b32 a22, v198
    v_accvgpr_write_b32 a23, v199
    v_accvgpr_write_b32 a24, v200
    v_accvgpr_write_b32 a25, v201
    v_accvgpr_write_b32 a26, v202
    v_accvgpr_write_b32 a27, v203
    v_accvgpr_write_b32 a28, v204
    v_accvgpr_write_b32 a29, v205
    v_accvgpr_write_b32 a30, v206
    v_accvgpr_write_b32 a31, v207
    s_waitcnt vmcnt(24)
    v_perm_b32 v176, v52, v48, s21
    v_perm_b32 v177, v60, v56, s21
    v_perm_b32 v178, v68, v64, s21
    v_perm_b32 v179, v76, v72, s21
    v_perm_b32 v180, v52, v48, s22
    v_perm_b32 v181, v60, v56, s22
    v_perm_b32 v182, v68, v64, s22
    v_perm_b32 v183, v76, v72, s22
    v_perm_b32 v184, v53, v49, s21
    v_perm_b32 v185, v61, v57, s21
    v_perm_b32 v186, v69, v65, s21
    v_perm_b32 v187, v77, v73, s21
    v_perm_b32 v188, v53, v49, s22
    v_perm_b32 v189, v61, v57, s22
    v_perm_b32 v190, v69, v65, s22
    v_perm_b32 v191, v77, v73, s22
    v_perm_b32 v192, v54, v50, s21
    v_perm_b32 v193, v62, v58, s21
    v_perm_b32 v194, v70, v66, s21
    v_perm_b32 v195, v78, v74, s21
    v_perm_b32 v196, v54, v50, s22
    v_perm_b32 v197, v62, v58, s22
    v_perm_b32 v198, v70, v66, s22
    v_perm_b32 v199, v78, v74, s22
    v_perm_b32 v200, v55, v51, s21
    v_perm_b32 v201, v63, v59, s21
    v_perm_b32 v202, v71, v67, s21
    v_perm_b32 v203, v79, v75, s21
    v_perm_b32 v204, v55, v51, s22
    v_perm_b32 v205, v63, v59, s22
    v_perm_b32 v206, v71, v67, s22
    v_perm_b32 v207, v79, v75, s22
    buffer_load_dwordx4 v[48:51], v10, s[12:15], s24 offen
    buffer_load_dwordx4 v[52:55], v10, s[12:15], s25 offen
    buffer_load_dwordx4 v[56:59], v10, s[12:15], s26 offen
    buffer_load_dwordx4 v[60:63], v10, s[12:15], s27 offen
    buffer_load_dwordx4 v[64:67], v10, s[12:15], s28 offen
    buffer_load_dwordx4 v[68:71], v10, s[12:15], s29 offen
    buffer_load_dwordx4 v[72:75], v10, s[12:15], s30 offen
    buffer_load_dwordx4 v[76:79], v10, s[12:15], s31 offen
    v_add_u32 v10, s23, v10
    v_accvgpr_write_b32 a32, v176
    v_accvgpr_write_b32 a33, v177
    v_accvgpr_write_b32 a34, v178
    v_accvgpr_write_b32 a35, v179
    v_accvgpr_write_b32 a36, v180
    v_accvgpr_write_b32 a37, v181
    v_accvgpr_write_b32 a38, v182
    v_accvgpr_write_b32 a39, v183
    v_accvgpr_write_b32 a40, v184
    v_accvgpr_write_b32 a41, v185
    v_accvgpr_write_b32 a42, v186
    v_accvgpr_write_b32 a43, v187
    v_accvgpr_write_b32 a44, v188
    v_accvgpr_write_b32 a45, v189
    v_accvgpr_write_b32 a46, v190
    v_accvgpr_write_b32 a47, v191
    v_accvgpr_write_b32 a48, v192
    v_accvgpr_write_b32 a49, v193
    v_accvgpr_write_b32 a50, v194
    v_accvgpr_write_b32 a51, v195
    v_accvgpr_write_b32 a52, v196
    v_accvgpr_write_b32 a53, v197
    v_accvgpr_write_b32 a54, v198
    v_accvgpr_write_b32 a55, v199
    v_accvgpr_write_b32 a56, v200
    v_accvgpr_write_b32 a57, v201
    v_accvgpr_write_b32 a58, v202
    v_accvgpr_write_b32 a59, v203
    v_accvgpr_write_b32 a60, v204
    v_accvgpr_write_b32 a61, v205
    v_accvgpr_write_b32 a62, v206
    v_accvgpr_write_b32 a63, v207
    s_waitcnt vmcnt(24)
    v_perm_b32 v176, v84, v80, s21
    v_perm_b32 v177, v92, v88, s21
    v_perm_b32 v178, v100, v96, s21
    v_perm_b32 v179, v108, v104, s21
    v_perm_b32 v180, v84, v80, s22
    v_perm_b32 v181, v92, v88, s22
    v_perm_b32 v182, v100, v96, s22
    v_perm_b32 v183, v108, v104, s22
    v_perm_b32 v184, v85, v81, s21
    v_perm_b32 v185, v93, v89, s21
    v_perm_b32 v186, v101, v97, s21
    v_perm_b32 v187, v109, v105, s21
    v_perm_b32 v188, v85, v81, s22
    v_perm_b32 v189, v93, v89, s22
    v_perm_b32 v190, v101, v97, s22
    v_perm_b32 v191, v109, v105, s22
    v_perm_b32 v192, v86, v82, s21
    v_perm_b32 v193, v94, v90, s21
    v_perm_b32 v194, v102, v98, s21
    v_perm_b32 v195, v110, v106, s21
    v_perm_b32 v196, v86, v82, s22
    v_perm_b32 v197, v94, v90, s22
    v_perm_b32 v198, v102, v98, s22
    v_perm_b32 v199, v110, v106, s22
    v_perm_b32 v200, v87, v83, s21
    v_perm_b32 v201, v95, v91, s21
    v_perm_b32 v202, v103, v99, s21
    v_perm_b32 v203, v111, v107, s21
    v_perm_b32 v204, v87, v83, s22
    v_perm_b32 v205, v95, v91, s22
    v_perm_b32 v206, v103, v99, s22
    v_perm_b32 v207, v111, v107, s22
    buffer_load_dwordx4 v[80:83], v10, s[12:15], s24 offen
    buffer_load_dwordx4 v[84:87], v10, s[12:15], s25 offen
    buffer_load_dwordx4 v[88:91], v10, s[12:15], s26 offen
    buffer_load_dwordx4 v[92:95], v10, s[12:15], s27 offen
    buffer_load_dwordx4 v[96:99], v10, s[12:15], s28 offen
    buffer_load_dwordx4 v[100:103], v10, s[12:15], s29 offen
    buffer_load_dwordx4 v[104:107], v10, s[12:15], s30 offen
    buffer_load_dwordx4 v[108:111], v10, s[12:15], s31 offen
    v_add_u32 v10, s23, v10
    v_accvgpr_write_b32 a64, v176
    v_accvgpr_write_b32 a65, v177
    v_accvgpr_write_b32 a66, v178
    v_accvgpr_write_b32 a67, v179
    v_accvgpr_write_b32 a68, v180
    v_accvgpr_write_b32 a69, v181
    v_accvgpr_write_b32 a70, v182
    v_accvgpr_write_b32 a71, v183
    v_accvgpr_write_b32 a72, v184
    v_accvgpr_write_b32 a73, v185
    v_accvgpr_write_b32 a74, v186
    v_accvgpr_write_b32 a75, v187
    v_accvgpr_write_b32 a76, v188
    v_accvgpr_write_b32 a77, v189
    v_accvgpr_write_b32 a78, v190
    v_accvgpr_write_b32 a79, v191
    v_accvgpr_write_b32 a80, v192
    v_accvgpr_write_b32 a81, v193
    v_accvgpr_write_b32 a82, v194
    v_accvgpr_write_b32 a83, v195
    v_accvgpr_write_b32 a84, v196
    v_accvgpr_write_b32 a85, v197
    v_accvgpr_write_b32 a86, v198
    v_accvgpr_write_b32 a87, v199
    v_accvgpr_write_b32 a88, v200
    v_accvgpr_write_b32 a89, v201
    v_accvgpr_write_b32 a90, v202
    v_accvgpr_write_b32 a91, v203
    v_accvgpr_write_b32 a92, v204
    v_accvgpr_write_b32 a93, v205
    v_accvgpr_write_b32 a94, v206
    v_accvgpr_write_b32 a95, v207
    s_waitcnt vmcnt(24)
    v_perm_b32 v176, v116, v112, s21
    v_perm_b32 v177, v124, v120, s21
    v_perm_b32 v178, v132, v128, s21
    v_perm_b32 v179, v140, v136, s21
    v_perm_b32 v180, v116, v112, s22
    v_perm_b32 v181, v124, v120, s22
    v_perm_b32 v182, v132, v128, s22
    v_perm_b32 v183, v140, v136, s22
    v_perm_b32 v184, v117, v113, s21
    v_perm_b32 v185, v125, v121, s21
    v_perm_b32 v186, v133, v129, s21
    v_perm_b32 v187, v141, v137, s21
    v_perm_b32 v188, v117, v113, s22
    v_perm_b32 v189, v125, v121, s22
    v_perm_b32 v190, v133, v129, s22
    v_perm_b32 v191, v141, v137, s22
    v_perm_b32 v192, v118, v114, s21
    v_perm_b32 v193, v126, v122, s21
    v_perm_b32 v194, v134, v130, s21
    v_perm_b32 v195, v142, v138, s21
    v_perm_b32 v196, v118, v114, s22
    v_perm_b32 v197, v126, v122, s22
    v_perm_b32 v198, v134, v130, s22
    v_perm_b32 v199, v142, v138, s22
    v_perm_b32 v200, v119, v115, s21
    v_perm_b32 v201, v127, v123, s21
    v_perm_b32 v202, v135, v131, s21
    v_perm_b32 v203, v143, v139, s21
    v_perm_b32 v204, v119, v115, s22
    v_perm_b32 v205, v127, v123, s22
    v_perm_b32 v206, v135, v131, s22
    v_perm_b32 v207, v143, v139, s22
    buffer_load_dwordx4 v[112:115], v10, s[12:15], s24 offen
    buffer_load_dwordx4 v[116:119], v10, s[12:15], s25 offen
    buffer_load_dwordx4 v[120:123], v10, s[12:15], s26 offen
    buffer_load_dwordx4 v[124:127], v10, s[12:15], s27 offen
    buffer_load_dwordx4 v[128:131], v10, s[12:15], s28 offen
    buffer_load_dwordx4 v[132:135], v10, s[12:15], s29 offen
    buffer_load_dwordx4 v[136:139], v10, s[12:15], s30 offen
    buffer_load_dwordx4 v[140:143], v10, s[12:15], s31 offen
    v_add_u32 v10, s23, v10
    v_accvgpr_write_b32 a96, v176
    v_accvgpr_write_b32 a97, v177
    v_accvgpr_write_b32 a98, v178
    v_accvgpr_write_b32 a99, v179
    v_accvgpr_write_b32 a100, v180
    v_accvgpr_write_b32 a101, v181
    v_accvgpr_write_b32 a102, v182
    v_accvgpr_write_b32 a103, v183
    v_accvgpr_write_b32 a104, v184
    v_accvgpr_write_b32 a105, v185
    v_accvgpr_write_b32 a106, v186
    v_accvgpr_write_b32 a107, v187
    v_accvgpr_write_b32 a108, v188
    v_accvgpr_write_b32 a109, v189
    v_accvgpr_write_b32 a110, v190
    v_accvgpr_write_b32 a111, v191
    v_accvgpr_write_b32 a112, v192
    v_accvgpr_write_b32 a113, v193
    v_accvgpr_write_b32 a114, v194
    v_accvgpr_write_b32 a115, v195
    v_accvgpr_write_b32 a116, v196
    v_accvgpr_write_b32 a117, v197
    v_accvgpr_write_b32 a118, v198
    v_accvgpr_write_b32 a119, v199
    v_accvgpr_write_b32 a120, v200
    v_accvgpr_write_b32 a121, v201
    v_accvgpr_write_b32 a122, v202
    v_accvgpr_write_b32 a123, v203
    v_accvgpr_write_b32 a124, v204
    v_accvgpr_write_b32 a125, v205
    v_accvgpr_write_b32 a126, v206
    v_accvgpr_write_b32 a127, v207
    s_waitcnt vmcnt(24)
    v_perm_b32 v176, v20, v16, s21
    v_perm_b32 v177, v28, v24, s21
    v_perm_b32 v178, v36, v32, s21
    v_perm_b32 v179, v44, v40, s21
    v_perm_b32 v180, v20, v16, s22
    v_perm_b32 v181, v28, v24, s22
    v_perm_b32 v182, v36, v32, s22
    v_perm_b32 v183, v44, v40, s22
    v_perm_b32 v184, v21, v17, s21
    v_perm_b32 v185, v29, v25, s21
    v_perm_b32 v186, v37, v33, s21
    v_perm_b32 v187, v45, v41, s21
    v_perm_b32 v188, v21, v17, s22
    v_perm_b32 v189, v29, v25, s22
    v_perm_b32 v190, v37, v33, s22
    v_perm_b32 v191, v45, v41, s22
    v_perm_b32 v192, v22, v18, s21
    v_perm_b32 v193, v30, v26, s21
    v_perm_b32 v194, v38, v34, s21
    v_perm_b32 v195, v46, v42, s21
    v_perm_b32 v196, v22, v18, s22
    v_perm_b32 v197, v30, v26, s22
    v_perm_b32 v198, v38, v34, s22
    v_perm_b32 v199, v46, v42, s22
    v_perm_b32 v200, v23, v19, s21
    v_perm_b32 v201, v31, v27, s21
    v_perm_b32 v202, v39, v35, s21
    v_perm_b32 v203, v47, v43, s21
    v_perm_b32 v204, v23, v19, s22
    v_perm_b32 v205, v31, v27, s22
    v_perm_b32 v206, v39, v35, s22
    v_perm_b32 v207, v47, v43, s22
    buffer_load_dwordx4 v[16:19], v10, s[12:15], s24 offen
    buffer_load_dwordx4 v[20:23], v10, s[12:15], s25 offen
    buffer_load_dwordx4 v[24:27], v10, s[12:15], s26 offen
    buffer_load_dwordx4 v[28:31], v10, s[12:15], s27 offen
    buffer_load_dwordx4 v[32:35], v10, s[12:15], s28 offen
    buffer_load_dwordx4 v[36:39], v10, s[12:15], s29 offen
    buffer_load_dwordx4 v[40:43], v10, s[12:15], s30 offen
    buffer_load_dwordx4 v[44:47], v10, s[12:15], s31 offen
    v_add_u32 v10, s23, v10
    v_accvgpr_write_b32 a128, v176
    v_accvgpr_write_b32 a129, v177
    v_accvgpr_write_b32 a130, v178
    v_accvgpr_write_b32 a131, v179
    v_accvgpr_write_b32 a132, v180
    v_accvgpr_write_b32 a133, v181
    v_accvgpr_write_b32 a134, v182
    v_accvgpr_write_b32 a135, v183
    v_accvgpr_write_b32 a136, v184
    v_accvgpr_write_b32 a137, v185
    v_accvgpr_write_b32 a138, v186
    v_accvgpr_write_b32 a139, v187
    v_accvgpr_write_b32 a140, v188
    v_accvgpr_write_b32 a141, v189
    v_accvgpr_write_b32 a142, v190
    v_accvgpr_write_b32 a143, v191
    v_accvgpr_write_b32 a144, v192
    v_accvgpr_write_b32 a145, v193
    v_accvgpr_write_b32 a146, v194
    v_accvgpr_write_b32 a147, v195
    v_accvgpr_write_b32 a148, v196
    v_accvgpr_write_b32 a149, v197
    v_accvgpr_write_b32 a150, v198
    v_accvgpr_write_b32 a151, v199
    v_accvgpr_write_b32 a152, v200
    v_accvgpr_write_b32 a153, v201
    v_accvgpr_write_b32 a154, v202
    v_accvgpr_write_b32 a155, v203
    v_accvgpr_write_b32 a156, v204
    v_accvgpr_write_b32 a157, v205
    v_accvgpr_write_b32 a158, v206
    v_accvgpr_write_b32 a159, v207
    s_waitcnt vmcnt(24)
    v_perm_b32 v176, v52, v48, s21
    v_perm_b32 v177, v60, v56, s21
    v_perm_b32 v178, v68, v64, s21
    v_perm_b32 v179, v76, v72, s21
    v_perm_b32 v180, v52, v48, s22
    v_perm_b32 v181, v60, v56, s22
    v_perm_b32 v182, v68, v64, s22
    v_perm_b32 v183, v76, v72, s22
    v_perm_b32 v184, v53, v49, s21
    v_perm_b32 v185, v61, v57, s21
    v_perm_b32 v186, v69, v65, s21
    v_perm_b32 v187, v77, v73, s21
    v_perm_b32 v188, v53, v49, s22
    v_perm_b32 v189, v61, v57, s22
    v_perm_b32 v190, v69, v65, s22
    v_perm_b32 v191, v77, v73, s22
    v_perm_b32 v192, v54, v50, s21
    v_perm_b32 v193, v62, v58, s21
    v_perm_b32 v194, v70, v66, s21
    v_perm_b32 v195, v78, v74, s21
    v_perm_b32 v196, v54, v50, s22
    v_perm_b32 v197, v62, v58, s22
    v_perm_b32 v198, v70, v66, s22
    v_perm_b32 v199, v78, v74, s22
    v_perm_b32 v200, v55, v51, s21
    v_perm_b32 v201, v63, v59, s21
    v_perm_b32 v202, v71, v67, s21
    v_perm_b32 v203, v79, v75, s21
    v_perm_b32 v204, v55, v51, s22
    v_perm_b32 v205, v63, v59, s22
    v_perm_b32 v206, v71, v67, s22
    v_perm_b32 v207, v79, v75, s22
    buffer_load_dwordx4 v[48:51], v10, s[12:15], s24 offen
    buffer_load_dwordx4 v[52:55], v10, s[12:15], s25 offen
    buffer_load_dwordx4 v[56:59], v10, s[12:15], s26 offen
    buffer_load_dwordx4 v[60:63], v10, s[12:15], s27 offen
    buffer_load_dwordx4 v[64:67], v10, s[12:15], s28 offen
    buffer_load_dwordx4 v[68:71], v10, s[12:15], s29 offen
    buffer_load_dwordx4 v[72:75], v10, s[12:15], s30 offen
    buffer_load_dwordx4 v[76:79], v10, s[12:15], s31 offen
    v_add_u32 v10, s23, v10
    v_accvgpr_write_b32 a160, v176
    v_accvgpr_write_b32 a161, v177
    v_accvgpr_write_b32 a162, v178
    v_accvgpr_write_b32 a163, v179
    v_accvgpr_write_b32 a164, v180
    v_accvgpr_write_b32 a165, v181
    v_accvgpr_write_b32 a166, v182
    v_accvgpr_write_b32 a167, v183
    v_accvgpr_write_b32 a168, v184
    v_accvgpr_write_b32 a169, v185
    v_accvgpr_write_b32 a170, v186
    v_accvgpr_write_b32 a171, v187
    v_accvgpr_write_b32 a172, v188
    v_accvgpr_write_b32 a173, v189
    v_accvgpr_write_b32 a174, v190
    v_accvgpr_write_b32 a175, v191
    v_accvgpr_write_b32 a176, v192
    v_accvgpr_write_b32 a177, v193
    v_accvgpr_write_b32 a178, v194
    v_accvgpr_write_b32 a179, v195
    v_accvgpr_write_b32 a180, v196
    v_accvgpr_write_b32 a181, v197
    v_accvgpr_write_b32 a182, v198
    v_accvgpr_write_b32 a183, v199
    v_accvgpr_write_b32 a184, v200
    v_accvgpr_write_b32 a185, v201
    v_accvgpr_write_b32 a186, v202
    v_accvgpr_write_b32 a187, v203
    v_accvgpr_write_b32 a188, v204
    v_accvgpr_write_b32 a189, v205
    v_accvgpr_write_b32 a190, v206
    v_accvgpr_write_b32 a191, v207
    s_waitcnt vmcnt(24)
    v_perm_b32 v176, v84, v80, s21
    v_perm_b32 v177, v92, v88, s21
    v_perm_b32 v178, v100, v96, s21
    v_perm_b32 v179, v108, v104, s21
    v_perm_b32 v180, v84, v80, s22
    v_perm_b32 v181, v92, v88, s22
    v_perm_b32 v182, v100, v96, s22
    v_perm_b32 v183, v108, v104, s22
    v_perm_b32 v184, v85, v81, s21
    v_perm_b32 v185, v93, v89, s21
    v_perm_b32 v186, v101, v97, s21
    v_perm_b32 v187, v109, v105, s21
    v_perm_b32 v188, v85, v81, s22
    v_perm_b32 v189, v93, v89, s22
    v_perm_b32 v190, v101, v97, s22
    v_perm_b32 v191, v109, v105, s22
    v_perm_b32 v192, v86, v82, s21
    v_perm_b32 v193, v94, v90, s21
    v_perm_b32 v194, v102, v98, s21
    v_perm_b32 v195, v110, v106, s21
    v_perm_b32 v196, v86, v82, s22
    v_perm_b32 v197, v94, v90, s22
    v_perm_b32 v198, v102, v98, s22
    v_perm_b32 v199, v110, v106, s22
    v_perm_b32 v200, v87, v83, s21
    v_perm_b32 v201, v95, v91, s21
    v_perm_b32 v202, v103, v99, s21
    v_perm_b32 v203, v111, v107, s21
    v_perm_b32 v204, v87, v83, s22
    v_perm_b32 v205, v95, v91, s22
    v_perm_b32 v206, v103, v99, s22
    v_perm_b32 v207, v111, v107, s22
    buffer_load_dwordx4 v[80:83], v10, s[12:15], s24 offen
    buffer_load_dwordx4 v[84:87], v10, s[12:15], s25 offen
    buffer_load_dwordx4 v[88:91], v10, s[12:15], s26 offen
    buffer_load_dwordx4 v[92:95], v10, s[12:15], s27 offen
    buffer_load_dwordx4 v[96:99], v10, s[12:15], s28 offen
    buffer_load_dwordx4 v[100:103], v10, s[12:15], s29 offen
    buffer_load_dwordx4 v[104:107], v10, s[12:15], s30 offen
    buffer_load_dwordx4 v[108:111], v10, s[12:15], s31 offen
    v_add_u32 v10, s23, v10
    v_accvgpr_write_b32 a192, v176
    v_accvgpr_write_b32 a193, v177
    v_accvgpr_write_b32 a194, v178
    v_accvgpr_write_b32 a195, v179
    v_accvgpr_write_b32 a196, v180
    v_accvgpr_write_b32 a197, v181
    v_accvgpr_write_b32 a198, v182
    v_accvgpr_write_b32 a199, v183
    v_accvgpr_write_b32 a200, v184
    v_accvgpr_write_b32 a201, v185
    v_accvgpr_write_b32 a202, v186
    v_accvgpr_write_b32 a203, v187
    v_accvgpr_write_b32 a204, v188
    v_accvgpr_write_b32 a205, v189
    v_accvgpr_write_b32 a206, v190
    v_accvgpr_write_b32 a207, v191
    v_accvgpr_write_b32 a208, v192
    v_accvgpr_write_b32 a209, v193
    v_accvgpr_write_b32 a210, v194
    v_accvgpr_write_b32 a211, v195
    v_accvgpr_write_b32 a212, v196
    v_accvgpr_write_b32 a213, v197
    v_accvgpr_write_b32 a214, v198
    v_accvgpr_write_b32 a215, v199
    v_accvgpr_write_b32 a216, v200
    v_accvgpr_write_b32 a217, v201
    v_accvgpr_write_b32 a218, v202
    v_accvgpr_write_b32 a219, v203
    v_accvgpr_write_b32 a220, v204
    v_accvgpr_write_b32 a221, v205
    v_accvgpr_write_b32 a222, v206
    v_accvgpr_write_b32 a223, v207
    s_waitcnt vmcnt(24)
    v_perm_b32 v176, v116, v112, s21
    v_perm_b32 v177, v124, v120, s21
    v_perm_b32 v178, v132, v128, s21
    v_perm_b32 v179, v140, v136, s21
    v_perm_b32 v180, v116, v112, s22
    v_perm_b32 v181, v124, v120, s22
    v_perm_b32 v182, v132, v128, s22
    v_perm_b32 v183, v140, v136, s22
    v_perm_b32 v184, v117, v113, s21
    v_perm_b32 v185, v125, v121, s21
    v_perm_b32 v186, v133, v129, s21
    v_perm_b32 v187, v141, v137, s21
    v_perm_b32 v188, v117, v113, s22
    v_perm_b32 v189, v125, v121, s22
    v_perm_b32 v190, v133, v129, s22
    v_perm_b32 v191, v141, v137, s22
    v_perm_b32 v192, v118, v114, s21
    v_perm_b32 v193, v126, v122, s21
    v_perm_b32 v194, v134, v130, s21
    v_perm_b32 v195, v142, v138, s21
    v_perm_b32 v196, v118, v114, s22
    v_perm_b32 v197, v126, v122, s22
    v_perm_b32 v198, v134, v130, s22
    v_perm_b32 v199, v142, v138, s22
    v_perm_b32 v200, v119, v115, s21
    v_perm_b32 v201, v127, v123, s21
    v_perm_b32 v202, v135, v131, s21
    v_perm_b32 v203, v143, v139, s21
    v_perm_b32 v204, v119, v115, s22
    v_perm_b32 v205, v127, v123, s22
    v_perm_b32 v206, v135, v131, s22
    v_perm_b32 v207, v143, v139, s22
    v_accvgpr_write_b32 a224, v176
    v_accvgpr_write_b32 a225, v177
    v_accvgpr_write_b32 a226, v178
    v_accvgpr_write_b32 a227, v179
    v_accvgpr_write_b32 a228, v180
    v_accvgpr_write_b32 a229, v181
    v_accvgpr_write_b32 a230, v182
    v_accvgpr_write_b32 a231, v183
    v_accvgpr_write_b32 a232, v184
    v_accvgpr_write_b32 a233, v185
    v_accvgpr_write_b32 a234, v186
    v_accvgpr_write_b32 a235, v187
    v_accvgpr_write_b32 a236, v188
    v_accvgpr_write_b32 a237, v189
    v_accvgpr_write_b32 a238, v190
    v_accvgpr_write_b32 a239, v191
    v_accvgpr_write_b32 a240, v192
    v_accvgpr_write_b32 a241, v193
    v_accvgpr_write_b32 a242, v194
    v_accvgpr_write_b32 a243, v195
    v_accvgpr_write_b32 a244, v196
    v_accvgpr_write_b32 a245, v197
    v_accvgpr_write_b32 a246, v198
    v_accvgpr_write_b32 a247, v199
    v_accvgpr_write_b32 a248, v200
    v_accvgpr_write_b32 a249, v201
    v_accvgpr_write_b32 a250, v202
    v_accvgpr_write_b32 a251, v203
    v_accvgpr_write_b32 a252, v204
    v_accvgpr_write_b32 a253, v205
    v_accvgpr_write_b32 a254, v206
    v_accvgpr_write_b32 a255, v207
    s_waitcnt vmcnt(16)
    v_perm_b32 v160, v20, v16, s21
    v_perm_b32 v161, v28, v24, s21
    v_perm_b32 v162, v36, v32, s21
    v_perm_b32 v163, v44, v40, s21
    v_perm_b32 v164, v20, v16, s22
    v_perm_b32 v165, v28, v24, s22
    v_perm_b32 v166, v36, v32, s22
    v_perm_b32 v167, v44, v40, s22
    v_perm_b32 v168, v21, v17, s21
    v_perm_b32 v169, v29, v25, s21
    v_perm_b32 v170, v37, v33, s21
    v_perm_b32 v171, v45, v41, s21
    v_perm_b32 v172, v21, v17, s22
    v_perm_b32 v173, v29, v25, s22
    v_perm_b32 v174, v37, v33, s22
    v_perm_b32 v175, v45, v41, s22
    v_perm_b32 v176, v22, v18, s21
    v_perm_b32 v177, v30, v26, s21
    v_perm_b32 v178, v38, v34, s21
    v_perm_b32 v179, v46, v42, s21
    v_perm_b32 v180, v22, v18, s22
    v_perm_b32 v181, v30, v26, s22
    v_perm_b32 v182, v38, v34, s22
    v_perm_b32 v183, v46, v42, s22
    v_perm_b32 v184, v23, v19, s21
    v_perm_b32 v185, v31, v27, s21
    v_perm_b32 v186, v39, v35, s21
    v_perm_b32 v187, v47, v43, s21
    v_perm_b32 v188, v23, v19, s22
    v_perm_b32 v189, v31, v27, s22
    v_perm_b32 v190, v39, v35, s22
    v_perm_b32 v191, v47, v43, s22
    s_waitcnt vmcnt(8)
    v_perm_b32 v192, v52, v48, s21
    v_perm_b32 v193, v60, v56, s21
    v_perm_b32 v194, v68, v64, s21
    v_perm_b32 v195, v76, v72, s21
    v_perm_b32 v196, v52, v48, s22
    v_perm_b32 v197, v60, v56, s22
    v_perm_b32 v198, v68, v64, s22
    v_perm_b32 v199, v76, v72, s22
    v_perm_b32 v200, v53, v49, s21
    v_perm_b32 v201, v61, v57, s21
    v_perm_b32 v202, v69, v65, s21
    v_perm_b32 v203, v77, v73, s21
    v_perm_b32 v204, v53, v49, s22
    v_perm_b32 v205, v61, v57, s22
    v_perm_b32 v206, v69, v65, s22
    v_perm_b32 v207, v77, v73, s22
    v_perm_b32 v208, v54, v50, s21
    v_perm_b32 v209, v62, v58, s21
    v_perm_b32 v210, v70, v66, s21
    v_perm_b32 v211, v78, v74, s21
    v_perm_b32 v212, v54, v50, s22
    v_perm_b32 v213, v62, v58, s22
    v_perm_b32 v214, v70, v66, s22
    v_perm_b32 v215, v78, v74, s22
    v_perm_b32 v216, v55, v51, s21
    v_perm_b32 v217, v63, v59, s21
    v_perm_b32 v218, v71, v67, s21
    v_perm_b32 v219, v79, v75, s21
    v_perm_b32 v220, v55, v51, s22
    v_perm_b32 v221, v63, v59, s22
    v_perm_b32 v222, v71, v67, s22
    v_perm_b32 v223, v79, v75, s22
    s_waitcnt vmcnt(0)
    v_perm_b32 v224, v84, v80, s21
    v_perm_b32 v225, v92, v88, s21
    v_perm_b32 v226, v100, v96, s21
    v_perm_b32 v227, v108, v104, s21
    v_perm_b32 v228, v84, v80, s22
    v_perm_b32 v229, v92, v88, s22
    v_perm_b32 v230, v100, v96, s22
    v_perm_b32 v231, v108, v104, s22
    v_perm_b32 v232, v85, v81, s21
    v_perm_b32 v233, v93, v89, s21
    v_perm_b32 v234, v101, v97, s21
    v_perm_b32 v235, v109, v105, s21
    v_perm_b32 v236, v85, v81, s22
    v_perm_b32 v237, v93, v89, s22
    v_perm_b32 v238, v101, v97, s22
    v_perm_b32 v239, v109, v105, s22
    v_perm_b32 v240, v86, v82, s21
    v_perm_b32 v241, v94, v90, s21
    v_perm_b32 v242, v102, v98, s21
    v_perm_b32 v243, v110, v106, s21
    v_perm_b32 v244, v86, v82, s22
    v_perm_b32 v245, v94, v90, s22
    v_perm_b32 v246, v102, v98, s22
    v_perm_b32 v247, v110, v106, s22
    v_perm_b32 v248, v87, v83, s21
    v_perm_b32 v249, v95, v91, s21
    v_perm_b32 v250, v103, v99, s21
    v_perm_b32 v251, v111, v107, s21
    v_perm_b32 v252, v87, v83, s22
    v_perm_b32 v253, v95, v91, s22
    v_perm_b32 v254, v103, v99, s22
    v_perm_b32 v255, v111, v107, s22
    s_nop 3
Ltl_76:
    s_mov_b32 s32, s63
    s_mov_b32 s33, s62
    s_mov_b32 s16, s90
    s_and_b32 s17, s91, 0xffff
    s_mov_b32 s18, 0x200000
    s_mov_b32 s19, 0x20000
    v_mul_u32_u24 v5, 2816, v2
    v_lshl_add_u32 v5, v3, 4, v5
    v_add_u32 v6, 45056, v5
    s_mul_i32 s39, s32, 90112
    s_mul_i32 s38, s4, 704
    s_add_u32 s39, s39, s38
    s_add_u32 s39, s39, 0x800000
    s_add_u32 s35, s32, 256
    s_lshl_b32 s35, s35, 6
Lw_77:
    buffer_load_dword v7, off, s[8:11], s35 sc1
    s_add_u32 s61, s61, 1
    s_cmp_gt_u32 s61, 0x40000
    s_cbranch_scc1 Lwd_78
    s_waitcnt vmcnt(0)
    v_readfirstlane_b32 s60, v7
    s_nop 3
    s_cmp_ge_u32 s60, 11
    s_cbranch_scc1 Lwd_78
    s_sleep 2
    s_branch Lw_77
Lwd_78:
    buffer_load_dwordx4 v[8:11], v5, s[8:11], s39 offen offset:0 sc1
    buffer_load_dwordx4 v[12:15], v6, s[8:11], s39 offen offset:0 sc1
    buffer_load_dwordx4 v[16:19], v5, s[8:11], s39 offen offset:64 sc1
    buffer_load_dwordx4 v[20:23], v6, s[8:11], s39 offen offset:64 sc1
    buffer_load_dwordx4 v[24:27], v5, s[8:11], s39 offen offset:128 sc1
    buffer_load_dwordx4 v[28:31], v6, s[8:11], s39 offen offset:128 sc1
    buffer_load_dwordx4 v[32:35], v5, s[8:11], s39 offen offset:192 sc1
    buffer_load_dwordx4 v[36:39], v6, s[8:11], s39 offen offset:192 sc1
    buffer_load_dwordx4 v[40:43], v5, s[8:11], s39 offen offset:256 sc1
    buffer_load_dwordx4 v[44:47], v6, s[8:11], s39 offen offset:256 sc1
    buffer_load_dwordx4 v[48:51], v5, s[8:11], s39 offen offset:320 sc1
    buffer_load_dwordx4 v[52:55], v6, s[8:11], s39 offen offset:320 sc1
    buffer_load_dwordx4 v[56:59], v5, s[8:11], s39 offen offset:384 sc1
    buffer_load_dwordx4 v[60:63], v6, s[8:11], s39 offen offset:384 sc1
    buffer_load_dwordx4 v[64:67], v5, s[8:11], s39 offen offset:448 sc1
    buffer_load_dwordx4 v[68:71], v6, s[8:11], s39 offen offset:448 sc1
    buffer_load_dwordx4 v[72:75], v5, s[8:11], s39 offen offset:512 sc1
    buffer_load_dwordx4 v[76:79], v6, s[8:11], s39 offen offset:512 sc1
    buffer_load_dwordx4 v[80:83], v5, s[8:11], s39 offen offset:576 sc1
    buffer_load_dwordx4 v[84:87], v6, s[8:11], s39 offen offset:576 sc1
    buffer_load_dwordx4 v[88:91], v5, s[8:11], s39 offen offset:640 sc1
    buffer_load_dwordx4 v[92:95], v6, s[8:11], s39 offen offset:640 sc1
    s_waitcnt vmcnt(20)
    v_mfma_f32_16x16x32_bf16 v[96:99], v[8:11], a[0:3], 0
    v_mfma_f32_16x16x32_bf16 v[128:131], v[12:15], a[0:3], 0
    v_mfma_f32_16x16x32_bf16 v[100:103], v[8:11], a[4:7], 0
    v_mfma_f32_16x16x32_bf16 v[132:135], v[12:15], a[4:7], 0
    v_mfma_f32_16x16x32_bf16 v[104:107], v[8:11], a[8:11], 0
    v_mfma_f32_16x16x32_bf16 v[136:139], v[12:15], a[8:11], 0
    v_mfma_f32_16x16x32_bf16 v[108:111], v[8:11], a[12:15], 0
    v_mfma_f32_16x16x32_bf16 v[140:143], v[12:15], a[12:15], 0
    v_mfma_f32_16x16x32_bf16 v[112:115], v[8:11], a[16:19], 0
    v_mfma_f32_16x16x32_bf16 v[144:147], v[12:15], a[16:19], 0
    v_mfma_f32_16x16x32_bf16 v[116:119], v[8:11], a[20:23], 0
    v_mfma_f32_16x16x32_bf16 v[148:151], v[12:15], a[20:23], 0
    v_mfma_f32_16x16x32_bf16 v[120:123], v[8:11], a[24:27], 0
    v_mfma_f32_16x16x32_bf16 v[152:155], v[12:15], a[24:27], 0
    v_mfma_f32_16x16x32_bf16 v[124:127], v[8:11], a[28:31], 0
    v_mfma_f32_16x16x32_bf16 v[156:159], v[12:15], a[28:31], 0
    s_waitcnt vmcnt(18)
    v_mfma_f32_16x16x32_bf16 v[96:99], v[16:19], a[32:35], v[96:99]
    v_mfma_f32_16x16x32_bf16 v[128:131], v[20:23], a[32:35], v[128:131]
    v_mfma_f32_16x16x32_bf16 v[100:103], v[16:19], a[36:39], v[100:103]
    v_mfma_f32_16x16x32_bf16 v[132:135], v[20:23], a[36:39], v[132:135]
    v_mfma_f32_16x16x32_bf16 v[104:107], v[16:19], a[40:43], v[104:107]
    v_mfma_f32_16x16x32_bf16 v[136:139], v[20:23], a[40:43], v[136:139]
    v_mfma_f32_16x16x32_bf16 v[108:111], v[16:19], a[44:47], v[108:111]
    v_mfma_f32_16x16x32_bf16 v[140:143], v[20:23], a[44:47], v[140:143]
    v_mfma_f32_16x16x32_bf16 v[112:115], v[16:19], a[48:51], v[112:115]
    v_mfma_f32_16x16x32_bf16 v[144:147], v[20:23], a[48:51], v[144:147]
    v_mfma_f32_16x16x32_bf16 v[116:119], v[16:19], a[52:55], v[116:119]
    v_mfma_f32_16x16x32_bf16 v[148:151], v[20:23], a[52:55], v[148:151]
    v_mfma_f32_16x16x32_bf16 v[120:123], v[16:19], a[56:59], v[120:123]
    v_mfma_f32_16x16x32_bf16 v[152:155], v[20:23], a[56:59], v[152:155]
    v_mfma_f32_16x16x32_bf16 v[124:127], v[16:19], a[60:63], v[124:127]
    v_mfma_f32_16x16x32_bf16 v[156:159], v[20:23], a[60:63], v[156:159]
    s_waitcnt vmcnt(16)
    v_mfma_f32_16x16x32_bf16 v[96:99], v[24:27], a[64:67], v[96:99]
    v_mfma_f32_16x16x32_bf16 v[128:131], v[28:31], a[64:67], v[128:131]
    v_mfma_f32_16x16x32_bf16 v[100:103], v[24:27], a[68:71], v[100:103]
    v_mfma_f32_16x16x32_bf16 v[132:135], v[28:31], a[68:71], v[132:135]
    v_mfma_f32_16x16x32_bf16 v[104:107], v[24:27], a[72:75], v[104:107]
    v_mfma_f32_16x16x32_bf16 v[136:139], v[28:31], a[72:75], v[136:139]
    v_mfma_f32_16x16x32_bf16 v[108:111], v[24:27], a[76:79], v[108:111]
    v_mfma_f32_16x16x32_bf16 v[140:143], v[28:31], a[76:79], v[140:143]
    v_mfma_f32_16x16x32_bf16 v[112:115], v[24:27], a[80:83], v[112:115]
    v_mfma_f32_16x16x32_bf16 v[144:147], v[28:31], a[80:83], v[144:147]
    v_mfma_f32_16x16x32_bf16 v[116:119], v[24:27], a[84:87], v[116:119]
    v_mfma_f32_16x16x32_bf16 v[148:151], v[28:31], a[84:87], v[148:151]
    v_mfma_f32_16x16x32_bf16 v[120:123], v[24:27], a[88:91], v[120:123]
    v_mfma_f32_16x16x32_bf16 v[152:155], v[28:31], a[88:91], v[152:155]
    v_mfma_f32_16x16x32_bf16 v[124:127], v[24:27], a[92:95], v[124:127]
    v_mfma_f32_16x16x32_bf16 v[156:159], v[28:31], a[92:95], v[156:159]
    s_waitcnt vmcnt(14)
    v_mfma_f32_16x16x32_bf16 v[96:99], v[32:35], a[96:99], v[96:99]
    v_mfma_f32_16x16x32_bf16 v[128:131], v[36:39], a[96:99], v[128:131]
    v_mfma_f32_16x16x32_bf16 v[100:103], v[32:35], a[100:103], v[100:103]
    v_mfma_f32_16x16x32_bf16 v[132:135], v[36:39], a[100:103], v[132:135]
    v_mfma_f32_16x16x32_bf16 v[104:107], v[32:35], a[104:107], v[104:107]
    v_mfma_f32_16x16x32_bf16 v[136:139], v[36:39], a[104:107], v[136:139]
    v_mfma_f32_16x16x32_bf16 v[108:111], v[32:35], a[108:111], v[108:111]
    v_mfma_f32_16x16x32_bf16 v[140:143], v[36:39], a[108:111], v[140:143]
    v_mfma_f32_16x16x32_bf16 v[112:115], v[32:35], a[112:115], v[112:115]
    v_mfma_f32_16x16x32_bf16 v[144:147], v[36:39], a[112:115], v[144:147]
    v_mfma_f32_16x16x32_bf16 v[116:119], v[32:35], a[116:119], v[116:119]
    v_mfma_f32_16x16x32_bf16 v[148:151], v[36:39], a[116:119], v[148:151]
    v_mfma_f32_16x16x32_bf16 v[120:123], v[32:35], a[120:123], v[120:123]
    v_mfma_f32_16x16x32_bf16 v[152:155], v[36:39], a[120:123], v[152:155]
    v_mfma_f32_16x16x32_bf16 v[124:127], v[32:35], a[124:127], v[124:127]
    v_mfma_f32_16x16x32_bf16 v[156:159], v[36:39], a[124:127], v[156:159]
    s_waitcnt vmcnt(12)
    v_mfma_f32_16x16x32_bf16 v[96:99], v[40:43], a[128:131], v[96:99]
    v_mfma_f32_16x16x32_bf16 v[128:131], v[44:47], a[128:131], v[128:131]
    v_mfma_f32_16x16x32_bf16 v[100:103], v[40:43], a[132:135], v[100:103]
    v_mfma_f32_16x16x32_bf16 v[132:135], v[44:47], a[132:135], v[132:135]
    v_mfma_f32_16x16x32_bf16 v[104:107], v[40:43], a[136:139], v[104:107]
    v_mfma_f32_16x16x32_bf16 v[136:139], v[44:47], a[136:139], v[136:139]
    v_mfma_f32_16x16x32_bf16 v[108:111], v[40:43], a[140:143], v[108:111]
    v_mfma_f32_16x16x32_bf16 v[140:143], v[44:47], a[140:143], v[140:143]
    v_mfma_f32_16x16x32_bf16 v[112:115], v[40:43], a[144:147], v[112:115]
    v_mfma_f32_16x16x32_bf16 v[144:147], v[44:47], a[144:147], v[144:147]
    v_mfma_f32_16x16x32_bf16 v[116:119], v[40:43], a[148:151], v[116:119]
    v_mfma_f32_16x16x32_bf16 v[148:151], v[44:47], a[148:151], v[148:151]
    v_mfma_f32_16x16x32_bf16 v[120:123], v[40:43], a[152:155], v[120:123]
    v_mfma_f32_16x16x32_bf16 v[152:155], v[44:47], a[152:155], v[152:155]
    v_mfma_f32_16x16x32_bf16 v[124:127], v[40:43], a[156:159], v[124:127]
    v_mfma_f32_16x16x32_bf16 v[156:159], v[44:47], a[156:159], v[156:159]
    s_waitcnt vmcnt(10)
    v_mfma_f32_16x16x32_bf16 v[96:99], v[48:51], a[160:163], v[96:99]
    v_mfma_f32_16x16x32_bf16 v[128:131], v[52:55], a[160:163], v[128:131]
    v_mfma_f32_16x16x32_bf16 v[100:103], v[48:51], a[164:167], v[100:103]
    v_mfma_f32_16x16x32_bf16 v[132:135], v[52:55], a[164:167], v[132:135]
    v_mfma_f32_16x16x32_bf16 v[104:107], v[48:51], a[168:171], v[104:107]
    v_mfma_f32_16x16x32_bf16 v[136:139], v[52:55], a[168:171], v[136:139]
    v_mfma_f32_16x16x32_bf16 v[108:111], v[48:51], a[172:175], v[108:111]
    v_mfma_f32_16x16x32_bf16 v[140:143], v[52:55], a[172:175], v[140:143]
    v_mfma_f32_16x16x32_bf16 v[112:115], v[48:51], a[176:179], v[112:115]
    v_mfma_f32_16x16x32_bf16 v[144:147], v[52:55], a[176:179], v[144:147]
    v_mfma_f32_16x16x32_bf16 v[116:119], v[48:51], a[180:183], v[116:119]
    v_mfma_f32_16x16x32_bf16 v[148:151], v[52:55], a[180:183], v[148:151]
    v_mfma_f32_16x16x32_bf16 v[120:123], v[48:51], a[184:187], v[120:123]
    v_mfma_f32_16x16x32_bf16 v[152:155], v[52:55], a[184:187], v[152:155]
    v_mfma_f32_16x16x32_bf16 v[124:127], v[48:51], a[188:191], v[124:127]
    v_mfma_f32_16x16x32_bf16 v[156:159], v[52:55], a[188:191], v[156:159]
    s_waitcnt vmcnt(8)
    v_mfma_f32_16x16x32_bf16 v[96:99], v[56:59], a[192:195], v[96:99]
    v_mfma_f32_16x16x32_bf16 v[128:131], v[60:63], a[192:195], v[128:131]
    v_mfma_f32_16x16x32_bf16 v[100:103], v[56:59], a[196:199], v[100:103]
    v_mfma_f32_16x16x32_bf16 v[132:135], v[60:63], a[196:199], v[132:135]
    v_mfma_f32_16x16x32_bf16 v[104:107], v[56:59], a[200:203], v[104:107]
    v_mfma_f32_16x16x32_bf16 v[136:139], v[60:63], a[200:203], v[136:139]
    v_mfma_f32_16x16x32_bf16 v[108:111], v[56:59], a[204:207], v[108:111]
    v_mfma_f32_16x16x32_bf16 v[140:143], v[60:63], a[204:207], v[140:143]
    v_mfma_f32_16x16x32_bf16 v[112:115], v[56:59], a[208:211], v[112:115]
    v_mfma_f32_16x16x32_bf16 v[144:147], v[60:63], a[208:211], v[144:147]
    v_mfma_f32_16x16x32_bf16 v[116:119], v[56:59], a[212:215], v[116:119]
    v_mfma_f32_16x16x32_bf16 v[148:151], v[60:63], a[212:215], v[148:151]
    v_mfma_f32_16x16x32_bf16 v[120:123], v[56:59], a[216:219], v[120:123]
    v_mfma_f32_16x16x32_bf16 v[152:155], v[60:63], a[216:219], v[152:155]
    v_mfma_f32_16x16x32_bf16 v[124:127], v[56:59], a[220:223], v[124:127]
    v_mfma_f32_16x16x32_bf16 v[156:159], v[60:63], a[220:223], v[156:159]
    s_waitcnt vmcnt(6)
    v_mfma_f32_16x16x32_bf16 v[96:99], v[64:67], a[224:227], v[96:99]
    v_mfma_f32_16x16x32_bf16 v[128:131], v[68:71], a[224:227], v[128:131]
    v_mfma_f32_16x16x32_bf16 v[100:103], v[64:67], a[228:231], v[100:103]
    v_mfma_f32_16x16x32_bf16 v[132:135], v[68:71], a[228:231], v[132:135]
    v_mfma_f32_16x16x32_bf16 v[104:107], v[64:67], a[232:235], v[104:107]
    v_mfma_f32_16x16x32_bf16 v[136:139], v[68:71], a[232:235], v[136:139]
    v_mfma_f32_16x16x32_bf16 v[108:111], v[64:67], a[236:239], v[108:111]
    v_mfma_f32_16x16x32_bf16 v[140:143], v[68:71], a[236:239], v[140:143]
    v_mfma_f32_16x16x32_bf16 v[112:115], v[64:67], a[240:243], v[112:115]
    v_mfma_f32_16x16x32_bf16 v[144:147], v[68:71], a[240:243], v[144:147]
    v_mfma_f32_16x16x32_bf16 v[116:119], v[64:67], a[244:247], v[116:119]
    v_mfma_f32_16x16x32_bf16 v[148:151], v[68:71], a[244:247], v[148:151]
    v_mfma_f32_16x16x32_bf16 v[120:123], v[64:67], a[248:251], v[120:123]
    v_mfma_f32_16x16x32_bf16 v[152:155], v[68:71], a[248:251], v[152:155]
    v_mfma_f32_16x16x32_bf16 v[124:127], v[64:67], a[252:255], v[124:127]
    v_mfma_f32_16x16x32_bf16 v[156:159], v[68:71], a[252:255], v[156:159]
    s_waitcnt vmcnt(4)
    v_mfma_f32_16x16x32_bf16 v[96:99], v[72:75], v[160:163], v[96:99]
    v_mfma_f32_16x16x32_bf16 v[128:131], v[76:79], v[160:163], v[128:131]
    v_mfma_f32_16x16x32_bf16 v[100:103], v[72:75], v[164:167], v[100:103]
    v_mfma_f32_16x16x32_bf16 v[132:135], v[76:79], v[164:167], v[132:135]
    v_mfma_f32_16x16x32_bf16 v[104:107], v[72:75], v[168:171], v[104:107]
    v_mfma_f32_16x16x32_bf16 v[136:139], v[76:79], v[168:171], v[136:139]
    v_mfma_f32_16x16x32_bf16 v[108:111], v[72:75], v[172:175], v[108:111]
    v_mfma_f32_16x16x32_bf16 v[140:143], v[76:79], v[172:175], v[140:143]
    v_mfma_f32_16x16x32_bf16 v[112:115], v[72:75], v[176:179], v[112:115]
    v_mfma_f32_16x16x32_bf16 v[144:147], v[76:79], v[176:179], v[144:147]
    v_mfma_f32_16x16x32_bf16 v[116:119], v[72:75], v[180:183], v[116:119]
    v_mfma_f32_16x16x32_bf16 v[148:151], v[76:79], v[180:183], v[148:151]
    v_mfma_f32_16x16x32_bf16 v[120:123], v[72:75], v[184:187], v[120:123]
    v_mfma_f32_16x16x32_bf16 v[152:155], v[76:79], v[184:187], v[152:155]
    v_mfma_f32_16x16x32_bf16 v[124:127], v[72:75], v[188:191], v[124:127]
    v_mfma_f32_16x16x32_bf16 v[156:159], v[76:79], v[188:191], v[156:159]
    s_waitcnt vmcnt(2)
    v_mfma_f32_16x16x32_bf16 v[96:99], v[80:83], v[192:195], v[96:99]
    v_mfma_f32_16x16x32_bf16 v[128:131], v[84:87], v[192:195], v[128:131]
    v_mfma_f32_16x16x32_bf16 v[100:103], v[80:83], v[196:199], v[100:103]
    v_mfma_f32_16x16x32_bf16 v[132:135], v[84:87], v[196:199], v[132:135]
    v_mfma_f32_16x16x32_bf16 v[104:107], v[80:83], v[200:203], v[104:107]
    v_mfma_f32_16x16x32_bf16 v[136:139], v[84:87], v[200:203], v[136:139]
    v_mfma_f32_16x16x32_bf16 v[108:111], v[80:83], v[204:207], v[108:111]
    v_mfma_f32_16x16x32_bf16 v[140:143], v[84:87], v[204:207], v[140:143]
    v_mfma_f32_16x16x32_bf16 v[112:115], v[80:83], v[208:211], v[112:115]
    v_mfma_f32_16x16x32_bf16 v[144:147], v[84:87], v[208:211], v[144:147]
    v_mfma_f32_16x16x32_bf16 v[116:119], v[80:83], v[212:215], v[116:119]
    v_mfma_f32_16x16x32_bf16 v[148:151], v[84:87], v[212:215], v[148:151]
    v_mfma_f32_16x16x32_bf16 v[120:123], v[80:83], v[216:219], v[120:123]
    v_mfma_f32_16x16x32_bf16 v[152:155], v[84:87], v[216:219], v[152:155]
    v_mfma_f32_16x16x32_bf16 v[124:127], v[80:83], v[220:223], v[124:127]
    v_mfma_f32_16x16x32_bf16 v[156:159], v[84:87], v[220:223], v[156:159]
    s_waitcnt vmcnt(0)
    v_mfma_f32_16x16x32_bf16 v[96:99], v[88:91], v[224:227], v[96:99]
    v_mfma_f32_16x16x32_bf16 v[128:131], v[92:95], v[224:227], v[128:131]
    v_mfma_f32_16x16x32_bf16 v[100:103], v[88:91], v[228:231], v[100:103]
    v_mfma_f32_16x16x32_bf16 v[132:135], v[92:95], v[228:231], v[132:135]
    v_mfma_f32_16x16x32_bf16 v[104:107], v[88:91], v[232:235], v[104:107]
    v_mfma_f32_16x16x32_bf16 v[136:139], v[92:95], v[232:235], v[136:139]
    v_mfma_f32_16x16x32_bf16 v[108:111], v[88:91], v[236:239], v[108:111]
    v_mfma_f32_16x16x32_bf16 v[140:143], v[92:95], v[236:239], v[140:143]
    v_mfma_f32_16x16x32_bf16 v[112:115], v[88:91], v[240:243], v[112:115]
    v_mfma_f32_16x16x32_bf16 v[144:147], v[92:95], v[240:243], v[144:147]
    v_mfma_f32_16x16x32_bf16 v[116:119], v[88:91], v[244:247], v[116:119]
    v_mfma_f32_16x16x32_bf16 v[148:151], v[92:95], v[244:247], v[148:151]
    v_mfma_f32_16x16x32_bf16 v[120:123], v[88:91], v[248:251], v[120:123]
    v_mfma_f32_16x16x32_bf16 v[152:155], v[92:95], v[248:251], v[152:155]
    v_mfma_f32_16x16x32_bf16 v[124:127], v[88:91], v[252:255], v[124:127]
    v_mfma_f32_16x16x32_bf16 v[156:159], v[92:95], v[252:255], v[156:159]
    s_nop 7
    s_nop 7
    s_lshr_b32 s40, s4, 1
    s_lshl_b32 s40, s40, 4
    s_and_b32 s41, s4, 1
    s_lshl_b32 s41, s41, 1
    s_add_u32 s40, s40, s41
    s_lshl_b32 s41, s32, 5
    s_add_u32 s40, s40, s41
    v_lshlrev_b32 v12, 12, v3
    v_lshl_add_u32 v12, v2, 4, v12
    s_lshl_b32 s41, s40, 10
    s_lshl_b32 s42, s33, 8
    s_add_u32 s41, s41, s42
    s_add_u32 s43, s41, 0x400000
    buffer_load_dwordx4 v[48:51], v12, s[8:11], s43 offen offset:0 sc1
    buffer_load_dwordx4 v[52:55], v12, s[8:11], s43 offen offset:1024 sc1
    v_lshlrev_b32 v13, 5, v2
    s_lshl_b32 s42, s33, 9
    s_add_u32 s42, s42, 0xa800
    buffer_load_dwordx4 v[56:59], v13, s[8:11], s42 offen
    buffer_load_dwordx4 v[60:63], v13, s[8:11], s42 offen offset:16
    s_lshl_b32 s49, s4, 14
    v_lshlrev_b32 v8, 4, v1
    v_add_u32 v9, s49, v8
    v_mov_b32 v16, v96
    v_mov_b32 v17, v100
    v_mov_b32 v18, v104
    v_mov_b32 v19, v108
    v_mov_b32 v20, v112
    v_mov_b32 v21, v116
    v_mov_b32 v22, v120
    v_mov_b32 v23, v124
    ds_write_b128 v9, v[16:19] offset:0
    ds_write_b128 v9, v[20:23] offset:1024
    v_mov_b32 v24, v97
    v_mov_b32 v25, v101
    v_mov_b32 v26, v105
    v_mov_b32 v27, v109
    v_mov_b32 v28, v113
    v_mov_b32 v29, v117
    v_mov_b32 v30, v121
    v_mov_b32 v31, v125
    ds_write_b128 v9, v[24:27] offset:2048
    ds_write_b128 v9, v[28:31] offset:3072
    v_mov_b32 v32, v98
    v_mov_b32 v33, v102
    v_mov_b32 v34, v106
    v_mov_b32 v35, v110
    v_mov_b32 v36, v114
    v_mov_b32 v37, v118
    v_mov_b32 v38, v122
    v_mov_b32 v39, v126
    ds_write_b128 v9, v[32:35] offset:4096
    ds_write_b128 v9, v[36:39] offset:5120
    v_mov_b32 v40, v99
    v_mov_b32 v41, v103
    v_mov_b32 v42, v107
    v_mov_b32 v43, v111
    v_mov_b32 v44, v115
    v_mov_b32 v45, v119
    v_mov_b32 v46, v123
    v_mov_b32 v47, v127
    ds_write_b128 v9, v[40:43] offset:6144
    ds_write_b128 v9, v[44:47] offset:7168
    v_mov_b32 v16, v128
    v_mov_b32 v17, v132
    v_mov_b32 v18, v136
    v_mov_b32 v19, v140
    v_mov_b32 v20, v144
    v_mov_b32 v21, v148
    v_mov_b32 v22, v152
    v_mov_b32 v23, v156
    ds_write_b128 v9, v[16:19] offset:8192
    ds_write_b128 v9, v[20:23] offset:9216
    v_mov_b32 v24, v129
    v_mov_b32 v25, v133
    v_mov_b32 v26, v137
    v_mov_b32 v27, v141
    v_mov_b32 v28, v145
    v_mov_b32 v29, v149
    v_mov_b32 v30, v153
    v_mov_b32 v31, v157
    ds_write_b128 v9, v[24:27] offset:10240
    ds_write_b128 v9, v[28:31] offset:11264
    v_mov_b32 v32, v130
    v_mov_b32 v33, v134
    v_mov_b32 v34, v138
    v_mov_b32 v35, v142
    v_mov_b32 v36, v146
    v_mov_b32 v37, v150
    v_mov_b32 v38, v154
    v_mov_b32 v39, v158
    ds_write_b128 v9, v[32:35] offset:12288
    ds_write_b128 v9, v[36:39] offset:13312
    v_mov_b32 v40, v131
    v_mov_b32 v41, v135
    v_mov_b32 v42, v139
    v_mov_b32 v43, v143
    v_mov_b32 v44, v147
    v_mov_b32 v45, v151
    v_mov_b32 v46, v155
    v_mov_b32 v47, v159
    ds_write_b128 v9, v[40:43] offset:14336
    ds_write_b128 v9, v[44:47] offset:15360
    s_waitcnt lgkmcnt(0)
    s_barrier
    s_lshl_b32 s49, s4, 12
    v_add_u32 v9, s49, v8
    v_add_u32 v11, 0x8000, v9
    ds_read_b128 v[64:67], v9 offset:0
    ds_read_b128 v[68:71], v9 offset:1024
    ds_read_b128 v[72:75], v9 offset:16384
    ds_read_b128 v[76:79], v9 offset:17408
    ds_read_b128 v[80:83], v11 offset:0
    ds_read_b128 v[84:87], v11 offset:1024
    ds_read_b128 v[88:91], v11 offset:16384
    ds_read_b128 v[92:95], v11 offset:17408
    ds_read_b128 v[96:99], v9 offset:2048
    ds_read_b128 v[100:103], v9 offset:3072
    ds_read_b128 v[104:107], v9 offset:18432
    ds_read_b128 v[108:111], v9 offset:19456
    ds_read_b128 v[112:115], v11 offset:2048
    ds_read_b128 v[116:119], v11 offset:3072
    ds_read_b128 v[120:123], v11 offset:18432
    ds_read_b128 v[124:127], v11 offset:19456
    s_waitcnt vmcnt(0) lgkmcnt(0)
    v_lshlrev_b32 v16, 16, v48
    v_and_b32 v17, 0xffff0000, v48
    v_lshlrev_b32 v18, 16, v49
    v_and_b32 v19, 0xffff0000, v49
    v_lshlrev_b32 v20, 16, v50
    v_and_b32 v21, 0xffff0000, v50
    v_lshlrev_b32 v22, 16, v51
    v_and_b32 v23, 0xffff0000, v51
    v_add_f32 v64, v64, v72
    v_add_f32 v80, v80, v88
    v_add_f32 v64, v64, v80
    v_cvt_pk_bf16_f32 v64, v64, v64
    v_lshlrev_b32 v64, 16, v64
    v_mul_f32 v64, v64, v56
    v_cvt_pk_bf16_f32 v64, v64, v64
    v_lshlrev_b32 v64, 16, v64
    v_add_f32 v64, v64, v16
    v_add_f32 v65, v65, v73
    v_add_f32 v81, v81, v89
    v_add_f32 v65, v65, v81
    v_cvt_pk_bf16_f32 v65, v65, v65
    v_lshlrev_b32 v65, 16, v65
    v_mul_f32 v65, v65, v57
    v_cvt_pk_bf16_f32 v65, v65, v65
    v_lshlrev_b32 v65, 16, v65
    v_add_f32 v65, v65, v17
    v_add_f32 v66, v66, v74
    v_add_f32 v82, v82, v90
    v_add_f32 v66, v66, v82
    v_cvt_pk_bf16_f32 v66, v66, v66
    v_lshlrev_b32 v66, 16, v66
    v_mul_f32 v66, v66, v58
    v_cvt_pk_bf16_f32 v66, v66, v66
    v_lshlrev_b32 v66, 16, v66
    v_add_f32 v66, v66, v18
    v_add_f32 v67, v67, v75
    v_add_f32 v83, v83, v91
    v_add_f32 v67, v67, v83
    v_cvt_pk_bf16_f32 v67, v67, v67
    v_lshlrev_b32 v67, 16, v67
    v_mul_f32 v67, v67, v59
    v_cvt_pk_bf16_f32 v67, v67, v67
    v_lshlrev_b32 v67, 16, v67
    v_add_f32 v67, v67, v19
    v_add_f32 v68, v68, v76
    v_add_f32 v84, v84, v92
    v_add_f32 v68, v68, v84
    v_cvt_pk_bf16_f32 v68, v68, v68
    v_lshlrev_b32 v68, 16, v68
    v_mul_f32 v68, v68, v60
    v_cvt_pk_bf16_f32 v68, v68, v68
    v_lshlrev_b32 v68, 16, v68
    v_add_f32 v68, v68, v20
    v_add_f32 v69, v69, v77
    v_add_f32 v85, v85, v93
    v_add_f32 v69, v69, v85
    v_cvt_pk_bf16_f32 v69, v69, v69
    v_lshlrev_b32 v69, 16, v69
    v_mul_f32 v69, v69, v61
    v_cvt_pk_bf16_f32 v69, v69, v69
    v_lshlrev_b32 v69, 16, v69
    v_add_f32 v69, v69, v21
    v_add_f32 v70, v70, v78
    v_add_f32 v86, v86, v94
    v_add_f32 v70, v70, v86
    v_cvt_pk_bf16_f32 v70, v70, v70
    v_lshlrev_b32 v70, 16, v70
    v_mul_f32 v70, v70, v62
    v_cvt_pk_bf16_f32 v70, v70, v70
    v_lshlrev_b32 v70, 16, v70
    v_add_f32 v70, v70, v22
    v_add_f32 v71, v71, v79
    v_add_f32 v87, v87, v95
    v_add_f32 v71, v71, v87
    v_cvt_pk_bf16_f32 v71, v71, v71
    v_lshlrev_b32 v71, 16, v71
    v_mul_f32 v71, v71, v63
    v_cvt_pk_bf16_f32 v71, v71, v71
    v_lshlrev_b32 v71, 16, v71
    v_add_f32 v71, v71, v23
    v_cvt_pk_bf16_f32 v32, v64, v65
    v_cvt_pk_bf16_f32 v33, v66, v67
    v_cvt_pk_bf16_f32 v34, v68, v69
    v_cvt_pk_bf16_f32 v35, v70, v71
    buffer_store_dwordx4 v[32:35], v12, s[16:19], s41 offen offset:0
    v_lshlrev_b32 v16, 16, v52
    v_and_b32 v17, 0xffff0000, v52
    v_lshlrev_b32 v18, 16, v53
    v_and_b32 v19, 0xffff0000, v53
    v_lshlrev_b32 v20, 16, v54
    v_and_b32 v21, 0xffff0000, v54
    v_lshlrev_b32 v22, 16, v55
    v_and_b32 v23, 0xffff0000, v55
    v_add_f32 v96, v96, v104
    v_add_f32 v112, v112, v120
    v_add_f32 v96, v96, v112
    v_cvt_pk_bf16_f32 v96, v96, v96
    v_lshlrev_b32 v96, 16, v96
    v_mul_f32 v96, v96, v56
    v_cvt_pk_bf16_f32 v96, v96, v96
    v_lshlrev_b32 v96, 16, v96
    v_add_f32 v96, v96, v16
    v_add_f32 v97, v97, v105
    v_add_f32 v113, v113, v121
    v_add_f32 v97, v97, v113
    v_cvt_pk_bf16_f32 v97, v97, v97
    v_lshlrev_b32 v97, 16, v97
    v_mul_f32 v97, v97, v57
    v_cvt_pk_bf16_f32 v97, v97, v97
    v_lshlrev_b32 v97, 16, v97
    v_add_f32 v97, v97, v17
    v_add_f32 v98, v98, v106
    v_add_f32 v114, v114, v122
    v_add_f32 v98, v98, v114
    v_cvt_pk_bf16_f32 v98, v98, v98
    v_lshlrev_b32 v98, 16, v98
    v_mul_f32 v98, v98, v58
    v_cvt_pk_bf16_f32 v98, v98, v98
    v_lshlrev_b32 v98, 16, v98
    v_add_f32 v98, v98, v18
    v_add_f32 v99, v99, v107
    v_add_f32 v115, v115, v123
    v_add_f32 v99, v99, v115
    v_cvt_pk_bf16_f32 v99, v99, v99
    v_lshlrev_b32 v99, 16, v99
    v_mul_f32 v99, v99, v59
    v_cvt_pk_bf16_f32 v99, v99, v99
    v_lshlrev_b32 v99, 16, v99
    v_add_f32 v99, v99, v19
    v_add_f32 v100, v100, v108
    v_add_f32 v116, v116, v124
    v_add_f32 v100, v100, v116
    v_cvt_pk_bf16_f32 v100, v100, v100
    v_lshlrev_b32 v100, 16, v100
    v_mul_f32 v100, v100, v60
    v_cvt_pk_bf16_f32 v100, v100, v100
    v_lshlrev_b32 v100, 16, v100
    v_add_f32 v100, v100, v20
    v_add_f32 v101, v101, v109
    v_add_f32 v117, v117, v125
    v_add_f32 v101, v101, v117
    v_cvt_pk_bf16_f32 v101, v101, v101
    v_lshlrev_b32 v101, 16, v101
    v_mul_f32 v101, v101, v61
    v_cvt_pk_bf16_f32 v101, v101, v101
    v_lshlrev_b32 v101, 16, v101
    v_add_f32 v101, v101, v21
    v_add_f32 v102, v102, v110
    v_add_f32 v118, v118, v126
    v_add_f32 v102, v102, v118
    v_cvt_pk_bf16_f32 v102, v102, v102
    v_lshlrev_b32 v102, 16, v102
    v_mul_f32 v102, v102, v62
    v_cvt_pk_bf16_f32 v102, v102, v102
    v_lshlrev_b32 v102, 16, v102
    v_add_f32 v102, v102, v22
    v_add_f32 v103, v103, v111
    v_add_f32 v119, v119, v127
    v_add_f32 v103, v103, v119
    v_cvt_pk_bf16_f32 v103, v103, v103
    v_lshlrev_b32 v103, 16, v103
    v_mul_f32 v103, v103, v63
    v_cvt_pk_bf16_f32 v103, v103, v103
    v_lshlrev_b32 v103, 16, v103
    v_add_f32 v103, v103, v23
    v_cvt_pk_bf16_f32 v36, v96, v97
    v_cvt_pk_bf16_f32 v37, v98, v99
    v_cvt_pk_bf16_f32 v38, v100, v101
    v_cvt_pk_bf16_f32 v39, v102, v103
    buffer_store_dwordx4 v[36:39], v12, s[16:19], s41 offen offset:1024
    s_waitcnt vmcnt(0) lgkmcnt(0)
    s_barrier
    s_add_u32 s63, s63, 5
    s_cmp_lt_u32 s63, 64
    s_cbranch_scc1 Ltl_76
    s_branch Lwend_59
Lrole_75:
    s_cmp_ge_u32 s5, 219
    s_cbranch_scc1 Lrole_79
    s_sub_u32 s62, s5, 171
    s_mul_hi_u32 s63, s62, 0x20000000
    s_mul_i32 s33, s63, 8
    s_sub_u32 s62, s62, s33
    s_mov_b32 s33, s62
Ltl_80:
    s_mov_b32 s32, s63
    s_mov_b32 s33, s62
    s_mov_b32 s16, s64
    s_and_b32 s17, s65, 0xffff
    s_mov_b32 s18, 0x200000
    s_mov_b32 s19, 0x20000
    v_lshlrev_b32 v4, 5, v1
    v_lshlrev_b32 v5, 4, v1
    v_lshlrev_b32 v6, 9, v3
    v_lshl_add_u32 v6, v2, 4, v6
    s_lshl_b32 s36, s33, 2
    s_add_u32 s36, s36, s4
    s_lshl_b32 s37, s32, 5
    s_add_u32 s37, s37, s36
    s_lshl_b32 s37, s37, 10
    s_mov_b32 s20, 0x9000
    buffer_load_dwordx4 v[16:19], v4, s[8:11], s20 offen
    buffer_load_dwordx4 v[20:23], v4, s[8:11], s20 offen offset:16
    s_mov_b32 s20, 0xa000
    buffer_load_dwordx4 v[24:27], v4, s[8:11], s20 offen
    buffer_load_dwordx4 v[28:31], v4, s[8:11], s20 offen offset:16
    s_mov_b32 s20, 0x9800
    buffer_load_dwordx4 v[32:35], v4, s[8:11], s20 offen
    buffer_load_dwordx4 v[36:39], v4, s[8:11], s20 offen offset:16
    buffer_load_dwordx4 v[40:43], v5, s[16:19], s37 offen
    s_add_u32 s35, s32, 128
    s_lshl_b32 s35, s35, 6
Lw_81:
    buffer_load_dword v7, off, s[8:11], s35 sc1
    s_add_u32 s61, s61, 1
    s_cmp_gt_u32 s61, 0x40000
    s_cbranch_scc1 Lwd_82
    s_waitcnt vmcnt(0)
    v_readfirstlane_b32 s60, v7
    s_nop 3
    s_cmp_ge_u32 s60, 16
    s_cbranch_scc1 Lwd_82
    s_sleep 2
    s_branch Lw_81
Lwd_82:
    s_lshl_b32 s38, s32, 20
    s_lshl_b32 s39, s36, 11
    s_add_u32 s38, s38, s39
    s_add_u32 s38, s38, 0x5000000
    buffer_load_dwordx4 v[64:67], v6, s[8:11], s38 offen sc1
    buffer_load_dwordx4 v[68:71], v6, s[8:11], s38 offen offset:256 sc1
    s_add_u32 s38, s38, 0x10000
    buffer_load_dwordx4 v[72:75], v6, s[8:11], s38 offen sc1
    buffer_load_dwordx4 v[76:79], v6, s[8:11], s38 offen offset:256 sc1
    s_add_u32 s38, s38, 0x10000
    buffer_load_dwordx4 v[80:83], v6, s[8:11], s38 offen sc1
    buffer_load_dwordx4 v[84:87], v6, s[8:11], s38 offen offset:256 sc1
    s_add_u32 s38, s38, 0x10000
    buffer_load_dwordx4 v[88:91], v6, s[8:11], s38 offen sc1
    buffer_load_dwordx4 v[92:95], v6, s[8:11], s38 offen offset:256 sc1
    s_add_u32 s38, s38, 0x10000
    buffer_load_dwordx4 v[96:99], v6, s[8:11], s38 offen sc1
    buffer_load_dwordx4 v[100:103], v6, s[8:11], s38 offen offset:256 sc1
    s_add_u32 s38, s38, 0x10000
    buffer_load_dwordx4 v[104:107], v6, s[8:11], s38 offen sc1
    buffer_load_dwordx4 v[108:111], v6, s[8:11], s38 offen offset:256 sc1
    s_add_u32 s38, s38, 0x10000
    buffer_load_dwordx4 v[112:115], v6, s[8:11], s38 offen sc1
    buffer_load_dwordx4 v[116:119], v6, s[8:11], s38 offen offset:256 sc1
    s_add_u32 s38, s38, 0x10000
    buffer_load_dwordx4 v[120:123], v6, s[8:11], s38 offen sc1
    buffer_load_dwordx4 v[124:127], v6, s[8:11], s38 offen offset:256 sc1
    s_add_u32 s38, s38, 0x10000
    buffer_load_dwordx4 v[128:131], v6, s[8:11], s38 offen sc1
    buffer_load_dwordx4 v[132:135], v6, s[8:11], s38 offen offset:256 sc1
    s_add_u32 s38, s38, 0x10000
    buffer_load_dwordx4 v[136:139], v6, s[8:11], s38 offen sc1
    buffer_load_dwordx4 v[140:143], v6, s[8:11], s38 offen offset:256 sc1
    s_add_u32 s38, s38, 0x10000
    buffer_load_dwordx4 v[144:147], v6, s[8:11], s38 offen sc1
    buffer_load_dwordx4 v[148:151], v6, s[8:11], s38 offen offset:256 sc1
    s_add_u32 s38, s38, 0x10000
    buffer_load_dwordx4 v[152:155], v6, s[8:11], s38 offen sc1
    buffer_load_dwordx4 v[156:159], v6, s[8:11], s38 offen offset:256 sc1
    s_add_u32 s38, s38, 0x10000
    buffer_load_dwordx4 v[160:163], v6, s[8:11], s38 offen sc1
    buffer_load_dwordx4 v[164:167], v6, s[8:11], s38 offen offset:256 sc1
    s_add_u32 s38, s38, 0x10000
    buffer_load_dwordx4 v[168:171], v6, s[8:11], s38 offen sc1
    buffer_load_dwordx4 v[172:175], v6, s[8:11], s38 offen offset:256 sc1
    s_add_u32 s38, s38, 0x10000
    buffer_load_dwordx4 v[176:179], v6, s[8:11], s38 offen sc1
    buffer_load_dwordx4 v[180:183], v6, s[8:11], s38 offen offset:256 sc1
    s_add_u32 s38, s38, 0x10000
    buffer_load_dwordx4 v[184:187], v6, s[8:11], s38 offen sc1
    buffer_load_dwordx4 v[188:191], v6, s[8:11], s38 offen offset:256 sc1
    s_add_u32 s38, s38, 0x10000
    s_waitcnt vmcnt(32)
    v_add_f32 v24, 1.0, v24
    v_cvt_pk_bf16_f32 v24, v24, v24
    v_lshlrev_b32 v24, 16, v24
    v_add_f32 v25, 1.0, v25
    v_cvt_pk_bf16_f32 v25, v25, v25
    v_lshlrev_b32 v25, 16, v25
    v_add_f32 v26, 1.0, v26
    v_cvt_pk_bf16_f32 v26, v26, v26
    v_lshlrev_b32 v26, 16, v26
    v_add_f32 v27, 1.0, v27
    v_cvt_pk_bf16_f32 v27, v27, v27
    v_lshlrev_b32 v27, 16, v27
    v_add_f32 v28, 1.0, v28
    v_cvt_pk_bf16_f32 v28, v28, v28
    v_lshlrev_b32 v28, 16, v28
    v_add_f32 v29, 1.0, v29
    v_cvt_pk_bf16_f32 v29, v29, v29
    v_lshlrev_b32 v29, 16, v29
    v_add_f32 v30, 1.0, v30
    v_cvt_pk_bf16_f32 v30, v30, v30
    v_lshlrev_b32 v30, 16, v30
    v_add_f32 v31, 1.0, v31
    v_cvt_pk_bf16_f32 v31, v31, v31
    v_lshlrev_b32 v31, 16, v31
    v_lshlrev_b32 v48, 16, v40
    v_and_b32 v49, 0xffff0000, v40
    v_lshlrev_b32 v50, 16, v41
    v_and_b32 v51, 0xffff0000, v41
    v_lshlrev_b32 v52, 16, v42
    v_and_b32 v53, 0xffff0000, v42
    v_lshlrev_b32 v54, 16, v43
    v_and_b32 v55, 0xffff0000, v43
    s_waitcnt vmcnt(28)
    v_add_f32 v64, v64, v72
    v_add_f32 v65, v65, v73
    v_add_f32 v66, v66, v74
    v_add_f32 v67, v67, v75
    v_add_f32 v68, v68, v76
    v_add_f32 v69, v69, v77
    v_add_f32 v70, v70, v78
    v_add_f32 v71, v71, v79
    s_waitcnt vmcnt(26)
    v_add_f32 v64, v64, v80
    v_add_f32 v65, v65, v81
    v_add_f32 v66, v66, v82
    v_add_f32 v67, v67, v83
    v_add_f32 v68, v68, v84
    v_add_f32 v69, v69, v85
    v_add_f32 v70, v70, v86
    v_add_f32 v71, v71, v87
    s_waitcnt vmcnt(24)
    v_add_f32 v64, v64, v88
    v_add_f32 v65, v65, v89
    v_add_f32 v66, v66, v90
    v_add_f32 v67, v67, v91
    v_add_f32 v68, v68, v92
    v_add_f32 v69, v69, v93
    v_add_f32 v70, v70, v94
    v_add_f32 v71, v71, v95
    s_waitcnt vmcnt(22)
    v_add_f32 v64, v64, v96
    v_add_f32 v65, v65, v97
    v_add_f32 v66, v66, v98
    v_add_f32 v67, v67, v99
    v_add_f32 v68, v68, v100
    v_add_f32 v69, v69, v101
    v_add_f32 v70, v70, v102
    v_add_f32 v71, v71, v103
    s_waitcnt vmcnt(20)
    v_add_f32 v64, v64, v104
    v_add_f32 v65, v65, v105
    v_add_f32 v66, v66, v106
    v_add_f32 v67, v67, v107
    v_add_f32 v68, v68, v108
    v_add_f32 v69, v69, v109
    v_add_f32 v70, v70, v110
    v_add_f32 v71, v71, v111
    s_waitcnt vmcnt(18)
    v_add_f32 v64, v64, v112
    v_add_f32 v65, v65, v113
    v_add_f32 v66, v66, v114
    v_add_f32 v67, v67, v115
    v_add_f32 v68, v68, v116
    v_add_f32 v69, v69, v117
    v_add_f32 v70, v70, v118
    v_add_f32 v71, v71, v119
    s_waitcnt vmcnt(16)
    v_add_f32 v64, v64, v120
    v_add_f32 v65, v65, v121
    v_add_f32 v66, v66, v122
    v_add_f32 v67, v67, v123
    v_add_f32 v68, v68, v124
    v_add_f32 v69, v69, v125
    v_add_f32 v70, v70, v126
    v_add_f32 v71, v71, v127
    s_waitcnt vmcnt(14)
    v_add_f32 v64, v64, v128
    v_add_f32 v65, v65, v129
    v_add_f32 v66, v66, v130
    v_add_f32 v67, v67, v131
    v_add_f32 v68, v68, v132
    v_add_f32 v69, v69, v133
    v_add_f32 v70, v70, v134
    v_add_f32 v71, v71, v135
    s_waitcnt vmcnt(12)
    v_add_f32 v64, v64, v136
    v_add_f32 v65, v65, v137
    v_add_f32 v66, v66, v138
    v_add_f32 v67, v67, v139
    v_add_f32 v68, v68, v140
    v_add_f32 v69, v69, v141
    v_add_f32 v70, v70, v142
    v_add_f32 v71, v71, v143
    s_waitcnt vmcnt(10)
    v_add_f32 v64, v64, v144
    v_add_f32 v65, v65, v145
    v_add_f32 v66, v66, v146
    v_add_f32 v67, v67, v147
    v_add_f32 v68, v68, v148
    v_add_f32 v69, v69, v149
    v_add_f32 v70, v70, v150
    v_add_f32 v71, v71, v151
    s_waitcnt vmcnt(8)
    v_add_f32 v64, v64, v152
    v_add_f32 v65, v65, v153
    v_add_f32 v66, v66, v154
    v_add_f32 v67, v67, v155
    v_add_f32 v68, v68, v156
    v_add_f32 v69, v69, v157
    v_add_f32 v70, v70, v158
    v_add_f32 v71, v71, v159
    s_waitcnt vmcnt(6)
    v_add_f32 v64, v64, v160
    v_add_f32 v65, v65, v161
    v_add_f32 v66, v66, v162
    v_add_f32 v67, v67, v163
    v_add_f32 v68, v68, v164
    v_add_f32 v69, v69, v165
    v_add_f32 v70, v70, v166
    v_add_f32 v71, v71, v167
    s_waitcnt vmcnt(4)
    v_add_f32 v64, v64, v168
    v_add_f32 v65, v65, v169
    v_add_f32 v66, v66, v170
    v_add_f32 v67, v67, v171
    v_add_f32 v68, v68, v172
    v_add_f32 v69, v69, v173
    v_add_f32 v70, v70, v174
    v_add_f32 v71, v71, v175
    s_waitcnt vmcnt(2)
    v_add_f32 v64, v64, v176
    v_add_f32 v65, v65, v177
    v_add_f32 v66, v66, v178
    v_add_f32 v67, v67, v179
    v_add_f32 v68, v68, v180
    v_add_f32 v69, v69, v181
    v_add_f32 v70, v70, v182
    v_add_f32 v71, v71, v183
    s_waitcnt vmcnt(0)
    v_add_f32 v64, v64, v184
    v_add_f32 v65, v65, v185
    v_add_f32 v66, v66, v186
    v_add_f32 v67, v67, v187
    v_add_f32 v68, v68, v188
    v_add_f32 v69, v69, v189
    v_add_f32 v70, v70, v190
    v_add_f32 v71, v71, v191
    v_cvt_pk_bf16_f32 v64, v64, v64
    v_lshlrev_b32 v64, 16, v64
    v_mul_f32 v64, v64, v16
    v_cvt_pk_bf16_f32 v64, v64, v64
    v_lshlrev_b32 v64, 16, v64
    v_add_f32 v48, v48, v64
    v_cvt_pk_bf16_f32 v65, v65, v65
    v_lshlrev_b32 v65, 16, v65
    v_mul_f32 v65, v65, v17
    v_cvt_pk_bf16_f32 v65, v65, v65
    v_lshlrev_b32 v65, 16, v65
    v_add_f32 v49, v49, v65
    v_cvt_pk_bf16_f32 v66, v66, v66
    v_lshlrev_b32 v66, 16, v66
    v_mul_f32 v66, v66, v18
    v_cvt_pk_bf16_f32 v66, v66, v66
    v_lshlrev_b32 v66, 16, v66
    v_add_f32 v50, v50, v66
    v_cvt_pk_bf16_f32 v67, v67, v67
    v_lshlrev_b32 v67, 16, v67
    v_mul_f32 v67, v67, v19
    v_cvt_pk_bf16_f32 v67, v67, v67
    v_lshlrev_b32 v67, 16, v67
    v_add_f32 v51, v51, v67
    v_cvt_pk_bf16_f32 v68, v68, v68
    v_lshlrev_b32 v68, 16, v68
    v_mul_f32 v68, v68, v20
    v_cvt_pk_bf16_f32 v68, v68, v68
    v_lshlrev_b32 v68, 16, v68
    v_add_f32 v52, v52, v68
    v_cvt_pk_bf16_f32 v69, v69, v69
    v_lshlrev_b32 v69, 16, v69
    v_mul_f32 v69, v69, v21
    v_cvt_pk_bf16_f32 v69, v69, v69
    v_lshlrev_b32 v69, 16, v69
    v_add_f32 v53, v53, v69
    v_cvt_pk_bf16_f32 v70, v70, v70
    v_lshlrev_b32 v70, 16, v70
    v_mul_f32 v70, v70, v22
    v_cvt_pk_bf16_f32 v70, v70, v70
    v_lshlrev_b32 v70, 16, v70
    v_add_f32 v54, v54, v70
    v_cvt_pk_bf16_f32 v71, v71, v71
    v_lshlrev_b32 v71, 16, v71
    v_mul_f32 v71, v71, v23
    v_cvt_pk_bf16_f32 v71, v71, v71
    v_lshlrev_b32 v71, 16, v71
    v_add_f32 v55, v55, v71
    v_cvt_pk_bf16_f32 v60, v48, v49
    v_cvt_pk_bf16_f32 v61, v50, v51
    v_cvt_pk_bf16_f32 v62, v52, v53
    v_cvt_pk_bf16_f32 v63, v54, v55
    s_add_u32 s38, s37, 0x400000
    buffer_store_dwordx4 v[60:63], v5, s[8:11], s38 offen sc1
    v_lshlrev_b32 v48, 16, v60
    v_and_b32 v49, 0xffff0000, v60
    v_lshlrev_b32 v50, 16, v61
    v_and_b32 v51, 0xffff0000, v61
    v_lshlrev_b32 v52, 16, v62
    v_and_b32 v53, 0xffff0000, v62
    v_lshlrev_b32 v54, 16, v63
    v_and_b32 v55, 0xffff0000, v63
    v_add_f32 v56, v48, v49
    v_add_f32 v56, v56, v50
    v_add_f32 v56, v56, v51
    v_add_f32 v56, v56, v52
    v_add_f32 v56, v56, v53
    v_add_f32 v56, v56, v54
    v_add_f32 v56, v56, v55
    s_nop 1
    v_add_f32_dpp v56, v56, v56 quad_perm:[1,0,3,2] row_mask:0xf bank_mask:0xf
    s_nop 1
    v_add_f32_dpp v56, v56, v56 quad_perm:[2,3,0,1] row_mask:0xf bank_mask:0xf
    s_nop 1
    v_add_f32_dpp v56, v56, v56 row_half_mirror row_mask:0xf bank_mask:0xf
    s_nop 1
    v_add_f32_dpp v56, v56, v56 row_mirror row_mask:0xf bank_mask:0xf
    v_mov_b32 v57, v56
    s_nop 1
    v_permlane16_swap_b32 v56, v57
    s_nop 1
    v_add_f32 v56, v56, v57
    v_mov_b32 v57, v56
    s_nop 1
    v_permlane32_swap_b32 v56, v57
    s_nop 1
    v_add_f32 v56, v56, v57
    v_mul_f32 v56, 0x3b000000, v56
    v_sub_f32 v48, v48, v56
    v_sub_f32 v49, v49, v56
    v_sub_f32 v50, v50, v56
    v_sub_f32 v51, v51, v56
    v_sub_f32 v52, v52, v56
    v_sub_f32 v53, v53, v56
    v_sub_f32 v54, v54, v56
    v_sub_f32 v55, v55, v56
    v_mul_f32 v56, v48, v48
    v_fmac_f32 v56, v49, v49
    v_fmac_f32 v56, v50, v50
    v_fmac_f32 v56, v51, v51
    v_fmac_f32 v56, v52, v52
    v_fmac_f32 v56, v53, v53
    v_fmac_f32 v56, v54, v54
    v_fmac_f32 v56, v55, v55
    s_nop 1
    v_add_f32_dpp v56, v56, v56 quad_perm:[1,0,3,2] row_mask:0xf bank_mask:0xf
    s_nop 1
    v_add_f32_dpp v56, v56, v56 quad_perm:[2,3,0,1] row_mask:0xf bank_mask:0xf
    s_nop 1
    v_add_f32_dpp v56, v56, v56 row_half_mirror row_mask:0xf bank_mask:0xf
    s_nop 1
    v_add_f32_dpp v56, v56, v56 row_mirror row_mask:0xf bank_mask:0xf
    v_mov_b32 v57, v56
    s_nop 1
    v_permlane16_swap_b32 v56, v57
    s_nop 1
    v_add_f32 v56, v56, v57
    v_mov_b32 v57, v56
    s_nop 1
    v_permlane32_swap_b32 v56, v57
    s_nop 1
    v_add_f32 v56, v56, v57
    v_mov_b32 v57, 0x3727c5ac
    v_fmac_f32 v57, 0x3b000000, v56
    v_rsq_f32 v56, v57
    s_nop 0
    v_mul_f32 v48, v48, v56
    v_fma_f32 v48, v48, v24, v32
    v_mul_f32 v49, v49, v56
    v_fma_f32 v49, v49, v25, v33
    v_mul_f32 v50, v50, v56
    v_fma_f32 v50, v50, v26, v34
    v_mul_f32 v51, v51, v56
    v_fma_f32 v51, v51, v27, v35
    v_mul_f32 v52, v52, v56
    v_fma_f32 v52, v52, v28, v36
    v_mul_f32 v53, v53, v56
    v_fma_f32 v53, v53, v29, v37
    v_mul_f32 v54, v54, v56
    v_fma_f32 v54, v54, v30, v38
    v_mul_f32 v55, v55, v56
    v_fma_f32 v55, v55, v31, v39
    v_cvt_pk_bf16_f32 v44, v48, v49
    v_cvt_pk_bf16_f32 v45, v50, v51
    v_cvt_pk_bf16_f32 v46, v52, v53
    v_cvt_pk_bf16_f32 v47, v54, v55
    s_add_u32 s38, s37, 0x600000
    buffer_store_dwordx4 v[44:47], v5, s[8:11], s38 offen sc1
    s_add_u32 s35, s32, 192
    s_lshl_b32 s35, s35, 6
    s_waitcnt vmcnt(0) lgkmcnt(0)
    s_barrier
    s_cmp_lg_u32 s4, 0
    s_cbranch_scc1 Lsg_83
    v_mov_b32 v7, 1
    s_mov_b64 exec, 1
    buffer_atomic_add v7, off, s[8:11], s35 sc1
    s_mov_b64 exec, -1
Lsg_83:
    s_add_u32 s63, s63, 6
    s_cmp_lt_u32 s63, 64
    s_cbranch_scc1 Ltl_80
    s_branch Lwend_59
Lrole_79:
Lwend_59:
L_main_kernel_end:
    s_endpgm
.section .rodata,"a"
.p2align 6
.amdhsa_kernel main_kernel
  .amdhsa_next_free_vgpr 512
  .amdhsa_next_free_sgpr 102
  .amdhsa_accum_offset 256
  .amdhsa_group_segment_fixed_size 0
  .amdhsa_kernarg_size 128
  .amdhsa_user_sgpr_count 2
  .amdhsa_user_sgpr_kernarg_segment_ptr 1
  .amdhsa_system_sgpr_workgroup_id_x 1
.end_amdhsa_kernel
.text
```
